```python
import torch

def _softmax(x, axis=-1):
    return torch.softmax(x, dim=axis)
def _gelu(x):
    return torch.nn.functional.gelu(x, approximate="tanh")
def _silu(x):
    return torch.nn.functional.silu(x)
def _sigmoid(x):
    return torch.sigmoid(x)
def _layernorm(x, axis=-1, eps=1e-5):
    m = x.mean(dim=axis, keepdim=True)
    v = x.var(dim=axis, keepdim=True, unbiased=False)
    return (x - m) / torch.sqrt(v + eps)
def _scatter_add(tgt, idx, src, axis=0):
    return tgt.clone().index_add_(axis, idx, src)
def _segment_sum(src, seg, n):
    out = torch.zeros((n,) + src.shape[1:], dtype=src.dtype)
    return out.index_add_(0, seg, src)
def _pad(x, pw):
    flat = tuple(v for pair in reversed(pw) for v in pair)
    return torch.nn.functional.pad(x, flat)

kernel_name = 'parallel_sum__ssm_conv_s5__glu_gated_geglu__prompt'

def setup_inputs():

    _w = (lambda a: (lambda t: t.to(torch.bfloat16) if t.is_floating_point() else t)(torch.as_tensor(a)))
    def _A_setup():
        B, S, D = 1, 2048, 640
        P = D
        Lambda_re = -0.5 * (lambda _x: torch.exp(torch.as_tensor(_x)))((lambda *s: torch.randn(*s, dtype=torch.bfloat16) * 0.2)(P))
        Lambda_im = (lambda *s: torch.randn(*s, dtype=torch.bfloat16) * 0.4)(P) * 1.0
        B_re = (lambda *s: torch.randn(*s, dtype=torch.bfloat16) * 0.2)(P, D) * (D ** -0.5)
        B_im = (lambda *s: torch.randn(*s, dtype=torch.bfloat16) * 0.2)(P, D) * (D ** -0.5)
        C_re = (lambda *s: torch.randn(*s, dtype=torch.bfloat16) * 0.2)(D, P) * (P ** -0.5)
        C_im = (lambda *s: torch.randn(*s, dtype=torch.bfloat16) * 0.2)(D, P) * (P ** -0.5)
        log_dt = (lambda *s: torch.randn(*s, dtype=torch.bfloat16) * 0.2)(P) * 0.3 - 2.0
        Dskip = (lambda *s: torch.randn(*s, dtype=torch.bfloat16) * 0.05)(D)
        return {
            "x": _w((lambda *s: torch.randn(*s, dtype=torch.bfloat16) * 0.05)(B, S, D)),
            "Lambda_re": _w(Lambda_re),
            "Lambda_im": _w(Lambda_im),
            "B_re": _w(B_re),
            "B_im": _w(B_im),
            "C_re": _w(C_re),
            "C_im": _w(C_im),
            "log_dt": _w(log_dt),
            "Dskip": _w(Dskip),
        }
    _A_in = _A_setup()

    def _B_setup():
        B, S, Dm, Df = 1, 2048, 640, 1728
        return {
            "x": _w((lambda *s: torch.randn(*s, dtype=torch.bfloat16) * 0.05)(B, S, Dm)),
            "w_gate": _w((lambda *s: torch.randn(*s, dtype=torch.bfloat16) * 0.4)(Dm, Df) * (Dm ** -0.5)),
            "w_up": _w((lambda *s: torch.randn(*s, dtype=torch.bfloat16) * 0.4)(Dm, Df) * (Dm ** -0.5)),
            "w_down": _w((lambda *s: torch.randn(*s, dtype=torch.bfloat16) * 0.4)(Df, Dm) * (Df ** -0.5)),
        }
    _B_in = _B_setup()

    return {
        "A_x": _A_in["x"],
        "A_Lambda_re": _A_in["Lambda_re"],
        "A_Lambda_im": _A_in["Lambda_im"],
        "A_B_re": _A_in["B_re"],
        "A_B_im": _A_in["B_im"],
        "A_C_re": _A_in["C_re"],
        "A_C_im": _A_in["C_im"],
        "A_log_dt": _A_in["log_dt"],
        "A_Dskip": _A_in["Dskip"],
        "B_x": _B_in["x"],
        "B_w_gate": _B_in["w_gate"],
        "B_w_up": _B_in["w_up"],
        "B_w_down": _B_in["w_down"],
    }

def reference(A_x, A_Lambda_re, A_Lambda_im, A_B_re, A_B_im, A_C_re, A_C_im, A_log_dt, A_Dskip, B_x, B_w_gate, B_w_up, B_w_down):
    def _A_ref(x, Lambda_re, Lambda_im, B_re, B_im, C_re, C_im, log_dt, Dskip):
        Bsz, L, H = x.shape
        Lam = Lambda_re + 1j * Lambda_im
        Bmat = B_re + 1j * B_im
        Cmat = C_re + 1j * C_im
        dt = torch.exp(log_dt)
        Lam_bar = torch.exp(dt * Lam)
        B_bar = ((Lam_bar - 1.0) / Lam)[:, None] * Bmat
        Bu = torch.einsum("bld,pd->blp", x + 0j, B_bar)
        h = torch.zeros_like(Bu[:, 0, :])
        hs = []
        for t in range(L):
            h = Lam_bar[None, :] * h + Bu[:, t, :]
            hs.append(h)
        hseq = torch.stack(hs, 1)
        y = 2.0 * torch.einsum("blp,dp->bld", hseq, Cmat).real + x * Dskip[None, None, :]
        return y

    def _B_ref(x, w_gate, w_up, w_down):
        g = torch.einsum("bsd,df->bsf", x, w_gate)
        u = torch.einsum("bsd,df->bsf", x, w_up)
        h = _gelu(g) * u
        return torch.einsum("bsf,fd->bsd", h, w_down)

    x = A_x
    xn = _layernorm(x, axis=-1)
    return x + _A_ref(xn, A_Lambda_re, A_Lambda_im, A_B_re, A_B_im, A_C_re, A_C_im, A_log_dt, A_Dskip) + _B_ref(xn, B_w_gate, B_w_up, B_w_down)
```

```asm
; @launch grid=(256,1,1) block=(256,1,1) lds=163840
.amdgcn_target "amdgcn-amd-amdhsa--gfx950"
.text
.globl parallel_sum__ssm_conv_s5__glu_gated_geglu__prompt_kernel
.type parallel_sum__ssm_conv_s5__glu_gated_geglu__prompt_kernel,@function
.p2align 8
parallel_sum__ssm_conv_s5__glu_gated_geglu__prompt_kernel:
    s_cmp_ge_u32 s2, 256
    s_cbranch_scc1 K1_END
    s_load_dwordx16 s[36:51], s[0:1], 0
    s_load_dwordx16 s[52:67], s[0:1], 64
    s_getpc_b64 s[32:33]
K1_PC:
    v_lshrrev_b32 v2, 6, v0
    v_and_b32 v1, 63, v0
    v_readfirstlane_b32 s4, v2
    s_lshr_b32 s3, s2, 3
    s_lshl_b32 s34, s3, 2
    s_add_u32 s34, s34, s4
    s_mul_i32 s34, s34, 768
    v_lshlrev_b32 v2, 7, v1
    v_add_u32 v2, s34, v2
    v_min_u32 v2, TEXT_END-K1_PC-4, v2
    s_mov_b64 exec, 63
    global_load_dword v242, v2, s[32:33]
    s_mov_b64 exec, -1
    s_and_b32 s34, s2, 7
    s_lshr_b32 s5, s34, 1
    s_lshl_b32 s5, s5, 2
    s_and_b32 s35, s3, 3
    s_add_u32 s5, s5, s35
    s_and_b32 s6, s34, 1
    s_lshl_b32 s6, s6, 3
    s_lshr_b32 s3, s3, 2
    s_add_u32 s6, s6, s3
    s_add_u32 s7, s3, s35
    s_sub_u32 s34, s7, 5
    s_cmp_ge_u32 s7, 5
    s_cselect_b32 s7, s34, s7
    s_sub_u32 s34, s7, 5
    s_cmp_ge_u32 s7, 5
    s_cselect_b32 s7, s34, s7
    s_lshl_b32 s68, s7, 8
    s_add_u32 s69, s68, 256
    s_cmp_eq_u32 s69, 1280
    s_cselect_b32 s69, 0, s69
    s_add_u32 s70, s69, 256
    s_cmp_eq_u32 s70, 1280
    s_cselect_b32 s70, 0, s70
    s_add_u32 s71, s70, 256
    s_cmp_eq_u32 s71, 1280
    s_cselect_b32 s71, 0, s71
    s_add_u32 s72, s71, 256
    s_cmp_eq_u32 s72, 1280
    s_cselect_b32 s72, 0, s72
    s_lshl_b32 s78, s4, 12
    s_lshl_b32 s79, s5, 2
    s_add_u32 s79, s79, s4
    s_mul_i32 s79, s79, 40960
    v_lshrrev_b32 v248, 4, v1
    v_and_b32 v249, 15, v1
    v_xor_b32 v249, v249, v248
    v_lshlrev_b32 v249, 4, v249
    v_mul_u32_u24 v248, 1280, v248
    v_xor_b32_e64 v212, 0, v249
    v_add_u32 v212, v212, v248
    v_add_u32 v244, 0, v212
    v_xor_b32 v213, 64, v249
    v_add_u32 v213, v213, v248
    v_add_u32 v245, 19456, v213
    v_xor_b32 v214, 128, v249
    v_add_u32_e64 v214, v214, v248
    v_add_u32 v246, 3072, v214
    v_xor_b32 v215, 192, v249
    v_add_u32_e64 v215, v215, v248
    v_add_u32 v247, 22528, v215
    s_cmp_ge_u32 s6, 8
    s_cselect_b32 s34, 1, 0
    s_sub_u32 s80, s6, s34
    s_lshl_b32 s82, s80, 1
    s_mov_b32 s84, 0
    s_cmp_eq_u32 s6, 14
    s_cselect_b32 s84, 1, s84
    s_cmp_eq_u32 s6, 7
    s_cselect_b32 s84, 2, s84
    s_cselect_b32 s80, 14, s80
    s_cmp_eq_u32 s6, 15
    s_cselect_b32 s84, 2, s84
    s_cselect_b32 s80, 17, s80
    v_and_b32 v12, 31, v1
    s_lshl_b32 s34, s80, 6
    v_lshl_add_u32 v13, v12, 1, s34
    v_min_u32 v15, 1150, v13
    v_mov_b32 v14, 17039360
    s_lshl_b32 s93, s4, 13
    s_add_u32 s93, s93, 131072
    s_waitcnt lgkmcnt(0)
    s_mov_b32 s8, s36
    s_mov_b32 s9, s37
    s_mov_b32 s10, 2621440
    s_mov_b32 s11, 0x20000
    s_mov_b32 s20, s66
    s_mov_b32 s21, s67
    s_mov_b32 s22, 24248320
    s_mov_b32 s23, 0x20000
    s_mov_b32 s34, 0
    buffer_load_dword v241, v14, s[20:23], s34 offen sc1
    global_load_ushort v182, v13, s[38:39] offset:0
    global_load_ushort v183, v13, s[40:41] offset:0
    global_load_ushort v184, v13, s[50:51] offset:0
    global_load_ushort v194, v15, s[38:39] offset:64
    global_load_ushort v195, v15, s[40:41] offset:64
    global_load_ushort v196, v15, s[50:51] offset:64
    global_load_ushort v206, v15, s[38:39] offset:128
    global_load_ushort v207, v15, s[40:41] offset:128
    global_load_ushort v208, v15, s[50:51] offset:128
    s_add_u32 m0, s78, 0
    s_add_u32 s32, s79, s68
    buffer_load_dwordx4 v244, s[8:11], s32 offen offset:0 lds
    buffer_load_dwordx4 v245, s[8:11], s32 offen offset:1024 lds
    buffer_load_dwordx4 v246, s[8:11], s32 offen offset:2048 lds
    buffer_load_dwordx4 v247, s[8:11], s32 offen offset:3072 lds
    s_add_u32 m0, s78, 65536
    s_add_u32 s32, s79, s68
    s_add_u32 s32, s32, 10240
    buffer_load_dwordx4 v244, s[8:11], s32 offen offset:0 lds
    buffer_load_dwordx4 v245, s[8:11], s32 offen offset:1024 lds
    buffer_load_dwordx4 v246, s[8:11], s32 offen offset:2048 lds
    buffer_load_dwordx4 v247, s[8:11], s32 offen offset:3072 lds
    s_add_u32 m0, s78, 16384
    s_add_u32 s32, s79, s69
    buffer_load_dwordx4 v244, s[8:11], s32 offen offset:0 lds
    v_add_u32 v213, 4096, v213
    v_add_u32 v214, 8192, v214
    v_add_u32 v215, 12288, v215
    s_mov_b32 s98, 0
    s_mov_b32 s99, -1
    s_mov_b32 s86, 0xffff0000
    v_lshrrev_b32 v248, 5, v1
    v_and_b32 v249, 15, v1
    v_xor_b32 v250, v249, v248
    v_lshlrev_b32 v250, 4, v250
    v_lshl_add_u32 v250, v249, 8, v250
    v_bfe_u32 v249, v1, 4, 1
    v_lshlrev_b32 v252, 16, v249
    v_add_u32 v252, s78, v252
    v_lshlrev_b32 v249, 12, v249
    v_xor_b32 v216, 0, v250
    v_add_u32 v224, v216, v252
    v_add_u32 v216, v216, v249
    buffer_load_dwordx4 v245, s[8:11], s32 offen offset:1024 lds
    v_xor_b32 v217, 32, v250
    v_add_u32 v225, v217, v252
    v_add_u32 v217, v217, v249
    v_xor_b32 v218, 64, v250
    v_add_u32 v226, v218, v252
    v_add_u32 v218, v218, v249
    v_xor_b32 v219, 96, v250
    v_add_u32 v227, v219, v252
    v_add_u32 v219, v219, v249
    v_xor_b32 v220, 128, v250
    v_add_u32 v228, v220, v252
    v_add_u32 v220, v220, v249
    v_xor_b32 v221, 160, v250
    v_add_u32 v229, v221, v252
    v_add_u32 v221, v221, v249
    v_xor_b32 v222, 192, v250
    v_add_u32 v230, v222, v252
    v_add_u32 v222, v222, v249
    buffer_load_dwordx4 v246, s[8:11], s32 offen offset:2048 lds
    v_xor_b32 v223, 224, v250
    v_add_u32_e64 v231, v223, v252
    v_add_u32 v223, v223, v249
    v_mov_b32 v237, 0
    v_mov_b32 v238, 0
    s_mov_b32 s92, 0x3f803f80
    s_cmp_ge_u32 s4, 2
    s_cselect_b32 s12, s44, s42
    s_cselect_b32 s13, s45, s43
    s_cselect_b32 s16, s58, s56
    s_cselect_b32 s17, s59, s57
    s_mov_b32 s14, 819200
    s_mov_b32 s15, 0x20000
    s_mov_b32 s18, 2211840
    s_mov_b32 s19, 0x20000
    s_mul_i32 s73, s68, 1728
    s_mul_i32 s74, s69, 1728
    s_mul_i32 s75, s70, 1728
    buffer_load_dwordx4 v247, s[8:11], s32 offen offset:3072 lds
    s_mul_i32 s76, s71, 1728
    s_mul_i32 s77, s72, 1728
    s_and_b32 s34, s4, 1
    s_lshl_b32 s81, s80, 1
    s_add_u32 s81, s81, s34
    s_mul_i32 s81, s81, 20480
    s_lshr_b32 s35, s4, 1
    s_lshl_b32 s87, s5, 1
    s_add_u32 s87, s87, s35
    s_mul_i32 s87, s87, 385024
    s_lshl_b32 s35, s34, 11
    s_add_u32 s87, s87, s35
    s_lshl_b32 s90, s82, 13
    s_add_u32 s90, s90, s87
    s_add_u32 s91, s90, 8192
    s_lshl_b32 s82, s82, 7
    s_mul_i32 s35, s34, 110592
    s_add_u32 s82, s82, s35
    s_add_u32 m0, s78, 81920
    s_add_u32 s32, s79, s69
    s_add_u32 s32, s32, 10240
    buffer_load_dwordx4 v244, s[8:11], s32 offen offset:0 lds
    s_add_u32 s83, s82, 128
    s_mov_b32 s88, 0xbdd2d3e8
    v_mov_b32 v11, 0xc0135761
    v_lshrrev_b32 v249, 3, v1
    v_mul_u32_u24 v249, 3456, v249
    v_bfe_u32 v250, v1, 4, 1
    v_lshlrev_b32_e64 v250, 2, v250
    v_and_b32 v2, 7, v1
    v_xor_b32 v2, v2, v250
    v_lshl_add_u32 v2, v2, 4, v249
    v_add_u32 v3, 26624, v2
    v_add_u32 v4, 53248, v2
    v_add_u32 v5, 79872, v2
    v_bfe_u32 v249, v1, 2, 2
    v_lshl_add_u32 v250, v248, 3, v249
    v_lshlrev_b32 v6, 7, v250
    v_lshrrev_b32 v249, 1, v249
    v_lshl_add_u32 v6, v249, 6, v6
    buffer_load_dwordx4 v245, s[8:11], s32 offen offset:1024 lds
    v_bfe_u32 v249, v1, 4, 1
    v_lshl_add_u32 v6, v249, 5, v6
    v_and_b32_e64 v249, 3, v1
    v_lshl_add_u32 v6, v249, 3, v6
    v_xor_b32_e64 v7, 64, v6
    v_add_u32 v8, 0x10000, v6
    v_add_u32 v9, 0x10000, v7
    v_lshrrev_b32_e64 v250, 3, v12
    v_lshl_add_u32 v250, v250, 2, v249
    v_lshl_add_u32 v10, v248, 4, v250
    v_lshlrev_b32_e64 v10, 4, v10
    v_bfe_u32 v249, v12, 2, 1
    v_lshl_add_u32 v10, v249, 10, v10
    v_lshl_add_u32 v251, v249, 4, v250
    v_lshlrev_b32 v251, 3, v251
    s_lshl_b32 s34, s4, 8
    s_add_u32 s34, s34, 161792
    v_add_u32_e64 v0, s34, v251
    buffer_load_dwordx4 v246, s[8:11], s32 offen offset:2048 lds
    v_lshlrev_b32 v233, 4, v12
    v_sub_u32 v249, s5, v248
    v_lshl_add_u32 v232, v249, 9, v233
    s_add_u32 s34, s5, 1
    s_lshl_b32 s34, s34, 9
    s_cmp_eq_u32 s4, 3
    s_cselect_b32 s34, s34, 1073741824
    v_add_u32 v249, s34, v233
    v_mov_b32 v250, 1073741824
    v_cndmask_b32 v13, v250, v249, s[98:99]
    v_and_b32_e64 v15, 15, v12
    v_mul_u32_u24 v15, 120, v15
    v_lshrrev_b32_e64 v249, 4, v12
    v_lshl_add_u32 v15, v249, 13, v15
    v_add_u32 v15, 137216, v15
    v_mul_u32_u24 v234, 2304, v248
    v_lshl_add_u32 v234, v12, 2, v234
    v_add_u32_e64 v234, s93, v234
    buffer_load_dwordx4 v247, s[8:11], s32 offen offset:3072 lds
    v_and_b32_e64 v249, 15, v1
    v_mul_u32_u24 v249, 144, v249
    v_lshrrev_b32_e64 v250, 4, v1
    v_lshl_add_u32 v235, v250, 4, v249
    v_add_u32 v235, s93, v235
    v_lshlrev_b32 v236, 4, v1
    s_lshl_b32 s34, s4, 1
    v_add_u32 v12, s34, v248
    v_lshl_add_u32 v15, v12, 3, v15
    s_waitcnt vmcnt(16)
    v_readfirstlane_b32 s85, v241
    s_lshl_b32 s7, s5, 2
    s_add_u32 s7, s7, s4
    s_and_b32 s33, s6, 7
    s_cmp_ge_u32 s6, 8
    s_cselect_b32 s34, 7, 64
    s_cselect_b32 s35, 47, 0
    s_cselect_b32 s89, 57, 47
    s_cmp_lt_u32 s7, s89
    s_cselect_b32 s100, 0, 1073741824
    s_cmp_ge_u32 s7, s34
    s_cselect_b32 s3, 1, 0
    s_cbranch_scc1 JOB_C
    s_mov_b32 s24, s60
    s_mov_b32 s25, s61
    s_mov_b32 s26, 2211840
    s_mov_b32 s27, 0x20000
    s_mov_b32 s28, s60
    s_mov_b32 s29, s61
    s_mov_b32 s30, 2211840
    s_mov_b32 s31, 0x20000
    s_add_u32 s7, s7, s35
    s_mul_i32 s101, s7, 40960
    s_mul_i32 s34, s33, 160
    s_add_u32 s101, s101, s34
    s_mul_i32 s89, s33, 94
    s_add_u32 s89, s89, s7
    s_mul_i32 s89, s89, 5120
    s_mov_b32 s34, 0xcccd
    v_add_u32 v193, 0, v1
    v_mul_lo_u32 v188, v193, s34
    v_lshrrev_b32_e64 v188, 19, v188
    v_mul_u32_u24 v188, 1120, v188
    v_lshl_add_u32 v188, v193, 4, v188
    v_add_u32_e64 v193, 64, v1
    v_mul_lo_u32 v189, v193, s34
    v_lshrrev_b32_e64 v189, 19, v189
    v_mul_u32_u24 v189, 1120, v189
    v_lshl_add_u32 v189, v193, 4, v189
    v_add_u32 v193, 128, v1
    v_mul_lo_u32 v190, v193, s34
    v_lshrrev_b32_e64 v190, 19, v190
    v_mul_u32_u24 v190, 1120, v190
    v_lshl_add_u32 v190, v193, 4, v190
    v_add_u32 v193, 192, v1
    v_mul_lo_u32 v191, v193, s34
    v_lshrrev_b32_e64 v191, 19, v191
    v_mul_u32_u24 v191, 1120, v191
    v_lshl_add_u32 v191, v193, 4, v191
    v_add_u32 v193, 256, v1
    v_mul_lo_u32 v192, v193, s34
    v_lshrrev_b32_e64 v192, 19, v192
    v_mul_u32_u24 v192, 1120, v192
    v_lshl_add_u32 v192, v193, 4, v192
    s_branch JOB_LD
JOB_C:
    s_mov_b32 s24, s46
    s_mov_b32 s25, s47
    s_mov_b32 s26, 819200
    s_mov_b32 s27, 0x20000
    s_mov_b32 s28, s48
    s_mov_b32 s29, s49
    s_mov_b32 s30, 819200
    s_mov_b32 s31, 0x20000
    s_sub_u32 s7, s7, 7
    s_mul_hi_u32 s34, s7, 0x1999999a
    s_mul_i32 s35, s34, 10
    s_sub_u32 s7, s7, s35
    s_mul_i32 s35, s33, 5
    s_add_u32 s35, s35, s34
    s_mul_i32 s101, s35, 20480
    s_lshl_b32 s35, s7, 7
    s_add_u32 s101, s101, s35
    s_mul_i32 s89, s33, 94
    s_lshl_b32 s7, s7, 2
    s_add_u32 s89, s89, s7
    s_add_u32 s89, s89, 54
    s_mul_i32 s89, s89, 5
    s_add_u32 s89, s89, s34
    s_lshl_b32 s89, s89, 10
    v_lshrrev_b32_e64 v188, 3, v1
    v_mul_u32_u24 v188, 1280, v188
    v_lshrrev_b32_e64 v190, 3, v1
    v_xor_b32 v189, v190, v1
    v_and_b32 v189, 7, v189
    v_lshl_add_u32 v188, v189, 4, v188
    v_add_u32 v189, 10240, v188
    v_mov_b32_e64 v190, v188
    v_mov_b32 v191, v189
    v_mov_b32 v192, 1073741824
JOB_LD:
    s_add_u32 s89, s89, 12582912
    s_or_b32 s89, s89, s100
    s_or_b32 s7, s101, s100
    s_add_u32 m0, s78, 32768
    s_add_u32 s32, s79, s70
    buffer_load_dwordx4 v244, s[8:11], s32 offen offset:0 lds
    v_lshlrev_b32 v182, 16, v182
    v_lshlrev_b32 v183, 16, v183
    v_lshlrev_b32 v184, 16, v184
    v_mul_f32 v184, 0x3fb8aa3b, v184
    v_exp_f32 v184, v184
    s_nop 0
    v_cvt_pk_bf16_f32 v184, v184, v184
    v_lshlrev_b32_e64 v184, 16, v184
    v_mul_f32 v168, v184, v182
    v_mul_f32 v169, v184, v183
    v_mul_f32 v168, 0x3fb8aa3b, v168
    v_mul_f32 v169, 0.15915494, v169
    v_exp_f32 v168, v168
    v_fract_f32 v169, v169
    v_cos_f32 v170, v169
    buffer_load_dwordx4 v245, s[8:11], s32 offen offset:1024 lds
    v_sin_f32_e64 v171, v169
    v_mul_f32 v176, v168, v170
    v_mul_f32 v177, v168, v171
    v_add_f32 v168, -1.0, v176
    v_mul_f32 v169, v182, v182
    v_fma_f32 v169, v183, v183, v169
    v_rcp_f32 v169, v169
    v_mul_f32 v170, v168, v182
    v_fmac_f32 v170, v177, v183
    v_mul_f32 v171, v177, v182
    v_fma_f32 v171, -v168, v183, v171
    v_add_f32_e64 v169, v169, v169
    v_mul_f32 v178, v170, v169
    v_mul_f32 v179, v171, v169
    v_mul_f32 v168, v176, v176
    v_mul_f32 v169, v176, v177
    buffer_load_dwordx4 v246, s[8:11], s32 offen offset:2048 lds
    v_fma_f32 v168, -v177, v177, v168
    v_fma_f32 v169, v177, v176, v169
    v_mul_f32 v170, v168, v168
    v_mul_f32 v171, v168, v169
    v_fma_f32 v170, -v169, v169, v170
    v_fma_f32 v171, v169, v168, v171
    v_mul_f32 v168, v170, v170
    v_mul_f32 v169, v170, v171
    v_fma_f32 v168, -v171, v171, v168
    v_fma_f32 v169, v171, v170, v169
    v_mul_f32 v180, v168, v168
    v_mul_f32 v181, v168, v169
    v_fma_f32 v180, -v169, v169, v180
    v_fma_f32 v181, v169, v168, v181
    v_mul_f32 v168, v180, v180
    v_mul_f32 v169, v180, v181
    v_fma_f32 v168, -v181, v181, v168
    v_fma_f32 v169, v181, v180, v169
    buffer_load_dwordx4 v247, s[8:11], s32 offen offset:3072 lds
    v_mul_f32 v170, v168, v168
    v_mul_f32 v171, v168, v169
    v_fma_f32 v170, -v169, v169, v170
    v_fma_f32 v171, v169, v168, v171
    v_mul_f32 v184, v170, v170
    v_mul_f32 v185, v170, v171
    v_fma_f32 v184, -v171, v171, v184
    v_fma_f32 v185, v171, v170, v185
    v_mul_f32 v186, v184, v184
    v_mul_f32 v187, v184, v185
    v_fma_f32 v186, -v185, v185, v186
    v_fma_f32 v187, v185, v184, v187
    v_cndmask_b32 v172, 1.0, v180, s[98:99]
    v_cndmask_b32 v173, 0, v181, s[98:99]
    s_bitcmp1_b32 s4, 0
    s_cselect_b64 s[100:101], -1, 0
    v_cndmask_b32 v168, 1.0, v168, s[100:101]
    v_cndmask_b32 v169, 0, v169, s[100:101]
    s_add_u32 m0, s78, 98304
    s_add_u32 s32, s79, s70
    s_add_u32 s32, s32, 10240
    buffer_load_dwordx4 v244, s[8:11], s32 offen offset:0 lds
    v_mul_f32 v174, v172, v168
    v_mul_f32_e64 v175, v172, v169
    v_fma_f32 v174, -v173, v169, v174
    v_fma_f32 v175, v173, v168, v175
    s_bitcmp1_b32 s4, 1
    s_cselect_b64 s[100:101], -1, 0
    v_cndmask_b32 v170, 1.0, v170, s[100:101]
    v_cndmask_b32 v171, 0, v171, s[100:101]
    v_mul_f32 v182, v174, v170
    v_mul_f32 v183, v174, v171
    v_fma_f32 v182, -v175, v171, v182
    v_fmac_f32 v183, v175, v170
    s_add_u32 s85, s85, 1
    v_mov_b32 v168, 0
    v_mov_b32 v169, s85
    v_mov_b32 v170, 0
    v_mov_b32 v171, s85
    s_add_u32 s34, s80, 0
    buffer_load_dwordx4 v245, s[8:11], s32 offen offset:1024 lds
    s_mul_i32 s34, s34, 8704
    s_add_u32 s34, s34, 16842752
    buffer_store_dwordx4 v[168:171], v233, s[20:23], s34 offen sc1
    s_waitcnt vmcnt(15)
    ds_read_b128 v[16:19], v224 offset:0
    ds_read_b128 v[20:23], v225 offset:0
    ds_read_b128 v[24:27], v226 offset:0
    ds_read_b128 v[28:31], v227 offset:0
    ds_read_b128 v[32:35], v228 offset:0
    ds_read_b128 v[36:39], v229 offset:0
    ds_read_b128 v[40:43], v230 offset:0
    ds_read_b128 v[44:47], v231 offset:0
    s_waitcnt lgkmcnt(7)
    v_dot2c_f32_bf16 v237, s92, v16
    v_dot2c_f32_bf16 v238, v16, v16
    v_dot2c_f32_bf16 v237, s92, v17
    v_dot2c_f32_bf16 v238, v17, v17
    buffer_load_dwordx4 v246, s[8:11], s32 offen offset:2048 lds
    v_dot2c_f32_bf16 v237, s92, v18
    v_dot2c_f32_bf16 v238, v18, v18
    v_dot2c_f32_bf16 v237, s92, v19
    v_dot2c_f32_bf16 v238, v19, v19
    s_waitcnt lgkmcnt(6)
    v_dot2c_f32_bf16 v237, s92, v20
    v_dot2c_f32_bf16 v238, v20, v20
    v_dot2c_f32_bf16 v237, s92, v21
    v_dot2c_f32_bf16 v238, v21, v21
    v_dot2c_f32_bf16 v237, s92, v22
    v_dot2c_f32_bf16 v238, v22, v22
    v_dot2c_f32_bf16 v237, s92, v23
    v_dot2c_f32_bf16 v238, v23, v23
    s_waitcnt lgkmcnt(5)
    v_dot2c_f32_bf16 v237, s92, v24
    v_dot2c_f32_bf16 v238, v24, v24
    v_dot2c_f32_bf16 v237, s92, v25
    v_dot2c_f32_bf16 v238, v25, v25
    buffer_load_dwordx4 v247, s[8:11], s32 offen offset:3072 lds
    v_dot2c_f32_bf16 v237, s92, v26
    v_dot2c_f32_bf16 v238, v26, v26
    v_dot2c_f32_bf16 v237, s92, v27
    v_dot2c_f32_bf16 v238, v27, v27
    s_waitcnt lgkmcnt(4)
    v_dot2c_f32_bf16 v237, s92, v28
    v_dot2c_f32_bf16 v238, v28, v28
    v_dot2c_f32_bf16 v237, s92, v29
    v_dot2c_f32_bf16 v238, v29, v29
    v_dot2c_f32_bf16 v237, s92, v30
    v_dot2c_f32_bf16 v238, v30, v30
    v_dot2c_f32_bf16 v237, s92, v31
    v_dot2c_f32_bf16 v238, v31, v31
    s_waitcnt lgkmcnt(3)
    v_dot2c_f32_bf16 v237, s92, v32
    v_dot2c_f32_bf16 v238, v32, v32
    v_dot2c_f32_bf16 v237, s92, v33
    v_dot2c_f32_bf16 v238, v33, v33
    s_add_u32 m0, s78, 49152
    s_add_u32 s32, s79, s71
    buffer_load_dwordx4 v244, s[8:11], s32 offen offset:0 lds
    v_dot2c_f32_bf16 v237, s92, v34
    v_dot2c_f32_bf16 v238, v34, v34
    v_dot2c_f32_bf16 v237, s92, v35
    v_dot2c_f32_bf16 v238, v35, v35
    s_waitcnt lgkmcnt(2)
    v_dot2c_f32_bf16 v237, s92, v36
    v_dot2c_f32_bf16 v238, v36, v36
    v_dot2c_f32_bf16 v237, s92, v37
    v_dot2c_f32_bf16 v238, v37, v37
    v_dot2c_f32_bf16 v237, s92, v38
    v_dot2c_f32_bf16 v238, v38, v38
    v_dot2c_f32_bf16 v237, s92, v39
    v_dot2c_f32_bf16 v238, v39, v39
    s_waitcnt lgkmcnt(1)
    v_dot2c_f32_bf16 v237, s92, v40
    v_dot2c_f32_bf16 v238, v40, v40
    v_dot2c_f32_bf16 v237, s92, v41
    v_dot2c_f32_bf16 v238, v41, v41
    buffer_load_dwordx4 v245, s[8:11], s32 offen offset:1024 lds
    v_dot2c_f32_bf16 v237, s92, v42
    v_dot2c_f32_bf16 v238, v42, v42
    v_dot2c_f32_bf16 v237, s92, v43
    v_dot2c_f32_bf16 v238, v43, v43
    s_waitcnt lgkmcnt(0)
    v_dot2c_f32_bf16 v237, s92, v44
    v_dot2c_f32_bf16 v238, v44, v44
    v_dot2c_f32_bf16 v237, s92, v45
    v_dot2c_f32_bf16 v238, v45, v45
    v_dot2c_f32_bf16 v237, s92, v46
    v_dot2c_f32_bf16 v238, v46, v46
    v_dot2c_f32_bf16 v237, s92, v47
    v_dot2c_f32_bf16 v238, v47, v47
    s_waitcnt vmcnt(11)
    ds_read_b128 v[48:51], v224 offset:16384
    ds_read_b128 v[52:55], v225 offset:16384
    ds_read_b128 v[56:59], v226 offset:16384
    ds_read_b128 v[60:63], v227 offset:16384
    buffer_load_dwordx4 v246, s[8:11], s32 offen offset:2048 lds
    ds_read_b128 v[64:67], v228 offset:16384
    ds_read_b128 v[68:71], v229 offset:16384
    ds_read_b128 v[72:75], v230 offset:16384
    ds_read_b128 v[76:79], v231 offset:16384
    s_waitcnt lgkmcnt(7)
    v_dot2c_f32_bf16 v237, s92, v48
    v_dot2c_f32_bf16 v238, v48, v48
    v_dot2c_f32_bf16 v237, s92, v49
    v_dot2c_f32_bf16 v238, v49, v49
    v_dot2c_f32_bf16 v237, s92, v50
    v_dot2c_f32_bf16 v238, v50, v50
    v_dot2c_f32_bf16 v237, s92, v51
    v_dot2c_f32_bf16 v238, v51, v51
    s_waitcnt lgkmcnt(6)
    v_dot2c_f32_bf16 v237, s92, v52
    v_dot2c_f32_bf16 v238, v52, v52
    v_dot2c_f32_bf16 v237, s92, v53
    v_dot2c_f32_bf16 v238, v53, v53
    buffer_load_dwordx4 v247, s[8:11], s32 offen offset:3072 lds
    v_dot2c_f32_bf16 v237, s92, v54
    v_dot2c_f32_bf16 v238, v54, v54
    v_dot2c_f32_bf16 v237, s92, v55
    v_dot2c_f32_bf16 v238, v55, v55
    s_waitcnt lgkmcnt(5)
    v_dot2c_f32_bf16 v237, s92, v56
    v_dot2c_f32_bf16 v238, v56, v56
    v_dot2c_f32_bf16 v237, s92, v57
    v_dot2c_f32_bf16 v238, v57, v57
    v_dot2c_f32_bf16 v237, s92, v58
    v_dot2c_f32_bf16 v238, v58, v58
    v_dot2c_f32_bf16 v237, s92, v59
    v_dot2c_f32_bf16 v238, v59, v59
    s_waitcnt lgkmcnt(4)
    v_dot2c_f32_bf16 v237, s92, v60
    v_dot2c_f32_bf16 v238, v60, v60
    v_dot2c_f32_bf16 v237, s92, v61
    v_dot2c_f32_bf16 v238, v61, v61
    s_add_u32 m0, s78, 114688
    s_add_u32 s32, s79, s71
    s_add_u32 s32, s32, 10240
    buffer_load_dwordx4 v244, s[8:11], s32 offen offset:0 lds
    v_dot2c_f32_bf16 v237, s92, v62
    v_dot2c_f32_bf16 v238, v62, v62
    v_dot2c_f32_bf16 v237, s92, v63
    v_dot2c_f32_bf16 v238, v63, v63
    s_waitcnt lgkmcnt(3)
    v_dot2c_f32_bf16 v237, s92, v64
    v_dot2c_f32_bf16 v238, v64, v64
    v_dot2c_f32_bf16 v237, s92, v65
    v_dot2c_f32_bf16 v238, v65, v65
    v_dot2c_f32_bf16 v237, s92, v66
    v_dot2c_f32_bf16 v238, v66, v66
    v_dot2c_f32_bf16 v237, s92, v67
    v_dot2c_f32_bf16 v238, v67, v67
    s_waitcnt lgkmcnt(2)
    v_dot2c_f32_bf16 v237, s92, v68
    v_dot2c_f32_bf16 v238, v68, v68
    v_dot2c_f32_bf16 v237, s92, v69
    v_dot2c_f32_bf16 v238, v69, v69
    buffer_load_dwordx4 v245, s[8:11], s32 offen offset:1024 lds
    v_dot2c_f32_bf16 v237, s92, v70
    v_dot2c_f32_bf16 v238, v70, v70
    v_dot2c_f32_bf16 v237, s92, v71
    v_dot2c_f32_bf16 v238, v71, v71
    s_waitcnt lgkmcnt(1)
    v_dot2c_f32_bf16 v237, s92, v72
    v_dot2c_f32_bf16 v238, v72, v72
    v_dot2c_f32_bf16 v237, s92, v73
    v_dot2c_f32_bf16 v238, v73, v73
    v_dot2c_f32_bf16 v237, s92, v74
    v_dot2c_f32_bf16 v238, v74, v74
    v_dot2c_f32_bf16 v237, s92, v75
    v_dot2c_f32_bf16 v238, v75, v75
    s_waitcnt lgkmcnt(0)
    v_dot2c_f32_bf16 v237, s92, v76
    v_dot2c_f32_bf16 v238, v76, v76
    v_dot2c_f32_bf16 v237, s92, v77
    v_dot2c_f32_bf16 v238, v77, v77
    buffer_load_dwordx4 v246, s[8:11], s32 offen offset:2048 lds
    v_dot2c_f32_bf16 v237, s92, v78
    v_dot2c_f32_bf16 v238, v78, v78
    v_dot2c_f32_bf16 v237, s92, v79
    v_dot2c_f32_bf16 v238, v79, v79
    buffer_load_dwordx4 v247, s[8:11], s32 offen offset:3072 lds
    s_mov_b32 m0, s93
    s_add_u32 s32, s79, s72
    buffer_load_dwordx4 v244, s[8:11], s32 offen offset:0 lds
    s_waitcnt vmcnt(9)
    ds_read_b128 v[80:83], v224 offset:32768
    ds_read_b128 v[84:87], v225 offset:32768
    ds_read_b128 v[88:91], v226 offset:32768
    ds_read_b128 v[92:95], v227 offset:32768
    ds_read_b128 v[96:99], v228 offset:32768
    ds_read_b128 v[100:103], v229 offset:32768
    ds_read_b128 v[104:107], v230 offset:32768
    ds_read_b128 v[108:111], v231 offset:32768
    s_waitcnt lgkmcnt(7)
    v_dot2c_f32_bf16 v237, s92, v80
    v_dot2c_f32_bf16 v238, v80, v80
    v_dot2c_f32_bf16 v237, s92, v81
    v_dot2c_f32_bf16 v238, v81, v81
    v_dot2c_f32_bf16 v237, s92, v82
    v_dot2c_f32_bf16 v238, v82, v82
    v_dot2c_f32_bf16 v237, s92, v83
    v_dot2c_f32_bf16 v238, v83, v83
    buffer_load_dwordx4 v245, s[8:11], s32 offen offset:1024 lds
    s_waitcnt lgkmcnt(6)
    v_dot2c_f32_bf16 v237, s92, v84
    v_dot2c_f32_bf16 v238, v84, v84
    v_dot2c_f32_bf16 v237, s92, v85
    v_dot2c_f32_bf16 v238, v85, v85
    v_dot2c_f32_bf16 v237, s92, v86
    v_dot2c_f32_bf16 v238, v86, v86
    v_dot2c_f32_bf16 v237, s92, v87
    v_dot2c_f32_bf16 v238, v87, v87
    s_waitcnt lgkmcnt(5)
    v_dot2c_f32_bf16 v237, s92, v88
    v_dot2c_f32_bf16 v238, v88, v88
    v_dot2c_f32_bf16 v237, s92, v89
    v_dot2c_f32_bf16 v238, v89, v89
    v_dot2c_f32_bf16 v237, s92, v90
    v_dot2c_f32_bf16 v238, v90, v90
    v_dot2c_f32_bf16 v237, s92, v91
    v_dot2c_f32_bf16 v238, v91, v91
    buffer_load_dwordx4 v246, s[8:11], s32 offen offset:2048 lds
    s_waitcnt lgkmcnt(4)
    v_dot2c_f32_bf16 v237, s92, v92
    v_dot2c_f32_bf16 v238, v92, v92
    v_dot2c_f32_bf16 v237, s92, v93
    v_dot2c_f32_bf16 v238, v93, v93
    v_dot2c_f32_bf16 v237, s92, v94
    v_dot2c_f32_bf16 v238, v94, v94
    v_dot2c_f32_bf16 v237, s92, v95
    v_dot2c_f32_bf16 v238, v95, v95
    s_waitcnt lgkmcnt(3)
    v_dot2c_f32_bf16 v237, s92, v96
    v_dot2c_f32_bf16 v238, v96, v96
    v_dot2c_f32_bf16 v237, s92, v97
    v_dot2c_f32_bf16 v238, v97, v97
    v_dot2c_f32_bf16 v237, s92, v98
    v_dot2c_f32_bf16 v238, v98, v98
    v_dot2c_f32_bf16 v237, s92, v99
    v_dot2c_f32_bf16 v238, v99, v99
    buffer_load_dwordx4 v247, s[8:11], s32 offen offset:3072 lds
    s_waitcnt lgkmcnt(2)
    v_dot2c_f32_bf16 v237, s92, v100
    v_dot2c_f32_bf16 v238, v100, v100
    v_dot2c_f32_bf16 v237, s92, v101
    v_dot2c_f32_bf16 v238, v101, v101
    v_dot2c_f32_bf16 v237, s92, v102
    v_dot2c_f32_bf16 v238, v102, v102
    v_dot2c_f32_bf16 v237, s92, v103
    v_dot2c_f32_bf16 v238, v103, v103
    s_waitcnt lgkmcnt(1)
    v_dot2c_f32_bf16 v237, s92, v104
    v_dot2c_f32_bf16 v238, v104, v104
    v_dot2c_f32_bf16 v237, s92, v105
    v_dot2c_f32_bf16 v238, v105, v105
    v_dot2c_f32_bf16 v237, s92, v106
    v_dot2c_f32_bf16 v238, v106, v106
    v_dot2c_f32_bf16 v237, s92, v107
    v_dot2c_f32_bf16 v238, v107, v107
    s_add_u32 m0, s93, 4096
    s_add_u32 s32, s79, s72
    s_add_u32 s32, s32, 10240
    buffer_load_dwordx4 v244, s[8:11], s32 offen offset:0 lds
    s_waitcnt lgkmcnt(0)
    v_dot2c_f32_bf16 v237, s92, v108
    v_dot2c_f32_bf16 v238, v108, v108
    v_dot2c_f32_bf16 v237, s92, v109
    v_dot2c_f32_bf16 v238, v109, v109
    v_dot2c_f32_bf16 v237, s92, v110
    v_dot2c_f32_bf16 v238, v110, v110
    v_dot2c_f32_bf16 v237, s92, v111
    v_dot2c_f32_bf16 v238, v111, v111
    buffer_load_dwordx4 v245, s[8:11], s32 offen offset:1024 lds
    buffer_load_dwordx4 v246, s[8:11], s32 offen offset:2048 lds
    buffer_load_dwordx4 v247, s[8:11], s32 offen offset:3072 lds
    s_waitcnt vmcnt(8)
    ds_read_b128 v[112:115], v224 offset:49152
    ds_read_b128 v[116:119], v225 offset:49152
    ds_read_b128 v[120:123], v226 offset:49152
    ds_read_b128 v[124:127], v227 offset:49152
    ds_read_b128 v[128:131], v228 offset:49152
    ds_read_b128 v[132:135], v229 offset:49152
    ds_read_b128 v[136:139], v230 offset:49152
    ds_read_b128 v[140:143], v231 offset:49152
    s_waitcnt lgkmcnt(7)
    v_dot2c_f32_bf16 v237, s92, v112
    v_dot2c_f32_bf16 v238, v112, v112
    v_dot2c_f32_bf16 v237, s92, v113
    v_dot2c_f32_bf16 v238, v113, v113
    v_dot2c_f32_bf16 v237, s92, v114
    v_dot2c_f32_bf16 v238, v114, v114
    v_dot2c_f32_bf16 v237, s92, v115
    v_dot2c_f32_bf16 v238, v115, v115
    s_add_u32 m0, s78, 0
    s_add_u32 s32, s81, s68
    buffer_load_dwordx4 v212, s[12:15], s32 offen offset:0 lds
    s_waitcnt lgkmcnt(6)
    v_dot2c_f32_bf16 v237, s92, v116
    v_dot2c_f32_bf16 v238, v116, v116
    v_dot2c_f32_bf16 v237, s92, v117
    v_dot2c_f32_bf16 v238, v117, v117
    v_dot2c_f32_bf16 v237, s92, v118
    v_dot2c_f32_bf16 v238, v118, v118
    v_dot2c_f32_bf16 v237, s92, v119
    v_dot2c_f32_bf16 v238, v119, v119
    s_waitcnt lgkmcnt(5)
    v_dot2c_f32_bf16 v237, s92, v120
    v_dot2c_f32_bf16 v238, v120, v120
    v_dot2c_f32_bf16 v237, s92, v121
    v_dot2c_f32_bf16 v238, v121, v121
    v_dot2c_f32_bf16 v237, s92, v122
    v_dot2c_f32_bf16 v238, v122, v122
    v_dot2c_f32_bf16 v237, s92, v123
    v_dot2c_f32_bf16 v238, v123, v123
    buffer_load_dwordx4 v213, s[12:15], s32 offen offset:1024 lds
    s_waitcnt lgkmcnt(4)
    v_dot2c_f32_bf16 v237, s92, v124
    v_dot2c_f32_bf16 v238, v124, v124
    v_dot2c_f32_bf16 v237, s92, v125
    v_dot2c_f32_bf16 v238, v125, v125
    v_dot2c_f32_bf16 v237, s92, v126
    v_dot2c_f32_bf16 v238, v126, v126
    v_dot2c_f32_bf16 v237, s92, v127
    v_dot2c_f32_bf16 v238, v127, v127
    s_waitcnt lgkmcnt(3)
    v_dot2c_f32_bf16 v237, s92, v128
    v_dot2c_f32_bf16 v238, v128, v128
    v_dot2c_f32_bf16 v237, s92, v129
    v_dot2c_f32_bf16 v238, v129, v129
    v_dot2c_f32_bf16 v237, s92, v130
    v_dot2c_f32_bf16 v238, v130, v130
    v_dot2c_f32_bf16 v237, s92, v131
    v_dot2c_f32_bf16 v238, v131, v131
    buffer_load_dwordx4 v214, s[12:15], s32 offen offset:2048 lds
    s_waitcnt lgkmcnt(2)
    v_dot2c_f32_bf16 v237, s92, v132
    v_dot2c_f32_bf16 v238, v132, v132
    v_dot2c_f32_bf16 v237, s92, v133
    v_dot2c_f32_bf16 v238, v133, v133
    v_dot2c_f32_bf16 v237, s92, v134
    v_dot2c_f32_bf16 v238, v134, v134
    v_dot2c_f32_bf16 v237, s92, v135
    v_dot2c_f32_bf16 v238, v135, v135
    s_waitcnt lgkmcnt(1)
    v_dot2c_f32_bf16 v237, s92, v136
    v_dot2c_f32_bf16 v238, v136, v136
    v_dot2c_f32_bf16 v237, s92, v137
    v_dot2c_f32_bf16 v238, v137, v137
    v_dot2c_f32_bf16 v237, s92, v138
    v_dot2c_f32_bf16 v238, v138, v138
    v_dot2c_f32_bf16 v237, s92, v139
    v_dot2c_f32_bf16 v238, v139, v139
    buffer_load_dwordx4 v215, s[12:15], s32 offen offset:3072 lds
    s_waitcnt lgkmcnt(0)
    v_dot2c_f32_bf16 v237, s92, v140
    v_dot2c_f32_bf16 v238, v140, v140
    v_dot2c_f32_bf16 v237, s92, v141
    v_dot2c_f32_bf16 v238, v141, v141
    v_dot2c_f32_bf16 v237, s92, v142
    v_dot2c_f32_bf16 v238, v142, v142
    v_dot2c_f32_bf16 v237, s92, v143
    v_dot2c_f32_bf16 v238, v143, v143
    v_add_u32 v224, s93, v216
    v_add_u32 v225, s93, v217
    v_add_u32 v226, s93, v218
    v_add_u32 v227, s93, v219
    v_add_u32 v228, s93, v220
    v_add_u32 v229, s93, v221
    v_add_u32 v230, s93, v222
    v_add_u32 v231, s93, v223
    s_waitcnt vmcnt(4)
    ds_read_b128 v[144:147], v224 offset:0
    ds_read_b128 v[148:151], v225 offset:0
    ds_read_b128 v[152:155], v226 offset:0
    ds_read_b128 v[156:159], v227 offset:0
    s_add_u32 m0, s78, 16384
    s_add_u32 s32, s81, s69
    buffer_load_dwordx4 v212, s[12:15], s32 offen offset:0 lds
    ds_read_b128 v[160:163], v228 offset:0
    ds_read_b128 v[164:167], v229 offset:0
    ds_read_b128 v[168:171], v230 offset:0
    ds_read_b128 v[172:175], v231 offset:0
    s_waitcnt lgkmcnt(7)
    v_dot2c_f32_bf16 v237, s92, v144
    v_dot2c_f32_bf16 v238, v144, v144
    v_dot2c_f32_bf16 v237, s92, v145
    v_dot2c_f32_bf16 v238, v145, v145
    v_dot2c_f32_bf16 v237, s92, v146
    v_dot2c_f32_bf16 v238, v146, v146
    v_dot2c_f32_bf16 v237, s92, v147
    v_dot2c_f32_bf16 v238, v147, v147
    s_waitcnt lgkmcnt(6)
    v_dot2c_f32_bf16 v237, s92, v148
    v_dot2c_f32_bf16 v238, v148, v148
    v_dot2c_f32_bf16 v237, s92, v149
    v_dot2c_f32_bf16 v238, v149, v149
    buffer_load_dwordx4 v213, s[12:15], s32 offen offset:1024 lds
    v_dot2c_f32_bf16 v237, s92, v150
    v_dot2c_f32_bf16 v238, v150, v150
    v_dot2c_f32_bf16 v237, s92, v151
    v_dot2c_f32_bf16 v238, v151, v151
    s_waitcnt lgkmcnt(5)
    v_dot2c_f32_bf16 v237, s92, v152
    v_dot2c_f32_bf16 v238, v152, v152
    v_dot2c_f32_bf16 v237, s92, v153
    v_dot2c_f32_bf16 v238, v153, v153
    v_dot2c_f32_bf16 v237, s92, v154
    v_dot2c_f32_bf16 v238, v154, v154
    v_dot2c_f32_bf16 v237, s92, v155
    v_dot2c_f32_bf16 v238, v155, v155
    s_waitcnt lgkmcnt(4)
    v_dot2c_f32_bf16 v237, s92, v156
    v_dot2c_f32_bf16 v238, v156, v156
    v_dot2c_f32_bf16 v237, s92, v157
    v_dot2c_f32_bf16 v238, v157, v157
    buffer_load_dwordx4 v214, s[12:15], s32 offen offset:2048 lds
    v_dot2c_f32_bf16 v237, s92, v158
    v_dot2c_f32_bf16 v238, v158, v158
    v_dot2c_f32_bf16 v237, s92, v159
    v_dot2c_f32_bf16 v238, v159, v159
    s_waitcnt lgkmcnt(3)
    v_dot2c_f32_bf16 v237, s92, v160
    v_dot2c_f32_bf16 v238, v160, v160
    v_dot2c_f32_bf16 v237, s92, v161
    v_dot2c_f32_bf16 v238, v161, v161
    v_dot2c_f32_bf16 v237, s92, v162
    v_dot2c_f32_bf16 v238, v162, v162
    v_dot2c_f32_bf16 v237, s92, v163
    v_dot2c_f32_bf16 v238, v163, v163
    s_waitcnt lgkmcnt(2)
    v_dot2c_f32_bf16 v237, s92, v164
    v_dot2c_f32_bf16 v238, v164, v164
    v_dot2c_f32_bf16 v237, s92, v165
    v_dot2c_f32_bf16 v238, v165, v165
    buffer_load_dwordx4 v215, s[12:15], s32 offen offset:3072 lds
    v_dot2c_f32_bf16 v237, s92, v166
    v_dot2c_f32_bf16 v238, v166, v166
    v_dot2c_f32_bf16 v237, s92, v167
    v_dot2c_f32_bf16 v238, v167, v167
    s_waitcnt lgkmcnt(1)
    v_dot2c_f32_bf16 v237, s92, v168
    v_dot2c_f32_bf16 v238, v168, v168
    v_dot2c_f32_bf16 v237, s92, v169
    v_dot2c_f32_bf16 v238, v169, v169
    v_dot2c_f32_bf16 v237, s92, v170
    v_dot2c_f32_bf16 v238, v170, v170
    v_dot2c_f32_bf16 v237, s92, v171
    v_dot2c_f32_bf16 v238, v171, v171
    s_waitcnt lgkmcnt(0)
    v_dot2c_f32_bf16 v237, s92, v172
    v_dot2c_f32_bf16 v238, v172, v172
    v_dot2c_f32_bf16 v237, s92, v173
    v_dot2c_f32_bf16 v238, v173, v173
    s_add_u32 m0, s78, 32768
    s_add_u32 s32, s81, s70
    buffer_load_dwordx4 v212, s[12:15], s32 offen offset:0 lds
    v_dot2c_f32_bf16 v237, s92, v174
    v_dot2c_f32_bf16 v238, v174, v174
    v_dot2c_f32_bf16 v237, s92, v175
    v_dot2c_f32_bf16 v238, v175, v175
    s_nop 1
    v_mov_b32_e64 v252, v237
    v_mov_b32 v253, v238
    s_nop 0
    v_permlane32_swap_b32 v237, v252
    v_permlane32_swap_b32 v238, v253
    v_add_f32 v237, v237, v252
    v_add_f32 v238, v238, v253
    v_mul_f32 v237, 0x3acccccd, v237
    v_mul_f32 v238, 0x3acccccd, v238
    v_fma_f32 v238, -v237, v237, v238
    v_max_f32_e64 v238, 0, v238
    v_cvt_pk_bf16_f32 v252, v238, v237
    v_lshlrev_b32 v238, 16, v252
    v_and_b32 v237, s86, v252
    v_add_f32 v238, 0x3727c5ac, v238
    v_cvt_pk_bf16_f32 v238, v238, v238
    v_lshlrev_b32 v238, 16, v238
    v_sqrt_f32 v238, v238
    s_lshl_b32 s34, s5, 2
    s_add_u32 s34, s34, s4
    v_cvt_pk_bf16_f32 v238, v238, v238
    v_lshlrev_b32_e64 v238, 16, v238
    v_rcp_f32 v252, v238
    s_lshl_b32 s34, s34, 8
    s_add_u32 s34, s34, 16777216
    v_mul_f32 v254, -v237, v252
    v_mov_b32 v253, v252
    v_mov_b32 v255, v254
    s_cmp_eq_u32 s6, 0
    s_cselect_b32 s34, s34, 1073741824
    v_lshlrev_b32 v244, 16, v16
    v_and_b32 v245, s86, v16
    v_pk_fma_f32 v[244:245], v[244:245], v[252:253], v[254:255]
    v_cvt_pk_bf16_f32 v16, v244, v245
    v_accvgpr_write_b32 a0, v16
    v_lshlrev_b32 v246, 16, v17
    v_and_b32 v247, s86, v17
    v_pk_fma_f32 v[246:247], v[246:247], v[252:253], v[254:255]
    v_cvt_pk_bf16_f32 v17, v246, v247
    v_accvgpr_write_b32 a1, v17
    v_lshlrev_b32 v244, 16, v18
    v_and_b32 v245, s86, v18
    v_pk_fma_f32 v[244:245], v[244:245], v[252:253], v[254:255]
    v_cvt_pk_bf16_f32 v18, v244, v245
    v_accvgpr_write_b32 a2, v18
    v_lshlrev_b32 v246, 16, v19
    v_and_b32 v247, s86, v19
    v_pk_fma_f32 v[246:247], v[246:247], v[252:253], v[254:255]
    v_cvt_pk_bf16_f32 v19, v246, v247
    v_accvgpr_write_b32 a3, v19
    buffer_load_dwordx4 v213, s[12:15], s32 offen offset:1024 lds
    v_lshlrev_b32 v244, 16, v20
    v_and_b32 v245, s86, v20
    v_pk_fma_f32 v[244:245], v[244:245], v[252:253], v[254:255]
    v_cvt_pk_bf16_f32 v20, v244, v245
    v_accvgpr_write_b32 a4, v20
    v_lshlrev_b32 v246, 16, v21
    v_and_b32 v247, s86, v21
    v_pk_fma_f32 v[246:247], v[246:247], v[252:253], v[254:255]
    v_cvt_pk_bf16_f32 v21, v246, v247
    v_accvgpr_write_b32 a5, v21
    v_lshlrev_b32 v244, 16, v22
    v_and_b32 v245, s86, v22
    v_pk_fma_f32 v[244:245], v[244:245], v[252:253], v[254:255]
    v_cvt_pk_bf16_f32 v22, v244, v245
    v_accvgpr_write_b32 a6, v22
    v_lshlrev_b32 v246, 16, v23
    v_and_b32 v247, s86, v23
    v_pk_fma_f32 v[246:247], v[246:247], v[252:253], v[254:255]
    v_cvt_pk_bf16_f32 v23, v246, v247
    v_accvgpr_write_b32 a7, v23
    buffer_load_dwordx4 v214, s[12:15], s32 offen offset:2048 lds
    v_lshlrev_b32 v244, 16, v24
    v_and_b32 v245, s86, v24
    v_pk_fma_f32 v[244:245], v[244:245], v[252:253], v[254:255]
    v_cvt_pk_bf16_f32 v24, v244, v245
    v_accvgpr_write_b32 a8, v24
    v_lshlrev_b32 v246, 16, v25
    v_and_b32 v247, s86, v25
    v_pk_fma_f32 v[246:247], v[246:247], v[252:253], v[254:255]
    v_cvt_pk_bf16_f32 v25, v246, v247
    v_accvgpr_write_b32 a9, v25
    v_lshlrev_b32 v244, 16, v26
    v_and_b32 v245, s86, v26
    v_pk_fma_f32 v[244:245], v[244:245], v[252:253], v[254:255]
    v_cvt_pk_bf16_f32 v26, v244, v245
    v_accvgpr_write_b32 a10, v26
    v_lshlrev_b32 v246, 16, v27
    v_and_b32 v247, s86, v27
    v_pk_fma_f32 v[246:247], v[246:247], v[252:253], v[254:255]
    v_cvt_pk_bf16_f32 v27, v246, v247
    v_accvgpr_write_b32 a11, v27
    buffer_load_dwordx4 v215, s[12:15], s32 offen offset:3072 lds
    v_lshlrev_b32 v244, 16, v28
    v_and_b32 v245, s86, v28
    v_pk_fma_f32 v[244:245], v[244:245], v[252:253], v[254:255]
    v_cvt_pk_bf16_f32 v28, v244, v245
    v_accvgpr_write_b32 a12, v28
    v_lshlrev_b32 v246, 16, v29
    v_and_b32 v247, s86, v29
    v_pk_fma_f32 v[246:247], v[246:247], v[252:253], v[254:255]
    v_cvt_pk_bf16_f32 v29, v246, v247
    v_accvgpr_write_b32 a13, v29
    v_lshlrev_b32 v244, 16, v30
    v_and_b32 v245, s86, v30
    v_pk_fma_f32 v[244:245], v[244:245], v[252:253], v[254:255]
    v_cvt_pk_bf16_f32 v30, v244, v245
    v_accvgpr_write_b32 a14, v30
    v_lshlrev_b32 v246, 16, v31
    v_and_b32 v247, s86, v31
    v_pk_fma_f32 v[246:247], v[246:247], v[252:253], v[254:255]
    v_cvt_pk_bf16_f32 v31, v246, v247
    v_accvgpr_write_b32 a15, v31
    s_add_u32 m0, s78, 49152
    s_add_u32 s32, s81, s71
    buffer_load_dwordx4 v212, s[12:15], s32 offen offset:0 lds
    v_lshlrev_b32 v244, 16, v32
    v_and_b32_e64 v245, s86, v32
    v_pk_fma_f32 v[244:245], v[244:245], v[252:253], v[254:255]
    v_cvt_pk_bf16_f32 v32, v244, v245
    v_accvgpr_write_b32 a16, v32
    v_lshlrev_b32 v246, 16, v33
    v_and_b32 v247, s86, v33
    v_pk_fma_f32 v[246:247], v[246:247], v[252:253], v[254:255]
    v_cvt_pk_bf16_f32 v33, v246, v247
    v_accvgpr_write_b32 a17, v33
    v_lshlrev_b32 v244, 16, v34
    v_and_b32 v245, s86, v34
    v_pk_fma_f32 v[244:245], v[244:245], v[252:253], v[254:255]
    v_cvt_pk_bf16_f32 v34, v244, v245
    v_accvgpr_write_b32 a18, v34
    v_lshlrev_b32 v246, 16, v35
    v_and_b32 v247, s86, v35
    v_pk_fma_f32 v[246:247], v[246:247], v[252:253], v[254:255]
    v_cvt_pk_bf16_f32 v35, v246, v247
    v_accvgpr_write_b32 a19, v35
    buffer_load_dwordx4 v213, s[12:15], s32 offen offset:1024 lds
    v_lshlrev_b32 v244, 16, v36
    v_and_b32 v245, s86, v36
    v_pk_fma_f32 v[244:245], v[244:245], v[252:253], v[254:255]
    v_cvt_pk_bf16_f32 v36, v244, v245
    v_accvgpr_write_b32 a20, v36
    v_lshlrev_b32 v246, 16, v37
    v_and_b32 v247, s86, v37
    v_pk_fma_f32 v[246:247], v[246:247], v[252:253], v[254:255]
    v_cvt_pk_bf16_f32 v37, v246, v247
    v_accvgpr_write_b32 a21, v37
    v_lshlrev_b32 v244, 16, v38
    v_and_b32 v245, s86, v38
    v_pk_fma_f32 v[244:245], v[244:245], v[252:253], v[254:255]
    v_cvt_pk_bf16_f32 v38, v244, v245
    v_accvgpr_write_b32 a22, v38
    v_lshlrev_b32 v246, 16, v39
    v_and_b32 v247, s86, v39
    v_pk_fma_f32 v[246:247], v[246:247], v[252:253], v[254:255]
    v_cvt_pk_bf16_f32 v39, v246, v247
    v_accvgpr_write_b32 a23, v39
    buffer_load_dwordx4 v214, s[12:15], s32 offen offset:2048 lds
    v_lshlrev_b32 v244, 16, v40
    v_and_b32 v245, s86, v40
    v_pk_fma_f32 v[244:245], v[244:245], v[252:253], v[254:255]
    v_cvt_pk_bf16_f32 v40, v244, v245
    v_accvgpr_write_b32 a24, v40
    v_lshlrev_b32 v246, 16, v41
    v_and_b32 v247, s86, v41
    v_pk_fma_f32 v[246:247], v[246:247], v[252:253], v[254:255]
    v_cvt_pk_bf16_f32 v41, v246, v247
    v_accvgpr_write_b32 a25, v41
    v_lshlrev_b32 v244, 16, v42
    v_and_b32 v245, s86, v42
    v_pk_fma_f32 v[244:245], v[244:245], v[252:253], v[254:255]
    v_cvt_pk_bf16_f32 v42, v244, v245
    v_accvgpr_write_b32 a26, v42
    v_lshlrev_b32 v246, 16, v43
    v_and_b32 v247, s86, v43
    v_pk_fma_f32 v[246:247], v[246:247], v[252:253], v[254:255]
    v_cvt_pk_bf16_f32 v43, v246, v247
    v_accvgpr_write_b32 a27, v43
    buffer_load_dwordx4 v215, s[12:15], s32 offen offset:3072 lds
    v_lshlrev_b32 v244, 16, v44
    v_and_b32 v245, s86, v44
    v_pk_fma_f32 v[244:245], v[244:245], v[252:253], v[254:255]
    v_cvt_pk_bf16_f32 v44, v244, v245
    v_accvgpr_write_b32 a28, v44
    v_lshlrev_b32 v246, 16, v45
    v_and_b32 v247, s86, v45
    v_pk_fma_f32 v[246:247], v[246:247], v[252:253], v[254:255]
    v_cvt_pk_bf16_f32 v45, v246, v247
    v_accvgpr_write_b32 a29, v45
    v_lshlrev_b32 v244, 16, v46
    v_and_b32 v245, s86, v46
    v_pk_fma_f32 v[244:245], v[244:245], v[252:253], v[254:255]
    v_cvt_pk_bf16_f32 v46, v244, v245
    v_accvgpr_write_b32 a30, v46
    v_lshlrev_b32_e64 v246, 16, v47
    v_and_b32 v247, s86, v47
    v_pk_fma_f32 v[246:247], v[246:247], v[252:253], v[254:255]
    v_cvt_pk_bf16_f32 v47, v246, v247
    v_accvgpr_write_b32 a31, v47
    s_add_u32 m0, s78, 65536
    s_add_u32 s32, s81, s72
    buffer_load_dwordx4 v212, s[12:15], s32 offen offset:0 lds
    v_add_u32 v224, 0x10000, v216
    v_add_u32 v225, 0x10000, v217
    v_add_u32 v226, 0x10000, v218
    v_add_u32 v227, 0x10000, v219
    v_add_u32 v228, 0x10000, v220
    v_add_u32 v229, 0x10000, v221
    v_add_u32 v230, 0x10000, v222
    v_add_u32 v231, 0x10000, v223
    s_cmp_eq_u32 s84, 2
    s_cbranch_scc1 K1_TYPE_C
    s_cmp_eq_u32 s84, 1
    s_cbranch_scc1 K1_TYPE_B
    s_waitcnt vmcnt(13)
    s_barrier
    ds_read_b128 a[160:163], v216 offset:0
    ds_read_b128 a[164:167], v216 offset:8192
    ds_read_b128 a[168:171], v217 offset:0
    ds_read_b128 a[172:175], v217 offset:8192
    ds_read_b128 a[176:179], v218 offset:0
    ds_read_b128 a[180:183], v218 offset:8192
    ds_read_b128 a[184:187], v219 offset:0
    s_waitcnt lgkmcnt(3)
    v_mfma_f32_32x32x16_bf16 v[16:31], a[0:3], a[160:163], 0
    ds_read_b128 a[188:191], v219 offset:8192
    v_lshlrev_b32 v244, 16, v48
    v_and_b32_e64 v245, s86, v48
    v_lshlrev_b32 v246, 16, v49
    v_and_b32 v247, s86, v49
    v_pk_fma_f32 v[244:245], v[244:245], v[252:253], v[254:255]
    v_pk_fma_f32 v[246:247], v[246:247], v[252:253], v[254:255]
    v_mfma_f32_32x32x16_bf16 v[32:47], a[0:3], a[164:167], 0
    ds_read_b128 a[160:163], v220 offset:0
    buffer_load_dwordx4 v213, s[12:15], s32 offen offset:1024 lds
    v_cvt_pk_bf16_f32 v48, v244, v245
    v_cvt_pk_bf16_f32 v49, v246, v247
    v_accvgpr_write_b32 a32, v48
    v_accvgpr_write_b32 a33, v49
    v_lshlrev_b32 v248, 16, v50
    v_and_b32 v249, s86, v50
    v_lshlrev_b32 v250, 16, v51
    v_and_b32 v251, s86, v51
    v_pk_fma_f32 v[248:249], v[248:249], v[252:253], v[254:255]
    v_pk_fma_f32 v[250:251], v[250:251], v[252:253], v[254:255]
    v_mfma_f32_32x32x16_bf16 v[16:31], a[4:7], a[168:171], v[16:31]
    ds_read_b128 a[164:167], v220 offset:8192
    v_cvt_pk_bf16_f32 v50, v248, v249
    v_cvt_pk_bf16_f32 v51, v250, v251
    v_accvgpr_write_b32 a34, v50
    v_accvgpr_write_b32 a35, v51
    v_lshlrev_b32 v244, 16, v52
    v_and_b32 v245, s86, v52
    v_lshlrev_b32 v246, 16, v53
    v_and_b32 v247, s86, v53
    v_pk_fma_f32 v[244:245], v[244:245], v[252:253], v[254:255]
    v_pk_fma_f32 v[246:247], v[246:247], v[252:253], v[254:255]
    v_mfma_f32_32x32x16_bf16 v[32:47], a[4:7], a[172:175], v[32:47]
    ds_read_b128 a[168:171], v221 offset:0
    buffer_load_dwordx4 v214, s[12:15], s32 offen offset:2048 lds
    v_cvt_pk_bf16_f32 v52, v244, v245
    v_cvt_pk_bf16_f32 v53, v246, v247
    v_accvgpr_write_b32 a36, v52
    v_accvgpr_write_b32 a37, v53
    v_lshlrev_b32_e64 v248, 16, v54
    v_and_b32 v249, s86, v54
    v_lshlrev_b32 v250, 16, v55
    v_and_b32 v251, s86, v55
    v_pk_fma_f32 v[248:249], v[248:249], v[252:253], v[254:255]
    v_pk_fma_f32 v[250:251], v[250:251], v[252:253], v[254:255]
    s_waitcnt lgkmcnt(3)
    v_mfma_f32_32x32x16_bf16 v[16:31], a[8:11], a[176:179], v[16:31]
    ds_read_b128 a[172:175], v221 offset:8192
    v_cvt_pk_bf16_f32 v54, v248, v249
    v_cvt_pk_bf16_f32 v55, v250, v251
    v_accvgpr_write_b32 a38, v54
    v_accvgpr_write_b32 a39, v55
    v_lshlrev_b32 v244, 16, v56
    v_and_b32 v245, s86, v56
    v_lshlrev_b32 v246, 16, v57
    v_and_b32 v247, s86, v57
    v_pk_fma_f32 v[244:245], v[244:245], v[252:253], v[254:255]
    v_pk_fma_f32 v[246:247], v[246:247], v[252:253], v[254:255]
    v_mfma_f32_32x32x16_bf16 v[32:47], a[8:11], a[180:183], v[32:47]
    ds_read_b128 a[176:179], v222 offset:0
    buffer_load_dwordx4 v215, s[12:15], s32 offen offset:3072 lds
    v_cvt_pk_bf16_f32 v56, v244, v245
    v_cvt_pk_bf16_f32 v57, v246, v247
    v_accvgpr_write_b32 a40, v56
    v_accvgpr_write_b32 a41, v57
    v_lshlrev_b32 v248, 16, v58
    v_and_b32 v249, s86, v58
    v_lshlrev_b32 v250, 16, v59
    v_and_b32 v251, s86, v59
    v_pk_fma_f32 v[248:249], v[248:249], v[252:253], v[254:255]
    v_pk_fma_f32 v[250:251], v[250:251], v[252:253], v[254:255]
    v_mfma_f32_32x32x16_bf16 v[16:31], a[12:15], a[184:187], v[16:31]
    ds_read_b128 a[180:183], v222 offset:8192
    v_cvt_pk_bf16_f32 v58, v248, v249
    v_cvt_pk_bf16_f32 v59, v250, v251
    v_accvgpr_write_b32 a42, v58
    v_accvgpr_write_b32 a43, v59
    v_lshlrev_b32 v244, 16, v60
    v_and_b32 v245, s86, v60
    v_lshlrev_b32 v246, 16, v61
    v_and_b32 v247, s86, v61
    v_pk_fma_f32 v[244:245], v[244:245], v[252:253], v[254:255]
    v_pk_fma_f32 v[246:247], v[246:247], v[252:253], v[254:255]
    v_mfma_f32_32x32x16_bf16 v[32:47], a[12:15], a[188:191], v[32:47]
    ds_read_b128 a[184:187], v223 offset:0
    s_add_u32 m0, s78, 81920
    s_add_u32 s32, s82, s73
    buffer_load_dwordx4 v2, s[16:19], s32 offen offset:0 lds
    v_cvt_pk_bf16_f32 v60, v244, v245
    v_cvt_pk_bf16_f32 v61, v246, v247
    v_accvgpr_write_b32 a44, v60
    v_accvgpr_write_b32 a45, v61
    v_lshlrev_b32 v248, 16, v62
    v_and_b32 v249, s86, v62
    v_lshlrev_b32 v250, 16, v63
    v_and_b32 v251, s86, v63
    v_pk_fma_f32 v[248:249], v[248:249], v[252:253], v[254:255]
    v_pk_fma_f32 v[250:251], v[250:251], v[252:253], v[254:255]
    s_waitcnt lgkmcnt(3)
    v_mfma_f32_32x32x16_bf16 v[16:31], a[16:19], a[160:163], v[16:31]
    ds_read_b128 a[188:191], v223 offset:8192
    v_cvt_pk_bf16_f32 v62, v248, v249
    v_cvt_pk_bf16_f32 v63, v250, v251
    v_accvgpr_write_b32 a46, v62
    v_accvgpr_write_b32 a47, v63
    v_lshlrev_b32 v244, 16, v64
    v_and_b32 v245, s86, v64
    v_lshlrev_b32 v246, 16, v65
    v_and_b32 v247, s86, v65
    v_pk_fma_f32 v[244:245], v[244:245], v[252:253], v[254:255]
    v_pk_fma_f32 v[246:247], v[246:247], v[252:253], v[254:255]
    v_mfma_f32_32x32x16_bf16 v[32:47], a[16:19], a[164:167], v[32:47]
    s_waitcnt vmcnt(13)
    s_barrier
    ds_read_b128 a[160:163], v216 offset:16384
    buffer_load_dwordx4 v3, s[16:19], s32 offen offset:1024 lds
    v_cvt_pk_bf16_f32 v64, v244, v245
    v_cvt_pk_bf16_f32 v65, v246, v247
    v_accvgpr_write_b32 a48, v64
    v_accvgpr_write_b32 a49, v65
    v_lshlrev_b32 v248, 16, v66
    v_and_b32 v249, s86, v66
    v_lshlrev_b32 v250, 16, v67
    v_and_b32 v251, s86, v67
    v_pk_fma_f32 v[248:249], v[248:249], v[252:253], v[254:255]
    v_pk_fma_f32 v[250:251], v[250:251], v[252:253], v[254:255]
    v_mfma_f32_32x32x16_bf16 v[16:31], a[20:23], a[168:171], v[16:31]
    ds_read_b128 a[164:167], v216 offset:24576
    v_cvt_pk_bf16_f32 v66, v248, v249
    v_cvt_pk_bf16_f32 v67, v250, v251
    v_accvgpr_write_b32 a50, v66
    v_accvgpr_write_b32 a51, v67
    v_lshlrev_b32 v244, 16, v68
    v_and_b32 v245, s86, v68
    v_lshlrev_b32 v246, 16, v69
    v_and_b32 v247, s86, v69
    v_pk_fma_f32 v[244:245], v[244:245], v[252:253], v[254:255]
    v_pk_fma_f32 v[246:247], v[246:247], v[252:253], v[254:255]
    v_mfma_f32_32x32x16_bf16 v[32:47], a[20:23], a[172:175], v[32:47]
    ds_read_b128 a[168:171], v217 offset:16384
    buffer_load_dwordx4 v4, s[16:19], s32 offen offset:2048 lds
    v_cvt_pk_bf16_f32 v68, v244, v245
    v_cvt_pk_bf16_f32 v69, v246, v247
    v_accvgpr_write_b32 a52, v68
    v_accvgpr_write_b32 a53, v69
    v_lshlrev_b32_e64 v248, 16, v70
    v_and_b32 v249, s86, v70
    v_lshlrev_b32 v250, 16, v71
    v_and_b32 v251, s86, v71
    v_pk_fma_f32 v[248:249], v[248:249], v[252:253], v[254:255]
    v_pk_fma_f32 v[250:251], v[250:251], v[252:253], v[254:255]
    s_waitcnt lgkmcnt(3)
    v_mfma_f32_32x32x16_bf16 v[16:31], a[24:27], a[176:179], v[16:31]
    ds_read_b128 a[172:175], v217 offset:24576
    v_cvt_pk_bf16_f32 v70, v248, v249
    v_cvt_pk_bf16_f32 v71, v250, v251
    v_accvgpr_write_b32 a54, v70
    v_accvgpr_write_b32 a55, v71
    v_lshlrev_b32 v244, 16, v72
    v_and_b32 v245, s86, v72
    v_lshlrev_b32 v246, 16, v73
    v_and_b32 v247, s86, v73
    v_pk_fma_f32 v[244:245], v[244:245], v[252:253], v[254:255]
    v_pk_fma_f32 v[246:247], v[246:247], v[252:253], v[254:255]
    v_mfma_f32_32x32x16_bf16 v[32:47], a[24:27], a[180:183], v[32:47]
    ds_read_b128 a[176:179], v218 offset:16384
    buffer_load_dwordx4 v5, s[16:19], s32 offen offset:3072 lds
    v_cvt_pk_bf16_f32 v72, v244, v245
    v_cvt_pk_bf16_f32 v73, v246, v247
    v_accvgpr_write_b32 a56, v72
    v_accvgpr_write_b32 a57, v73
    v_lshlrev_b32 v248, 16, v74
    v_and_b32 v249, s86, v74
    v_lshlrev_b32 v250, 16, v75
    v_and_b32 v251, s86, v75
    v_pk_fma_f32 v[248:249], v[248:249], v[252:253], v[254:255]
    v_pk_fma_f32 v[250:251], v[250:251], v[252:253], v[254:255]
    v_mfma_f32_32x32x16_bf16 v[16:31], a[28:31], a[184:187], v[16:31]
    ds_read_b128 a[180:183], v218 offset:24576
    v_cvt_pk_bf16_f32 v74, v248, v249
    v_cvt_pk_bf16_f32 v75, v250, v251
    v_accvgpr_write_b32 a58, v74
    v_accvgpr_write_b32 a59, v75
    v_lshlrev_b32 v244, 16, v76
    v_and_b32 v245, s86, v76
    v_lshlrev_b32 v246, 16, v77
    v_and_b32 v247, s86, v77
    v_pk_fma_f32 v[244:245], v[244:245], v[252:253], v[254:255]
    v_pk_fma_f32 v[246:247], v[246:247], v[252:253], v[254:255]
    v_mfma_f32_32x32x16_bf16 v[32:47], a[28:31], a[188:191], v[32:47]
    ds_read_b128 a[184:187], v219 offset:16384
    s_add_u32 m0, s93, 0
    s_nop 0
    buffer_load_dwordx4 v188, s[24:27], s7 offen nt lds
    v_cvt_pk_bf16_f32 v76, v244, v245
    v_cvt_pk_bf16_f32 v77, v246, v247
    v_accvgpr_write_b32 a60, v76
    v_accvgpr_write_b32 a61, v77
    v_lshlrev_b32_e64 v248, 16, v78
    v_and_b32 v249, s86, v78
    v_lshlrev_b32 v250, 16, v79
    v_and_b32 v251, s86, v79
    v_pk_fma_f32 v[248:249], v[248:249], v[252:253], v[254:255]
    v_pk_fma_f32 v[250:251], v[250:251], v[252:253], v[254:255]
    s_waitcnt lgkmcnt(3)
    v_mfma_f32_32x32x16_bf16 v[16:31], a[32:35], a[160:163], v[16:31]
    ds_read_b128 a[188:191], v219 offset:24576
    v_cvt_pk_bf16_f32 v78, v248, v249
    v_cvt_pk_bf16_f32 v79, v250, v251
    v_accvgpr_write_b32 a62, v78
    v_accvgpr_write_b32 a63, v79
    v_lshlrev_b32_e64 v244, 16, v80
    v_and_b32 v245, s86, v80
    v_lshlrev_b32 v246, 16, v81
    v_and_b32 v247, s86, v81
    v_pk_fma_f32 v[244:245], v[244:245], v[252:253], v[254:255]
    v_pk_fma_f32 v[246:247], v[246:247], v[252:253], v[254:255]
    v_mfma_f32_32x32x16_bf16 v[32:47], a[32:35], a[164:167], v[32:47]
    ds_read_b128 a[160:163], v220 offset:16384
    s_add_u32 m0, s93, 1024
    s_nop 0
    buffer_load_dwordx4 v189, s[24:27], s7 offen nt lds
    v_cvt_pk_bf16_f32 v80, v244, v245
    v_cvt_pk_bf16_f32 v81, v246, v247
    v_accvgpr_write_b32 a64, v80
    v_accvgpr_write_b32 a65, v81
    v_lshlrev_b32 v248, 16, v82
    v_and_b32 v249, s86, v82
    v_lshlrev_b32 v250, 16, v83
    v_and_b32 v251, s86, v83
    v_pk_fma_f32 v[248:249], v[248:249], v[252:253], v[254:255]
    v_pk_fma_f32 v[250:251], v[250:251], v[252:253], v[254:255]
    v_mfma_f32_32x32x16_bf16 v[16:31], a[36:39], a[168:171], v[16:31]
    ds_read_b128 a[164:167], v220 offset:24576
    v_cvt_pk_bf16_f32 v82, v248, v249
    v_cvt_pk_bf16_f32 v83, v250, v251
    v_accvgpr_write_b32 a66, v82
    v_accvgpr_write_b32 a67, v83
    v_lshlrev_b32 v244, 16, v84
    v_and_b32 v245, s86, v84
    v_lshlrev_b32 v246, 16, v85
    v_and_b32 v247, s86, v85
    v_pk_fma_f32 v[244:245], v[244:245], v[252:253], v[254:255]
    v_pk_fma_f32 v[246:247], v[246:247], v[252:253], v[254:255]
    v_mfma_f32_32x32x16_bf16 v[32:47], a[36:39], a[172:175], v[32:47]
    ds_read_b128 a[168:171], v221 offset:16384
    s_add_u32 m0, s93, 2048
    s_nop 0
    buffer_load_dwordx4 v190, s[28:31], s7 offen nt lds
    v_cvt_pk_bf16_f32 v84, v244, v245
    v_cvt_pk_bf16_f32 v85, v246, v247
    v_accvgpr_write_b32 a68, v84
    v_accvgpr_write_b32 a69, v85
    v_lshlrev_b32 v248, 16, v86
    v_and_b32 v249, s86, v86
    v_lshlrev_b32 v250, 16, v87
    v_and_b32 v251, s86, v87
    v_pk_fma_f32 v[248:249], v[248:249], v[252:253], v[254:255]
    v_pk_fma_f32 v[250:251], v[250:251], v[252:253], v[254:255]
    s_waitcnt lgkmcnt(3)
    v_mfma_f32_32x32x16_bf16 v[16:31], a[40:43], a[176:179], v[16:31]
    ds_read_b128 a[172:175], v221 offset:24576
    v_cvt_pk_bf16_f32 v86, v248, v249
    v_cvt_pk_bf16_f32 v87, v250, v251
    v_accvgpr_write_b32 a70, v86
    v_accvgpr_write_b32 a71, v87
    v_lshlrev_b32_e64 v244, 16, v88
    v_and_b32 v245, s86, v88
    v_lshlrev_b32 v246, 16, v89
    v_and_b32 v247, s86, v89
    v_pk_fma_f32 v[244:245], v[244:245], v[252:253], v[254:255]
    v_pk_fma_f32 v[246:247], v[246:247], v[252:253], v[254:255]
    v_mfma_f32_32x32x16_bf16 v[32:47], a[40:43], a[180:183], v[32:47]
    ds_read_b128 a[176:179], v222 offset:16384
    s_add_u32 m0, s93, 3072
    s_nop 0
    buffer_load_dwordx4 v191, s[28:31], s7 offen nt lds
    v_cvt_pk_bf16_f32 v88, v244, v245
    v_cvt_pk_bf16_f32 v89, v246, v247
    v_accvgpr_write_b32 a72, v88
    v_accvgpr_write_b32 a73, v89
    v_lshlrev_b32 v248, 16, v90
    v_and_b32 v249, s86, v90
    v_lshlrev_b32 v250, 16, v91
    v_and_b32 v251, s86, v91
    v_pk_fma_f32 v[248:249], v[248:249], v[252:253], v[254:255]
    v_pk_fma_f32 v[250:251], v[250:251], v[252:253], v[254:255]
    v_mfma_f32_32x32x16_bf16 v[16:31], a[44:47], a[184:187], v[16:31]
    ds_read_b128 a[180:183], v222 offset:24576
    v_cvt_pk_bf16_f32 v90, v248, v249
    v_cvt_pk_bf16_f32 v91, v250, v251
    v_accvgpr_write_b32 a74, v90
    v_accvgpr_write_b32 a75, v91
    v_lshlrev_b32 v244, 16, v92
    v_and_b32 v245, s86, v92
    v_lshlrev_b32 v246, 16, v93
    v_and_b32 v247, s86, v93
    v_pk_fma_f32 v[244:245], v[244:245], v[252:253], v[254:255]
    v_pk_fma_f32 v[246:247], v[246:247], v[252:253], v[254:255]
    v_mfma_f32_32x32x16_bf16 v[32:47], a[44:47], a[188:191], v[32:47]
    ds_read_b128 a[184:187], v223 offset:16384
    s_add_u32 m0, s93, 4096
    s_nop 0
    buffer_load_dwordx4 v192, s[28:31], s7 offen nt lds
    v_cvt_pk_bf16_f32 v92, v244, v245
    v_cvt_pk_bf16_f32 v93, v246, v247
    v_accvgpr_write_b32 a76, v92
    v_accvgpr_write_b32 a77, v93
    v_lshlrev_b32 v248, 16, v94
    v_and_b32 v249, s86, v94
    v_lshlrev_b32 v250, 16, v95
    v_and_b32 v251, s86, v95
    v_pk_fma_f32 v[248:249], v[248:249], v[252:253], v[254:255]
    v_pk_fma_f32 v[250:251], v[250:251], v[252:253], v[254:255]
    s_waitcnt lgkmcnt(3)
    v_mfma_f32_32x32x16_bf16 v[16:31], a[48:51], a[160:163], v[16:31]
    ds_read_b128 a[188:191], v223 offset:24576
    v_cvt_pk_bf16_f32 v94, v248, v249
    v_cvt_pk_bf16_f32 v95, v250, v251
    v_accvgpr_write_b32 a78, v94
    v_accvgpr_write_b32 a79, v95
    v_lshlrev_b32_e64 v244, 16, v96
    v_and_b32 v245, s86, v96
    v_lshlrev_b32 v246, 16, v97
    v_and_b32 v247, s86, v97
    v_pk_fma_f32 v[244:245], v[244:245], v[252:253], v[254:255]
    v_pk_fma_f32 v[246:247], v[246:247], v[252:253], v[254:255]
    v_mfma_f32_32x32x16_bf16 v[32:47], a[48:51], a[164:167], v[32:47]
    s_waitcnt vmcnt(17)
    s_barrier
    ds_read_b128 a[160:163], v216 offset:32768
    s_add_u32 m0, s78, 98304
    s_add_u32 s32, s82, s73
    s_add_u32 s32, s32, 221184
    buffer_load_dwordx4 v2, s[16:19], s32 offen offset:0 lds
    v_cvt_pk_bf16_f32 v96, v244, v245
    v_cvt_pk_bf16_f32 v97, v246, v247
    v_accvgpr_write_b32 a80, v96
    v_accvgpr_write_b32 a81, v97
    v_lshlrev_b32 v248, 16, v98
    v_and_b32 v249, s86, v98
    v_lshlrev_b32 v250, 16, v99
    v_and_b32 v251, s86, v99
    v_pk_fma_f32 v[248:249], v[248:249], v[252:253], v[254:255]
    v_pk_fma_f32 v[250:251], v[250:251], v[252:253], v[254:255]
    v_mfma_f32_32x32x16_bf16 v[16:31], a[52:55], a[168:171], v[16:31]
    ds_read_b128 a[164:167], v216 offset:40960
    v_cvt_pk_bf16_f32 v98, v248, v249
    v_cvt_pk_bf16_f32 v99, v250, v251
    v_accvgpr_write_b32 a82, v98
    v_accvgpr_write_b32 a83, v99
    v_lshlrev_b32 v244, 16, v100
    v_and_b32 v245, s86, v100
    v_lshlrev_b32 v246, 16, v101
    v_and_b32 v247, s86, v101
    v_pk_fma_f32 v[244:245], v[244:245], v[252:253], v[254:255]
    v_pk_fma_f32 v[246:247], v[246:247], v[252:253], v[254:255]
    v_mfma_f32_32x32x16_bf16 v[32:47], a[52:55], a[172:175], v[32:47]
    ds_read_b128 a[168:171], v217 offset:32768
    buffer_load_dwordx4 v3, s[16:19], s32 offen offset:1024 lds
    v_cvt_pk_bf16_f32 v100, v244, v245
    v_cvt_pk_bf16_f32 v101, v246, v247
    v_accvgpr_write_b32 a84, v100
    v_accvgpr_write_b32 a85, v101
    v_lshlrev_b32_e64 v248, 16, v102
    v_and_b32 v249, s86, v102
    v_lshlrev_b32 v250, 16, v103
    v_and_b32 v251, s86, v103
    v_pk_fma_f32 v[248:249], v[248:249], v[252:253], v[254:255]
    v_pk_fma_f32 v[250:251], v[250:251], v[252:253], v[254:255]
    s_waitcnt lgkmcnt(3)
    v_mfma_f32_32x32x16_bf16 v[16:31], a[56:59], a[176:179], v[16:31]
    ds_read_b128 a[172:175], v217 offset:40960
    v_cvt_pk_bf16_f32 v102, v248, v249
    v_cvt_pk_bf16_f32 v103, v250, v251
    v_accvgpr_write_b32 a86, v102
    v_accvgpr_write_b32 a87, v103
    v_lshlrev_b32 v244, 16, v104
    v_and_b32 v245, s86, v104
    v_lshlrev_b32 v246, 16, v105
    v_and_b32 v247, s86, v105
    v_pk_fma_f32 v[244:245], v[244:245], v[252:253], v[254:255]
    v_pk_fma_f32 v[246:247], v[246:247], v[252:253], v[254:255]
    v_mfma_f32_32x32x16_bf16 v[32:47], a[56:59], a[180:183], v[32:47]
    ds_read_b128 a[176:179], v218 offset:32768
    buffer_load_dwordx4 v4, s[16:19], s32 offen offset:2048 lds
    v_cvt_pk_bf16_f32 v104, v244, v245
    v_cvt_pk_bf16_f32 v105, v246, v247
    v_accvgpr_write_b32 a88, v104
    v_accvgpr_write_b32 a89, v105
    v_lshlrev_b32 v248, 16, v106
    v_and_b32 v249, s86, v106
    v_lshlrev_b32 v250, 16, v107
    v_and_b32 v251, s86, v107
    v_pk_fma_f32 v[248:249], v[248:249], v[252:253], v[254:255]
    v_pk_fma_f32 v[250:251], v[250:251], v[252:253], v[254:255]
    v_mfma_f32_32x32x16_bf16 v[16:31], a[60:63], a[184:187], v[16:31]
    ds_read_b128 a[180:183], v218 offset:40960
    v_cvt_pk_bf16_f32 v106, v248, v249
    v_cvt_pk_bf16_f32 v107, v250, v251
    v_accvgpr_write_b32 a90, v106
    v_accvgpr_write_b32 a91, v107
    v_lshlrev_b32 v244, 16, v108
    v_and_b32 v245, s86, v108
    v_lshlrev_b32 v246, 16, v109
    v_and_b32 v247, s86, v109
    v_pk_fma_f32 v[244:245], v[244:245], v[252:253], v[254:255]
    v_pk_fma_f32 v[246:247], v[246:247], v[252:253], v[254:255]
    v_mfma_f32_32x32x16_bf16 v[32:47], a[60:63], a[188:191], v[32:47]
    ds_read_b128 a[184:187], v219 offset:32768
    buffer_load_dwordx4 v5, s[16:19], s32 offen offset:3072 lds
    v_cvt_pk_bf16_f32 v108, v244, v245
    v_cvt_pk_bf16_f32 v109, v246, v247
    v_accvgpr_write_b32 a92, v108
    v_accvgpr_write_b32 a93, v109
    v_lshlrev_b32_e64 v248, 16, v110
    v_and_b32 v249, s86, v110
    v_lshlrev_b32 v250, 16, v111
    v_and_b32 v251, s86, v111
    v_pk_fma_f32 v[248:249], v[248:249], v[252:253], v[254:255]
    v_pk_fma_f32 v[250:251], v[250:251], v[252:253], v[254:255]
    s_waitcnt lgkmcnt(3)
    v_mfma_f32_32x32x16_bf16 v[16:31], a[64:67], a[160:163], v[16:31]
    ds_read_b128 a[188:191], v219 offset:40960
    v_cvt_pk_bf16_f32 v110, v248, v249
    v_cvt_pk_bf16_f32 v111, v250, v251
    v_accvgpr_write_b32 a94, v110
    v_accvgpr_write_b32 a95, v111
    v_lshlrev_b32_e64 v244, 16, v112
    v_and_b32 v245, s86, v112
    v_lshlrev_b32 v246, 16, v113
    v_and_b32 v247, s86, v113
    v_pk_fma_f32 v[244:245], v[244:245], v[252:253], v[254:255]
    v_pk_fma_f32 v[246:247], v[246:247], v[252:253], v[254:255]
    v_mfma_f32_32x32x16_bf16 v[32:47], a[64:67], a[164:167], v[32:47]
    ds_read_b128 a[160:163], v220 offset:32768
    s_add_u32 m0, s78, 114688
    s_add_u32 s32, s82, s74
    buffer_load_dwordx4 v2, s[16:19], s32 offen offset:0 lds
    v_cvt_pk_bf16_f32 v112, v244, v245
    v_cvt_pk_bf16_f32 v113, v246, v247
    v_accvgpr_write_b32 a96, v112
    v_accvgpr_write_b32 a97, v113
    v_lshlrev_b32 v248, 16, v114
    v_and_b32 v249, s86, v114
    v_lshlrev_b32 v250, 16, v115
    v_and_b32 v251, s86, v115
    v_pk_fma_f32 v[248:249], v[248:249], v[252:253], v[254:255]
    v_pk_fma_f32 v[250:251], v[250:251], v[252:253], v[254:255]
    v_mfma_f32_32x32x16_bf16 v[16:31], a[68:71], a[168:171], v[16:31]
    ds_read_b128 a[164:167], v220 offset:40960
    v_cvt_pk_bf16_f32 v114, v248, v249
    v_cvt_pk_bf16_f32 v115, v250, v251
    v_accvgpr_write_b32 a98, v114
    v_accvgpr_write_b32 a99, v115
    v_lshlrev_b32 v244, 16, v116
    v_and_b32 v245, s86, v116
    v_lshlrev_b32 v246, 16, v117
    v_and_b32 v247, s86, v117
    v_pk_fma_f32 v[244:245], v[244:245], v[252:253], v[254:255]
    v_pk_fma_f32 v[246:247], v[246:247], v[252:253], v[254:255]
    v_mfma_f32_32x32x16_bf16 v[32:47], a[68:71], a[172:175], v[32:47]
    ds_read_b128 a[168:171], v221 offset:32768
    buffer_load_dwordx4 v3, s[16:19], s32 offen offset:1024 lds
    v_cvt_pk_bf16_f32 v116, v244, v245
    v_cvt_pk_bf16_f32 v117, v246, v247
    v_accvgpr_write_b32 a100, v116
    v_accvgpr_write_b32 a101, v117
    v_lshlrev_b32_e64 v248, 16, v118
    v_and_b32 v249, s86, v118
    v_lshlrev_b32 v250, 16, v119
    v_and_b32 v251, s86, v119
    v_pk_fma_f32 v[248:249], v[248:249], v[252:253], v[254:255]
    v_pk_fma_f32 v[250:251], v[250:251], v[252:253], v[254:255]
    s_waitcnt lgkmcnt(3)
    v_mfma_f32_32x32x16_bf16 v[16:31], a[72:75], a[176:179], v[16:31]
    ds_read_b128 a[172:175], v221 offset:40960
    v_cvt_pk_bf16_f32 v118, v248, v249
    v_cvt_pk_bf16_f32 v119, v250, v251
    v_accvgpr_write_b32 a102, v118
    v_accvgpr_write_b32 a103, v119
    v_lshlrev_b32 v244, 16, v120
    v_and_b32 v245, s86, v120
    v_lshlrev_b32 v246, 16, v121
    v_and_b32 v247, s86, v121
    v_pk_fma_f32 v[244:245], v[244:245], v[252:253], v[254:255]
    v_pk_fma_f32 v[246:247], v[246:247], v[252:253], v[254:255]
    v_mfma_f32_32x32x16_bf16 v[32:47], a[72:75], a[180:183], v[32:47]
    ds_read_b128 a[176:179], v222 offset:32768
    buffer_load_dwordx4 v4, s[16:19], s32 offen offset:2048 lds
    v_cvt_pk_bf16_f32 v120, v244, v245
    v_cvt_pk_bf16_f32 v121, v246, v247
    v_accvgpr_write_b32 a104, v120
    v_accvgpr_write_b32 a105, v121
    v_lshlrev_b32 v248, 16, v122
    v_and_b32 v249, s86, v122
    v_lshlrev_b32 v250, 16, v123
    v_and_b32 v251, s86, v123
    v_pk_fma_f32 v[248:249], v[248:249], v[252:253], v[254:255]
    v_pk_fma_f32 v[250:251], v[250:251], v[252:253], v[254:255]
    v_mfma_f32_32x32x16_bf16 v[16:31], a[76:79], a[184:187], v[16:31]
    ds_read_b128 a[180:183], v222 offset:40960
    v_cvt_pk_bf16_f32 v122, v248, v249
    v_cvt_pk_bf16_f32 v123, v250, v251
    v_accvgpr_write_b32 a106, v122
    v_accvgpr_write_b32 a107, v123
    v_lshlrev_b32 v244, 16, v124
    v_and_b32 v245, s86, v124
    v_lshlrev_b32 v246, 16, v125
    v_and_b32 v247, s86, v125
    v_pk_fma_f32 v[244:245], v[244:245], v[252:253], v[254:255]
    v_pk_fma_f32 v[246:247], v[246:247], v[252:253], v[254:255]
    v_mfma_f32_32x32x16_bf16 v[32:47], a[76:79], a[188:191], v[32:47]
    ds_read_b128 a[184:187], v223 offset:32768
    buffer_load_dwordx4 v5, s[16:19], s32 offen offset:3072 lds
    v_cvt_pk_bf16_f32 v124, v244, v245
    v_cvt_pk_bf16_f32 v125, v246, v247
    v_accvgpr_write_b32 a108, v124
    v_accvgpr_write_b32 a109, v125
    v_lshlrev_b32_e64 v248, 16, v126
    v_and_b32 v249, s86, v126
    v_lshlrev_b32 v250, 16, v127
    v_and_b32 v251, s86, v127
    v_pk_fma_f32 v[248:249], v[248:249], v[252:253], v[254:255]
    v_pk_fma_f32 v[250:251], v[250:251], v[252:253], v[254:255]
    s_waitcnt lgkmcnt(3)
    v_mfma_f32_32x32x16_bf16 v[16:31], a[80:83], a[160:163], v[16:31]
    ds_read_b128 a[188:191], v223 offset:40960
    v_cvt_pk_bf16_f32 v126, v248, v249
    v_cvt_pk_bf16_f32 v127, v250, v251
    v_accvgpr_write_b32 a110, v126
    v_accvgpr_write_b32 a111, v127
    v_lshlrev_b32 v244, 16, v128
    v_and_b32 v245, s86, v128
    v_lshlrev_b32 v246, 16, v129
    v_and_b32 v247, s86, v129
    v_pk_fma_f32 v[244:245], v[244:245], v[252:253], v[254:255]
    v_pk_fma_f32 v[246:247], v[246:247], v[252:253], v[254:255]
    v_mfma_f32_32x32x16_bf16 v[32:47], a[80:83], a[164:167], v[32:47]
    s_waitcnt vmcnt(21)
    s_barrier
    ds_read_b128 a[160:163], v216 offset:49152
    s_add_u32 m0, s78, 0
    s_add_u32 s32, s82, s74
    s_add_u32 s32, s32, 221184
    buffer_load_dwordx4 v2, s[16:19], s32 offen offset:0 lds
    v_cvt_pk_bf16_f32 v128, v244, v245
    v_cvt_pk_bf16_f32 v129, v246, v247
    v_accvgpr_write_b32 a112, v128
    v_accvgpr_write_b32 a113, v129
    v_lshlrev_b32 v248, 16, v130
    v_and_b32 v249, s86, v130
    v_lshlrev_b32 v250, 16, v131
    v_and_b32 v251, s86, v131
    v_pk_fma_f32 v[248:249], v[248:249], v[252:253], v[254:255]
    v_pk_fma_f32 v[250:251], v[250:251], v[252:253], v[254:255]
    v_mfma_f32_32x32x16_bf16 v[16:31], a[84:87], a[168:171], v[16:31]
    ds_read_b128 a[164:167], v216 offset:57344
    v_cvt_pk_bf16_f32 v130, v248, v249
    v_cvt_pk_bf16_f32 v131, v250, v251
    v_accvgpr_write_b32 a114, v130
    v_accvgpr_write_b32 a115, v131
    v_lshlrev_b32 v244, 16, v132
    v_and_b32 v245, s86, v132
    v_lshlrev_b32 v246, 16, v133
    v_and_b32 v247, s86, v133
    v_pk_fma_f32 v[244:245], v[244:245], v[252:253], v[254:255]
    v_pk_fma_f32 v[246:247], v[246:247], v[252:253], v[254:255]
    v_mfma_f32_32x32x16_bf16 v[32:47], a[84:87], a[172:175], v[32:47]
    ds_read_b128 a[168:171], v217 offset:49152
    buffer_load_dwordx4 v3, s[16:19], s32 offen offset:1024 lds
    v_cvt_pk_bf16_f32 v132, v244, v245
    v_cvt_pk_bf16_f32 v133, v246, v247
    v_accvgpr_write_b32 a116, v132
    v_accvgpr_write_b32 a117, v133
    v_lshlrev_b32_e64 v248, 16, v134
    v_and_b32 v249, s86, v134
    v_lshlrev_b32 v250, 16, v135
    v_and_b32 v251, s86, v135
    v_pk_fma_f32 v[248:249], v[248:249], v[252:253], v[254:255]
    v_pk_fma_f32 v[250:251], v[250:251], v[252:253], v[254:255]
    s_waitcnt lgkmcnt(3)
    v_mfma_f32_32x32x16_bf16 v[16:31], a[88:91], a[176:179], v[16:31]
    ds_read_b128 a[172:175], v217 offset:57344
    v_cvt_pk_bf16_f32 v134, v248, v249
    v_cvt_pk_bf16_f32 v135, v250, v251
    v_accvgpr_write_b32 a118, v134
    v_accvgpr_write_b32 a119, v135
    v_lshlrev_b32 v244, 16, v136
    v_and_b32 v245, s86, v136
    v_lshlrev_b32 v246, 16, v137
    v_and_b32 v247, s86, v137
    v_pk_fma_f32 v[244:245], v[244:245], v[252:253], v[254:255]
    v_pk_fma_f32 v[246:247], v[246:247], v[252:253], v[254:255]
    v_mfma_f32_32x32x16_bf16 v[32:47], a[88:91], a[180:183], v[32:47]
    ds_read_b128 a[176:179], v218 offset:49152
    buffer_load_dwordx4 v4, s[16:19], s32 offen offset:2048 lds
    v_cvt_pk_bf16_f32 v136, v244, v245
    v_cvt_pk_bf16_f32 v137, v246, v247
    v_accvgpr_write_b32 a120, v136
    v_accvgpr_write_b32 a121, v137
    v_lshlrev_b32 v248, 16, v138
    v_and_b32 v249, s86, v138
    v_lshlrev_b32 v250, 16, v139
    v_and_b32 v251, s86, v139
    v_pk_fma_f32 v[248:249], v[248:249], v[252:253], v[254:255]
    v_pk_fma_f32 v[250:251], v[250:251], v[252:253], v[254:255]
    v_mfma_f32_32x32x16_bf16 v[16:31], a[92:95], a[184:187], v[16:31]
    ds_read_b128 a[180:183], v218 offset:57344
    v_cvt_pk_bf16_f32 v138, v248, v249
    v_cvt_pk_bf16_f32 v139, v250, v251
    v_accvgpr_write_b32 a122, v138
    v_accvgpr_write_b32 a123, v139
    v_lshlrev_b32 v244, 16, v140
    v_and_b32 v245, s86, v140
    v_lshlrev_b32 v246, 16, v141
    v_and_b32 v247, s86, v141
    v_pk_fma_f32 v[244:245], v[244:245], v[252:253], v[254:255]
    v_pk_fma_f32 v[246:247], v[246:247], v[252:253], v[254:255]
    v_mfma_f32_32x32x16_bf16 v[32:47], a[92:95], a[188:191], v[32:47]
    ds_read_b128 a[184:187], v219 offset:49152
    buffer_load_dwordx4 v5, s[16:19], s32 offen offset:3072 lds
    v_cvt_pk_bf16_f32 v140, v244, v245
    v_cvt_pk_bf16_f32 v141, v246, v247
    v_accvgpr_write_b32 a124, v140
    v_accvgpr_write_b32 a125, v141
    v_lshlrev_b32_e64 v248, 16, v142
    v_and_b32 v249, s86, v142
    v_lshlrev_b32 v250, 16, v143
    v_and_b32 v251, s86, v143
    v_pk_fma_f32 v[248:249], v[248:249], v[252:253], v[254:255]
    v_pk_fma_f32 v[250:251], v[250:251], v[252:253], v[254:255]
    s_waitcnt lgkmcnt(3)
    v_mfma_f32_32x32x16_bf16 v[16:31], a[96:99], a[160:163], v[16:31]
    ds_read_b128 a[188:191], v219 offset:57344
    v_cvt_pk_bf16_f32 v142, v248, v249
    v_cvt_pk_bf16_f32 v143, v250, v251
    v_accvgpr_write_b32 a126, v142
    v_accvgpr_write_b32 a127, v143
    v_lshlrev_b32_e64 v244, 16, v144
    v_and_b32 v245, s86, v144
    v_lshlrev_b32 v246, 16, v145
    v_and_b32 v247, s86, v145
    v_pk_fma_f32 v[244:245], v[244:245], v[252:253], v[254:255]
    v_pk_fma_f32 v[246:247], v[246:247], v[252:253], v[254:255]
    v_mfma_f32_32x32x16_bf16 v[32:47], a[96:99], a[164:167], v[32:47]
    ds_read_b128 a[160:163], v220 offset:49152
    s_add_u32 m0, s78, 16384
    s_add_u32 s32, s82, s75
    buffer_load_dwordx4 v2, s[16:19], s32 offen offset:0 lds
    v_cvt_pk_bf16_f32 v144, v244, v245
    v_cvt_pk_bf16_f32 v145, v246, v247
    v_accvgpr_write_b32 a128, v144
    v_accvgpr_write_b32 a129, v145
    v_lshlrev_b32 v248, 16, v146
    v_and_b32 v249, s86, v146
    v_lshlrev_b32 v250, 16, v147
    v_and_b32 v251, s86, v147
    v_pk_fma_f32 v[248:249], v[248:249], v[252:253], v[254:255]
    v_pk_fma_f32 v[250:251], v[250:251], v[252:253], v[254:255]
    v_mfma_f32_32x32x16_bf16 v[16:31], a[100:103], a[168:171], v[16:31]
    ds_read_b128 a[164:167], v220 offset:57344
    v_cvt_pk_bf16_f32 v146, v248, v249
    v_cvt_pk_bf16_f32 v147, v250, v251
    v_accvgpr_write_b32 a130, v146
    v_accvgpr_write_b32 a131, v147
    v_lshlrev_b32 v244, 16, v148
    v_and_b32 v245, s86, v148
    v_lshlrev_b32 v246, 16, v149
    v_and_b32 v247, s86, v149
    v_pk_fma_f32 v[244:245], v[244:245], v[252:253], v[254:255]
    v_pk_fma_f32 v[246:247], v[246:247], v[252:253], v[254:255]
    v_mfma_f32_32x32x16_bf16 v[32:47], a[100:103], a[172:175], v[32:47]
    ds_read_b128 a[168:171], v221 offset:49152
    v_cvt_pk_bf16_f32 v148, v244, v245
    v_cvt_pk_bf16_f32 v149, v246, v247
    v_accvgpr_write_b32 a132, v148
    v_accvgpr_write_b32 a133, v149
    v_lshlrev_b32_e64 v248, 16, v150
    v_and_b32 v249, s86, v150
    v_lshlrev_b32 v250, 16, v151
    v_and_b32 v251, s86, v151
    v_pk_fma_f32 v[248:249], v[248:249], v[252:253], v[254:255]
    v_pk_fma_f32 v[250:251], v[250:251], v[252:253], v[254:255]
    s_waitcnt lgkmcnt(3)
    v_mfma_f32_32x32x16_bf16 v[16:31], a[104:107], a[176:179], v[16:31]
    ds_read_b128 a[172:175], v221 offset:57344
    v_cvt_pk_bf16_f32 v150, v248, v249
    v_cvt_pk_bf16_f32 v151, v250, v251
    v_accvgpr_write_b32 a134, v150
    v_accvgpr_write_b32 a135, v151
    v_lshlrev_b32 v244, 16, v152
    v_and_b32 v245, s86, v152
    v_lshlrev_b32 v246, 16, v153
    v_and_b32 v247, s86, v153
    v_pk_fma_f32 v[244:245], v[244:245], v[252:253], v[254:255]
    v_pk_fma_f32 v[246:247], v[246:247], v[252:253], v[254:255]
    v_mfma_f32_32x32x16_bf16 v[32:47], a[104:107], a[180:183], v[32:47]
    ds_read_b128 a[176:179], v222 offset:49152
    buffer_load_dwordx4 v3, s[16:19], s32 offen offset:1024 lds
    v_cvt_pk_bf16_f32 v152, v244, v245
    v_cvt_pk_bf16_f32 v153, v246, v247
    v_accvgpr_write_b32 a136, v152
    v_accvgpr_write_b32 a137, v153
    v_lshlrev_b32 v248, 16, v154
    v_and_b32 v249, s86, v154
    v_lshlrev_b32 v250, 16, v155
    v_and_b32 v251, s86, v155
    v_pk_fma_f32 v[248:249], v[248:249], v[252:253], v[254:255]
    v_pk_fma_f32 v[250:251], v[250:251], v[252:253], v[254:255]
    v_mfma_f32_32x32x16_bf16 v[16:31], a[108:111], a[184:187], v[16:31]
    ds_read_b128 a[180:183], v222 offset:57344
    v_cvt_pk_bf16_f32 v154, v248, v249
    v_cvt_pk_bf16_f32 v155, v250, v251
    v_accvgpr_write_b32 a138, v154
    v_accvgpr_write_b32 a139, v155
    v_lshlrev_b32 v244, 16, v156
    v_and_b32 v245, s86, v156
    v_lshlrev_b32 v246, 16, v157
    v_and_b32 v247, s86, v157
    v_pk_fma_f32 v[244:245], v[244:245], v[252:253], v[254:255]
    v_pk_fma_f32 v[246:247], v[246:247], v[252:253], v[254:255]
    v_mfma_f32_32x32x16_bf16 v[32:47], a[108:111], a[188:191], v[32:47]
    ds_read_b128 a[184:187], v223 offset:49152
    v_cvt_pk_bf16_f32 v156, v244, v245
    v_cvt_pk_bf16_f32 v157, v246, v247
    v_accvgpr_write_b32 a140, v156
    v_accvgpr_write_b32 a141, v157
    v_lshlrev_b32_e64 v248, 16, v158
    v_and_b32 v249, s86, v158
    v_lshlrev_b32 v250, 16, v159
    v_and_b32 v251, s86, v159
    v_pk_fma_f32 v[248:249], v[248:249], v[252:253], v[254:255]
    v_pk_fma_f32 v[250:251], v[250:251], v[252:253], v[254:255]
    s_waitcnt lgkmcnt(3)
    v_mfma_f32_32x32x16_bf16 v[16:31], a[112:115], a[160:163], v[16:31]
    ds_read_b128 a[188:191], v223 offset:57344
    v_cvt_pk_bf16_f32 v158, v248, v249
    v_cvt_pk_bf16_f32 v159, v250, v251
    v_accvgpr_write_b32 a142, v158
    v_accvgpr_write_b32 a143, v159
    v_lshlrev_b32 v244, 16, v160
    v_and_b32 v245, s86, v160
    v_lshlrev_b32 v246, 16, v161
    v_and_b32 v247, s86, v161
    v_pk_fma_f32 v[244:245], v[244:245], v[252:253], v[254:255]
    v_pk_fma_f32 v[246:247], v[246:247], v[252:253], v[254:255]
    v_mfma_f32_32x32x16_bf16 v[32:47], a[112:115], a[164:167], v[32:47]
    s_waitcnt vmcnt(23)
    s_barrier
    ds_read_b128 a[160:163], v224 offset:0
    buffer_load_dwordx4 v4, s[16:19], s32 offen offset:2048 lds
    v_cvt_pk_bf16_f32 v160, v244, v245
    v_cvt_pk_bf16_f32 v161, v246, v247
    v_accvgpr_write_b32 a144, v160
    v_accvgpr_write_b32 a145, v161
    v_lshlrev_b32 v248, 16, v162
    v_and_b32 v249, s86, v162
    v_lshlrev_b32 v250, 16, v163
    v_and_b32 v251, s86, v163
    v_pk_fma_f32 v[248:249], v[248:249], v[252:253], v[254:255]
    v_pk_fma_f32 v[250:251], v[250:251], v[252:253], v[254:255]
    v_mfma_f32_32x32x16_bf16 v[16:31], a[116:119], a[168:171], v[16:31]
    ds_read_b128 a[164:167], v224 offset:8192
    v_cvt_pk_bf16_f32 v162, v248, v249
    v_cvt_pk_bf16_f32 v163, v250, v251
    v_accvgpr_write_b32 a146, v162
    v_accvgpr_write_b32 a147, v163
    v_lshlrev_b32 v244, 16, v164
    v_and_b32 v245, s86, v164
    v_lshlrev_b32 v246, 16, v165
    v_and_b32 v247, s86, v165
    v_pk_fma_f32 v[244:245], v[244:245], v[252:253], v[254:255]
    v_pk_fma_f32 v[246:247], v[246:247], v[252:253], v[254:255]
    v_mfma_f32_32x32x16_bf16 v[32:47], a[116:119], a[172:175], v[32:47]
    ds_read_b128 a[168:171], v225 offset:0
    buffer_load_dwordx4 v5, s[16:19], s32 offen offset:3072 lds
    v_cvt_pk_bf16_f32 v164, v244, v245
    v_cvt_pk_bf16_f32 v165, v246, v247
    v_accvgpr_write_b32 a148, v164
    v_accvgpr_write_b32 a149, v165
    v_lshlrev_b32_e64 v248, 16, v166
    v_and_b32 v249, s86, v166
    v_lshlrev_b32 v250, 16, v167
    v_and_b32 v251, s86, v167
    v_pk_fma_f32 v[248:249], v[248:249], v[252:253], v[254:255]
    v_pk_fma_f32 v[250:251], v[250:251], v[252:253], v[254:255]
    s_waitcnt lgkmcnt(3)
    v_mfma_f32_32x32x16_bf16 v[16:31], a[120:123], a[176:179], v[16:31]
    ds_read_b128 a[172:175], v225 offset:8192
    v_cvt_pk_bf16_f32 v166, v248, v249
    v_cvt_pk_bf16_f32 v167, v250, v251
    v_accvgpr_write_b32 a150, v166
    v_accvgpr_write_b32 a151, v167
    v_lshlrev_b32_e64 v244, 16, v168
    v_and_b32 v245, s86, v168
    v_lshlrev_b32 v246, 16, v169
    v_and_b32 v247, s86, v169
    v_pk_fma_f32 v[244:245], v[244:245], v[252:253], v[254:255]
    v_pk_fma_f32 v[246:247], v[246:247], v[252:253], v[254:255]
    v_mfma_f32_32x32x16_bf16 v[32:47], a[120:123], a[180:183], v[32:47]
    ds_read_b128 a[176:179], v226 offset:0
    s_add_u32 m0, s78, 32768
    s_add_u32 s32, s82, s75
    s_add_u32 s32, s32, 221184
    buffer_load_dwordx4 v2, s[16:19], s32 offen offset:0 lds
    v_cvt_pk_bf16_f32 v168, v244, v245
    v_cvt_pk_bf16_f32 v169, v246, v247
    v_accvgpr_write_b32 a152, v168
    v_accvgpr_write_b32 a153, v169
    v_lshlrev_b32 v248, 16, v170
    v_and_b32 v249, s86, v170
    v_lshlrev_b32 v250, 16, v171
    v_and_b32 v251, s86, v171
    v_pk_fma_f32 v[248:249], v[248:249], v[252:253], v[254:255]
    v_pk_fma_f32 v[250:251], v[250:251], v[252:253], v[254:255]
    v_mfma_f32_32x32x16_bf16 v[16:31], a[124:127], a[184:187], v[16:31]
    ds_read_b128 a[180:183], v226 offset:8192
    v_cvt_pk_bf16_f32 v170, v248, v249
    v_cvt_pk_bf16_f32 v171, v250, v251
    v_accvgpr_write_b32 a154, v170
    v_accvgpr_write_b32 a155, v171
    v_lshlrev_b32 v244, 16, v172
    v_and_b32 v245, s86, v172
    v_lshlrev_b32 v246, 16, v173
    v_and_b32 v247, s86, v173
    v_pk_fma_f32 v[244:245], v[244:245], v[252:253], v[254:255]
    v_pk_fma_f32 v[246:247], v[246:247], v[252:253], v[254:255]
    v_mfma_f32_32x32x16_bf16 v[32:47], a[124:127], a[188:191], v[32:47]
    ds_read_b128 a[184:187], v227 offset:0
    v_cvt_pk_bf16_f32 v172, v244, v245
    v_cvt_pk_bf16_f32 v173, v246, v247
    v_accvgpr_write_b32 a156, v172
    v_accvgpr_write_b32 a157, v173
    v_lshlrev_b32_e64 v248, 16, v174
    v_and_b32 v249, s86, v174
    v_lshlrev_b32 v250, 16, v175
    v_and_b32 v251, s86, v175
    v_pk_fma_f32 v[248:249], v[248:249], v[252:253], v[254:255]
    v_pk_fma_f32 v[250:251], v[250:251], v[252:253], v[254:255]
    s_waitcnt lgkmcnt(3)
    v_mfma_f32_32x32x16_bf16 v[16:31], a[128:131], a[160:163], v[16:31]
    ds_read_b128 a[188:191], v227 offset:8192
    v_cvt_pk_bf16_f32 v174, v248, v249
    v_cvt_pk_bf16_f32 v175, v250, v251
    v_accvgpr_write_b32 a158, v174
    v_accvgpr_write_b32 a159, v175
    s_cmp_eq_u32 s3, 1
    s_cbranch_scc1 FORK_ALT_A
    v_mfma_f32_32x32x16_bf16 v[32:47], a[128:131], a[164:167], v[32:47]
    ds_read_b128 a[160:163], v228 offset:0
    buffer_load_dwordx4 v3, s[16:19], s32 offen offset:1024 lds
    v_lshrrev_b32 v188, 5, v1
    v_lshlrev_b32 v188, 4, v188
    v_bfe_u32 v189, v1, 2, 3
    v_mfma_f32_32x32x16_bf16 v[16:31], a[132:135], a[168:171], v[16:31]
    ds_read_b128 a[164:167], v228 offset:8192
    v_add_u32_e64 v188, v188, v189
    v_mul_u32_u24 v188, 160, v188
    v_and_b32_e64 v189, 3, v1
    v_lshl_add_u32 v188, v189, 3, v188
    v_add_u32_e64 v188, s93, v188
    v_mfma_f32_32x32x16_bf16 v[32:47], a[132:135], a[172:175], v[32:47]
    ds_read_b128 a[168:171], v229 offset:0
    s_waitcnt vmcnt(18)
    ds_read_b64_tr_b16 v[190:191], v188 offset:0
    ds_read_b64_tr_b16 v[192:193], v188 offset:1280
    s_waitcnt lgkmcnt(5)
    v_mfma_f32_32x32x16_bf16 v[16:31], a[136:139], a[176:179], v[16:31]
    ds_read_b128 a[172:175], v229 offset:8192
    ds_read_b64_tr_b16 v[194:195], v188 offset:32
    ds_read_b64_tr_b16 v[196:197], v188 offset:1312
    ds_read_b64_tr_b16 v[198:199], v188 offset:64
    ds_read_b64_tr_b16 v[200:201], v188 offset:1344
    v_mfma_f32_32x32x16_bf16 v[32:47], a[136:139], a[180:183], v[32:47]
    ds_read_b128 a[176:179], v230 offset:0
    buffer_load_dwordx4 v4, s[16:19], s32 offen offset:2048 lds
    ds_read_b64_tr_b16 v[202:203], v188 offset:96
    ds_read_b64_tr_b16 v[204:205], v188 offset:1376
    v_mfma_f32_32x32x16_bf16 v[16:31], a[140:143], a[184:187], v[16:31]
    ds_read_b128 a[180:183], v230 offset:8192
    ds_read_b64_tr_b16 v[206:207], v188 offset:128
    ds_read_b64_tr_b16 v[208:209], v188 offset:1408
    v_mfma_f32_32x32x16_bf16 v[32:47], a[140:143], a[188:191], v[32:47]
    ds_read_b128 a[184:187], v231 offset:0
    s_waitcnt lgkmcnt(11)
    v_mfma_f32_32x32x16_bf16 v[16:31], a[144:147], a[160:163], v[16:31]
    ds_read_b128 a[188:191], v231 offset:8192
    s_waitcnt lgkmcnt(2)
    v_mfma_f32_32x32x16_bf16 v[32:47], a[144:147], a[164:167], v[32:47]
    s_barrier
    ds_read_b64_tr_b16 a[160:161], v8 offset:16384
    ds_read_b64_tr_b16 a[162:163], v8 offset:16896
    buffer_load_dwordx4 v5, s[16:19], s32 offen offset:3072 lds
    v_mfma_f32_32x32x16_bf16 v[16:31], a[148:151], a[168:171], v[16:31]
    ds_read_b64_tr_b16 a[164:165], v8 offset:24576
    ds_read_b64_tr_b16 a[166:167], v8 offset:25088
    buffer_store_dwordx4 v[190:193], v236, s[20:23], s89 offen sc1
    s_add_u32 s89, s89, 1024
    v_mfma_f32_32x32x16_bf16 v[32:47], a[148:151], a[172:175], v[32:47]
    ds_read_b64_tr_b16 a[168:169], v9 offset:16384
    ds_read_b64_tr_b16 a[170:171], v9 offset:16896
    s_waitcnt lgkmcnt(6)
    v_mfma_f32_32x32x16_bf16 v[16:31], a[152:155], a[176:179], v[16:31]
    ds_read_b64_tr_b16 a[172:173], v9 offset:24576
    ds_read_b64_tr_b16 a[174:175], v9 offset:25088
    buffer_store_dwordx4 v[194:197], v236, s[20:23], s89 offen sc1
    s_add_u32 s89, s89, 1024
    v_mfma_f32_32x32x16_bf16 v[32:47], a[152:155], a[180:183], v[32:47]
    ds_read_b64_tr_b16 a[176:177], v8 offset:18432
    ds_read_b64_tr_b16 a[178:179], v8 offset:18944
    s_add_u32 m0, s78, 49152
    s_add_u32 s32, s82, s76
    buffer_load_dwordx4 v2, s[16:19], s32 offen offset:0 lds
    v_mfma_f32_32x32x16_bf16 v[16:31], a[156:159], a[184:187], v[16:31]
    ds_read_b64_tr_b16 a[180:181], v8 offset:26624
    ds_read_b64_tr_b16 a[182:183], v8 offset:27136
    buffer_store_dwordx4 v[198:201], v236, s[20:23], s89 offen sc1
    s_add_u32 s89, s89, 1024
    v_mfma_f32_32x32x16_bf16 v[32:47], a[156:159], a[188:191], v[32:47]
    ds_read_b64_tr_b16 a[184:185], v9 offset:18432
    ds_read_b64_tr_b16 a[186:187], v9 offset:18944
    s_waitcnt lgkmcnt(6)
    v_mfma_f32_32x32x16_bf16 v[48:63], a[160:163], a[0:3], 0
    ds_read_b64_tr_b16 a[188:189], v9 offset:26624
    ds_read_b64_tr_b16 a[190:191], v9 offset:27136
    buffer_store_dwordx4 v[202:205], v236, s[20:23], s89 offen sc1
    s_add_u32 s89, s89, 1024
    v_mfma_f32_32x32x16_bf16 v[64:79], a[164:167], a[0:3], 0
    ds_read_b64_tr_b16 a[160:161], v8 offset:20480
    ds_read_b64_tr_b16 a[162:163], v8 offset:20992
    buffer_load_dwordx4 v3, s[16:19], s32 offen offset:1024 lds
    v_mfma_f32_32x32x16_bf16 v[80:95], a[168:171], a[0:3], 0
    ds_read_b64_tr_b16 a[164:165], v8 offset:28672
    ds_read_b64_tr_b16 a[166:167], v8 offset:29184
    buffer_store_dwordx4 v[206:209], v236, s[20:23], s89 offen sc1
    v_mfma_f32_32x32x16_bf16 v[96:111], a[172:175], a[0:3], 0
    ds_read_b64_tr_b16 a[168:169], v9 offset:20480
    ds_read_b64_tr_b16 a[170:171], v9 offset:20992
    s_waitcnt lgkmcnt(6)
    v_mfma_f32_32x32x16_bf16 v[48:63], a[176:179], a[4:7], v[48:63]
    ds_read_b64_tr_b16 a[172:173], v9 offset:28672
    ds_read_b64_tr_b16 a[174:175], v9 offset:29184
    s_branch FORK_JOIN_A
FORK_ALT_A:
    v_mfma_f32_32x32x16_bf16 v[32:47], a[128:131], a[164:167], v[32:47]
    ds_read_b128 a[160:163], v228 offset:0
    buffer_load_dwordx4 v3, s[16:19], s32 offen offset:1024 lds
    v_and_b32_e64 v188, 15, v1
    v_lshlrev_b32 v188, 7, v188
    v_lshrrev_b32 v189, 5, v1
    v_mfma_f32_32x32x16_bf16 v[16:31], a[132:135], a[168:171], v[16:31]
    ds_read_b128 a[164:167], v228 offset:8192
    v_xor_b32 v189, v189, v1
    v_and_b32 v189, 7, v189
    v_lshl_add_u32 v188, v189, 4, v188
    v_bfe_u32 v189, v1, 4, 1
    v_lshl_add_u32 v188, v189, 3, v188
    v_mfma_f32_32x32x16_bf16 v[32:47], a[132:135], a[172:175], v[32:47]
    ds_read_b128 a[168:171], v229 offset:0
    v_add_u32 v188, s93, v188
    s_waitcnt vmcnt(18)
    ds_read_b64 v[148:149], v188 offset:0
    ds_read_b64 v[150:151], v188 offset:2048
    s_waitcnt lgkmcnt(5)
    v_mfma_f32_32x32x16_bf16 v[16:31], a[136:139], a[176:179], v[16:31]
    ds_read_b128 a[172:175], v229 offset:8192
    v_xor_b32 v189, 32, v188
    ds_read_b64 v[152:153], v189 offset:0
    ds_read_b64 v[154:155], v189 offset:2048
    v_xor_b32_e64 v189, 64, v188
    ds_read_b64 v[156:157], v189 offset:0
    ds_read_b64 v[158:159], v189 offset:2048
    v_mfma_f32_32x32x16_bf16 v[32:47], a[136:139], a[180:183], v[32:47]
    ds_read_b128 a[176:179], v230 offset:0
    buffer_load_dwordx4 v4, s[16:19], s32 offen offset:2048 lds
    v_xor_b32 v189, 96, v188
    ds_read_b64 v[160:161], v189 offset:0
    ds_read_b64 v[162:163], v189 offset:2048
    v_mfma_f32_32x32x16_bf16 v[16:31], a[140:143], a[184:187], v[16:31]
    ds_read_b128 a[180:183], v230 offset:8192
    ds_read_b64 v[164:165], v188 offset:0
    ds_read_b64 v[166:167], v188 offset:2048
    s_mov_b32 s34, 0x05040100
    s_mov_b32 s35, 0x07060302
    v_mfma_f32_32x32x16_bf16 v[32:47], a[140:143], a[188:191], v[32:47]
    ds_read_b128 a[184:187], v231 offset:0
    s_waitcnt lgkmcnt(11)
    v_mfma_f32_32x32x16_bf16 v[16:31], a[144:147], a[160:163], v[16:31]
    ds_read_b128 a[188:191], v231 offset:8192
    s_waitcnt lgkmcnt(2)
    v_perm_b32 v190, v150, v148, s34
    v_perm_b32 v191, v150, v148, s35
    v_perm_b32 v192, v151, v149, s34
    v_perm_b32 v193, v151, v149, s35
    v_mfma_f32_32x32x16_bf16 v[32:47], a[144:147], a[164:167], v[32:47]
    s_barrier
    s_nop 0
    ds_read_b64_tr_b16 a[160:161], v8 offset:16384
    ds_read_b64_tr_b16 a[162:163], v8 offset:16896
    buffer_load_dwordx4 v5, s[16:19], s32 offen offset:3072 lds
    v_mfma_f32_32x32x16_bf16 v[16:31], a[148:151], a[168:171], v[16:31]
    ds_read_b64_tr_b16 a[164:165], v8 offset:24576
    ds_read_b64_tr_b16 a[166:167], v8 offset:25088
    buffer_store_dwordx4 v[190:193], v236, s[20:23], s89 offen sc1
    s_add_u32 s89, s89, 5120
    v_perm_b32 v194, v154, v152, s34
    v_mfma_f32_32x32x16_bf16 v[32:47], a[148:151], a[172:175], v[32:47]
    ds_read_b64_tr_b16 a[168:169], v9 offset:16384
    ds_read_b64_tr_b16 a[170:171], v9 offset:16896
    v_perm_b32 v195, v154, v152, s35
    v_perm_b32 v196, v155, v153, s34
    v_perm_b32 v197, v155, v153, s35
    s_waitcnt lgkmcnt(6)
    v_mfma_f32_32x32x16_bf16 v[16:31], a[152:155], a[176:179], v[16:31]
    ds_read_b64_tr_b16 a[172:173], v9 offset:24576
    ds_read_b64_tr_b16 a[174:175], v9 offset:25088
    buffer_store_dwordx4 v[194:197], v236, s[20:23], s89 offen sc1
    s_add_u32 s89, s89, 5120
    v_perm_b32 v198, v158, v156, s34
    v_mfma_f32_32x32x16_bf16 v[32:47], a[152:155], a[180:183], v[32:47]
    ds_read_b64_tr_b16 a[176:177], v8 offset:18432
    ds_read_b64_tr_b16 a[178:179], v8 offset:18944
    s_add_u32 m0, s78, 49152
    s_add_u32 s32, s82, s76
    buffer_load_dwordx4 v2, s[16:19], s32 offen offset:0 lds
    v_mfma_f32_32x32x16_bf16 v[16:31], a[156:159], a[184:187], v[16:31]
    ds_read_b64_tr_b16 a[180:181], v8 offset:26624
    ds_read_b64_tr_b16 a[182:183], v8 offset:27136
    v_perm_b32 v199, v158, v156, s35
    v_perm_b32 v200, v159, v157, s34
    v_perm_b32 v201, v159, v157, s35
    buffer_store_dwordx4 v[198:201], v236, s[20:23], s89 offen sc1
    v_mfma_f32_32x32x16_bf16 v[32:47], a[156:159], a[188:191], v[32:47]
    ds_read_b64_tr_b16 a[184:185], v9 offset:18432
    ds_read_b64_tr_b16 a[186:187], v9 offset:18944
    s_add_u32 s89, s89, 5120
    v_perm_b32 v202, v162, v160, s34
    v_perm_b32 v203, v162, v160, s35
    s_waitcnt lgkmcnt(6)
    s_nop 0
    v_mfma_f32_32x32x16_bf16 v[48:63], a[160:163], a[0:3], 0
    ds_read_b64_tr_b16 a[188:189], v9 offset:26624
    ds_read_b64_tr_b16 a[190:191], v9 offset:27136
    v_perm_b32 v204, v163, v161, s34
    v_perm_b32 v205, v163, v161, s35
    buffer_store_dwordx4 v[202:205], v236, s[20:23], s89 offen sc1
    v_mfma_f32_32x32x16_bf16 v[64:79], a[164:167], a[0:3], 0
    ds_read_b64_tr_b16 a[160:161], v8 offset:20480
    ds_read_b64_tr_b16 a[162:163], v8 offset:20992
    buffer_load_dwordx4 v3, s[16:19], s32 offen offset:1024 lds
    s_add_u32 s89, s89, 1073741824
    v_mfma_f32_32x32x16_bf16 v[80:95], a[168:171], a[0:3], 0
    ds_read_b64_tr_b16 a[164:165], v8 offset:28672
    ds_read_b64_tr_b16 a[166:167], v8 offset:29184
    buffer_store_dwordx4 v[206:209], v236, s[20:23], s89 offen sc1
    v_mfma_f32_32x32x16_bf16 v[96:111], a[172:175], a[0:3], 0
    ds_read_b64_tr_b16 a[168:169], v9 offset:20480
    ds_read_b64_tr_b16 a[170:171], v9 offset:20992
    s_waitcnt lgkmcnt(6)
    v_mfma_f32_32x32x16_bf16 v[48:63], a[176:179], a[4:7], v[48:63]
    ds_read_b64_tr_b16 a[172:173], v9 offset:28672
    ds_read_b64_tr_b16 a[174:175], v9 offset:29184
FORK_JOIN_A:
    ds_write2_b32 v0, v252, v254 offset1:1
    v_add_u32 v0, 0x1000, v236
    v_mov_b32_e64 v248, 0
    v_min_u32 v249, 6, v12
    v_sub_u32 v249, v249, v12
    v_lshl_add_u32 v249, v249, 3, v15
    ds_write2_b32 v249, v248, v248 offset1:1
    v_mfma_f32_32x32x16_bf16 v[64:79], a[180:183], a[4:7], v[64:79]
    ds_read_b64_tr_b16 a[176:177], v8 offset:22528
    ds_read_b64_tr_b16 a[178:179], v8 offset:23040
    buffer_load_dwordx4 v4, s[16:19], s32 offen offset:2048 lds
    v_fma_f32 v244, -v177, v32, v17
    v_fma_f32 v245, v177, v16, v33
    v_mfma_f32_32x32x16_bf16 v[80:95], a[184:187], a[4:7], v[80:95]
    ds_read_b64_tr_b16 a[180:181], v8 offset:30720
    ds_read_b64_tr_b16 a[182:183], v8 offset:31232
    v_fma_f32 v244, v176, v16, v244
    v_fma_f32 v245, v176, v32, v245
    v_fma_f32 v246, -v177, v245, v18
    v_fma_f32 v247, v177, v244, v34
    v_mfma_f32_32x32x16_bf16 v[96:111], a[188:191], a[4:7], v[96:111]
    ds_read_b64_tr_b16 a[184:185], v9 offset:22528
    ds_read_b64_tr_b16 a[186:187], v9 offset:23040
    v_fma_f32 v246, v176, v244, v246
    v_fmac_f32 v247, v176, v245
    v_fma_f32 v244, -v177, v247, v19
    s_waitcnt lgkmcnt(8)
    v_mfma_f32_32x32x16_bf16 v[48:63], a[160:163], a[8:11], v[48:63]
    ds_read_b64_tr_b16 a[188:189], v9 offset:30720
    ds_read_b64_tr_b16 a[190:191], v9 offset:31232
    v_fma_f32 v245, v177, v246, v35
    v_fma_f32 v244, v176, v246, v244
    v_fma_f32 v245, v176, v247, v245
    v_fma_f32 v246, -v177, v245, v20
    v_mfma_f32_32x32x16_bf16 v[64:79], a[164:167], a[8:11], v[64:79]
    s_waitcnt vmcnt(24)
    s_barrier
    ds_read_b64_tr_b16 a[160:161], v8 offset:32768
    ds_read_b64_tr_b16 a[162:163], v8 offset:33280
    buffer_load_dwordx4 v5, s[16:19], s32 offen offset:3072 lds
    v_mfma_f32_32x32x16_bf16 v[80:95], a[168:171], a[8:11], v[80:95]
    ds_read_b64_tr_b16 a[164:165], v8 offset:40960
    ds_read_b64_tr_b16 a[166:167], v8 offset:41472
    v_fma_f32 v247, v177, v244, v36
    v_fma_f32 v246, v176, v244, v246
    v_fma_f32 v247, v176, v245, v247
    v_fma_f32 v244, -v177, v247, v21
    v_mfma_f32_32x32x16_bf16 v[96:111], a[172:175], a[8:11], v[96:111]
    ds_read_b64_tr_b16 a[168:169], v9 offset:32768
    ds_read_b64_tr_b16 a[170:171], v9 offset:33280
    v_fma_f32 v245, v177, v246, v37
    v_fma_f32 v244, v176, v246, v244
    v_fmac_f32 v245, v176, v247
    s_waitcnt lgkmcnt(6)
    v_mfma_f32_32x32x16_bf16 v[48:63], a[176:179], a[12:15], v[48:63]
    ds_read_b64_tr_b16 a[172:173], v9 offset:40960
    ds_read_b64_tr_b16 a[174:175], v9 offset:41472
    v_fma_f32 v246, -v177, v245, v22
    v_fma_f32 v247, v177, v244, v38
    v_fma_f32 v246, v176, v244, v246
    v_fmac_f32 v247, v176, v245
    v_mfma_f32_32x32x16_bf16 v[64:79], a[180:183], a[12:15], v[64:79]
    ds_read_b64_tr_b16 a[176:177], v8 offset:34816
    ds_read_b64_tr_b16 a[178:179], v8 offset:35328
    s_add_u32 m0, s78, 65536
    s_add_u32 s32, s82, s76
    s_add_u32 s32, s32, 221184
    buffer_load_dwordx4 v2, s[16:19], s32 offen offset:0 lds
    v_mfma_f32_32x32x16_bf16 v[80:95], a[184:187], a[12:15], v[80:95]
    ds_read_b64_tr_b16 a[180:181], v8 offset:43008
    ds_read_b64_tr_b16 a[182:183], v8 offset:43520
    v_fma_f32 v244, -v177, v247, v23
    v_fma_f32 v245, v177, v246, v39
    v_fma_f32 v244, v176, v246, v244
    v_fma_f32 v245, v176, v247, v245
    v_mfma_f32_32x32x16_bf16 v[96:111], a[188:191], a[12:15], v[96:111]
    ds_read_b64_tr_b16 a[184:185], v9 offset:34816
    ds_read_b64_tr_b16 a[186:187], v9 offset:35328
    v_fma_f32 v246, -v177, v245, v24
    v_fma_f32 v247, v177, v244, v40
    v_fmac_f32 v246, v176, v244
    s_waitcnt lgkmcnt(6)
    v_mfma_f32_32x32x16_bf16 v[48:63], a[160:163], a[16:19], v[48:63]
    ds_read_b64_tr_b16 a[188:189], v9 offset:43008
    ds_read_b64_tr_b16 a[190:191], v9 offset:43520
    v_fma_f32 v247, v176, v245, v247
    v_fma_f32 v244, -v177, v247, v25
    v_fma_f32 v245, v177, v246, v41
    v_fma_f32 v244, v176, v246, v244
    v_mfma_f32_32x32x16_bf16 v[64:79], a[164:167], a[16:19], v[64:79]
    ds_read_b64_tr_b16 a[160:161], v8 offset:36864
    ds_read_b64_tr_b16 a[162:163], v8 offset:37376
    buffer_load_dwordx4 v3, s[16:19], s32 offen offset:1024 lds
    v_fma_f32 v245, v176, v247, v245
    v_fma_f32 v246, -v177, v245, v26
    v_mfma_f32_32x32x16_bf16 v[80:95], a[168:171], a[16:19], v[80:95]
    ds_read_b64_tr_b16 a[164:165], v8 offset:45056
    ds_read_b64_tr_b16 a[166:167], v8 offset:45568
    v_fma_f32 v247, v177, v244, v42
    v_fma_f32 v246, v176, v244, v246
    v_fma_f32 v247, v176, v245, v247
    v_fma_f32 v244, -v177, v247, v27
    v_mfma_f32_32x32x16_bf16 v[96:111], a[172:175], a[16:19], v[96:111]
    ds_read_b64_tr_b16 a[168:169], v9 offset:36864
    ds_read_b64_tr_b16 a[170:171], v9 offset:37376
    v_fma_f32 v245, v177, v246, v43
    v_fma_f32 v244, v176, v246, v244
    v_fmac_f32 v245, v176, v247
    s_waitcnt lgkmcnt(6)
    v_mfma_f32_32x32x16_bf16 v[48:63], a[176:179], a[20:23], v[48:63]
    ds_read_b64_tr_b16 a[172:173], v9 offset:45056
    ds_read_b64_tr_b16 a[174:175], v9 offset:45568
    v_fma_f32 v246, -v177, v245, v28
    v_fma_f32 v247, v177, v244, v44
    v_fma_f32 v246, v176, v244, v246
    v_fma_f32 v247, v176, v245, v247
    v_mfma_f32_32x32x16_bf16 v[64:79], a[180:183], a[20:23], v[64:79]
    ds_read_b64_tr_b16 a[176:177], v8 offset:38912
    ds_read_b64_tr_b16 a[178:179], v8 offset:39424
    buffer_load_dwordx4 v4, s[16:19], s32 offen offset:2048 lds
    v_fma_f32 v244, -v177, v247, v29
    v_fma_f32 v245, v177, v246, v45
    v_mfma_f32_32x32x16_bf16 v[80:95], a[184:187], a[20:23], v[80:95]
    ds_read_b64_tr_b16 a[180:181], v8 offset:47104
    ds_read_b64_tr_b16 a[182:183], v8 offset:47616
    v_fma_f32 v244, v176, v246, v244
    v_fma_f32 v245, v176, v247, v245
    v_fma_f32 v246, -v177, v245, v30
    v_fma_f32 v247, v177, v244, v46
    v_mfma_f32_32x32x16_bf16 v[96:111], a[188:191], a[20:23], v[96:111]
    ds_read_b64_tr_b16 a[184:185], v9 offset:38912
    ds_read_b64_tr_b16 a[186:187], v9 offset:39424
    v_fma_f32 v246, v176, v244, v246
    v_fmac_f32 v247, v176, v245
    v_fma_f32 v244, -v177, v247, v31
    s_waitcnt lgkmcnt(6)
    v_mfma_f32_32x32x16_bf16 v[48:63], a[160:163], a[24:27], v[48:63]
    ds_read_b64_tr_b16 a[188:189], v9 offset:47104
    ds_read_b64_tr_b16 a[190:191], v9 offset:47616
    v_fma_f32 v245, v177, v246, v47
    v_fma_f32 v244, v176, v246, v244
    v_fma_f32 v245, v176, v247, v245
    ds_write2_b32 v15, v244, v245 offset0:14 offset1:15
    v_mfma_f32_32x32x16_bf16 v[64:79], a[164:167], a[24:27], v[64:79]
    s_waitcnt vmcnt(24)
    s_barrier
    ds_read_b64_tr_b16 a[160:161], v8 offset:49152
    ds_read_b64_tr_b16 a[162:163], v8 offset:49664
    buffer_load_dwordx4 v5, s[16:19], s32 offen offset:3072 lds
    v_mfma_f32_32x32x16_bf16 v[80:95], a[168:171], a[24:27], v[80:95]
    ds_read_b64_tr_b16 a[164:165], v8 offset:57344
    ds_read_b64_tr_b16 a[166:167], v8 offset:57856
    v_mfma_f32_32x32x16_bf16 v[96:111], a[172:175], a[24:27], v[96:111]
    ds_read_b64_tr_b16 a[168:169], v9 offset:49152
    ds_read_b64_tr_b16 a[170:171], v9 offset:49664
    s_waitcnt lgkmcnt(7)
    s_nop 0
    v_mfma_f32_32x32x16_bf16 v[48:63], a[176:179], a[28:31], v[48:63]
    ds_read_b64_tr_b16 a[172:173], v9 offset:57344
    ds_read_b64_tr_b16 a[174:175], v9 offset:57856
    v_mfma_f32_32x32x16_bf16 v[64:79], a[180:183], a[28:31], v[64:79]
    ds_read_b64_tr_b16 a[176:177], v8 offset:51200
    ds_read_b64_tr_b16 a[178:179], v8 offset:51712
    s_add_u32 m0, s78, 81920
    s_add_u32 s32, s82, s77
    buffer_load_dwordx4 v2, s[16:19], s32 offen offset:0 lds
    v_mfma_f32_32x32x16_bf16 v[80:95], a[184:187], a[28:31], v[80:95]
    ds_read_b64_tr_b16 a[180:181], v8 offset:59392
    ds_read_b64_tr_b16 a[182:183], v8 offset:59904
    v_mfma_f32_32x32x16_bf16 v[96:111], a[188:191], a[28:31], v[96:111]
    ds_read_b64_tr_b16 a[184:185], v9 offset:51200
    ds_read_b64_tr_b16 a[186:187], v9 offset:51712
    s_waitcnt lgkmcnt(6)
    v_mfma_f32_32x32x16_bf16 v[48:63], a[160:163], a[32:35], v[48:63]
    ds_read_b64_tr_b16 a[188:189], v9 offset:59392
    ds_read_b64_tr_b16 a[190:191], v9 offset:59904
    v_mfma_f32_32x32x16_bf16 v[64:79], a[164:167], a[32:35], v[64:79]
    ds_read_b64_tr_b16 a[160:161], v8 offset:53248
    ds_read_b64_tr_b16 a[162:163], v8 offset:53760
    buffer_load_dwordx4 v3, s[16:19], s32 offen offset:1024 lds
    v_mfma_f32_32x32x16_bf16 v[80:95], a[168:171], a[32:35], v[80:95]
    ds_read_b64_tr_b16 a[164:165], v8 offset:61440
    ds_read_b64_tr_b16 a[166:167], v8 offset:61952
    v_mfma_f32_32x32x16_bf16 v[96:111], a[172:175], a[32:35], v[96:111]
    ds_read_b64_tr_b16 a[168:169], v9 offset:53248
    ds_read_b64_tr_b16 a[170:171], v9 offset:53760
    s_waitcnt lgkmcnt(6)
    v_mfma_f32_32x32x16_bf16 v[48:63], a[176:179], a[36:39], v[48:63]
    ds_read_b64_tr_b16 a[172:173], v9 offset:61440
    ds_read_b64_tr_b16 a[174:175], v9 offset:61952
    v_mfma_f32_32x32x16_bf16 v[64:79], a[180:183], a[36:39], v[64:79]
    ds_read_b64_tr_b16 a[176:177], v8 offset:55296
    ds_read_b64_tr_b16 a[178:179], v8 offset:55808
    buffer_load_dwordx4 v4, s[16:19], s32 offen offset:2048 lds
    v_mfma_f32_32x32x16_bf16 v[80:95], a[184:187], a[36:39], v[80:95]
    ds_read_b64_tr_b16 a[180:181], v8 offset:63488
    ds_read_b64_tr_b16 a[182:183], v8 offset:64000
    v_mfma_f32_32x32x16_bf16 v[96:111], a[188:191], a[36:39], v[96:111]
    ds_read_b64_tr_b16 a[184:185], v9 offset:55296
    ds_read_b64_tr_b16 a[186:187], v9 offset:55808
    s_waitcnt lgkmcnt(6)
    v_mfma_f32_32x32x16_bf16 v[48:63], a[160:163], a[40:43], v[48:63]
    ds_read_b64_tr_b16 a[188:189], v9 offset:63488
    ds_read_b64_tr_b16 a[190:191], v9 offset:64000
    v_mfma_f32_32x32x16_bf16 v[64:79], a[164:167], a[40:43], v[64:79]
    s_waitcnt vmcnt(24)
    s_barrier
    ds_read_b64_tr_b16 a[160:161], v6 offset:0
    ds_read_b64_tr_b16 a[162:163], v6 offset:512
    buffer_load_dwordx4 v5, s[16:19], s32 offen offset:3072 lds
    v_mfma_f32_32x32x16_bf16 v[80:95], a[168:171], a[40:43], v[80:95]
    ds_read_b64_tr_b16 a[164:165], v6 offset:8192
    ds_read_b64_tr_b16 a[166:167], v6 offset:8704
    ds_read2_b64 v[188:191], v15 offset0:0 offset1:1
    ds_read2_b64 v[192:195], v15 offset0:2 offset1:3
    ds_read2_b64 v[196:199], v15 offset0:4 offset1:5
    ds_read_b64 v[200:201], v15 offset:48
    v_mfma_f32_32x32x16_bf16 v[96:111], a[172:175], a[40:43], v[96:111]
    ds_read_b64_tr_b16 a[168:169], v7 offset:0
    ds_read_b64_tr_b16 a[170:171], v7 offset:512
    v_mov_b32 v249, s85
    v_mov_b32 v251, s85
    s_add_u32 s34, s80, 0
    s_waitcnt lgkmcnt(10)
    v_mfma_f32_32x32x16_bf16 v[48:63], a[176:179], a[44:47], v[48:63]
    ds_read_b64_tr_b16 a[172:173], v7 offset:8192
    ds_read_b64_tr_b16 a[174:175], v7 offset:8704
    s_mul_i32 s34, s34, 8704
    s_add_u32 s34, s34, 16842752
    v_mfma_f32_32x32x16_bf16 v[64:79], a[180:183], a[44:47], v[64:79]
    ds_read_b64_tr_b16 a[176:177], v6 offset:2048
    ds_read_b64_tr_b16 a[178:179], v6 offset:2560
    s_add_u32 m0, s78, 98304
    s_add_u32 s32, s82, s77
    s_add_u32 s32, s32, 221184
    buffer_load_dwordx4 v2, s[16:19], s32 offen offset:0 lds
    v_mfma_f32_32x32x16_bf16 v[80:95], a[184:187], a[44:47], v[80:95]
    ds_read_b64_tr_b16 a[180:181], v6 offset:10240
    ds_read_b64_tr_b16 a[182:183], v6 offset:10752
    v_mfma_f32_32x32x16_bf16 v[96:111], a[188:191], a[44:47], v[96:111]
    ds_read_b64_tr_b16 a[184:185], v7 offset:2048
    ds_read_b64_tr_b16 a[186:187], v7 offset:2560
    s_waitcnt lgkmcnt(6)
    v_mfma_f32_32x32x16_bf16 v[48:63], a[160:163], a[48:51], v[48:63]
    ds_read_b64_tr_b16 a[188:189], v7 offset:10240
    ds_read_b64_tr_b16 a[190:191], v7 offset:10752
    v_fma_f32 v190, -v181, v189, v190
    v_fma_f32 v191, v181, v188, v191
    v_fma_f32 v190, v180, v188, v190
    v_fma_f32 v191, v180, v189, v191
    v_mfma_f32_32x32x16_bf16 v[64:79], a[164:167], a[48:51], v[64:79]
    ds_read_b64_tr_b16 a[160:161], v6 offset:4096
    ds_read_b64_tr_b16 a[162:163], v6 offset:4608
    buffer_load_dwordx4 v3, s[16:19], s32 offen offset:1024 lds
    v_fma_f32 v192, -v181, v191, v192
    v_fma_f32 v193, v181, v190, v193
    v_mfma_f32_32x32x16_bf16 v[80:95], a[168:171], a[48:51], v[80:95]
    ds_read_b64_tr_b16 a[164:165], v6 offset:12288
    ds_read_b64_tr_b16 a[166:167], v6 offset:12800
    v_fma_f32 v192, v180, v190, v192
    v_fma_f32 v193, v180, v191, v193
    v_fma_f32 v194, -v181, v193, v194
    v_fma_f32 v195, v181, v192, v195
    v_mfma_f32_32x32x16_bf16 v[96:111], a[172:175], a[48:51], v[96:111]
    ds_read_b64_tr_b16 a[168:169], v7 offset:4096
    ds_read_b64_tr_b16 a[170:171], v7 offset:4608
    v_fma_f32 v194, v180, v192, v194
    v_fmac_f32 v195, v180, v193
    v_fma_f32 v196, -v181, v195, v196
    s_waitcnt lgkmcnt(6)
    v_mfma_f32_32x32x16_bf16 v[48:63], a[176:179], a[52:55], v[48:63]
    ds_read_b64_tr_b16 a[172:173], v7 offset:12288
    ds_read_b64_tr_b16 a[174:175], v7 offset:12800
    v_fma_f32 v197, v181, v194, v197
    v_fma_f32 v196, v180, v194, v196
    v_fma_f32 v197, v180, v195, v197
    v_fma_f32 v198, -v181, v197, v198
    v_mfma_f32_32x32x16_bf16 v[64:79], a[180:183], a[52:55], v[64:79]
    ds_read_b64_tr_b16 a[176:177], v6 offset:6144
    ds_read_b64_tr_b16 a[178:179], v6 offset:6656
    buffer_load_dwordx4 v4, s[16:19], s32 offen offset:2048 lds
    v_fma_f32 v199, v181, v196, v199
    v_fma_f32 v198, v180, v196, v198
    v_mfma_f32_32x32x16_bf16 v[80:95], a[184:187], a[52:55], v[80:95]
    ds_read_b64_tr_b16 a[180:181], v6 offset:14336
    ds_read_b64_tr_b16 a[182:183], v6 offset:14848
    v_fma_f32 v199, v180, v197, v199
    v_fma_f32 v200, -v181, v199, v200
    v_fma_f32 v201, v181, v198, v201
    v_fma_f32 v237, v180, v198, v200
    v_mfma_f32_32x32x16_bf16 v[96:111], a[188:191], a[52:55], v[96:111]
    ds_read_b64_tr_b16 a[184:185], v7 offset:6144
    ds_read_b64_tr_b16 a[186:187], v7 offset:6656
    v_fma_f32 v238, v180, v199, v201
    v_fma_f32 v248, -v181, v238, v244
    v_fma_f32 v250, v181, v237, v245
    s_waitcnt lgkmcnt(6)
    v_mfma_f32_32x32x16_bf16 v[48:63], a[160:163], a[56:59], v[48:63]
    ds_read_b64_tr_b16 a[188:189], v7 offset:14336
    ds_read_b64_tr_b16 a[190:191], v7 offset:14848
    v_fmac_f32 v248, v180, v237
    v_fma_f32 v250, v180, v238, v250
    buffer_store_dwordx4 v[248:251], v13, s[20:23], s34 offen sc1
    v_mfma_f32_32x32x16_bf16 v[64:79], a[164:167], a[56:59], v[64:79]
    s_waitcnt vmcnt(25)
    s_barrier
    ds_read_b64_tr_b16 a[160:161], v6 offset:16384
    ds_read_b64_tr_b16 a[162:163], v6 offset:16896
    buffer_load_dwordx4 v5, s[16:19], s32 offen offset:3072 lds
    v_mfma_f32_32x32x16_bf16 v[80:95], a[168:171], a[56:59], v[80:95]
    ds_read_b64_tr_b16 a[164:165], v6 offset:24576
    ds_read_b64_tr_b16 a[166:167], v6 offset:25088
    v_mfma_f32_32x32x16_bf16 v[96:111], a[172:175], a[56:59], v[96:111]
    ds_read_b64_tr_b16 a[168:169], v7 offset:16384
    ds_read_b64_tr_b16 a[170:171], v7 offset:16896
    s_waitcnt lgkmcnt(6)
    v_mfma_f32_32x32x16_bf16 v[48:63], a[176:179], a[60:63], v[48:63]
    ds_read_b64_tr_b16 a[172:173], v7 offset:24576
    ds_read_b64_tr_b16 a[174:175], v7 offset:25088
    v_mfma_f32_32x32x16_bf16 v[64:79], a[180:183], a[60:63], v[64:79]
    ds_read_b64_tr_b16 a[176:177], v6 offset:18432
    ds_read_b64_tr_b16 a[178:179], v6 offset:18944
    s_add_u32 m0, s78, 114688
    s_add_u32 s32, s83, s73
    buffer_load_dwordx4 v2, s[16:19], s32 offen offset:0 lds
    v_mfma_f32_32x32x16_bf16 v[80:95], a[184:187], a[60:63], v[80:95]
    ds_read_b64_tr_b16 a[180:181], v6 offset:26624
    ds_read_b64_tr_b16 a[182:183], v6 offset:27136
    v_mfma_f32_32x32x16_bf16 v[96:111], a[188:191], a[60:63], v[96:111]
    ds_read_b64_tr_b16 a[184:185], v7 offset:18432
    ds_read_b64_tr_b16 a[186:187], v7 offset:18944
    s_waitcnt lgkmcnt(6)
    v_mfma_f32_32x32x16_bf16 v[48:63], a[160:163], a[64:67], v[48:63]
    ds_read_b64_tr_b16 a[188:189], v7 offset:26624
    ds_read_b64_tr_b16 a[190:191], v7 offset:27136
    v_mfma_f32_32x32x16_bf16 v[64:79], a[164:167], a[64:67], v[64:79]
    ds_read_b64_tr_b16 a[160:161], v6 offset:20480
    ds_read_b64_tr_b16 a[162:163], v6 offset:20992
    buffer_load_dwordx4 v3, s[16:19], s32 offen offset:1024 lds
    v_mfma_f32_32x32x16_bf16 v[80:95], a[168:171], a[64:67], v[80:95]
    ds_read_b64_tr_b16 a[164:165], v6 offset:28672
    ds_read_b64_tr_b16 a[166:167], v6 offset:29184
    v_mfma_f32_32x32x16_bf16 v[96:111], a[172:175], a[64:67], v[96:111]
    ds_read_b64_tr_b16 a[168:169], v7 offset:20480
    ds_read_b64_tr_b16 a[170:171], v7 offset:20992
    s_waitcnt lgkmcnt(6)
    v_mfma_f32_32x32x16_bf16 v[48:63], a[176:179], a[68:71], v[48:63]
    ds_read_b64_tr_b16 a[172:173], v7 offset:28672
    ds_read_b64_tr_b16 a[174:175], v7 offset:29184
    v_mfma_f32_32x32x16_bf16 v[64:79], a[180:183], a[68:71], v[64:79]
    ds_read_b64_tr_b16 a[176:177], v6 offset:22528
    ds_read_b64_tr_b16 a[178:179], v6 offset:23040
    buffer_load_dwordx4 v4, s[16:19], s32 offen offset:2048 lds
    v_mfma_f32_32x32x16_bf16 v[80:95], a[184:187], a[68:71], v[80:95]
    ds_read_b64_tr_b16 a[180:181], v6 offset:30720
    ds_read_b64_tr_b16 a[182:183], v6 offset:31232
    v_mfma_f32_32x32x16_bf16 v[96:111], a[188:191], a[68:71], v[96:111]
    ds_read_b64_tr_b16 a[184:185], v7 offset:22528
    ds_read_b64_tr_b16 a[186:187], v7 offset:23040
    s_waitcnt lgkmcnt(6)
    v_mfma_f32_32x32x16_bf16 v[48:63], a[160:163], a[72:75], v[48:63]
    ds_read_b64_tr_b16 a[188:189], v7 offset:30720
    ds_read_b64_tr_b16 a[190:191], v7 offset:31232
    v_mfma_f32_32x32x16_bf16 v[64:79], a[164:167], a[72:75], v[64:79]
    s_waitcnt vmcnt(25)
    s_barrier
    ds_read_b64_tr_b16 a[160:161], v6 offset:32768
    ds_read_b64_tr_b16 a[162:163], v6 offset:33280
    buffer_load_dwordx4 v5, s[16:19], s32 offen offset:3072 lds
    v_mfma_f32_32x32x16_bf16 v[80:95], a[168:171], a[72:75], v[80:95]
    ds_read_b64_tr_b16 a[164:165], v6 offset:40960
    ds_read_b64_tr_b16 a[166:167], v6 offset:41472
    v_mfma_f32_32x32x16_bf16 v[96:111], a[172:175], a[72:75], v[96:111]
    ds_read_b64_tr_b16 a[168:169], v7 offset:32768
    ds_read_b64_tr_b16 a[170:171], v7 offset:33280
    s_waitcnt lgkmcnt(6)
    v_mfma_f32_32x32x16_bf16 v[48:63], a[176:179], a[76:79], v[48:63]
    ds_read_b64_tr_b16 a[172:173], v7 offset:40960
    ds_read_b64_tr_b16 a[174:175], v7 offset:41472
    v_mfma_f32_32x32x16_bf16 v[64:79], a[180:183], a[76:79], v[64:79]
    ds_read_b64_tr_b16 a[176:177], v6 offset:34816
    ds_read_b64_tr_b16 a[178:179], v6 offset:35328
    s_add_u32 m0, s78, 0
    s_add_u32 s32, s83, s73
    s_add_u32 s32, s32, 221184
    buffer_load_dwordx4 v2, s[16:19], s32 offen offset:0 lds
    v_mfma_f32_32x32x16_bf16 v[80:95], a[184:187], a[76:79], v[80:95]
    ds_read_b64_tr_b16 a[180:181], v6 offset:43008
    ds_read_b64_tr_b16 a[182:183], v6 offset:43520
    v_mfma_f32_32x32x16_bf16 v[96:111], a[188:191], a[76:79], v[96:111]
    ds_read_b64_tr_b16 a[184:185], v7 offset:34816
    ds_read_b64_tr_b16 a[186:187], v7 offset:35328
    s_waitcnt lgkmcnt(6)
    v_mfma_f32_32x32x16_bf16 v[48:63], a[160:163], a[80:83], v[48:63]
    ds_read_b64_tr_b16 a[188:189], v7 offset:43008
    ds_read_b64_tr_b16 a[190:191], v7 offset:43520
    v_mfma_f32_32x32x16_bf16 v[64:79], a[164:167], a[80:83], v[64:79]
    ds_read_b64_tr_b16 a[160:161], v6 offset:36864
    ds_read_b64_tr_b16 a[162:163], v6 offset:37376
    buffer_load_dwordx4 v3, s[16:19], s32 offen offset:1024 lds
    v_mfma_f32_32x32x16_bf16 v[80:95], a[168:171], a[80:83], v[80:95]
    ds_read_b64_tr_b16 a[164:165], v6 offset:45056
    ds_read_b64_tr_b16 a[166:167], v6 offset:45568
    v_mfma_f32_32x32x16_bf16 v[96:111], a[172:175], a[80:83], v[96:111]
    ds_read_b64_tr_b16 a[168:169], v7 offset:36864
    ds_read_b64_tr_b16 a[170:171], v7 offset:37376
    s_waitcnt lgkmcnt(6)
    v_mfma_f32_32x32x16_bf16 v[48:63], a[176:179], a[84:87], v[48:63]
    ds_read_b64_tr_b16 a[172:173], v7 offset:45056
    ds_read_b64_tr_b16 a[174:175], v7 offset:45568
    v_mfma_f32_32x32x16_bf16 v[64:79], a[180:183], a[84:87], v[64:79]
    ds_read_b64_tr_b16 a[176:177], v6 offset:38912
    ds_read_b64_tr_b16 a[178:179], v6 offset:39424
    buffer_load_dwordx4 v4, s[16:19], s32 offen offset:2048 lds
    v_mfma_f32_32x32x16_bf16 v[80:95], a[184:187], a[84:87], v[80:95]
    ds_read_b64_tr_b16 a[180:181], v6 offset:47104
    ds_read_b64_tr_b16 a[182:183], v6 offset:47616
    v_mfma_f32_32x32x16_bf16 v[96:111], a[188:191], a[84:87], v[96:111]
    ds_read_b64_tr_b16 a[184:185], v7 offset:38912
    ds_read_b64_tr_b16 a[186:187], v7 offset:39424
    s_waitcnt lgkmcnt(6)
    v_mfma_f32_32x32x16_bf16 v[48:63], a[160:163], a[88:91], v[48:63]
    ds_read_b64_tr_b16 a[188:189], v7 offset:47104
    ds_read_b64_tr_b16 a[190:191], v7 offset:47616
    v_mfma_f32_32x32x16_bf16 v[64:79], a[164:167], a[88:91], v[64:79]
    s_waitcnt vmcnt(20)
    s_barrier
    s_lshl_b32 s33, s6, 4
    s_add_u32 s33, s33, s5
    s_lshl_b32 s33, s33, 7
    s_add_u32 s33, s33, 24117248
    s_cmp_eq_u32 s4, 0
    s_cselect_b32 s33, s33, 1073741824
    v_mov_b32_e64 v224, s85
    s_mov_b64 exec, 1
    buffer_store_dword v224, off, s[20:23], s33 sc1
    s_mov_b64 exec, -1
    ds_read_b64_tr_b16 a[160:161], v6 offset:49152
    ds_read_b64_tr_b16 a[162:163], v6 offset:49664
    buffer_load_dwordx4 v5, s[16:19], s32 offen offset:3072 lds
    v_mfma_f32_32x32x16_bf16 v[80:95], a[168:171], a[88:91], v[80:95]
    ds_read_b64_tr_b16 a[164:165], v6 offset:57344
    ds_read_b64_tr_b16 a[166:167], v6 offset:57856
    v_mfma_f32_32x32x16_bf16 v[96:111], a[172:175], a[88:91], v[96:111]
    ds_read_b64_tr_b16 a[168:169], v7 offset:49152
    ds_read_b64_tr_b16 a[170:171], v7 offset:49664
    s_waitcnt lgkmcnt(6)
    s_nop 0
    v_mfma_f32_32x32x16_bf16 v[48:63], a[176:179], a[92:95], v[48:63]
    ds_read_b64_tr_b16 a[172:173], v7 offset:57344
    ds_read_b64_tr_b16 a[174:175], v7 offset:57856
    v_mfma_f32_32x32x16_bf16 v[64:79], a[180:183], a[92:95], v[64:79]
    ds_read_b64_tr_b16 a[176:177], v6 offset:51200
    ds_read_b64_tr_b16 a[178:179], v6 offset:51712
    s_add_u32 m0, s78, 16384
    s_add_u32 s32, s83, s74
    buffer_load_dwordx4 v2, s[16:19], s32 offen offset:0 lds
    v_mfma_f32_32x32x16_bf16 v[80:95], a[184:187], a[92:95], v[80:95]
    ds_read_b64_tr_b16 a[180:181], v6 offset:59392
    ds_read_b64_tr_b16 a[182:183], v6 offset:59904
    v_mfma_f32_32x32x16_bf16 v[96:111], a[188:191], a[92:95], v[96:111]
    ds_read_b64_tr_b16 a[184:185], v7 offset:51200
    ds_read_b64_tr_b16 a[186:187], v7 offset:51712
    s_waitcnt lgkmcnt(6)
    v_mfma_f32_32x32x16_bf16 v[48:63], a[160:163], a[96:99], v[48:63]
    ds_read_b64_tr_b16 a[188:189], v7 offset:59392
    ds_read_b64_tr_b16 a[190:191], v7 offset:59904
    v_mfma_f32_32x32x16_bf16 v[64:79], a[164:167], a[96:99], v[64:79]
    ds_read_b64_tr_b16 a[160:161], v6 offset:53248
    ds_read_b64_tr_b16 a[162:163], v6 offset:53760
    buffer_load_dwordx4 v3, s[16:19], s32 offen offset:1024 lds
    v_mfma_f32_32x32x16_bf16 v[80:95], a[168:171], a[96:99], v[80:95]
    ds_read_b64_tr_b16 a[164:165], v6 offset:61440
    ds_read_b64_tr_b16 a[166:167], v6 offset:61952
    v_mfma_f32_32x32x16_bf16 v[96:111], a[172:175], a[96:99], v[96:111]
    ds_read_b64_tr_b16 a[168:169], v7 offset:53248
    ds_read_b64_tr_b16 a[170:171], v7 offset:53760
    s_waitcnt lgkmcnt(6)
    v_mfma_f32_32x32x16_bf16 v[48:63], a[176:179], a[100:103], v[48:63]
    ds_read_b64_tr_b16 a[172:173], v7 offset:61440
    ds_read_b64_tr_b16 a[174:175], v7 offset:61952
    v_mfma_f32_32x32x16_bf16 v[64:79], a[180:183], a[100:103], v[64:79]
    ds_read_b64_tr_b16 a[176:177], v6 offset:55296
    ds_read_b64_tr_b16 a[178:179], v6 offset:55808
    buffer_load_dwordx4 v4, s[16:19], s32 offen offset:2048 lds
    v_mfma_f32_32x32x16_bf16 v[80:95], a[184:187], a[100:103], v[80:95]
    ds_read_b64_tr_b16 a[180:181], v6 offset:63488
    ds_read_b64_tr_b16 a[182:183], v6 offset:64000
    v_mfma_f32_32x32x16_bf16 v[96:111], a[188:191], a[100:103], v[96:111]
    ds_read_b64_tr_b16 a[184:185], v7 offset:55296
    ds_read_b64_tr_b16 a[186:187], v7 offset:55808
    s_waitcnt lgkmcnt(6)
    v_mfma_f32_32x32x16_bf16 v[48:63], a[160:163], a[104:107], v[48:63]
    ds_read_b64_tr_b16 a[188:189], v7 offset:63488
    ds_read_b64_tr_b16 a[190:191], v7 offset:64000
    v_mfma_f32_32x32x16_bf16 v[64:79], a[164:167], a[104:107], v[64:79]
    s_waitcnt vmcnt(21)
    s_barrier
    ds_read_b64_tr_b16 a[160:161], v8 offset:0
    ds_read_b64_tr_b16 a[162:163], v8 offset:512
    buffer_load_dwordx4 v5, s[16:19], s32 offen offset:3072 lds
    v_mfma_f32_32x32x16_bf16 v[80:95], a[168:171], a[104:107], v[80:95]
    ds_read_b64_tr_b16 a[164:165], v8 offset:8192
    ds_read_b64_tr_b16 a[166:167], v8 offset:8704
    v_mfma_f32_32x32x16_bf16 v[96:111], a[172:175], a[104:107], v[96:111]
    ds_read_b64_tr_b16 a[168:169], v9 offset:0
    ds_read_b64_tr_b16 a[170:171], v9 offset:512
    s_waitcnt lgkmcnt(6)
    v_mfma_f32_32x32x16_bf16 v[48:63], a[176:179], a[108:111], v[48:63]
    ds_read_b64_tr_b16 a[172:173], v9 offset:8192
    ds_read_b64_tr_b16 a[174:175], v9 offset:8704
    v_mfma_f32_32x32x16_bf16 v[64:79], a[180:183], a[108:111], v[64:79]
    ds_read_b64_tr_b16 a[176:177], v8 offset:2048
    ds_read_b64_tr_b16 a[178:179], v8 offset:2560
    s_add_u32 m0, s78, 32768
    s_add_u32 s32, s83, s74
    s_add_u32 s32, s32, 221184
    buffer_load_dwordx4 v2, s[16:19], s32 offen offset:0 lds
    v_mfma_f32_32x32x16_bf16 v[80:95], a[184:187], a[108:111], v[80:95]
    ds_read_b64_tr_b16 a[180:181], v8 offset:10240
    ds_read_b64_tr_b16 a[182:183], v8 offset:10752
    v_mfma_f32_32x32x16_bf16 v[96:111], a[188:191], a[108:111], v[96:111]
    ds_read_b64_tr_b16 a[184:185], v9 offset:2048
    ds_read_b64_tr_b16 a[186:187], v9 offset:2560
    s_waitcnt lgkmcnt(6)
    v_mfma_f32_32x32x16_bf16 v[48:63], a[160:163], a[112:115], v[48:63]
    ds_read_b64_tr_b16 a[188:189], v9 offset:10240
    ds_read_b64_tr_b16 a[190:191], v9 offset:10752
    v_mfma_f32_32x32x16_bf16 v[64:79], a[164:167], a[112:115], v[64:79]
    ds_read_b64_tr_b16 a[160:161], v8 offset:4096
    ds_read_b64_tr_b16 a[162:163], v8 offset:4608
    buffer_load_dwordx4 v3, s[16:19], s32 offen offset:1024 lds
    v_mfma_f32_32x32x16_bf16 v[80:95], a[168:171], a[112:115], v[80:95]
    ds_read_b64_tr_b16 a[164:165], v8 offset:12288
    ds_read_b64_tr_b16 a[166:167], v8 offset:12800
    v_mfma_f32_32x32x16_bf16 v[96:111], a[172:175], a[112:115], v[96:111]
    ds_read_b64_tr_b16 a[168:169], v9 offset:4096
    ds_read_b64_tr_b16 a[170:171], v9 offset:4608
    s_waitcnt lgkmcnt(6)
    v_mfma_f32_32x32x16_bf16 v[48:63], a[176:179], a[116:119], v[48:63]
    ds_read_b64_tr_b16 a[172:173], v9 offset:12288
    ds_read_b64_tr_b16 a[174:175], v9 offset:12800
    v_mfma_f32_32x32x16_bf16 v[64:79], a[180:183], a[116:119], v[64:79]
    ds_read_b64_tr_b16 a[176:177], v8 offset:6144
    ds_read_b64_tr_b16 a[178:179], v8 offset:6656
    buffer_load_dwordx4 v4, s[16:19], s32 offen offset:2048 lds
    v_mfma_f32_32x32x16_bf16 v[80:95], a[184:187], a[116:119], v[80:95]
    ds_read_b64_tr_b16 a[180:181], v8 offset:14336
    ds_read_b64_tr_b16 a[182:183], v8 offset:14848
    v_mfma_f32_32x32x16_bf16 v[96:111], a[188:191], a[116:119], v[96:111]
    ds_read_b64_tr_b16 a[184:185], v9 offset:6144
    ds_read_b64_tr_b16 a[186:187], v9 offset:6656
    s_add_u32 s35, s80, 0
    s_mul_i32 s35, s35, 8704
    s_add_u32 s35, s35, 16842752
    s_waitcnt lgkmcnt(6)
    v_mfma_f32_32x32x16_bf16 v[48:63], a[160:163], a[120:123], v[48:63]
    ds_read_b64_tr_b16 a[188:189], v9 offset:14336
    ds_read_b64_tr_b16 a[190:191], v9 offset:14848
    s_mov_b32 s92, 0
    v_mov_b32 v220, v232
    v_max_i32_e64 v220, v220, v233
    buffer_load_dwordx4 v[188:191], v220, s[20:23], s35 offen sc1
    v_mfma_f32_32x32x16_bf16 v[64:79], a[164:167], a[120:123], v[64:79]
    s_waitcnt vmcnt(22)
    s_barrier
    ds_read_b64_tr_b16 a[160:161], v8 offset:16384
    ds_read_b64_tr_b16 a[162:163], v8 offset:16896
    buffer_load_dwordx4 v5, s[16:19], s32 offen offset:3072 lds
    v_mfma_f32_32x32x16_bf16 v[80:95], a[168:171], a[120:123], v[80:95]
    ds_read_b64_tr_b16 a[164:165], v8 offset:24576
    ds_read_b64_tr_b16 a[166:167], v8 offset:25088
    v_add_u32 v220, 0xfffffc00, v232
    v_max_i32_e64 v220, v220, v233
    buffer_load_dwordx4 v[192:195], v220, s[20:23], s35 offen sc1
    v_mfma_f32_32x32x16_bf16 v[96:111], a[172:175], a[120:123], v[96:111]
    ds_read_b64_tr_b16 a[168:169], v9 offset:16384
    ds_read_b64_tr_b16 a[170:171], v9 offset:16896
    v_add_u32 v220, 0xfffff800, v232
    v_max_i32 v220, v220, v233
    buffer_load_dwordx4 v[196:199], v220, s[20:23], s35 offen sc1
    s_waitcnt lgkmcnt(6)
    v_mfma_f32_32x32x16_bf16 v[48:63], a[176:179], a[124:127], v[48:63]
    ds_read_b64_tr_b16 a[172:173], v9 offset:24576
    ds_read_b64_tr_b16 a[174:175], v9 offset:25088
    v_add_u32 v220, 0xfffff400, v232
    v_max_i32_e64 v220, v220, v233
    buffer_load_dwordx4 v[200:203], v220, s[20:23], s35 offen sc1
    v_mfma_f32_32x32x16_bf16 v[64:79], a[180:183], a[124:127], v[64:79]
    ds_read_b64_tr_b16 a[176:177], v8 offset:18432
    ds_read_b64_tr_b16 a[178:179], v8 offset:18944
    s_add_u32 m0, s78, 49152
    s_add_u32 s32, s83, s75
    buffer_load_dwordx4 v2, s[16:19], s32 offen offset:0 lds
    v_mfma_f32_32x32x16_bf16 v[80:95], a[184:187], a[124:127], v[80:95]
    ds_read_b64_tr_b16 a[180:181], v8 offset:26624
    ds_read_b64_tr_b16 a[182:183], v8 offset:27136
    v_add_u32 v220, 0xfffff000, v232
    v_max_i32 v220, v220, v233
    buffer_load_dwordx4 v[204:207], v220, s[20:23], s35 offen sc1
    v_mfma_f32_32x32x16_bf16 v[96:111], a[188:191], a[124:127], v[96:111]
    ds_read_b64_tr_b16 a[184:185], v9 offset:18432
    ds_read_b64_tr_b16 a[186:187], v9 offset:18944
    v_add_u32 v220, 0xffffec00, v232
    v_max_i32 v220, v220, v233
    buffer_load_dwordx4 v[208:211], v220, s[20:23], s35 offen sc1
    s_waitcnt lgkmcnt(6)
    v_mfma_f32_32x32x16_bf16 v[48:63], a[160:163], a[128:131], v[48:63]
    ds_read_b64_tr_b16 a[188:189], v9 offset:26624
    ds_read_b64_tr_b16 a[190:191], v9 offset:27136
    v_add_u32 v220, 0xffffe800, v232
    v_max_i32_e64 v220, v220, v233
    buffer_load_dwordx4 v[212:215], v220, s[20:23], s35 offen sc1
    v_mfma_f32_32x32x16_bf16 v[64:79], a[164:167], a[128:131], v[64:79]
    ds_read_b64_tr_b16 a[160:161], v8 offset:20480
    ds_read_b64_tr_b16 a[162:163], v8 offset:20992
    buffer_load_dwordx4 v3, s[16:19], s32 offen offset:1024 lds
    v_add_u32 v220, 0xffffe400, v232
    v_max_i32 v220, v220, v233
    buffer_load_dwordx4 v[216:219], v220, s[20:23], s35 offen sc1
    v_mfma_f32_32x32x16_bf16 v[80:95], a[168:171], a[128:131], v[80:95]
    ds_read_b64_tr_b16 a[164:165], v8 offset:28672
    ds_read_b64_tr_b16 a[166:167], v8 offset:29184
    v_mfma_f32_32x32x16_bf16 v[96:111], a[172:175], a[128:131], v[96:111]
    ds_read_b64_tr_b16 a[168:169], v9 offset:20480
    ds_read_b64_tr_b16 a[170:171], v9 offset:20992
    s_waitcnt lgkmcnt(6)
    v_mfma_f32_32x32x16_bf16 v[48:63], a[176:179], a[132:135], v[48:63]
    ds_read_b64_tr_b16 a[172:173], v9 offset:28672
    ds_read_b64_tr_b16 a[174:175], v9 offset:29184
    v_mfma_f32_32x32x16_bf16 v[64:79], a[180:183], a[132:135], v[64:79]
    ds_read_b64_tr_b16 a[176:177], v8 offset:22528
    ds_read_b64_tr_b16 a[178:179], v8 offset:23040
    buffer_load_dwordx4 v4, s[16:19], s32 offen offset:2048 lds
    v_mfma_f32_32x32x16_bf16 v[80:95], a[184:187], a[132:135], v[80:95]
    ds_read_b64_tr_b16 a[180:181], v8 offset:30720
    ds_read_b64_tr_b16 a[182:183], v8 offset:31232
    v_mfma_f32_32x32x16_bf16 v[96:111], a[188:191], a[132:135], v[96:111]
    ds_read_b64_tr_b16 a[184:185], v9 offset:22528
    ds_read_b64_tr_b16 a[186:187], v9 offset:23040
    s_waitcnt lgkmcnt(6)
    v_mfma_f32_32x32x16_bf16 v[48:63], a[160:163], a[136:139], v[48:63]
    ds_read_b64_tr_b16 a[188:189], v9 offset:30720
    ds_read_b64_tr_b16 a[190:191], v9 offset:31232
    s_lshl_b32 s29, s6, 11
    s_add_u32 s29, s29, 24117248
    v_and_b32 v225, 15, v1
    v_lshlrev_b32 v225, 7, v225
    v_mov_b32 v224, s85
    s_mov_b64 exec, 0xffff
    buffer_load_dword v224, v225, s[20:23], s29 offen sc1
    s_mov_b64 exec, -1
    v_mfma_f32_32x32x16_bf16 v[64:79], a[164:167], a[136:139], v[64:79]
    s_waitcnt vmcnt(29)
    s_barrier
    ds_read_b64_tr_b16 a[160:161], v8 offset:32768
    ds_read_b64_tr_b16 a[162:163], v8 offset:33280
    buffer_load_dwordx4 v5, s[16:19], s32 offen offset:3072 lds
    v_mfma_f32_32x32x16_bf16 v[80:95], a[168:171], a[136:139], v[80:95]
    ds_read_b64_tr_b16 a[164:165], v8 offset:40960
    ds_read_b64_tr_b16 a[166:167], v8 offset:41472
    v_mfma_f32_32x32x16_bf16 v[96:111], a[172:175], a[136:139], v[96:111]
    ds_read_b64_tr_b16 a[168:169], v9 offset:32768
    ds_read_b64_tr_b16 a[170:171], v9 offset:33280
    s_waitcnt lgkmcnt(6)
    v_mfma_f32_32x32x16_bf16 v[48:63], a[176:179], a[140:143], v[48:63]
    ds_read_b64_tr_b16 a[172:173], v9 offset:40960
    ds_read_b64_tr_b16 a[174:175], v9 offset:41472
    v_mfma_f32_32x32x16_bf16 v[64:79], a[180:183], a[140:143], v[64:79]
    ds_read_b64_tr_b16 a[176:177], v8 offset:34816
    ds_read_b64_tr_b16 a[178:179], v8 offset:35328
    s_add_u32 m0, s78, 65536
    s_add_u32 s32, s83, s75
    s_add_u32 s32, s32, 221184
    buffer_load_dwordx4 v2, s[16:19], s32 offen offset:0 lds
    v_mfma_f32_32x32x16_bf16 v[80:95], a[184:187], a[140:143], v[80:95]
    ds_read_b64_tr_b16 a[180:181], v8 offset:43008
    ds_read_b64_tr_b16 a[182:183], v8 offset:43520
    v_mfma_f32_32x32x16_bf16 v[96:111], a[188:191], a[140:143], v[96:111]
    ds_read_b64_tr_b16 a[184:185], v9 offset:34816
    ds_read_b64_tr_b16 a[186:187], v9 offset:35328
    s_waitcnt lgkmcnt(6)
    v_mfma_f32_32x32x16_bf16 v[48:63], a[160:163], a[144:147], v[48:63]
    ds_read_b64_tr_b16 a[188:189], v9 offset:43008
    ds_read_b64_tr_b16 a[190:191], v9 offset:43520
    s_waitcnt vmcnt(4)
    v_mov_b32_e64 v221, s85
    v_bitop3_b32 v220, v189, v191, v221 bitop3:0x7e
    v_bitop3_b32 v223, v193, v195, v221 bitop3:0x7e
    v_mfma_f32_32x32x16_bf16 v[64:79], a[164:167], a[144:147], v[64:79]
    ds_read_b64_tr_b16 a[160:161], v8 offset:36864
    ds_read_b64_tr_b16 a[162:163], v8 offset:37376
    buffer_load_dwordx4 v3, s[16:19], s32 offen offset:1024 lds
    v_bitop3_b32 v222, v197, v199, v221 bitop3:0x7e
    v_or3_b32 v220, v220, v222, v223
    v_mfma_f32_32x32x16_bf16 v[80:95], a[168:171], a[144:147], v[80:95]
    ds_read_b64_tr_b16 a[164:165], v8 offset:45056
    ds_read_b64_tr_b16 a[166:167], v8 offset:45568
    v_bitop3_b32 v223, v201, v203, v221 bitop3:0x7e
    v_bitop3_b32 v222, v205, v207, v221 bitop3:0x7e
    v_or3_b32 v220, v220, v222, v223
    v_bitop3_b32 v223, v209, v211, v221 bitop3:0x7e
    v_mfma_f32_32x32x16_bf16 v[96:111], a[172:175], a[144:147], v[96:111]
    ds_read_b64_tr_b16 a[168:169], v9 offset:36864
    ds_read_b64_tr_b16 a[170:171], v9 offset:37376
    v_bitop3_b32 v222, v213, v215, v221 bitop3:0x7e
    v_or3_b32 v220, v220, v222, v223
    v_bitop3_b32 v223, v217, v219, v221 bitop3:0x7e
    s_waitcnt lgkmcnt(6)
    v_mfma_f32_32x32x16_bf16 v[48:63], a[176:179], a[148:151], v[48:63]
    ds_read_b64_tr_b16 a[172:173], v9 offset:45056
    ds_read_b64_tr_b16 a[174:175], v9 offset:45568
    v_or_b32 v220, v220, v223
    v_cmp_ne_u32 vcc, 0, v220
    s_nop 1
    s_cbranch_vccnz LB_SLOW_A
LB_OK_A:
    v_mov_b32 v220, v216
    v_mfma_f32_32x32x16_bf16 v[64:79], a[180:183], a[148:151], v[64:79]
    ds_read_b64_tr_b16 a[176:177], v8 offset:38912
    ds_read_b64_tr_b16 a[178:179], v8 offset:39424
    buffer_load_dwordx4 v4, s[16:19], s32 offen offset:2048 lds
    v_mov_b32_e64 v221, v218
    v_fma_f32 v212, -v187, v221, v212
    v_mfma_f32_32x32x16_bf16 v[80:95], a[184:187], a[148:151], v[80:95]
    ds_read_b64_tr_b16 a[180:181], v8 offset:47104
    ds_read_b64_tr_b16 a[182:183], v8 offset:47616
    v_fma_f32 v214, v187, v220, v214
    v_fma_f32 v220, v186, v220, v212
    v_fma_f32 v221, v186, v221, v214
    v_fma_f32 v208, -v187, v221, v208
    v_mfma_f32_32x32x16_bf16 v[96:111], a[188:191], a[148:151], v[96:111]
    ds_read_b64_tr_b16 a[184:185], v9 offset:38912
    ds_read_b64_tr_b16 a[186:187], v9 offset:39424
    v_fmac_f32 v210, v187, v220
    v_fma_f32 v220, v186, v220, v208
    v_fma_f32 v221, v186, v221, v210
    s_waitcnt lgkmcnt(6)
    v_mfma_f32_32x32x16_bf16 v[48:63], a[160:163], a[152:155], v[48:63]
    ds_read_b64_tr_b16 a[188:189], v9 offset:47104
    ds_read_b64_tr_b16 a[190:191], v9 offset:47616
    v_fma_f32 v204, -v187, v221, v204
    v_fmac_f32 v206, v187, v220
    v_fma_f32 v220, v186, v220, v204
    v_fma_f32 v221, v186, v221, v206
    v_mfma_f32_32x32x16_bf16 v[64:79], a[164:167], a[152:155], v[64:79]
    s_barrier
    ds_read_b64_tr_b16 a[160:161], v8 offset:49152
    ds_read_b64_tr_b16 a[162:163], v8 offset:49664
    buffer_load_dwordx4 v5, s[16:19], s32 offen offset:3072 lds
    v_fma_f32 v200, -v187, v221, v200
    v_mfma_f32_32x32x16_bf16 v[80:95], a[168:171], a[152:155], v[80:95]
    ds_read_b64_tr_b16 a[164:165], v8 offset:57344
    ds_read_b64_tr_b16 a[166:167], v8 offset:57856
    v_fma_f32 v202, v187, v220, v202
    v_fma_f32 v220, v186, v220, v200
    v_fma_f32 v221, v186, v221, v202
    v_fma_f32 v196, -v187, v221, v196
    v_mfma_f32_32x32x16_bf16 v[96:111], a[172:175], a[152:155], v[96:111]
    ds_read_b64_tr_b16 a[168:169], v9 offset:49152
    ds_read_b64_tr_b16 a[170:171], v9 offset:49664
    v_fmac_f32 v198, v187, v220
    v_fma_f32 v220, v186, v220, v196
    v_fma_f32 v221, v186, v221, v198
    s_waitcnt lgkmcnt(6)
    v_mfma_f32_32x32x16_bf16 v[48:63], a[176:179], a[156:159], v[48:63]
    ds_read_b64_tr_b16 a[172:173], v9 offset:57344
    ds_read_b64_tr_b16 a[174:175], v9 offset:57856
    v_fma_f32 v192, -v187, v221, v192
    v_fma_f32 v194, v187, v220, v194
    v_fma_f32 v220, v186, v220, v192
    v_fma_f32 v221, v186, v221, v194
    v_mfma_f32_32x32x16_bf16 v[64:79], a[180:183], a[156:159], v[64:79]
    ds_read_b64_tr_b16 a[176:177], v8 offset:51200
    ds_read_b64_tr_b16 a[178:179], v8 offset:51712
    s_add_u32 m0, s78, 81920
    s_add_u32 s32, s83, s76
    buffer_load_dwordx4 v2, s[16:19], s32 offen offset:0 lds
    v_mfma_f32_32x32x16_bf16 v[80:95], a[184:187], a[156:159], v[80:95]
    ds_read_b64_tr_b16 a[180:181], v8 offset:59392
    ds_read_b64_tr_b16 a[182:183], v8 offset:59904
    v_fma_f32 v188, -v187, v221, v188
    v_fmac_f32 v190, v187, v220
    v_fma_f32 v220, v186, v220, v188
    v_fma_f32 v221, v186, v221, v190
    v_mfma_f32_32x32x16_bf16 v[96:111], a[188:191], a[156:159], v[96:111]
    ds_read_b64_tr_b16 a[184:185], v9 offset:51200
    ds_read_b64_tr_b16 a[186:187], v9 offset:51712
    v_mov_b32 v188, v220
    v_mov_b32 v190, v220
    v_mov_b32 v189, v221
    s_waitcnt lgkmcnt(6)
    v_mfma_f32_32x32x16_bf16 v[112:127], a[160:163], a[0:3], 0
    ds_read_b64_tr_b16 a[188:189], v9 offset:59392
    ds_read_b64_tr_b16 a[190:191], v9 offset:59904
    v_mov_b32 v191, v221
    v_permlane32_swap_b32 v188, v190
    s_nop 0
    v_permlane32_swap_b32 v189, v191
    v_fma_f32 v188, -v185, v191, v188
    s_mov_b32 s30, 0
    s_waitcnt vmcnt(6)
    v_cmp_ne_u32 vcc, s85, v224
    s_nop 1
    s_cbranch_vccnz JF_SLOW_A
JF_OK_A:
    s_lshr_b32 s28, s6, 3
    s_mul_i32 s28, s28, 47
    s_mul_i32 s29, s4, 12
    s_add_u32 s31, s28, s29
    s_and_b32 s28, s6, 7
    s_mul_i32 s28, s28, 94
    s_add_u32 s28, s28, s31
    s_mul_i32 s28, s28, 5120
    s_add_u32 s27, s28, 12582912
    s_mov_b32 s24, 0x76543210
    s_mov_b32 s25, 0xba98
    s_cmp_eq_u32 s4, 0
    s_cselect_b32 s24, 0xba98721, s24
    s_cselect_b32 s25, 0x6543, s25
    s_cmp_eq_u32 s4, 3
    s_cselect_b32 s24, 0x38765210, s24
    s_cselect_b32 s25, 0xba94, s25
    s_cmp_lt_u32 s6, 8
    s_cselect_b32 s24, 0x32985410, s24
    s_cselect_b32 s25, 0xba76, s25
    v_mfma_f32_32x32x16_bf16 v[128:143], a[164:167], a[0:3], 0
    ds_read_b64_tr_b16 a[160:161], v8 offset:53248
    ds_read_b64_tr_b16 a[162:163], v8 offset:53760
    buffer_load_dwordx4 v3, s[16:19], s32 offen offset:1024 lds
    v_fma_f32 v189, v185, v190, v189
    v_fma_f32 v188, v184, v190, v188
    v_mfma_f32_32x32x16_bf16 v[144:159], a[168:171], a[0:3], 0
    ds_read_b64_tr_b16 a[164:165], v8 offset:61440
    ds_read_b64_tr_b16 a[166:167], v8 offset:61952
    v_fma_f32 v189, v184, v191, v189
    v_fma_f32 v237, -v183, v189, v237
    v_fma_f32 v238, v183, v188, v238
    v_fma_f32 v237, v182, v188, v237
    v_mfma_f32_32x32x16_bf16 v[160:175], a[172:175], a[0:3], 0
    ds_read_b64_tr_b16 a[168:169], v9 offset:53248
    ds_read_b64_tr_b16 a[170:171], v9 offset:53760
    s_bfe_u32 s28, s24, 0x40000
    s_mul_i32 s28, s28, 5120
    s_add_u32 s28, s28, s27
    buffer_load_dwordx4 a[192:195], v236, s[20:23], s28 offen offset:0 sc1
    s_waitcnt lgkmcnt(6)
    v_mfma_f32_32x32x16_bf16 v[112:127], a[176:179], a[4:7], v[112:127]
    ds_read_b64_tr_b16 a[172:173], v9 offset:61440
    ds_read_b64_tr_b16 a[174:175], v9 offset:61952
    v_fma_f32 v238, v182, v189, v238
    v_fma_f32 v16, -v177, v238, v16
    v_fma_f32 v32, v177, v237, v32
    v_fma_f32 v16, v176, v237, v16
    v_mfma_f32_32x32x16_bf16 v[128:143], a[180:183], a[4:7], v[128:143]
    ds_read_b64_tr_b16 a[176:177], v8 offset:55296
    ds_read_b64_tr_b16 a[178:179], v8 offset:55808
    buffer_load_dwordx4 v4, s[16:19], s32 offen offset:2048 lds
    v_fmac_f32 v32, v176, v238
    v_mul_f32 v192, v178, v16
    v_mfma_f32_32x32x16_bf16 v[144:159], a[184:187], a[4:7], v[144:159]
    ds_read_b64_tr_b16 a[180:181], v8 offset:63488
    ds_read_b64_tr_b16 a[182:183], v8 offset:64000
    v_mul_f32_e64 v193, v178, v32
    v_fma_f32 v192, -v179, v32, v192
    v_fma_f32 v193, v179, v16, v193
    v_cvt_pk_bf16_f32 v194, v192, -v193
    v_mfma_f32_32x32x16_bf16 v[160:175], a[188:191], a[4:7], v[160:175]
    ds_read_b64_tr_b16 a[184:185], v9 offset:55296
    ds_read_b64_tr_b16 a[186:187], v9 offset:55808
    buffer_load_dwordx4 a[196:199], v236, s[20:23], s28 offen offset:1024 sc1
    ds_write_b32 v234, v194 offset:0
    s_waitcnt lgkmcnt(7)
    v_mfma_f32_32x32x16_bf16 v[112:127], a[160:163], a[8:11], v[112:127]
    ds_read_b64_tr_b16 a[188:189], v9 offset:63488
    ds_read_b64_tr_b16 a[190:191], v9 offset:64000
    v_fma_f32 v17, -v177, v32, v17
    v_fmac_f32 v33, v177, v16
    v_fma_f32 v17, v176, v16, v17
    v_fmac_f32 v33, v176, v32
    v_mfma_f32_32x32x16_bf16 v[128:143], a[164:167], a[8:11], v[128:143]
    s_barrier
    ds_read_b64_tr_b16 a[160:161], v6 offset:0
    ds_read_b64_tr_b16 a[162:163], v6 offset:512
    buffer_load_dwordx4 v5, s[16:19], s32 offen offset:3072 lds
    v_mul_f32_e64 v196, v178, v17
    v_mfma_f32_32x32x16_bf16 v[144:159], a[168:171], a[8:11], v[144:159]
    ds_read_b64_tr_b16 a[164:165], v6 offset:8192
    ds_read_b64_tr_b16 a[166:167], v6 offset:8704
    v_mul_f32_e64 v197, v178, v33
    v_fma_f32 v196, -v179, v33, v196
    v_fma_f32 v197, v179, v17, v197
    v_cvt_pk_bf16_f32 v198, v196, -v197
    v_mfma_f32_32x32x16_bf16 v[160:175], a[172:175], a[8:11], v[160:175]
    ds_read_b64_tr_b16 a[168:169], v7 offset:0
    ds_read_b64_tr_b16 a[170:171], v7 offset:512
    buffer_load_dwordx4 a[200:203], v236, s[20:23], s28 offen offset:2048 sc1
    ds_write_b32 v234, v198 offset:144
    s_waitcnt lgkmcnt(7)
    v_mfma_f32_32x32x16_bf16 v[112:127], a[176:179], a[12:15], v[112:127]
    ds_read_b64_tr_b16 a[172:173], v7 offset:8192
    ds_read_b64_tr_b16 a[174:175], v7 offset:8704
    v_fma_f32 v18, -v177, v33, v18
    v_fmac_f32 v34, v177, v17
    v_fma_f32 v18, v176, v17, v18
    v_fmac_f32 v34, v176, v33
    v_mfma_f32_32x32x16_bf16 v[128:143], a[180:183], a[12:15], v[128:143]
    ds_read_b64_tr_b16 a[176:177], v6 offset:2048
    ds_read_b64_tr_b16 a[178:179], v6 offset:2560
    s_add_u32 m0, s78, 98304
    s_add_u32 s32, s83, s76
    s_add_u32 s32, s32, 221184
    buffer_load_dwordx4 v2, s[16:19], s32 offen offset:0 lds
    v_mfma_f32_32x32x16_bf16 v[144:159], a[184:187], a[12:15], v[144:159]
    ds_read_b64_tr_b16 a[180:181], v6 offset:10240
    ds_read_b64_tr_b16 a[182:183], v6 offset:10752
    v_mul_f32 v192, v178, v18
    v_mul_f32 v193, v178, v34
    v_fma_f32 v192, -v179, v34, v192
    v_fmac_f32 v193, v179, v18
    v_mfma_f32_32x32x16_bf16 v[160:175], a[188:191], a[12:15], v[160:175]
    ds_read_b64_tr_b16 a[184:185], v7 offset:2048
    ds_read_b64_tr_b16 a[186:187], v7 offset:2560
    buffer_load_dwordx4 a[204:207], v236, s[20:23], s28 offen offset:3072 sc1
    v_cvt_pk_bf16_f32 v194, v192, -v193
    s_waitcnt lgkmcnt(6)
    v_mfma_f32_32x32x16_bf16 v[112:127], a[160:163], a[16:19], v[112:127]
    ds_read_b64_tr_b16 a[188:189], v7 offset:10240
    ds_read_b64_tr_b16 a[190:191], v7 offset:10752
    ds_write_b32 v234, v194 offset:288
    v_fma_f32 v19, -v177, v34, v19
    v_fma_f32 v35, v177, v18, v35
    v_fma_f32 v19, v176, v18, v19
    v_mfma_f32_32x32x16_bf16 v[128:143], a[164:167], a[16:19], v[128:143]
    ds_read_b64_tr_b16 a[160:161], v6 offset:4096
    ds_read_b64_tr_b16 a[162:163], v6 offset:4608
    buffer_load_dwordx4 v3, s[16:19], s32 offen offset:1024 lds
    v_fmac_f32 v35, v176, v34
    v_mul_f32 v196, v178, v19
    v_mfma_f32_32x32x16_bf16 v[144:159], a[168:171], a[16:19], v[144:159]
    ds_read_b64_tr_b16 a[164:165], v6 offset:12288
    ds_read_b64_tr_b16 a[166:167], v6 offset:12800
    v_mul_f32_e64 v197, v178, v35
    v_fma_f32 v196, -v179, v35, v196
    v_fma_f32 v197, v179, v19, v197
    v_cvt_pk_bf16_f32 v198, v196, -v197
    v_mfma_f32_32x32x16_bf16 v[160:175], a[172:175], a[16:19], v[160:175]
    ds_read_b64_tr_b16 a[168:169], v7 offset:4096
    ds_read_b64_tr_b16 a[170:171], v7 offset:4608
    buffer_load_dwordx4 a[208:211], v0, s[20:23], s28 offen offset:0 sc1
    ds_write_b32 v234, v198 offset:432
    s_waitcnt lgkmcnt(8)
    v_mfma_f32_32x32x16_bf16 v[112:127], a[176:179], a[20:23], v[112:127]
    ds_read_b64_tr_b16 a[172:173], v7 offset:12288
    ds_read_b64_tr_b16 a[174:175], v7 offset:12800
    v_fma_f32 v20, -v177, v35, v20
    v_fmac_f32 v36, v177, v19
    v_fma_f32 v20, v176, v19, v20
    v_fma_f32 v36, v176, v35, v36
    v_mfma_f32_32x32x16_bf16 v[128:143], a[180:183], a[20:23], v[128:143]
    ds_read_b64_tr_b16 a[176:177], v6 offset:6144
    ds_read_b64_tr_b16 a[178:179], v6 offset:6656
    buffer_load_dwordx4 v4, s[16:19], s32 offen offset:2048 lds
    v_mul_f32 v192, v178, v20
    v_mul_f32 v193, v178, v36
    v_mfma_f32_32x32x16_bf16 v[144:159], a[184:187], a[20:23], v[144:159]
    ds_read_b64_tr_b16 a[180:181], v6 offset:14336
    ds_read_b64_tr_b16 a[182:183], v6 offset:14848
    v_fma_f32 v192, -v179, v36, v192
    v_fma_f32 v193, v179, v20, v193
    v_cvt_pk_bf16_f32 v194, v192, -v193
    ds_write_b32 v234, v194 offset:576
    v_mfma_f32_32x32x16_bf16 v[160:175], a[188:191], a[20:23], v[160:175]
    ds_read_b64_tr_b16 a[184:185], v7 offset:6144
    ds_read_b64_tr_b16 a[186:187], v7 offset:6656
    s_bfe_u32 s28, s24, 0x40004
    s_mul_i32 s28, s28, 5120
    s_add_u32 s28, s28, s27
    buffer_load_dwordx4 a[212:215], v236, s[20:23], s28 offen offset:0 sc1
    s_waitcnt lgkmcnt(7)
    v_mfma_f32_32x32x16_bf16 v[112:127], a[160:163], a[24:27], v[112:127]
    ds_read_b64_tr_b16 a[188:189], v7 offset:14336
    ds_read_b64_tr_b16 a[190:191], v7 offset:14848
    v_fma_f32 v21, -v177, v36, v21
    v_fma_f32 v37, v177, v20, v37
    v_fma_f32 v21, v176, v20, v21
    v_fmac_f32 v37, v176, v36
    v_mfma_f32_32x32x16_bf16 v[128:143], a[164:167], a[24:27], v[128:143]
    s_barrier
    ds_read_b64_tr_b16 a[160:161], v6 offset:16384
    ds_read_b64_tr_b16 a[162:163], v6 offset:16896
    buffer_load_dwordx4 v5, s[16:19], s32 offen offset:3072 lds
    v_mul_f32_e64 v196, v178, v21
    v_mfma_f32_32x32x16_bf16 v[144:159], a[168:171], a[24:27], v[144:159]
    ds_read_b64_tr_b16 a[164:165], v6 offset:24576
    ds_read_b64_tr_b16 a[166:167], v6 offset:25088
    v_mul_f32_e64 v197, v178, v37
    v_fma_f32 v196, -v179, v37, v196
    v_fma_f32 v197, v179, v21, v197
    v_cvt_pk_bf16_f32 v198, v196, -v197
    v_mfma_f32_32x32x16_bf16 v[160:175], a[172:175], a[24:27], v[160:175]
    ds_read_b64_tr_b16 a[168:169], v7 offset:16384
    ds_read_b64_tr_b16 a[170:171], v7 offset:16896
    buffer_load_dwordx4 a[216:219], v236, s[20:23], s28 offen offset:1024 sc1
    ds_write_b32 v234, v198 offset:720
    s_waitcnt lgkmcnt(7)
    v_mfma_f32_32x32x16_bf16 v[112:127], a[176:179], a[28:31], v[112:127]
    ds_read_b64_tr_b16 a[172:173], v7 offset:24576
    ds_read_b64_tr_b16 a[174:175], v7 offset:25088
    v_fma_f32 v22, -v177, v37, v22
    v_fmac_f32 v38, v177, v21
    v_fma_f32 v22, v176, v21, v22
    v_fmac_f32 v38, v176, v37
    v_mfma_f32_32x32x16_bf16 v[128:143], a[180:183], a[28:31], v[128:143]
    ds_read_b64_tr_b16 a[176:177], v6 offset:18432
    ds_read_b64_tr_b16 a[178:179], v6 offset:18944
    s_add_u32 m0, s78, 114688
    s_add_u32 s32, s83, s77
    buffer_load_dwordx4 v2, s[16:19], s32 offen offset:0 lds
    v_mfma_f32_32x32x16_bf16 v[144:159], a[184:187], a[28:31], v[144:159]
    ds_read_b64_tr_b16 a[180:181], v6 offset:26624
    ds_read_b64_tr_b16 a[182:183], v6 offset:27136
    v_mul_f32 v192, v178, v22
    v_mul_f32 v193, v178, v38
    v_fma_f32 v192, -v179, v38, v192
    v_fmac_f32 v193, v179, v22
    v_mfma_f32_32x32x16_bf16 v[160:175], a[188:191], a[28:31], v[160:175]
    ds_read_b64_tr_b16 a[184:185], v7 offset:18432
    ds_read_b64_tr_b16 a[186:187], v7 offset:18944
    buffer_load_dwordx4 a[220:223], v236, s[20:23], s28 offen offset:2048 sc1
    v_cvt_pk_bf16_f32 v194, v192, -v193
    s_waitcnt lgkmcnt(6)
    v_mfma_f32_32x32x16_bf16 v[112:127], a[160:163], a[32:35], v[112:127]
    ds_read_b64_tr_b16 a[188:189], v7 offset:26624
    ds_read_b64_tr_b16 a[190:191], v7 offset:27136
    ds_write_b32 v234, v194 offset:864
    v_fma_f32 v23, -v177, v38, v23
    v_fma_f32 v39, v177, v22, v39
    v_fma_f32 v23, v176, v22, v23
    v_mfma_f32_32x32x16_bf16 v[128:143], a[164:167], a[32:35], v[128:143]
    ds_read_b64_tr_b16 a[160:161], v6 offset:20480
    ds_read_b64_tr_b16 a[162:163], v6 offset:20992
    buffer_load_dwordx4 v3, s[16:19], s32 offen offset:1024 lds
    v_fmac_f32 v39, v176, v38
    v_mul_f32 v196, v178, v23
    v_mfma_f32_32x32x16_bf16 v[144:159], a[168:171], a[32:35], v[144:159]
    ds_read_b64_tr_b16 a[164:165], v6 offset:28672
    ds_read_b64_tr_b16 a[166:167], v6 offset:29184
    v_mul_f32_e64 v197, v178, v39
    v_fma_f32 v196, -v179, v39, v196
    v_fma_f32 v197, v179, v23, v197
    v_cvt_pk_bf16_f32 v198, v196, -v197
    v_mfma_f32_32x32x16_bf16 v[160:175], a[172:175], a[32:35], v[160:175]
    ds_read_b64_tr_b16 a[168:169], v7 offset:20480
    ds_read_b64_tr_b16 a[170:171], v7 offset:20992
    buffer_load_dwordx4 a[224:227], v236, s[20:23], s28 offen offset:3072 sc1
    ds_write_b32 v234, v198 offset:1008
    s_waitcnt lgkmcnt(8)
    v_mfma_f32_32x32x16_bf16 v[112:127], a[176:179], a[36:39], v[112:127]
    ds_read_b64_tr_b16 a[172:173], v7 offset:28672
    ds_read_b64_tr_b16 a[174:175], v7 offset:29184
    v_fma_f32 v24, -v177, v39, v24
    v_fmac_f32 v40, v177, v23
    v_fma_f32 v24, v176, v23, v24
    v_fma_f32 v40, v176, v39, v40
    v_mfma_f32_32x32x16_bf16 v[128:143], a[180:183], a[36:39], v[128:143]
    ds_read_b64_tr_b16 a[176:177], v6 offset:22528
    ds_read_b64_tr_b16 a[178:179], v6 offset:23040
    buffer_load_dwordx4 v4, s[16:19], s32 offen offset:2048 lds
    v_mul_f32 v192, v178, v24
    v_mul_f32 v193, v178, v40
    v_mfma_f32_32x32x16_bf16 v[144:159], a[184:187], a[36:39], v[144:159]
    ds_read_b64_tr_b16 a[180:181], v6 offset:30720
    ds_read_b64_tr_b16 a[182:183], v6 offset:31232
    v_fma_f32 v192, -v179, v40, v192
    v_fma_f32 v193, v179, v24, v193
    v_cvt_pk_bf16_f32 v194, v192, -v193
    ds_write_b32 v234, v194 offset:1152
    v_mfma_f32_32x32x16_bf16 v[160:175], a[188:191], a[36:39], v[160:175]
    ds_read_b64_tr_b16 a[184:185], v7 offset:22528
    ds_read_b64_tr_b16 a[186:187], v7 offset:23040
    buffer_load_dwordx4 a[228:231], v0, s[20:23], s28 offen offset:0 sc1
    v_fma_f32 v25, -v177, v40, v25
    s_waitcnt lgkmcnt(7)
    v_mfma_f32_32x32x16_bf16 v[112:127], a[160:163], a[40:43], v[112:127]
    ds_read_b64_tr_b16 a[188:189], v7 offset:30720
    ds_read_b64_tr_b16 a[190:191], v7 offset:31232
    v_fmac_f32 v41, v177, v24
    v_fma_f32 v25, v176, v24, v25
    v_fma_f32 v41, v176, v40, v41
    v_mul_f32 v196, v178, v25
    v_mfma_f32_32x32x16_bf16 v[128:143], a[164:167], a[40:43], v[128:143]
    s_barrier
    ds_read_b64_tr_b16 a[160:161], v6 offset:32768
    ds_read_b64_tr_b16 a[162:163], v6 offset:33280
    buffer_load_dwordx4 v5, s[16:19], s32 offen offset:3072 lds
    v_mul_f32_e64 v197, v178, v41
    v_mfma_f32_32x32x16_bf16 v[144:159], a[168:171], a[40:43], v[144:159]
    ds_read_b64_tr_b16 a[164:165], v6 offset:40960
    ds_read_b64_tr_b16 a[166:167], v6 offset:41472
    v_fma_f32 v196, -v179, v41, v196
    v_fma_f32 v197, v179, v25, v197
    v_cvt_pk_bf16_f32 v198, v196, -v197
    ds_write_b32 v234, v198 offset:1296
    v_mfma_f32_32x32x16_bf16 v[160:175], a[172:175], a[40:43], v[160:175]
    ds_read_b64_tr_b16 a[168:169], v7 offset:32768
    ds_read_b64_tr_b16 a[170:171], v7 offset:33280
    s_bfe_u32 s28, s24, 0x40008
    s_mul_i32 s28, s28, 5120
    s_add_u32 s28, s28, s27
    buffer_load_dwordx4 a[232:235], v236, s[20:23], s28 offen offset:0 sc1
    s_waitcnt lgkmcnt(7)
    v_mfma_f32_32x32x16_bf16 v[112:127], a[176:179], a[44:47], v[112:127]
    ds_read_b64_tr_b16 a[172:173], v7 offset:40960
    ds_read_b64_tr_b16 a[174:175], v7 offset:41472
    v_fma_f32 v26, -v177, v41, v26
    v_fma_f32 v42, v177, v25, v42
    v_fma_f32 v26, v176, v25, v26
    v_fma_f32 v42, v176, v41, v42
    v_mfma_f32_32x32x16_bf16 v[128:143], a[180:183], a[44:47], v[128:143]
    ds_read_b64_tr_b16 a[176:177], v6 offset:34816
    ds_read_b64_tr_b16 a[178:179], v6 offset:35328
    s_add_u32 m0, s78, 0
    s_add_u32 s32, s83, s77
    s_add_u32 s32, s32, 221184
    buffer_load_dwordx4 v2, s[16:19], s32 offen offset:0 lds
    v_mfma_f32_32x32x16_bf16 v[144:159], a[184:187], a[44:47], v[144:159]
    ds_read_b64_tr_b16 a[180:181], v6 offset:43008
    ds_read_b64_tr_b16 a[182:183], v6 offset:43520
    v_mul_f32 v192, v178, v26
    v_mul_f32 v193, v178, v42
    v_fma_f32 v192, -v179, v42, v192
    v_fmac_f32 v193, v179, v26
    v_mfma_f32_32x32x16_bf16 v[160:175], a[188:191], a[44:47], v[160:175]
    ds_read_b64_tr_b16 a[184:185], v7 offset:34816
    ds_read_b64_tr_b16 a[186:187], v7 offset:35328
    buffer_load_dwordx4 a[236:239], v236, s[20:23], s28 offen offset:1024 sc1
    v_cvt_pk_bf16_f32 v194, v192, -v193
    s_waitcnt lgkmcnt(6)
    v_mfma_f32_32x32x16_bf16 v[112:127], a[160:163], a[48:51], v[112:127]
    ds_read_b64_tr_b16 a[188:189], v7 offset:43008
    ds_read_b64_tr_b16 a[190:191], v7 offset:43520
    ds_write_b32 v234, v194 offset:1440
    v_fma_f32 v27, -v177, v42, v27
    v_fma_f32 v43, v177, v26, v43
    v_fma_f32 v27, v176, v26, v27
    v_mfma_f32_32x32x16_bf16 v[128:143], a[164:167], a[48:51], v[128:143]
    ds_read_b64_tr_b16 a[160:161], v6 offset:36864
    ds_read_b64_tr_b16 a[162:163], v6 offset:37376
    buffer_load_dwordx4 v3, s[16:19], s32 offen offset:1024 lds
    v_fmac_f32 v43, v176, v42
    v_mul_f32 v196, v178, v27
    v_mfma_f32_32x32x16_bf16 v[144:159], a[168:171], a[48:51], v[144:159]
    ds_read_b64_tr_b16 a[164:165], v6 offset:45056
    ds_read_b64_tr_b16 a[166:167], v6 offset:45568
    v_mul_f32_e64 v197, v178, v43
    v_fma_f32 v196, -v179, v43, v196
    v_fma_f32 v197, v179, v27, v197
    v_cvt_pk_bf16_f32 v198, v196, -v197
    v_mfma_f32_32x32x16_bf16 v[160:175], a[172:175], a[48:51], v[160:175]
    ds_read_b64_tr_b16 a[168:169], v7 offset:36864
    ds_read_b64_tr_b16 a[170:171], v7 offset:37376
    buffer_load_dwordx4 a[240:243], v236, s[20:23], s28 offen offset:2048 sc1
    ds_write_b32 v234, v198 offset:1584
    s_waitcnt lgkmcnt(8)
    v_mfma_f32_32x32x16_bf16 v[112:127], a[176:179], a[52:55], v[112:127]
    ds_read_b64_tr_b16 a[172:173], v7 offset:45056
    ds_read_b64_tr_b16 a[174:175], v7 offset:45568
    v_fma_f32 v28, -v177, v43, v28
    v_fmac_f32 v44, v177, v27
    v_fma_f32 v28, v176, v27, v28
    v_fma_f32 v44, v176, v43, v44
    v_mfma_f32_32x32x16_bf16 v[128:143], a[180:183], a[52:55], v[128:143]
    ds_read_b64_tr_b16 a[176:177], v6 offset:38912
    ds_read_b64_tr_b16 a[178:179], v6 offset:39424
    buffer_load_dwordx4 v4, s[16:19], s32 offen offset:2048 lds
    v_mul_f32 v192, v178, v28
    v_mul_f32 v193, v178, v44
    v_mfma_f32_32x32x16_bf16 v[144:159], a[184:187], a[52:55], v[144:159]
    ds_read_b64_tr_b16 a[180:181], v6 offset:47104
    ds_read_b64_tr_b16 a[182:183], v6 offset:47616
    v_fma_f32 v192, -v179, v44, v192
    v_fma_f32 v193, v179, v28, v193
    v_cvt_pk_bf16_f32 v194, v192, -v193
    ds_write_b32 v234, v194 offset:1728
    v_mfma_f32_32x32x16_bf16 v[160:175], a[188:191], a[52:55], v[160:175]
    ds_read_b64_tr_b16 a[184:185], v7 offset:38912
    ds_read_b64_tr_b16 a[186:187], v7 offset:39424
    buffer_load_dwordx4 a[244:247], v236, s[20:23], s28 offen offset:3072 sc1
    v_fma_f32 v29, -v177, v44, v29
    s_waitcnt lgkmcnt(7)
    v_mfma_f32_32x32x16_bf16 v[112:127], a[160:163], a[56:59], v[112:127]
    ds_read_b64_tr_b16 a[188:189], v7 offset:47104
    ds_read_b64_tr_b16 a[190:191], v7 offset:47616
    v_fmac_f32 v45, v177, v28
    v_fma_f32 v29, v176, v28, v29
    v_fmac_f32 v45, v176, v44
    v_mul_f32 v196, v178, v29
    v_mfma_f32_32x32x16_bf16 v[128:143], a[164:167], a[56:59], v[128:143]
    s_waitcnt vmcnt(33)
    s_barrier
    ds_read_b64_tr_b16 a[160:161], v6 offset:49152
    ds_read_b64_tr_b16 a[162:163], v6 offset:49664
    buffer_load_dwordx4 v5, s[16:19], s32 offen offset:3072 lds
    v_mfma_f32_32x32x16_bf16 v[144:159], a[168:171], a[56:59], v[144:159]
    ds_read_b64_tr_b16 a[164:165], v6 offset:57344
    ds_read_b64_tr_b16 a[166:167], v6 offset:57856
    v_mul_f32_e64 v197, v178, v45
    v_fma_f32 v196, -v179, v45, v196
    v_fma_f32 v197, v179, v29, v197
    v_cvt_pk_bf16_f32 v198, v196, -v197
    v_mfma_f32_32x32x16_bf16 v[160:175], a[172:175], a[56:59], v[160:175]
    ds_read_b64_tr_b16 a[168:169], v7 offset:49152
    ds_read_b64_tr_b16 a[170:171], v7 offset:49664
    ds_write_b32 v234, v198 offset:1872
    v_fma_f32 v30, -v177, v45, v30
    v_fmac_f32 v46, v177, v29
    s_waitcnt lgkmcnt(7)
    v_mfma_f32_32x32x16_bf16 v[112:127], a[176:179], a[60:63], v[112:127]
    ds_read_b64_tr_b16 a[172:173], v7 offset:57344
    ds_read_b64_tr_b16 a[174:175], v7 offset:57856
    v_fma_f32 v30, v176, v29, v30
    v_fma_f32 v46, v176, v45, v46
    v_mul_f32 v192, v178, v30
    v_mul_f32 v193, v178, v46
    v_mfma_f32_32x32x16_bf16 v[128:143], a[180:183], a[60:63], v[128:143]
    ds_read_b64_tr_b16 a[176:177], v6 offset:51200
    ds_read_b64_tr_b16 a[178:179], v6 offset:51712
    v_fma_f32 v192, -v179, v46, v192
    v_fma_f32 v193, v179, v30, v193
    v_cvt_pk_bf16_f32 v194, v192, -v193
    ds_write_b32 v234, v194 offset:2016
    v_mfma_f32_32x32x16_bf16 v[144:159], a[184:187], a[60:63], v[144:159]
    ds_read_b64_tr_b16 a[180:181], v6 offset:59392
    ds_read_b64_tr_b16 a[182:183], v6 offset:59904
    buffer_load_dwordx4 a[248:251], v0, s[20:23], s28 offen offset:0 sc1
    v_fma_f32 v31, -v177, v46, v31
    v_fma_f32 v47, v177, v30, v47
    v_mfma_f32_32x32x16_bf16 v[160:175], a[188:191], a[60:63], v[160:175]
    ds_read_b64_tr_b16 a[184:185], v7 offset:51200
    ds_read_b64_tr_b16 a[186:187], v7 offset:51712
    v_fma_f32 v31, v176, v30, v31
    v_fma_f32 v47, v176, v46, v47
    v_mul_f32 v196, v178, v31
    s_waitcnt lgkmcnt(7)
    v_mfma_f32_32x32x16_bf16 v[112:127], a[160:163], a[64:67], v[112:127]
    ds_read_b64_tr_b16 a[188:189], v7 offset:59392
    ds_read_b64_tr_b16 a[190:191], v7 offset:59904
    v_mul_f32_e64 v197, v178, v47
    v_fma_f32 v196, -v179, v47, v196
    v_fma_f32 v197, v179, v31, v197
    v_cvt_pk_bf16_f32 v198, v196, -v197
    v_mfma_f32_32x32x16_bf16 v[128:143], a[164:167], a[64:67], v[128:143]
    ds_read_b64_tr_b16 a[160:161], v6 offset:53248
    ds_read_b64_tr_b16 a[162:163], v6 offset:53760
    ds_write_b32 v234, v198 offset:2160
    v_mfma_f32_32x32x16_bf16 v[144:159], a[168:171], a[64:67], v[144:159]
    ds_read_b64_tr_b16 a[164:165], v6 offset:61440
    ds_read_b64_tr_b16 a[166:167], v6 offset:61952
    v_mfma_f32_32x32x16_bf16 v[160:175], a[172:175], a[64:67], v[160:175]
    ds_read_b64_tr_b16 a[168:169], v7 offset:53248
    ds_read_b64_tr_b16 a[170:171], v7 offset:53760
    s_bfe_u32 s28, s24, 0x4000c
    s_mul_i32 s28, s28, 5120
    s_add_u32 s28, s28, s27
    buffer_load_dwordx4 a[252:255], v236, s[20:23], s28 offen offset:0 sc1
    s_waitcnt lgkmcnt(7)
    v_mfma_f32_32x32x16_bf16 v[112:127], a[176:179], a[68:71], v[112:127]
    ds_read_b64_tr_b16 a[172:173], v7 offset:61440
    ds_read_b64_tr_b16 a[174:175], v7 offset:61952
    v_mfma_f32_32x32x16_bf16 v[128:143], a[180:183], a[68:71], v[128:143]
    ds_read_b64_tr_b16 a[176:177], v6 offset:55296
    ds_read_b64_tr_b16 a[178:179], v6 offset:55808
    s_waitcnt lgkmcnt(8)
    s_nop 0
    ds_read_b128 v[200:203], v235 offset:0
    ds_read_b128 v[204:207], v235 offset:64
    ds_read_b128 v[208:211], v235 offset:2304
    ds_read_b128 v[212:215], v235 offset:2368
    v_mfma_f32_32x32x16_bf16 v[144:159], a[184:187], a[68:71], v[144:159]
    ds_read_b64_tr_b16 a[180:181], v6 offset:63488
    ds_read_b64_tr_b16 a[182:183], v6 offset:64000
    s_add_u32 s35, s80, 0
    s_lshl_b32 s35, s35, 13
    s_add_u32 s35, s35, s87
    s_add_u32 s35, s35, 221184
    v_mfma_f32_32x32x16_bf16 v[160:175], a[188:191], a[68:71], v[160:175]
    ds_read_b64_tr_b16 a[184:185], v7 offset:55296
    ds_read_b64_tr_b16 a[186:187], v7 offset:55808
    s_add_u32 s34, s35, 4096
    s_waitcnt lgkmcnt(10)
    v_mfma_f32_32x32x16_bf16 v[112:127], a[160:163], a[72:75], v[112:127]
    ds_read_b64_tr_b16 a[188:189], v7 offset:63488
    ds_read_b64_tr_b16 a[190:191], v7 offset:64000
    buffer_load_dwordx4 a[0:3], v236, s[20:23], s28 offen offset:1024 sc1
    v_mfma_f32_32x32x16_bf16 v[128:143], a[164:167], a[72:75], v[128:143]
    s_waitcnt vmcnt(33)
    s_barrier
    ds_read_b64_tr_b16 a[160:161], v8 offset:0
    ds_read_b64_tr_b16 a[162:163], v8 offset:512
    v_mfma_f32_32x32x16_bf16 v[144:159], a[168:171], a[72:75], v[144:159]
    ds_read_b64_tr_b16 a[164:165], v8 offset:8192
    ds_read_b64_tr_b16 a[166:167], v8 offset:8704
    v_mfma_f32_32x32x16_bf16 v[160:175], a[172:175], a[72:75], v[160:175]
    ds_read_b64_tr_b16 a[168:169], v9 offset:0
    ds_read_b64_tr_b16 a[170:171], v9 offset:512
    s_waitcnt lgkmcnt(6)
    s_nop 0
    v_mfma_f32_32x32x16_bf16 v[112:127], a[176:179], a[76:79], v[112:127]
    ds_read_b64_tr_b16 a[172:173], v9 offset:8192
    ds_read_b64_tr_b16 a[174:175], v9 offset:8704
    buffer_store_dwordx4 v[200:203], v236, s[20:23], s35 offen offset:0 sc1
    buffer_store_dwordx4 v[204:207], v236, s[20:23], s34 offen offset:0 sc1
    v_mfma_f32_32x32x16_bf16 v[128:143], a[180:183], a[76:79], v[128:143]
    ds_read_b64_tr_b16 a[176:177], v8 offset:2048
    ds_read_b64_tr_b16 a[178:179], v8 offset:2560
    buffer_load_dwordx4 a[4:7], v236, s[20:23], s28 offen offset:2048 sc1
    buffer_store_dwordx4 v[208:211], v236, s[20:23], s35 offen offset:1024 sc1
    v_mfma_f32_32x32x16_bf16 v[144:159], a[184:187], a[76:79], v[144:159]
    ds_read_b64_tr_b16 a[180:181], v8 offset:10240
    ds_read_b64_tr_b16 a[182:183], v8 offset:10752
    buffer_store_dwordx4 v[212:215], v236, s[20:23], s34 offen offset:1024 sc1
    v_mul_f32 v244, v48, v48
    v_mul_f32 v245, v49, v49
    v_mfma_f32_32x32x16_bf16 v[160:175], a[188:191], a[76:79], v[160:175]
    ds_read_b64_tr_b16 a[184:185], v9 offset:2048
    ds_read_b64_tr_b16 a[186:187], v9 offset:2560
    v_fma_f32 v244, v244, s88, v11
    v_fma_f32 v245, v245, s88, v11
    v_mul_f32 v244, v244, v48
    s_waitcnt lgkmcnt(6)
    v_mfma_f32_32x32x16_bf16 v[112:127], a[160:163], a[80:83], v[112:127]
    ds_read_b64_tr_b16 a[188:189], v9 offset:10240
    ds_read_b64_tr_b16 a[190:191], v9 offset:10752
    v_mul_f32 v245, v245, v49
    v_exp_f32 v244, v244
    v_mfma_f32_32x32x16_bf16 v[128:143], a[164:167], a[80:83], v[128:143]
    ds_read_b64_tr_b16 a[160:161], v8 offset:4096
    ds_read_b64_tr_b16 a[162:163], v8 offset:4608
    v_exp_f32_e64 v245, v245
    v_mul_f32 v64, v64, v48
    v_mul_f32 v65, v65, v49
    v_mfma_f32_32x32x16_bf16 v[144:159], a[168:171], a[80:83], v[144:159]
    ds_read_b64_tr_b16 a[164:165], v8 offset:12288
    ds_read_b64_tr_b16 a[166:167], v8 offset:12800
    buffer_load_dwordx4 a[8:11], v236, s[20:23], s28 offen offset:3072 sc1
    v_add_f32 v244, 1.0, v244
    v_add_f32 v245, 1.0, v245
    v_mfma_f32_32x32x16_bf16 v[160:175], a[172:175], a[80:83], v[160:175]
    ds_read_b64_tr_b16 a[168:169], v9 offset:4096
    ds_read_b64_tr_b16 a[170:171], v9 offset:4608
    v_rcp_f32 v244, v244
    s_waitcnt lgkmcnt(6)
    v_mfma_f32_32x32x16_bf16 v[112:127], a[176:179], a[84:87], v[112:127]
    ds_read_b64_tr_b16 a[172:173], v9 offset:12288
    ds_read_b64_tr_b16 a[174:175], v9 offset:12800
    v_rcp_f32_e64 v245, v245
    v_mul_f32 v64, v64, v244
    v_mul_f32 v65, v65, v245
    v_mfma_f32_32x32x16_bf16 v[128:143], a[180:183], a[84:87], v[128:143]
    ds_read_b64_tr_b16 a[176:177], v8 offset:6144
    ds_read_b64_tr_b16 a[178:179], v8 offset:6656
    v_cvt_pk_bf16_f32 v248, v64, v65
    v_mul_f32 v246, v50, v50
    v_mul_f32 v247, v51, v51
    v_fma_f32 v246, v246, s88, v11
    v_mfma_f32_32x32x16_bf16 v[144:159], a[184:187], a[84:87], v[144:159]
    ds_read_b64_tr_b16 a[180:181], v8 offset:14336
    ds_read_b64_tr_b16 a[182:183], v8 offset:14848
    v_fma_f32 v247, v247, s88, v11
    v_mul_f32 v246, v246, v50
    v_mul_f32 v247, v247, v51
    v_mfma_f32_32x32x16_bf16 v[160:175], a[188:191], a[84:87], v[160:175]
    ds_read_b64_tr_b16 a[184:185], v9 offset:6144
    ds_read_b64_tr_b16 a[186:187], v9 offset:6656
    buffer_load_dwordx4 a[12:15], v0, s[20:23], s28 offen offset:0 sc1
    v_exp_f32 v246, v246
    s_waitcnt lgkmcnt(6)
    v_mfma_f32_32x32x16_bf16 v[112:127], a[160:163], a[88:91], v[112:127]
    ds_read_b64_tr_b16 a[188:189], v9 offset:14336
    ds_read_b64_tr_b16 a[190:191], v9 offset:14848
    v_exp_f32_e64 v247, v247
    v_mul_f32 v66, v66, v50
    v_mul_f32 v67, v67, v51
    v_mfma_f32_32x32x16_bf16 v[128:143], a[164:167], a[88:91], v[128:143]
    s_waitcnt vmcnt(34)
    s_barrier
    ds_read_b64_tr_b16 a[160:161], v8 offset:16384
    ds_read_b64_tr_b16 a[162:163], v8 offset:16896
    v_add_f32 v246, 1.0, v246
    v_add_f32 v247, 1.0, v247
    v_mfma_f32_32x32x16_bf16 v[144:159], a[168:171], a[88:91], v[144:159]
    ds_read_b64_tr_b16 a[164:165], v8 offset:24576
    ds_read_b64_tr_b16 a[166:167], v8 offset:25088
    v_rcp_f32 v246, v246
    v_rcp_f32 v247, v247
    v_mfma_f32_32x32x16_bf16 v[160:175], a[172:175], a[88:91], v[160:175]
    ds_read_b64_tr_b16 a[168:169], v9 offset:16384
    ds_read_b64_tr_b16 a[170:171], v9 offset:16896
    v_mul_f32 v66, v66, v246
    v_mul_f32 v67, v67, v247
    v_cvt_pk_bf16_f32 v249, v66, v67
    s_waitcnt lgkmcnt(6)
    v_mfma_f32_32x32x16_bf16 v[112:127], a[176:179], a[92:95], v[112:127]
    ds_read_b64_tr_b16 a[172:173], v9 offset:24576
    ds_read_b64_tr_b16 a[174:175], v9 offset:25088
    s_bfe_u32 s28, s24, 0x40010
    s_mul_i32 s28, s28, 5120
    s_add_u32 s28, s28, s27
    buffer_load_dwordx4 a[16:19], v236, s[20:23], s28 offen offset:0 sc1
    v_mfma_f32_32x32x16_bf16 v[128:143], a[180:183], a[92:95], v[128:143]
    ds_read_b64_tr_b16 a[176:177], v8 offset:18432
    ds_read_b64_tr_b16 a[178:179], v8 offset:18944
    v_mul_f32 v244, v52, v52
    v_mul_f32 v245, v53, v53
    v_fma_f32 v244, v244, s88, v11
    v_fma_f32 v245, v245, s88, v11
    v_mfma_f32_32x32x16_bf16 v[144:159], a[184:187], a[92:95], v[144:159]
    ds_read_b64_tr_b16 a[180:181], v8 offset:26624
    ds_read_b64_tr_b16 a[182:183], v8 offset:27136
    v_mul_f32_e64 v244, v244, v52
    v_mul_f32 v245, v245, v53
    v_exp_f32 v244, v244
    v_mfma_f32_32x32x16_bf16 v[160:175], a[188:191], a[92:95], v[160:175]
    ds_read_b64_tr_b16 a[184:185], v9 offset:18432
    ds_read_b64_tr_b16 a[186:187], v9 offset:18944
    v_exp_f32_e64 v245, v245
    v_mul_f32 v68, v68, v52
    s_waitcnt lgkmcnt(6)
    v_mfma_f32_32x32x16_bf16 v[112:127], a[160:163], a[96:99], v[112:127]
    ds_read_b64_tr_b16 a[188:189], v9 offset:26624
    ds_read_b64_tr_b16 a[190:191], v9 offset:27136
    v_mul_f32_e64 v69, v69, v53
    v_add_f32 v244, 1.0, v244
    v_add_f32 v245, 1.0, v245
    v_mfma_f32_32x32x16_bf16 v[128:143], a[164:167], a[96:99], v[128:143]
    ds_read_b64_tr_b16 a[160:161], v8 offset:20480
    ds_read_b64_tr_b16 a[162:163], v8 offset:20992
    buffer_load_dwordx4 a[20:23], v236, s[20:23], s28 offen offset:1024 sc1
    v_rcp_f32_e64 v244, v244
    v_mfma_f32_32x32x16_bf16 v[144:159], a[168:171], a[96:99], v[144:159]
    ds_read_b64_tr_b16 a[164:165], v8 offset:28672
    ds_read_b64_tr_b16 a[166:167], v8 offset:29184
    v_rcp_f32_e64 v245, v245
    v_mul_f32 v68, v68, v244
    v_mul_f32 v69, v69, v245
    v_mfma_f32_32x32x16_bf16 v[160:175], a[172:175], a[96:99], v[160:175]
    ds_read_b64_tr_b16 a[168:169], v9 offset:20480
    ds_read_b64_tr_b16 a[170:171], v9 offset:20992
    v_cvt_pk_bf16_f32 v250, v68, v69
    v_mul_f32_e64 v246, v54, v54
    v_mul_f32 v247, v55, v55
    s_waitcnt lgkmcnt(6)
    v_mfma_f32_32x32x16_bf16 v[112:127], a[176:179], a[100:103], v[112:127]
    ds_read_b64_tr_b16 a[172:173], v9 offset:28672
    ds_read_b64_tr_b16 a[174:175], v9 offset:29184
    v_fma_f32 v246, v246, s88, v11
    v_fma_f32 v247, v247, s88, v11
    v_mul_f32 v246, v246, v54
    v_mul_f32 v247, v247, v55
    v_mfma_f32_32x32x16_bf16 v[128:143], a[180:183], a[100:103], v[128:143]
    ds_read_b64_tr_b16 a[176:177], v8 offset:22528
    ds_read_b64_tr_b16 a[178:179], v8 offset:23040
    v_exp_f32 v246, v246
    v_exp_f32 v247, v247
    v_mfma_f32_32x32x16_bf16 v[144:159], a[184:187], a[100:103], v[144:159]
    ds_read_b64_tr_b16 a[180:181], v8 offset:30720
    ds_read_b64_tr_b16 a[182:183], v8 offset:31232
    buffer_load_dwordx4 a[24:27], v236, s[20:23], s28 offen offset:2048 sc1
    v_mul_f32 v70, v70, v54
    v_mul_f32 v71, v71, v55
    v_mfma_f32_32x32x16_bf16 v[160:175], a[188:191], a[100:103], v[160:175]
    ds_read_b64_tr_b16 a[184:185], v9 offset:22528
    ds_read_b64_tr_b16 a[186:187], v9 offset:23040
    v_add_f32_e64 v246, 1.0, v246
    v_add_f32 v247, 1.0, v247
    s_waitcnt lgkmcnt(6)
    v_mfma_f32_32x32x16_bf16 v[112:127], a[160:163], a[104:107], v[112:127]
    ds_read_b64_tr_b16 a[188:189], v9 offset:30720
    ds_read_b64_tr_b16 a[190:191], v9 offset:31232
    v_rcp_f32 v246, v246
    v_rcp_f32 v247, v247
    v_mfma_f32_32x32x16_bf16 v[128:143], a[164:167], a[104:107], v[128:143]
    s_waitcnt vmcnt(29)
    s_barrier
    ds_read_b64_tr_b16 a[160:161], v8 offset:32768
    ds_read_b64_tr_b16 a[162:163], v8 offset:33280
    v_mul_f32 v70, v70, v246
    v_mul_f32 v71, v71, v247
    v_mfma_f32_32x32x16_bf16 v[144:159], a[168:171], a[104:107], v[144:159]
    ds_read_b64_tr_b16 a[164:165], v8 offset:40960
    ds_read_b64_tr_b16 a[166:167], v8 offset:41472
    v_cvt_pk_bf16_f32 v251, v70, v71
    buffer_store_dwordx4 v[248:251], v10, s[20:23], s90 offen offset:0 sc1
    v_mul_f32_e64 v244, v56, v56
    v_mfma_f32_32x32x16_bf16 v[160:175], a[172:175], a[104:107], v[160:175]
    ds_read_b64_tr_b16 a[168:169], v9 offset:32768
    ds_read_b64_tr_b16 a[170:171], v9 offset:33280
    buffer_load_dwordx4 a[28:31], v236, s[20:23], s28 offen offset:3072 sc1
    v_mul_f32 v245, v57, v57
    s_waitcnt lgkmcnt(6)
    v_mfma_f32_32x32x16_bf16 v[112:127], a[176:179], a[108:111], v[112:127]
    ds_read_b64_tr_b16 a[172:173], v9 offset:40960
    ds_read_b64_tr_b16 a[174:175], v9 offset:41472
    v_fma_f32 v244, v244, s88, v11
    v_fma_f32 v245, v245, s88, v11
    v_mul_f32 v244, v244, v56
    v_mul_f32 v245, v245, v57
    v_mfma_f32_32x32x16_bf16 v[128:143], a[180:183], a[108:111], v[128:143]
    ds_read_b64_tr_b16 a[176:177], v8 offset:34816
    ds_read_b64_tr_b16 a[178:179], v8 offset:35328
    v_exp_f32_e64 v244, v244
    v_exp_f32 v245, v245
    s_getpc_b64 s[100:101]
CT_K2A:
    s_add_u32 s100, s100, K2_START-CT_K2A
    s_addc_u32 s101, s101, 0
    s_mul_i32 s33, s4, 2048
    s_add_u32 s33, s33, 0
    v_lshl_add_u32 v230, v1, 7, s33
    v_min_u32 v230, TEXT_END-K2_START-4, v230
    s_mov_b64 exec, 0xffff
    global_load_dword v231, v230, s[100:101]
    s_mov_b64 exec, -1
    v_mfma_f32_32x32x16_bf16 v[144:159], a[184:187], a[108:111], v[144:159]
    ds_read_b64_tr_b16 a[180:181], v8 offset:43008
    ds_read_b64_tr_b16 a[182:183], v8 offset:43520
    v_mul_f32 v72, v72, v56
    v_mul_f32_e64 v73, v73, v57
    v_add_f32 v244, 1.0, v244
    v_add_f32 v245, 1.0, v245
    v_mfma_f32_32x32x16_bf16 v[160:175], a[188:191], a[108:111], v[160:175]
    ds_read_b64_tr_b16 a[184:185], v9 offset:34816
    ds_read_b64_tr_b16 a[186:187], v9 offset:35328
    v_rcp_f32 v244, v244
    s_waitcnt lgkmcnt(6)
    v_mfma_f32_32x32x16_bf16 v[112:127], a[160:163], a[112:115], v[112:127]
    ds_read_b64_tr_b16 a[188:189], v9 offset:43008
    ds_read_b64_tr_b16 a[190:191], v9 offset:43520
    buffer_load_dwordx4 a[32:35], v0, s[20:23], s28 offen offset:0 sc1
    v_rcp_f32_e64 v245, v245
    v_mfma_f32_32x32x16_bf16 v[128:143], a[164:167], a[112:115], v[128:143]
    ds_read_b64_tr_b16 a[160:161], v8 offset:36864
    ds_read_b64_tr_b16 a[162:163], v8 offset:37376
    v_mul_f32 v72, v72, v244
    v_mul_f32 v73, v73, v245
    v_cvt_pk_bf16_f32 v252, v72, v73
    v_mul_f32_e64 v246, v58, v58
    v_mfma_f32_32x32x16_bf16 v[144:159], a[168:171], a[112:115], v[144:159]
    ds_read_b64_tr_b16 a[164:165], v8 offset:45056
    ds_read_b64_tr_b16 a[166:167], v8 offset:45568
    v_mul_f32_e64 v247, v59, v59
    v_fma_f32 v246, v246, s88, v11
    v_fma_f32 v247, v247, s88, v11
    v_mul_f32_e64 v246, v246, v58
    v_mfma_f32_32x32x16_bf16 v[160:175], a[172:175], a[112:115], v[160:175]
    ds_read_b64_tr_b16 a[168:169], v9 offset:36864
    ds_read_b64_tr_b16 a[170:171], v9 offset:37376
    v_mul_f32_e64 v247, v247, v59
    v_exp_f32 v246, v246
    s_waitcnt lgkmcnt(6)
    v_mfma_f32_32x32x16_bf16 v[112:127], a[176:179], a[116:119], v[112:127]
    ds_read_b64_tr_b16 a[172:173], v9 offset:45056
    ds_read_b64_tr_b16 a[174:175], v9 offset:45568
    v_exp_f32_e64 v247, v247
    v_mul_f32 v74, v74, v58
    v_mul_f32 v75, v75, v59
    v_mfma_f32_32x32x16_bf16 v[128:143], a[180:183], a[116:119], v[128:143]
    ds_read_b64_tr_b16 a[176:177], v8 offset:38912
    ds_read_b64_tr_b16 a[178:179], v8 offset:39424
    s_bfe_u32 s28, s24, 0x40014
    s_mul_i32 s28, s28, 5120
    s_add_u32 s28, s28, s27
    buffer_load_dwordx4 a[36:39], v236, s[20:23], s28 offen offset:0 sc1
    v_mfma_f32_32x32x16_bf16 v[144:159], a[184:187], a[116:119], v[144:159]
    ds_read_b64_tr_b16 a[180:181], v8 offset:47104
    ds_read_b64_tr_b16 a[182:183], v8 offset:47616
    v_add_f32 v246, 1.0, v246
    v_add_f32 v247, 1.0, v247
    v_rcp_f32 v246, v246
    v_mfma_f32_32x32x16_bf16 v[160:175], a[188:191], a[116:119], v[160:175]
    ds_read_b64_tr_b16 a[184:185], v9 offset:38912
    ds_read_b64_tr_b16 a[186:187], v9 offset:39424
    v_rcp_f32_e64 v247, v247
    v_mul_f32 v74, v74, v246
    s_waitcnt lgkmcnt(6)
    v_mfma_f32_32x32x16_bf16 v[112:127], a[160:163], a[120:123], v[112:127]
    ds_read_b64_tr_b16 a[188:189], v9 offset:47104
    ds_read_b64_tr_b16 a[190:191], v9 offset:47616
    v_mul_f32_e64 v75, v75, v247
    v_cvt_pk_bf16_f32 v253, v74, v75
    v_mul_f32 v244, v60, v60
    v_mul_f32 v245, v61, v61
    v_mfma_f32_32x32x16_bf16 v[128:143], a[164:167], a[120:123], v[128:143]
    s_waitcnt vmcnt(26)
    s_barrier
    ds_read_b64_tr_b16 a[160:161], v8 offset:49152
    ds_read_b64_tr_b16 a[162:163], v8 offset:49664
    v_fma_f32 v244, v244, s88, v11
    v_fma_f32 v245, v245, s88, v11
    v_mfma_f32_32x32x16_bf16 v[144:159], a[168:171], a[120:123], v[144:159]
    ds_read_b64_tr_b16 a[164:165], v8 offset:57344
    ds_read_b64_tr_b16 a[166:167], v8 offset:57856
    buffer_load_dwordx4 a[40:43], v236, s[20:23], s28 offen offset:1024 sc1
    v_mul_f32 v244, v244, v60
    v_mul_f32 v245, v245, v61
    v_mfma_f32_32x32x16_bf16 v[160:175], a[172:175], a[120:123], v[160:175]
    ds_read_b64_tr_b16 a[168:169], v9 offset:49152
    ds_read_b64_tr_b16 a[170:171], v9 offset:49664
    v_exp_f32 v244, v244
    s_waitcnt lgkmcnt(6)
    v_mfma_f32_32x32x16_bf16 v[112:127], a[176:179], a[124:127], v[112:127]
    ds_read_b64_tr_b16 a[172:173], v9 offset:57344
    ds_read_b64_tr_b16 a[174:175], v9 offset:57856
    v_exp_f32_e64 v245, v245
    v_mul_f32 v76, v76, v60
    v_mul_f32 v77, v77, v61
    v_mfma_f32_32x32x16_bf16 v[128:143], a[180:183], a[124:127], v[128:143]
    ds_read_b64_tr_b16 a[176:177], v8 offset:51200
    ds_read_b64_tr_b16 a[178:179], v8 offset:51712
    v_add_f32_e64 v244, 1.0, v244
    v_add_f32 v245, 1.0, v245
    v_rcp_f32 v244, v244
    v_mfma_f32_32x32x16_bf16 v[144:159], a[184:187], a[124:127], v[144:159]
    ds_read_b64_tr_b16 a[180:181], v8 offset:59392
    ds_read_b64_tr_b16 a[182:183], v8 offset:59904
    v_rcp_f32_e64 v245, v245
    v_mul_f32 v76, v76, v244
    v_mul_f32 v77, v77, v245
    v_mfma_f32_32x32x16_bf16 v[160:175], a[188:191], a[124:127], v[160:175]
    ds_read_b64_tr_b16 a[184:185], v9 offset:51200
    ds_read_b64_tr_b16 a[186:187], v9 offset:51712
    buffer_load_dwordx4 a[44:47], v236, s[20:23], s28 offen offset:2048 sc1
    v_cvt_pk_bf16_f32 v254, v76, v77
    s_waitcnt lgkmcnt(6)
    v_mfma_f32_32x32x16_bf16 v[112:127], a[160:163], a[128:131], v[112:127]
    ds_read_b64_tr_b16 a[188:189], v9 offset:59392
    ds_read_b64_tr_b16 a[190:191], v9 offset:59904
    v_mul_f32 v246, v62, v62
    v_mul_f32_e64 v247, v63, v63
    v_fma_f32 v246, v246, s88, v11
    v_fma_f32 v247, v247, s88, v11
    v_mfma_f32_32x32x16_bf16 v[128:143], a[164:167], a[128:131], v[128:143]
    ds_read_b64_tr_b16 a[160:161], v8 offset:53248
    ds_read_b64_tr_b16 a[162:163], v8 offset:53760
    v_mul_f32_e64 v246, v246, v62
    v_mul_f32 v247, v247, v63
    v_exp_f32 v246, v246
    v_mfma_f32_32x32x16_bf16 v[144:159], a[168:171], a[128:131], v[144:159]
    ds_read_b64_tr_b16 a[164:165], v8 offset:61440
    ds_read_b64_tr_b16 a[166:167], v8 offset:61952
    v_exp_f32_e64 v247, v247
    v_mul_f32 v78, v78, v62
    v_mul_f32 v79, v79, v63
    v_mfma_f32_32x32x16_bf16 v[160:175], a[172:175], a[128:131], v[160:175]
    ds_read_b64_tr_b16 a[168:169], v9 offset:53248
    ds_read_b64_tr_b16 a[170:171], v9 offset:53760
    v_add_f32_e64 v246, 1.0, v246
    v_add_f32 v247, 1.0, v247
    s_waitcnt lgkmcnt(6)
    v_mfma_f32_32x32x16_bf16 v[112:127], a[176:179], a[132:135], v[112:127]
    ds_read_b64_tr_b16 a[172:173], v9 offset:61440
    ds_read_b64_tr_b16 a[174:175], v9 offset:61952
    buffer_load_dwordx4 a[48:51], v236, s[20:23], s28 offen offset:3072 sc1
    v_rcp_f32_e64 v246, v246
    v_mfma_f32_32x32x16_bf16 v[128:143], a[180:183], a[132:135], v[128:143]
    ds_read_b64_tr_b16 a[176:177], v8 offset:55296
    ds_read_b64_tr_b16 a[178:179], v8 offset:55808
    v_rcp_f32_e64 v247, v247
    v_mul_f32 v78, v78, v246
    v_mul_f32 v79, v79, v247
    v_mfma_f32_32x32x16_bf16 v[144:159], a[184:187], a[132:135], v[144:159]
    ds_read_b64_tr_b16 a[180:181], v8 offset:63488
    ds_read_b64_tr_b16 a[182:183], v8 offset:64000
    v_cvt_pk_bf16_f32 v255, v78, v79
    buffer_store_dwordx4 v[252:255], v10, s[20:23], s90 offen offset:512 sc1
    v_mul_f32_e64 v244, v80, v80
    v_mfma_f32_32x32x16_bf16 v[160:175], a[188:191], a[132:135], v[160:175]
    ds_read_b64_tr_b16 a[184:185], v9 offset:55296
    ds_read_b64_tr_b16 a[186:187], v9 offset:55808
    v_mul_f32 v245, v81, v81
    v_fma_f32 v244, v244, s88, v11
    v_fma_f32 v245, v245, s88, v11
    s_waitcnt lgkmcnt(6)
    v_mfma_f32_32x32x16_bf16 v[112:127], a[160:163], a[136:139], v[112:127]
    ds_read_b64_tr_b16 a[188:189], v9 offset:63488
    ds_read_b64_tr_b16 a[190:191], v9 offset:64000
    v_mul_f32_e64 v244, v244, v80
    v_mul_f32 v245, v245, v81
    v_exp_f32 v244, v244
    v_mfma_f32_32x32x16_bf16 v[128:143], a[164:167], a[136:139], v[128:143]
    s_waitcnt vmcnt(22)
    s_barrier
    ds_read_b64_tr_b16 a[160:161], v6 offset:0
    ds_read_b64_tr_b16 a[162:163], v6 offset:512
    buffer_load_dwordx4 a[52:55], v0, s[20:23], s28 offen offset:0 sc1
    v_mfma_f32_32x32x16_bf16 v[144:159], a[168:171], a[136:139], v[144:159]
    ds_read_b64_tr_b16 a[164:165], v6 offset:8192
    ds_read_b64_tr_b16 a[166:167], v6 offset:8704
    v_exp_f32_e64 v245, v245
    v_mul_f32 v96, v96, v80
    v_mul_f32 v97, v97, v81
    v_mfma_f32_32x32x16_bf16 v[160:175], a[172:175], a[136:139], v[160:175]
    ds_read_b64_tr_b16 a[168:169], v7 offset:0
    ds_read_b64_tr_b16 a[170:171], v7 offset:512
    v_add_f32_e64 v244, 1.0, v244
    v_add_f32 v245, 1.0, v245
    s_waitcnt lgkmcnt(6)
    v_mfma_f32_32x32x16_bf16 v[112:127], a[176:179], a[140:143], v[112:127]
    ds_read_b64_tr_b16 a[172:173], v7 offset:8192
    ds_read_b64_tr_b16 a[174:175], v7 offset:8704
    v_rcp_f32 v244, v244
    v_rcp_f32 v245, v245
    v_mfma_f32_32x32x16_bf16 v[128:143], a[180:183], a[140:143], v[128:143]
    ds_read_b64_tr_b16 a[176:177], v6 offset:2048
    ds_read_b64_tr_b16 a[178:179], v6 offset:2560
    v_mul_f32 v96, v96, v244
    v_mul_f32 v97, v97, v245
    v_cvt_pk_bf16_f32 v248, v96, v97
    v_mul_f32_e64 v246, v82, v82
    v_mfma_f32_32x32x16_bf16 v[144:159], a[184:187], a[140:143], v[144:159]
    ds_read_b64_tr_b16 a[180:181], v6 offset:10240
    ds_read_b64_tr_b16 a[182:183], v6 offset:10752
    s_bfe_u32 s28, s24, 0x40018
    s_mul_i32 s28, s28, 5120
    s_add_u32 s28, s28, s27
    buffer_load_dwordx4 a[56:59], v236, s[20:23], s28 offen offset:0 sc1
    v_mfma_f32_32x32x16_bf16 v[160:175], a[188:191], a[140:143], v[160:175]
    ds_read_b64_tr_b16 a[184:185], v7 offset:2048
    ds_read_b64_tr_b16 a[186:187], v7 offset:2560
    v_mul_f32 v247, v83, v83
    v_fma_f32 v246, v246, s88, v11
    v_fma_f32 v247, v247, s88, v11
    s_waitcnt lgkmcnt(6)
    v_mfma_f32_32x32x16_bf16 v[112:127], a[160:163], a[144:147], v[112:127]
    ds_read_b64_tr_b16 a[188:189], v7 offset:10240
    ds_read_b64_tr_b16 a[190:191], v7 offset:10752
    v_mul_f32 v246, v246, v82
    v_mul_f32 v247, v247, v83
    v_exp_f32 v246, v246
    v_mfma_f32_32x32x16_bf16 v[128:143], a[164:167], a[144:147], v[128:143]
    ds_read_b64_tr_b16 a[160:161], v6 offset:4096
    ds_read_b64_tr_b16 a[162:163], v6 offset:4608
    v_exp_f32_e64 v247, v247
    v_mul_f32 v98, v98, v82
    v_mul_f32 v99, v99, v83
    v_mfma_f32_32x32x16_bf16 v[144:159], a[168:171], a[144:147], v[144:159]
    ds_read_b64_tr_b16 a[164:165], v6 offset:12288
    ds_read_b64_tr_b16 a[166:167], v6 offset:12800
    v_add_f32_e64 v246, 1.0, v246
    v_add_f32 v247, 1.0, v247
    v_rcp_f32 v246, v246
    v_mfma_f32_32x32x16_bf16 v[160:175], a[172:175], a[144:147], v[160:175]
    ds_read_b64_tr_b16 a[168:169], v7 offset:4096
    ds_read_b64_tr_b16 a[170:171], v7 offset:4608
    buffer_load_dwordx4 a[60:63], v236, s[20:23], s28 offen offset:1024 sc1
    s_waitcnt lgkmcnt(6)
    v_mfma_f32_32x32x16_bf16 v[112:127], a[176:179], a[148:151], v[112:127]
    ds_read_b64_tr_b16 a[172:173], v7 offset:12288
    ds_read_b64_tr_b16 a[174:175], v7 offset:12800
    v_rcp_f32 v247, v247
    v_mul_f32 v98, v98, v246
    v_mul_f32 v99, v99, v247
    v_mfma_f32_32x32x16_bf16 v[128:143], a[180:183], a[148:151], v[128:143]
    ds_read_b64_tr_b16 a[176:177], v6 offset:6144
    ds_read_b64_tr_b16 a[178:179], v6 offset:6656
    v_cvt_pk_bf16_f32 v249, v98, v99
    v_mul_f32 v244, v84, v84
    v_mul_f32 v245, v85, v85
    v_fma_f32 v244, v244, s88, v11
    v_mfma_f32_32x32x16_bf16 v[144:159], a[184:187], a[148:151], v[144:159]
    ds_read_b64_tr_b16 a[180:181], v6 offset:14336
    ds_read_b64_tr_b16 a[182:183], v6 offset:14848
    v_fma_f32 v245, v245, s88, v11
    v_mul_f32 v244, v244, v84
    v_mul_f32 v245, v245, v85
    v_mfma_f32_32x32x16_bf16 v[160:175], a[188:191], a[148:151], v[160:175]
    ds_read_b64_tr_b16 a[184:185], v7 offset:6144
    ds_read_b64_tr_b16 a[186:187], v7 offset:6656
    v_exp_f32 v244, v244
    s_waitcnt lgkmcnt(6)
    v_mfma_f32_32x32x16_bf16 v[112:127], a[160:163], a[152:155], v[112:127]
    ds_read_b64_tr_b16 a[188:189], v7 offset:14336
    ds_read_b64_tr_b16 a[190:191], v7 offset:14848
    buffer_load_dwordx4 a[64:67], v236, s[20:23], s28 offen offset:2048 sc1
    v_exp_f32_e64 v245, v245
    v_mfma_f32_32x32x16_bf16 v[128:143], a[164:167], a[152:155], v[128:143]
    v_mul_f32_e64 v100, v100, v84
    v_mul_f32 v101, v101, v85
    v_add_f32 v244, 1.0, v244
    v_add_f32 v245, 1.0, v245
    v_rcp_f32 v244, v244
    v_mfma_f32_32x32x16_bf16 v[144:159], a[168:171], a[152:155], v[144:159]
    v_rcp_f32_e64 v245, v245
    v_mul_f32 v100, v100, v244
    v_mul_f32 v101, v101, v245
    v_cvt_pk_bf16_f32 v250, v100, v101
    v_mul_f32_e64 v246, v86, v86
    v_mfma_f32_32x32x16_bf16 v[160:175], a[172:175], a[152:155], v[160:175]
    v_mul_f32_e64 v247, v87, v87
    v_fma_f32 v246, v246, s88, v11
    v_fma_f32 v247, v247, s88, v11
    v_mul_f32_e64 v246, v246, v86
    v_mul_f32 v247, v247, v87
    s_waitcnt lgkmcnt(0)
    v_mfma_f32_32x32x16_bf16 v[112:127], a[176:179], a[156:159], v[112:127]
    v_exp_f32 v246, v246
    v_exp_f32 v247, v247
    v_mul_f32 v102, v102, v86
    v_mul_f32 v103, v103, v87
    v_mfma_f32_32x32x16_bf16 v[128:143], a[180:183], a[156:159], v[128:143]
    buffer_load_dwordx4 a[68:71], v236, s[20:23], s28 offen offset:3072 sc1
    v_add_f32_e64 v246, 1.0, v246
    v_add_f32 v247, 1.0, v247
    v_rcp_f32 v246, v246
    v_mfma_f32_32x32x16_bf16 v[144:159], a[184:187], a[156:159], v[144:159]
    v_rcp_f32_e64 v247, v247
    v_mul_f32 v102, v102, v246
    v_mul_f32 v103, v103, v247
    v_cvt_pk_bf16_f32 v251, v102, v103
    s_add_u32 s90, s90, 4096
    v_mfma_f32_32x32x16_bf16 v[160:175], a[188:191], a[156:159], v[160:175]
    buffer_store_dwordx4 v[248:251], v10, s[20:23], s90 offen offset:0 sc1
    v_mul_f32 v244, v88, v88
    v_mul_f32 v245, v89, v89
    v_fma_f32 v244, v244, s88, v11
    v_fma_f32 v245, v245, s88, v11
    v_mul_f32 v244, v244, v88
    v_mul_f32 v245, v245, v89
    v_exp_f32 v244, v244
    v_exp_f32 v245, v245
    v_mul_f32 v104, v104, v88
    v_mul_f32 v105, v105, v89
    v_add_f32 v244, 1.0, v244
    v_add_f32 v245, 1.0, v245
    v_rcp_f32 v244, v244
    v_rcp_f32 v245, v245
    v_mul_f32 v104, v104, v244
    v_mul_f32 v105, v105, v245
    v_cvt_pk_bf16_f32 v252, v104, v105
    v_mul_f32 v246, v90, v90
    v_mul_f32 v247, v91, v91
    v_fma_f32 v246, v246, s88, v11
    v_fma_f32 v247, v247, s88, v11
    v_mul_f32 v246, v246, v90
    v_mul_f32 v247, v247, v91
    v_exp_f32 v246, v246
    v_exp_f32 v247, v247
    v_mul_f32 v106, v106, v90
    v_mul_f32 v107, v107, v91
    v_add_f32 v246, 1.0, v246
    v_add_f32 v247, 1.0, v247
    v_rcp_f32 v246, v246
    v_rcp_f32 v247, v247
    v_mul_f32 v106, v106, v246
    v_mul_f32 v107, v107, v247
    v_cvt_pk_bf16_f32 v253, v106, v107
    v_mul_f32 v244, v92, v92
    v_mul_f32 v245, v93, v93
    v_fma_f32 v244, v244, s88, v11
    v_fma_f32 v245, v245, s88, v11
    v_mul_f32 v244, v244, v92
    v_mul_f32 v245, v245, v93
    v_exp_f32 v244, v244
    v_exp_f32 v245, v245
    v_mul_f32 v108, v108, v92
    v_mul_f32 v109, v109, v93
    v_add_f32 v244, 1.0, v244
    v_add_f32 v245, 1.0, v245
    v_rcp_f32 v244, v244
    v_rcp_f32 v245, v245
    v_mul_f32 v108, v108, v244
    v_mul_f32 v109, v109, v245
    v_cvt_pk_bf16_f32 v254, v108, v109
    v_mul_f32 v246, v94, v94
    v_mul_f32 v247, v95, v95
    v_fma_f32 v246, v246, s88, v11
    v_fma_f32 v247, v247, s88, v11
    v_mul_f32 v246, v246, v94
    v_mul_f32 v247, v247, v95
    v_exp_f32 v246, v246
    v_exp_f32 v247, v247
    v_mul_f32 v110, v110, v94
    v_mul_f32 v111, v111, v95
    v_add_f32 v246, 1.0, v246
    v_add_f32 v247, 1.0, v247
    v_rcp_f32 v246, v246
    v_rcp_f32 v247, v247
    v_mul_f32 v110, v110, v246
    v_mul_f32 v111, v111, v247
    v_cvt_pk_bf16_f32 v255, v110, v111
    buffer_store_dwordx4 v[252:255], v10, s[20:23], s90 offen offset:512 sc1
    v_mov_b32 v16, v11
    v_mov_b32 v17, v11
    v_mov_b32 v18, s88
    v_mov_b32 v19, s88
    v_mov_b32 v20, 1.0
    v_mov_b32 v21, 1.0
    v_pk_mul_f32 v[22:23], v[112:113], v[112:113]
    v_pk_mul_f32 v[24:25], v[114:115], v[114:115]
    v_pk_mul_f32 v[26:27], v[116:117], v[116:117]
    v_pk_mul_f32 v[28:29], v[118:119], v[118:119]
    v_pk_fma_f32 v[22:23], v[22:23], v[18:19], v[16:17]
    v_pk_fma_f32 v[24:25], v[24:25], v[18:19], v[16:17]
    v_pk_fma_f32 v[26:27], v[26:27], v[18:19], v[16:17]
    v_pk_fma_f32 v[28:29], v[28:29], v[18:19], v[16:17]
    v_pk_mul_f32 v[22:23], v[22:23], v[112:113]
    v_pk_mul_f32 v[24:25], v[24:25], v[114:115]
    v_pk_mul_f32 v[26:27], v[26:27], v[116:117]
    v_pk_mul_f32 v[28:29], v[28:29], v[118:119]
    v_exp_f32_e64 v22, v22
    v_pk_mul_f32 v[128:129], v[128:129], v[112:113]
    v_exp_f32 v23, v23
    v_exp_f32 v24, v24
    v_pk_mul_f32 v[130:131], v[130:131], v[114:115]
    v_exp_f32 v25, v25
    v_exp_f32 v26, v26
    v_pk_mul_f32 v[132:133], v[132:133], v[116:117]
    v_exp_f32 v27, v27
    v_exp_f32 v28, v28
    v_pk_mul_f32 v[134:135], v[134:135], v[118:119]
    v_exp_f32_e64 v29, v29
    v_pk_add_f32 v[22:23], v[22:23], v[20:21]
    v_pk_add_f32 v[24:25], v[24:25], v[20:21]
    v_pk_add_f32 v[26:27], v[26:27], v[20:21]
    v_pk_add_f32 v[28:29], v[28:29], v[20:21]
    v_rcp_f32_e64 v22, v22
    v_rcp_f32 v23, v23
    v_rcp_f32 v24, v24
    v_pk_mul_f32 v[128:129], v[128:129], v[22:23]
    v_rcp_f32_e64 v25, v25
    v_cvt_pk_bf16_f32 v248, v128, v129
    v_rcp_f32_e64 v26, v26
    v_pk_mul_f32 v[130:131], v[130:131], v[24:25]
    v_rcp_f32_e64 v27, v27
    v_cvt_pk_bf16_f32 v249, v130, v131
    v_rcp_f32_e64 v28, v28
    v_pk_mul_f32 v[132:133], v[132:133], v[26:27]
    v_rcp_f32 v29, v29
    v_cvt_pk_bf16_f32 v250, v132, v133
    buffer_load_dwordx4 a[72:75], v0, s[20:23], s28 offen offset:0 sc1
    s_bfe_u32 s28, s24, 0x4001c
    s_mul_i32 s28, s28, 5120
    s_add_u32 s28, s28, s27
    buffer_load_dwordx4 a[76:79], v236, s[20:23], s28 offen offset:0 sc1
    buffer_load_dwordx4 a[80:83], v236, s[20:23], s28 offen offset:1024 sc1
    buffer_load_dwordx4 a[84:87], v236, s[20:23], s28 offen offset:2048 sc1
    buffer_load_dwordx4 a[88:91], v236, s[20:23], s28 offen offset:3072 sc1
    v_pk_mul_f32 v[134:135], v[134:135], v[28:29]
    v_cvt_pk_bf16_f32 v251, v134, v135
    buffer_store_dwordx4 v[248:251], v10, s[20:23], s91 offen offset:0 sc1
    v_pk_mul_f32 v[22:23], v[120:121], v[120:121]
    v_pk_mul_f32 v[24:25], v[122:123], v[122:123]
    v_pk_mul_f32 v[26:27], v[124:125], v[124:125]
    v_pk_mul_f32 v[28:29], v[126:127], v[126:127]
    v_pk_fma_f32 v[22:23], v[22:23], v[18:19], v[16:17]
    v_pk_fma_f32 v[24:25], v[24:25], v[18:19], v[16:17]
    v_pk_fma_f32 v[26:27], v[26:27], v[18:19], v[16:17]
    v_pk_fma_f32 v[28:29], v[28:29], v[18:19], v[16:17]
    v_pk_mul_f32 v[22:23], v[22:23], v[120:121]
    v_pk_mul_f32 v[24:25], v[24:25], v[122:123]
    v_pk_mul_f32 v[26:27], v[26:27], v[124:125]
    v_pk_mul_f32 v[28:29], v[28:29], v[126:127]
    v_exp_f32_e64 v22, v22
    v_pk_mul_f32 v[136:137], v[136:137], v[120:121]
    v_exp_f32 v23, v23
    v_exp_f32 v24, v24
    v_pk_mul_f32 v[138:139], v[138:139], v[122:123]
    v_exp_f32 v25, v25
    v_exp_f32 v26, v26
    v_pk_mul_f32 v[140:141], v[140:141], v[124:125]
    v_exp_f32 v27, v27
    v_exp_f32 v28, v28
    v_pk_mul_f32 v[142:143], v[142:143], v[126:127]
    v_exp_f32_e64 v29, v29
    v_pk_add_f32 v[22:23], v[22:23], v[20:21]
    v_pk_add_f32 v[24:25], v[24:25], v[20:21]
    v_pk_add_f32 v[26:27], v[26:27], v[20:21]
    v_pk_add_f32 v[28:29], v[28:29], v[20:21]
    v_rcp_f32_e64 v22, v22
    v_rcp_f32 v23, v23
    v_rcp_f32 v24, v24
    v_pk_mul_f32 v[136:137], v[136:137], v[22:23]
    v_rcp_f32_e64 v25, v25
    v_cvt_pk_bf16_f32 v252, v136, v137
    v_rcp_f32_e64 v26, v26
    v_pk_mul_f32 v[138:139], v[138:139], v[24:25]
    v_rcp_f32_e64 v27, v27
    v_cvt_pk_bf16_f32 v253, v138, v139
    v_rcp_f32_e64 v28, v28
    v_pk_mul_f32 v[140:141], v[140:141], v[26:27]
    v_rcp_f32 v29, v29
    v_cvt_pk_bf16_f32 v254, v140, v141
    buffer_load_dwordx4 a[92:95], v0, s[20:23], s28 offen offset:0 sc1
    s_bfe_u32 s28, s25, 0x40000
    s_mul_i32 s28, s28, 5120
    s_add_u32 s28, s28, s27
    buffer_load_dwordx4 a[96:99], v236, s[20:23], s28 offen offset:0 sc1
    buffer_load_dwordx4 a[100:103], v236, s[20:23], s28 offen offset:1024 sc1
    buffer_load_dwordx4 a[104:107], v236, s[20:23], s28 offen offset:2048 sc1
    buffer_load_dwordx4 a[108:111], v236, s[20:23], s28 offen offset:3072 sc1
    v_pk_mul_f32 v[142:143], v[142:143], v[28:29]
    v_cvt_pk_bf16_f32 v255, v142, v143
    buffer_store_dwordx4 v[252:255], v10, s[20:23], s91 offen offset:512 sc1
    v_pk_mul_f32 v[22:23], v[144:145], v[144:145]
    v_pk_mul_f32 v[24:25], v[146:147], v[146:147]
    v_pk_mul_f32 v[26:27], v[148:149], v[148:149]
    v_pk_mul_f32 v[28:29], v[150:151], v[150:151]
    v_pk_fma_f32 v[22:23], v[22:23], v[18:19], v[16:17]
    v_pk_fma_f32 v[24:25], v[24:25], v[18:19], v[16:17]
    v_pk_fma_f32 v[26:27], v[26:27], v[18:19], v[16:17]
    v_pk_fma_f32 v[28:29], v[28:29], v[18:19], v[16:17]
    v_pk_mul_f32 v[22:23], v[22:23], v[144:145]
    v_pk_mul_f32 v[24:25], v[24:25], v[146:147]
    v_pk_mul_f32 v[26:27], v[26:27], v[148:149]
    v_pk_mul_f32 v[28:29], v[28:29], v[150:151]
    v_exp_f32_e64 v22, v22
    v_pk_mul_f32 v[160:161], v[160:161], v[144:145]
    v_exp_f32 v23, v23
    v_exp_f32 v24, v24
    v_pk_mul_f32 v[162:163], v[162:163], v[146:147]
    v_exp_f32 v25, v25
    v_exp_f32 v26, v26
    v_pk_mul_f32 v[164:165], v[164:165], v[148:149]
    v_exp_f32 v27, v27
    v_exp_f32 v28, v28
    v_pk_mul_f32 v[166:167], v[166:167], v[150:151]
    v_exp_f32_e64 v29, v29
    v_pk_add_f32 v[22:23], v[22:23], v[20:21]
    v_pk_add_f32 v[24:25], v[24:25], v[20:21]
    v_pk_add_f32 v[26:27], v[26:27], v[20:21]
    v_pk_add_f32 v[28:29], v[28:29], v[20:21]
    v_rcp_f32_e64 v22, v22
    v_rcp_f32 v23, v23
    v_rcp_f32 v24, v24
    v_pk_mul_f32 v[160:161], v[160:161], v[22:23]
    v_rcp_f32_e64 v25, v25
    v_cvt_pk_bf16_f32 v248, v160, v161
    v_rcp_f32_e64 v26, v26
    v_pk_mul_f32 v[162:163], v[162:163], v[24:25]
    v_rcp_f32_e64 v27, v27
    v_cvt_pk_bf16_f32 v249, v162, v163
    v_rcp_f32_e64 v28, v28
    v_pk_mul_f32 v[164:165], v[164:165], v[26:27]
    v_rcp_f32_e64 v29, v29
    v_cvt_pk_bf16_f32 v250, v164, v165
    s_add_u32 s91, s91, 4096
    v_pk_mul_f32 v[166:167], v[166:167], v[28:29]
    v_cvt_pk_bf16_f32 v251, v166, v167
    buffer_store_dwordx4 v[248:251], v10, s[20:23], s91 offen offset:0 sc1
    v_pk_mul_f32 v[22:23], v[152:153], v[152:153]
    v_pk_mul_f32 v[24:25], v[154:155], v[154:155]
    v_pk_mul_f32 v[26:27], v[156:157], v[156:157]
    v_pk_mul_f32 v[28:29], v[158:159], v[158:159]
    v_pk_fma_f32 v[22:23], v[22:23], v[18:19], v[16:17]
    v_pk_fma_f32 v[24:25], v[24:25], v[18:19], v[16:17]
    v_pk_fma_f32 v[26:27], v[26:27], v[18:19], v[16:17]
    v_pk_fma_f32 v[28:29], v[28:29], v[18:19], v[16:17]
    v_pk_mul_f32 v[22:23], v[22:23], v[152:153]
    v_pk_mul_f32 v[24:25], v[24:25], v[154:155]
    v_pk_mul_f32 v[26:27], v[26:27], v[156:157]
    v_pk_mul_f32 v[28:29], v[28:29], v[158:159]
    v_exp_f32_e64 v22, v22
    v_pk_mul_f32 v[168:169], v[168:169], v[152:153]
    v_exp_f32 v23, v23
    v_exp_f32 v24, v24
    v_pk_mul_f32 v[170:171], v[170:171], v[154:155]
    v_exp_f32 v25, v25
    v_exp_f32 v26, v26
    v_pk_mul_f32 v[172:173], v[172:173], v[156:157]
    v_exp_f32 v27, v27
    v_exp_f32 v28, v28
    v_pk_mul_f32 v[174:175], v[174:175], v[158:159]
    v_exp_f32_e64 v29, v29
    v_pk_add_f32 v[22:23], v[22:23], v[20:21]
    v_pk_add_f32 v[24:25], v[24:25], v[20:21]
    v_pk_add_f32 v[26:27], v[26:27], v[20:21]
    v_pk_add_f32 v[28:29], v[28:29], v[20:21]
    v_rcp_f32_e64 v22, v22
    v_rcp_f32 v23, v23
    v_rcp_f32 v24, v24
    v_pk_mul_f32 v[168:169], v[168:169], v[22:23]
    v_rcp_f32_e64 v25, v25
    v_cvt_pk_bf16_f32 v252, v168, v169
    v_rcp_f32_e64 v26, v26
    v_pk_mul_f32 v[170:171], v[170:171], v[24:25]
    v_rcp_f32_e64 v27, v27
    v_cvt_pk_bf16_f32 v253, v170, v171
    v_rcp_f32_e64 v28, v28
    v_pk_mul_f32 v[172:173], v[172:173], v[26:27]
    v_rcp_f32_e64 v29, v29
    v_cvt_pk_bf16_f32 v254, v172, v173
    v_pk_mul_f32 v[174:175], v[174:175], v[28:29]
    v_cvt_pk_bf16_f32 v255, v174, v175
    buffer_store_dwordx4 v[252:255], v10, s[20:23], s91 offen offset:512 sc1
    s_lshl_b32 s80, s5, 11
    s_add_u32 s80, s80, 17072128
    s_add_u32 s83, s80, 7077888
    v_and_b32 v2, 15, v1
    v_lshlrev_b32_e64 v2, 7, v2
    s_mov_b32 s92, 0
    buffer_load_dwordx4 a[112:115], v0, s[20:23], s28 offen offset:0 sc1
    s_bfe_u32 s28, s25, 0x40004
    s_mul_i32 s28, s28, 5120
    s_add_u32 s28, s28, s27
    buffer_load_dwordx4 a[116:119], v236, s[20:23], s28 offen offset:0 sc1
    buffer_load_dwordx4 a[120:123], v236, s[20:23], s28 offen offset:1024 sc1
    buffer_load_dwordx4 a[124:127], v236, s[20:23], s28 offen offset:2048 sc1
    s_mov_b32 s12, s52
    s_mov_b32 s13, s53
    s_mov_b32 s14, 1280
    s_mov_b32 s15, 0x20000
    s_mov_b32 s16, s62
    s_mov_b32 s17, s63
    s_mov_b32 s18, 5242880
    s_mov_b32 s19, 0x20000
    v_mov_b32_e64 v3, v236
    v_mov_b32 v4, v0
    s_mov_b32 s74, s31
    s_lshr_b32 s34, s6, 3
    s_lshl_b32 s35, s5, 1
    s_add_u32 s35, s35, s34
    s_mul_i32 s75, s35, 94
    s_add_u32 s75, s75, s74
    s_lshl_b32 s75, s75, 12
    s_xor_b32 s82, s35, 1
    s_mul_i32 s82, s82, 94
    s_add_u32 s82, s82, s74
    s_lshl_b32 s82, s82, 12
    s_lshl_b32 s35, s35, 6
    s_lshl_b32 s32, s4, 4
    s_add_u32 s35, s35, s32
    s_and_b32 s33, s6, 7
    s_mul_i32 s33, s33, 160
    s_mul_i32 s70, s35, 1280
    s_add_u32 s70, s70, s33
    s_lshl_b32 s71, s70, 1
    s_mov_b32 s81, 0xcccd
    s_mov_b32 m0, s93
    v_add_u32 v6, 0, v1
    v_mul_lo_u32 v7, v6, s81
    v_lshrrev_b32_e64 v7, 19, v7
    v_mul_u32_u24 v8, 1120, v7
    v_lshl_add_u32 v8, v6, 4, v8
    buffer_load_dwordx4 v8, s[8:11], s70 offen offset:0 lds
    v_add_u32_e64 v6, 64, v1
    v_mul_lo_u32 v7, v6, s81
    v_lshrrev_b32_e64 v7, 19, v7
    v_mul_u32_u24 v8, 1120, v7
    v_lshl_add_u32 v8, v6, 4, v8
    v_add_u32 v8, 0xfffffc00, v8
    buffer_load_dwordx4 v8, s[8:11], s70 offen offset:1024 lds
    v_add_u32 v6, 128, v1
    v_mul_lo_u32 v7, v6, s81
    v_lshrrev_b32 v7, 19, v7
    v_mul_u32_u24 v8, 1120, v7
    v_lshl_add_u32 v8, v6, 4, v8
    v_add_u32 v8, 0xfffff800, v8
    s_mov_b32 exec_hi, 0
    buffer_load_dwordx4 v8, s[8:11], s70 offen offset:2048 lds
    s_add_u32 m0, s93, 3072
    s_mov_b32 exec_lo, 0x3ff
    buffer_load_dwordx4 v3, s[12:15], s33 offen lds
    s_mov_b64 exec, -1
    s_mov_b32 s69, 1073741824
    s_lshl_b32 s32, s6, 7
    s_add_u32 s32, s32, s80
    s_cmp_eq_u32 s4, 0
    s_cselect_b32 s32, s32, 1073741824
    v_mov_b32 v14, s85
    s_waitcnt vmcnt(8)
    s_barrier
    s_mov_b64 exec, 1
    buffer_store_dword v14, off, s[20:23], s32 sc1
    s_mov_b64 exec, -1
    s_and_b32 s35, s35, 127
    s_lshl_b32 s35, s35, 3
    s_add_u32 s35, s35, 161792
    s_mul_i32 s34, s4, 5376
    v_lshlrev_b32_e64 v10, 3, v1
    v_add_u32 v10, s93, v10
    v_add_u32 v6, 0, v1
    v_mul_lo_u32 v7, v6, s81
    v_lshrrev_b32_e64 v7, 20, v7
    v_mul_u32_u24 v8, 20, v7
    v_sub_u32 v8, v6, v8
    v_mul_u32_u24 v9, 2560, v7
    v_lshl_add_u32 v240, v8, 4, v9
    v_mul_u32_u24 v12, 336, v7
    v_lshl_add_u32 v12, v8, 4, v12
    v_add_u32_e64 v245, s34, v12
    v_lshl_add_u32 v156, v8, 3, s93
    v_lshl_add_u32 v11, v7, 3, s35
    ds_read_b64 v[116:117], v11
    v_add_u32_e64 v6, 64, v1
    v_mul_lo_u32 v7, v6, s81
    v_lshrrev_b32_e64 v7, 20, v7
    v_mul_u32_u24 v8, 20, v7
    v_sub_u32 v8, v6, v8
    v_mul_u32_u24 v9, 2560, v7
    v_lshl_add_u32 v241, v8, 4, v9
    v_mul_u32_u24 v12, 336, v7
    v_lshl_add_u32 v12, v8, 4, v12
    v_add_u32_e64 v246, s34, v12
    v_lshl_add_u32 v157, v8, 3, s93
    v_lshl_add_u32 v11, v7, 3, s35
    ds_read_b64 v[118:119], v11
    v_add_u32 v6, 128, v1
    v_mul_lo_u32 v7, v6, s81
    v_lshrrev_b32_e64 v7, 20, v7
    v_mul_u32_u24 v8, 20, v7
    v_sub_u32 v8, v6, v8
    v_mul_u32_u24 v9, 2560, v7
    v_lshl_add_u32 v242, v8, 4, v9
    v_mul_u32_u24 v12, 336, v7
    v_lshl_add_u32 v12, v8, 4, v12
    v_add_u32_e64 v247, s34, v12
    v_lshl_add_u32 v158, v8, 3, s93
    v_lshl_add_u32 v11, v7, 3, s35
    ds_read_b64 v[120:121], v11
    v_add_u32 v6, 192, v1
    v_mul_lo_u32 v7, v6, s81
    v_lshrrev_b32_e64 v7, 20, v7
    v_mul_u32_u24 v8, 20, v7
    v_sub_u32 v8, v6, v8
    v_mul_u32_u24 v9, 2560, v7
    v_lshl_add_u32 v243, v8, 4, v9
    v_mul_u32_u24 v12, 336, v7
    v_lshl_add_u32 v12, v8, 4, v12
    v_add_u32_e64 v248, s34, v12
    v_lshl_add_u32 v159, v8, 3, s93
    v_lshl_add_u32 v11, v7, 3, s35
    ds_read_b64 v[122:123], v11
    v_add_u32 v6, 256, v1
    v_mul_lo_u32 v7, v6, s81
    v_lshrrev_b32_e64 v7, 20, v7
    v_mul_u32_u24 v8, 20, v7
    v_sub_u32 v8, v6, v8
    v_mul_u32_u24 v9, 2560, v7
    v_lshl_add_u32 v244, v8, 4, v9
    v_mul_u32_u24 v12, 336, v7
    v_lshl_add_u32 v12, v8, 4, v12
    v_add_u32_e64 v249, s34, v12
    v_lshl_add_u32 v160, v8, 3, s93
    v_lshl_add_u32 v11, v7, 3, s35
    ds_read_b64 v[124:125], v11
    v_and_b32_e64 v5, 15, v1
    v_mul_u32_u24 v5, 336, v5
    v_lshrrev_b32_e64 v6, 4, v1
    v_lshl_add_u32 v5, v6, 4, v5
    s_mul_i32 s34, s4, 21504
    v_add_u32_e64 v5, s34, v5
    v_add_u32 v13, s93, v3
    s_lshl_b32 s3, s2, 2
    s_add_u32 s3, s3, s4
    s_mul_i32 s72, s3, 5120
    s_add_u32 s72, s72, 17825792
    s_xor_b32 s3, s3, 4
    s_mul_i32 s73, s3, 5120
    s_add_u32 s73, s73, 17825792
    v_mov_b32 v250, 0xff
    s_mov_b32 s76, s85
    s_lshr_b32 s77, s76, 8
    s_add_u32 s77, s77, s76
    s_lshr_b32 s78, s76, 16
    s_add_u32 s78, s78, s76
    s_lshr_b32 s79, s76, 24
    s_add_u32 s79, s79, s76
    s_waitcnt vmcnt(1)
    ds_read_b64 v[96:97], v10 offset:0
    ds_read_b64 v[106:107], v156 offset:3072
    ds_read_b64 v[98:99], v10 offset:512
    ds_read_b64 v[108:109], v157 offset:3072
    ds_read_b64 v[100:101], v10 offset:1024
    ds_read_b64 v[110:111], v158 offset:3072
    ds_read_b64 v[102:103], v10 offset:1536
    ds_read_b64 v[112:113], v159 offset:3072
    ds_read_b64 v[104:105], v10 offset:2048
    ds_read_b64 v[114:115], v160 offset:3072
    s_waitcnt lgkmcnt(0)
    v_lshlrev_b32 v128, 16, v96
    v_and_b32_e64 v129, s86, v96
    v_lshlrev_b32 v130, 16, v97
    v_and_b32 v131, s86, v97
    v_lshlrev_b32 v132, 16, v106
    v_and_b32 v133, s86, v106
    v_lshlrev_b32 v134, 16, v107
    v_and_b32 v135, s86, v107
    v_fma_f32 v136, v128, v116, v117
    v_fma_f32 v137, v129, v116, v117
    v_fma_f32 v138, v130, v116, v117
    v_fma_f32 v139, v131, v116, v117
    v_cvt_pk_bf16_f32 v140, v136, v137
    v_cvt_pk_bf16_f32 v141, v138, v139
    v_lshlrev_b32 v136, 16, v140
    v_and_b32 v137, s86, v140
    v_lshlrev_b32 v138, 16, v141
    v_and_b32 v139, s86, v141
    v_pk_mul_f32 v[136:137], v[136:137], v[132:133]
    v_pk_mul_f32 v[138:139], v[138:139], v[134:135]
    v_cvt_pk_bf16_f32 v140, v136, v137
    v_cvt_pk_bf16_f32 v141, v138, v139
    v_lshlrev_b32 v136, 16, v140
    v_and_b32 v137, s86, v140
    v_lshlrev_b32 v138, 16, v141
    v_and_b32 v139, s86, v141
    v_pk_add_f32 v[144:145], v[128:129], v[136:137]
    v_pk_add_f32 v[146:147], v[130:131], v[138:139]
    ds_write_b128 v13, v[144:147] offset:0
    v_lshlrev_b32 v128, 16, v98
    v_and_b32 v129, s86, v98
    v_lshlrev_b32 v130, 16, v99
    v_and_b32 v131, s86, v99
    v_lshlrev_b32 v132, 16, v108
    v_and_b32 v133, s86, v108
    v_lshlrev_b32 v134, 16, v109
    v_and_b32 v135, s86, v109
    v_fma_f32 v136, v128, v118, v119
    v_fma_f32 v137, v129, v118, v119
    v_fma_f32 v138, v130, v118, v119
    v_fma_f32 v139, v131, v118, v119
    v_cvt_pk_bf16_f32 v140, v136, v137
    v_cvt_pk_bf16_f32 v141, v138, v139
    v_lshlrev_b32 v136, 16, v140
    v_and_b32 v137, s86, v140
    v_lshlrev_b32 v138, 16, v141
    v_and_b32 v139, s86, v141
    v_pk_mul_f32 v[136:137], v[136:137], v[132:133]
    v_pk_mul_f32 v[138:139], v[138:139], v[134:135]
    v_cvt_pk_bf16_f32 v140, v136, v137
    v_cvt_pk_bf16_f32 v141, v138, v139
    v_lshlrev_b32 v136, 16, v140
    v_and_b32 v137, s86, v140
    v_lshlrev_b32 v138, 16, v141
    v_and_b32 v139, s86, v141
    v_pk_add_f32 v[148:149], v[128:129], v[136:137]
    v_pk_add_f32 v[150:151], v[130:131], v[138:139]
    ds_write_b128 v13, v[148:151] offset:1024
    v_lshlrev_b32 v128, 16, v100
    v_and_b32 v129, s86, v100
    v_lshlrev_b32 v130, 16, v101
    v_and_b32 v131, s86, v101
    v_lshlrev_b32 v132, 16, v110
    v_and_b32 v133, s86, v110
    v_lshlrev_b32 v134, 16, v111
    v_and_b32 v135, s86, v111
    v_fma_f32 v136, v128, v120, v121
    v_fma_f32 v137, v129, v120, v121
    v_fma_f32 v138, v130, v120, v121
    v_fma_f32 v139, v131, v120, v121
    v_cvt_pk_bf16_f32 v140, v136, v137
    v_cvt_pk_bf16_f32 v141, v138, v139
    v_lshlrev_b32 v136, 16, v140
    v_and_b32 v137, s86, v140
    v_lshlrev_b32 v138, 16, v141
    v_and_b32 v139, s86, v141
    v_pk_mul_f32 v[136:137], v[136:137], v[132:133]
    v_pk_mul_f32 v[138:139], v[138:139], v[134:135]
    v_cvt_pk_bf16_f32 v140, v136, v137
    v_cvt_pk_bf16_f32 v141, v138, v139
    v_lshlrev_b32 v136, 16, v140
    v_and_b32 v137, s86, v140
    v_lshlrev_b32 v138, 16, v141
    v_and_b32 v139, s86, v141
    v_pk_add_f32 v[144:145], v[128:129], v[136:137]
    v_pk_add_f32 v[146:147], v[130:131], v[138:139]
    ds_write_b128 v13, v[144:147] offset:2048
    v_lshlrev_b32 v128, 16, v102
    v_and_b32 v129, s86, v102
    v_lshlrev_b32 v130, 16, v103
    v_and_b32 v131, s86, v103
    v_lshlrev_b32 v132, 16, v112
    v_and_b32 v133, s86, v112
    v_lshlrev_b32 v134, 16, v113
    v_and_b32 v135, s86, v113
    v_fma_f32 v136, v128, v122, v123
    v_fma_f32 v137, v129, v122, v123
    v_fma_f32 v138, v130, v122, v123
    v_fma_f32 v139, v131, v122, v123
    v_cvt_pk_bf16_f32 v140, v136, v137
    v_cvt_pk_bf16_f32 v141, v138, v139
    v_lshlrev_b32 v136, 16, v140
    v_and_b32 v137, s86, v140
    v_lshlrev_b32 v138, 16, v141
    v_and_b32 v139, s86, v141
    v_pk_mul_f32 v[136:137], v[136:137], v[132:133]
    v_pk_mul_f32 v[138:139], v[138:139], v[134:135]
    v_cvt_pk_bf16_f32 v140, v136, v137
    v_cvt_pk_bf16_f32 v141, v138, v139
    v_lshlrev_b32 v136, 16, v140
    v_and_b32 v137, s86, v140
    v_lshlrev_b32 v138, 16, v141
    v_and_b32 v139, s86, v141
    v_pk_add_f32 v[148:149], v[128:129], v[136:137]
    v_pk_add_f32 v[150:151], v[130:131], v[138:139]
    ds_write_b128 v13, v[148:151] offset:3072
    v_lshlrev_b32 v128, 16, v104
    v_and_b32 v129, s86, v104
    v_lshlrev_b32 v130, 16, v105
    v_and_b32 v131, s86, v105
    v_lshlrev_b32 v132, 16, v114
    v_and_b32 v133, s86, v114
    v_lshlrev_b32 v134, 16, v115
    v_and_b32 v135, s86, v115
    v_fma_f32 v136, v128, v124, v125
    v_fma_f32 v137, v129, v124, v125
    v_fma_f32 v138, v130, v124, v125
    v_fma_f32 v139, v131, v124, v125
    v_cvt_pk_bf16_f32 v140, v136, v137
    v_cvt_pk_bf16_f32 v141, v138, v139
    v_lshlrev_b32 v136, 16, v140
    v_and_b32 v137, s86, v140
    v_lshlrev_b32 v138, 16, v141
    v_and_b32 v139, s86, v141
    v_pk_mul_f32 v[136:137], v[136:137], v[132:133]
    v_pk_mul_f32 v[138:139], v[138:139], v[134:135]
    v_cvt_pk_bf16_f32 v140, v136, v137
    v_cvt_pk_bf16_f32 v141, v138, v139
    v_lshlrev_b32_e64 v136, 16, v140
    v_and_b32 v137, s86, v140
    v_lshlrev_b32 v138, 16, v141
    v_and_b32 v139, s86, v141
    v_pk_add_f32 v[144:145], v[128:129], v[136:137]
    v_pk_add_f32 v[146:147], v[130:131], v[138:139]
    ds_write_b128 v13, v[144:147] offset:4096
    s_branch K2_START
K1_TYPE_B:
    s_waitcnt vmcnt(13)
    s_barrier
    ds_read_b128 a[160:163], v216 offset:0
    ds_read_b128 a[164:167], v216 offset:8192
    ds_read_b128 a[168:171], v217 offset:0
    ds_read_b128 a[172:175], v217 offset:8192
    ds_read_b128 a[176:179], v218 offset:0
    ds_read_b128 a[180:183], v218 offset:8192
    ds_read_b128 a[184:187], v219 offset:0
    s_waitcnt lgkmcnt(3)
    v_mfma_f32_32x32x16_bf16 v[16:31], a[0:3], a[160:163], 0
    ds_read_b128 a[188:191], v219 offset:8192
    v_lshlrev_b32 v244, 16, v48
    v_and_b32_e64 v245, s86, v48
    v_lshlrev_b32 v246, 16, v49
    v_and_b32 v247, s86, v49
    v_pk_fma_f32 v[244:245], v[244:245], v[252:253], v[254:255]
    v_pk_fma_f32 v[246:247], v[246:247], v[252:253], v[254:255]
    v_mfma_f32_32x32x16_bf16 v[32:47], a[0:3], a[164:167], 0
    ds_read_b128 a[160:163], v220 offset:0
    buffer_load_dwordx4 v213, s[12:15], s32 offen offset:1024 lds
    v_cvt_pk_bf16_f32 v48, v244, v245
    v_cvt_pk_bf16_f32 v49, v246, v247
    v_accvgpr_write_b32 a32, v48
    v_accvgpr_write_b32 a33, v49
    v_lshlrev_b32 v248, 16, v50
    v_and_b32 v249, s86, v50
    v_lshlrev_b32 v250, 16, v51
    v_and_b32 v251, s86, v51
    v_pk_fma_f32 v[248:249], v[248:249], v[252:253], v[254:255]
    v_pk_fma_f32 v[250:251], v[250:251], v[252:253], v[254:255]
    v_mfma_f32_32x32x16_bf16 v[16:31], a[4:7], a[168:171], v[16:31]
    ds_read_b128 a[164:167], v220 offset:8192
    v_cvt_pk_bf16_f32 v50, v248, v249
    v_cvt_pk_bf16_f32 v51, v250, v251
    v_accvgpr_write_b32 a34, v50
    v_accvgpr_write_b32 a35, v51
    v_lshlrev_b32 v244, 16, v52
    v_and_b32 v245, s86, v52
    v_lshlrev_b32 v246, 16, v53
    v_and_b32 v247, s86, v53
    v_pk_fma_f32 v[244:245], v[244:245], v[252:253], v[254:255]
    v_pk_fma_f32 v[246:247], v[246:247], v[252:253], v[254:255]
    v_mfma_f32_32x32x16_bf16 v[32:47], a[4:7], a[172:175], v[32:47]
    ds_read_b128 a[168:171], v221 offset:0
    buffer_load_dwordx4 v214, s[12:15], s32 offen offset:2048 lds
    v_cvt_pk_bf16_f32 v52, v244, v245
    v_cvt_pk_bf16_f32 v53, v246, v247
    v_accvgpr_write_b32 a36, v52
    v_accvgpr_write_b32 a37, v53
    v_lshlrev_b32_e64 v248, 16, v54
    v_and_b32 v249, s86, v54
    v_lshlrev_b32 v250, 16, v55
    v_and_b32 v251, s86, v55
    v_pk_fma_f32 v[248:249], v[248:249], v[252:253], v[254:255]
    v_pk_fma_f32 v[250:251], v[250:251], v[252:253], v[254:255]
    s_waitcnt lgkmcnt(3)
    v_mfma_f32_32x32x16_bf16 v[16:31], a[8:11], a[176:179], v[16:31]
    ds_read_b128 a[172:175], v221 offset:8192
    v_cvt_pk_bf16_f32 v54, v248, v249
    v_cvt_pk_bf16_f32 v55, v250, v251
    v_accvgpr_write_b32 a38, v54
    v_accvgpr_write_b32 a39, v55
    v_lshlrev_b32 v244, 16, v56
    v_and_b32 v245, s86, v56
    v_lshlrev_b32 v246, 16, v57
    v_and_b32 v247, s86, v57
    v_pk_fma_f32 v[244:245], v[244:245], v[252:253], v[254:255]
    v_pk_fma_f32 v[246:247], v[246:247], v[252:253], v[254:255]
    v_mfma_f32_32x32x16_bf16 v[32:47], a[8:11], a[180:183], v[32:47]
    ds_read_b128 a[176:179], v222 offset:0
    buffer_load_dwordx4 v215, s[12:15], s32 offen offset:3072 lds
    v_cvt_pk_bf16_f32 v56, v244, v245
    v_cvt_pk_bf16_f32 v57, v246, v247
    v_accvgpr_write_b32 a40, v56
    v_accvgpr_write_b32 a41, v57
    v_lshlrev_b32 v248, 16, v58
    v_and_b32 v249, s86, v58
    v_lshlrev_b32 v250, 16, v59
    v_and_b32 v251, s86, v59
    v_pk_fma_f32 v[248:249], v[248:249], v[252:253], v[254:255]
    v_pk_fma_f32 v[250:251], v[250:251], v[252:253], v[254:255]
    v_mfma_f32_32x32x16_bf16 v[16:31], a[12:15], a[184:187], v[16:31]
    ds_read_b128 a[180:183], v222 offset:8192
    v_cvt_pk_bf16_f32 v58, v248, v249
    v_cvt_pk_bf16_f32 v59, v250, v251
    v_accvgpr_write_b32 a42, v58
    v_accvgpr_write_b32 a43, v59
    v_lshlrev_b32 v244, 16, v60
    v_and_b32 v245, s86, v60
    v_lshlrev_b32 v246, 16, v61
    v_and_b32 v247, s86, v61
    v_pk_fma_f32 v[244:245], v[244:245], v[252:253], v[254:255]
    v_pk_fma_f32 v[246:247], v[246:247], v[252:253], v[254:255]
    v_mfma_f32_32x32x16_bf16 v[32:47], a[12:15], a[188:191], v[32:47]
    ds_read_b128 a[184:187], v223 offset:0
    s_add_u32 m0, s78, 81920
    s_add_u32 s32, s82, s73
    buffer_load_dwordx4 v2, s[16:19], s32 offen offset:0 lds
    v_cvt_pk_bf16_f32 v60, v244, v245
    v_cvt_pk_bf16_f32 v61, v246, v247
    v_accvgpr_write_b32 a44, v60
    v_accvgpr_write_b32 a45, v61
    v_lshlrev_b32 v248, 16, v62
    v_and_b32 v249, s86, v62
    v_lshlrev_b32 v250, 16, v63
    v_and_b32 v251, s86, v63
    v_pk_fma_f32 v[248:249], v[248:249], v[252:253], v[254:255]
    v_pk_fma_f32 v[250:251], v[250:251], v[252:253], v[254:255]
    s_waitcnt lgkmcnt(3)
    v_mfma_f32_32x32x16_bf16 v[16:31], a[16:19], a[160:163], v[16:31]
    ds_read_b128 a[188:191], v223 offset:8192
    v_cvt_pk_bf16_f32 v62, v248, v249
    v_cvt_pk_bf16_f32 v63, v250, v251
    v_accvgpr_write_b32 a46, v62
    v_accvgpr_write_b32 a47, v63
    v_lshlrev_b32 v244, 16, v64
    v_and_b32 v245, s86, v64
    v_lshlrev_b32 v246, 16, v65
    v_and_b32 v247, s86, v65
    v_pk_fma_f32 v[244:245], v[244:245], v[252:253], v[254:255]
    v_pk_fma_f32 v[246:247], v[246:247], v[252:253], v[254:255]
    v_mfma_f32_32x32x16_bf16 v[32:47], a[16:19], a[164:167], v[32:47]
    s_waitcnt vmcnt(13)
    s_barrier
    ds_read_b128 a[160:163], v216 offset:16384
    buffer_load_dwordx4 v3, s[16:19], s32 offen offset:1024 lds
    v_cvt_pk_bf16_f32 v64, v244, v245
    v_cvt_pk_bf16_f32 v65, v246, v247
    v_accvgpr_write_b32 a48, v64
    v_accvgpr_write_b32 a49, v65
    v_lshlrev_b32 v248, 16, v66
    v_and_b32 v249, s86, v66
    v_lshlrev_b32 v250, 16, v67
    v_and_b32 v251, s86, v67
    v_pk_fma_f32 v[248:249], v[248:249], v[252:253], v[254:255]
    v_pk_fma_f32 v[250:251], v[250:251], v[252:253], v[254:255]
    v_mfma_f32_32x32x16_bf16 v[16:31], a[20:23], a[168:171], v[16:31]
    ds_read_b128 a[164:167], v216 offset:24576
    v_cvt_pk_bf16_f32 v66, v248, v249
    v_cvt_pk_bf16_f32 v67, v250, v251
    v_accvgpr_write_b32 a50, v66
    v_accvgpr_write_b32 a51, v67
    v_lshlrev_b32 v244, 16, v68
    v_and_b32 v245, s86, v68
    v_lshlrev_b32 v246, 16, v69
    v_and_b32 v247, s86, v69
    v_pk_fma_f32 v[244:245], v[244:245], v[252:253], v[254:255]
    v_pk_fma_f32 v[246:247], v[246:247], v[252:253], v[254:255]
    v_mfma_f32_32x32x16_bf16 v[32:47], a[20:23], a[172:175], v[32:47]
    ds_read_b128 a[168:171], v217 offset:16384
    buffer_load_dwordx4 v4, s[16:19], s32 offen offset:2048 lds
    v_cvt_pk_bf16_f32 v68, v244, v245
    v_cvt_pk_bf16_f32 v69, v246, v247
    v_accvgpr_write_b32 a52, v68
    v_accvgpr_write_b32 a53, v69
    v_lshlrev_b32_e64 v248, 16, v70
    v_and_b32 v249, s86, v70
    v_lshlrev_b32 v250, 16, v71
    v_and_b32 v251, s86, v71
    v_pk_fma_f32 v[248:249], v[248:249], v[252:253], v[254:255]
    v_pk_fma_f32 v[250:251], v[250:251], v[252:253], v[254:255]
    s_waitcnt lgkmcnt(3)
    v_mfma_f32_32x32x16_bf16 v[16:31], a[24:27], a[176:179], v[16:31]
    ds_read_b128 a[172:175], v217 offset:24576
    v_cvt_pk_bf16_f32 v70, v248, v249
    v_cvt_pk_bf16_f32 v71, v250, v251
    v_accvgpr_write_b32 a54, v70
    v_accvgpr_write_b32 a55, v71
    v_lshlrev_b32 v244, 16, v72
    v_and_b32 v245, s86, v72
    v_lshlrev_b32 v246, 16, v73
    v_and_b32 v247, s86, v73
    v_pk_fma_f32 v[244:245], v[244:245], v[252:253], v[254:255]
    v_pk_fma_f32 v[246:247], v[246:247], v[252:253], v[254:255]
    v_mfma_f32_32x32x16_bf16 v[32:47], a[24:27], a[180:183], v[32:47]
    ds_read_b128 a[176:179], v218 offset:16384
    buffer_load_dwordx4 v5, s[16:19], s32 offen offset:3072 lds
    v_cvt_pk_bf16_f32 v72, v244, v245
    v_cvt_pk_bf16_f32 v73, v246, v247
    v_accvgpr_write_b32 a56, v72
    v_accvgpr_write_b32 a57, v73
    v_lshlrev_b32 v248, 16, v74
    v_and_b32 v249, s86, v74
    v_lshlrev_b32 v250, 16, v75
    v_and_b32 v251, s86, v75
    v_pk_fma_f32 v[248:249], v[248:249], v[252:253], v[254:255]
    v_pk_fma_f32 v[250:251], v[250:251], v[252:253], v[254:255]
    v_mfma_f32_32x32x16_bf16 v[16:31], a[28:31], a[184:187], v[16:31]
    ds_read_b128 a[180:183], v218 offset:24576
    v_cvt_pk_bf16_f32 v74, v248, v249
    v_cvt_pk_bf16_f32 v75, v250, v251
    v_accvgpr_write_b32 a58, v74
    v_accvgpr_write_b32 a59, v75
    v_lshlrev_b32 v244, 16, v76
    v_and_b32 v245, s86, v76
    v_lshlrev_b32 v246, 16, v77
    v_and_b32 v247, s86, v77
    v_pk_fma_f32 v[244:245], v[244:245], v[252:253], v[254:255]
    v_pk_fma_f32 v[246:247], v[246:247], v[252:253], v[254:255]
    v_mfma_f32_32x32x16_bf16 v[32:47], a[28:31], a[188:191], v[32:47]
    ds_read_b128 a[184:187], v219 offset:16384
    s_add_u32 m0, s93, 0
    s_nop 0
    buffer_load_dwordx4 v188, s[24:27], s7 offen nt lds
    v_cvt_pk_bf16_f32 v76, v244, v245
    v_cvt_pk_bf16_f32 v77, v246, v247
    v_accvgpr_write_b32 a60, v76
    v_accvgpr_write_b32 a61, v77
    v_lshlrev_b32_e64 v248, 16, v78
    v_and_b32 v249, s86, v78
    v_lshlrev_b32 v250, 16, v79
    v_and_b32 v251, s86, v79
    v_pk_fma_f32 v[248:249], v[248:249], v[252:253], v[254:255]
    v_pk_fma_f32 v[250:251], v[250:251], v[252:253], v[254:255]
    s_waitcnt lgkmcnt(3)
    v_mfma_f32_32x32x16_bf16 v[16:31], a[32:35], a[160:163], v[16:31]
    ds_read_b128 a[188:191], v219 offset:24576
    v_cvt_pk_bf16_f32 v78, v248, v249
    v_cvt_pk_bf16_f32 v79, v250, v251
    v_accvgpr_write_b32 a62, v78
    v_accvgpr_write_b32 a63, v79
    v_lshlrev_b32_e64 v244, 16, v80
    v_and_b32 v245, s86, v80
    v_lshlrev_b32 v246, 16, v81
    v_and_b32 v247, s86, v81
    v_pk_fma_f32 v[244:245], v[244:245], v[252:253], v[254:255]
    v_pk_fma_f32 v[246:247], v[246:247], v[252:253], v[254:255]
    v_mfma_f32_32x32x16_bf16 v[32:47], a[32:35], a[164:167], v[32:47]
    ds_read_b128 a[160:163], v220 offset:16384
    s_add_u32 m0, s93, 1024
    s_nop 0
    buffer_load_dwordx4 v189, s[24:27], s7 offen nt lds
    v_cvt_pk_bf16_f32 v80, v244, v245
    v_cvt_pk_bf16_f32 v81, v246, v247
    v_accvgpr_write_b32 a64, v80
    v_accvgpr_write_b32 a65, v81
    v_lshlrev_b32 v248, 16, v82
    v_and_b32 v249, s86, v82
    v_lshlrev_b32 v250, 16, v83
    v_and_b32 v251, s86, v83
    v_pk_fma_f32 v[248:249], v[248:249], v[252:253], v[254:255]
    v_pk_fma_f32 v[250:251], v[250:251], v[252:253], v[254:255]
    v_mfma_f32_32x32x16_bf16 v[16:31], a[36:39], a[168:171], v[16:31]
    ds_read_b128 a[164:167], v220 offset:24576
    v_cvt_pk_bf16_f32 v82, v248, v249
    v_cvt_pk_bf16_f32 v83, v250, v251
    v_accvgpr_write_b32 a66, v82
    v_accvgpr_write_b32 a67, v83
    v_lshlrev_b32 v244, 16, v84
    v_and_b32 v245, s86, v84
    v_lshlrev_b32 v246, 16, v85
    v_and_b32 v247, s86, v85
    v_pk_fma_f32 v[244:245], v[244:245], v[252:253], v[254:255]
    v_pk_fma_f32 v[246:247], v[246:247], v[252:253], v[254:255]
    v_mfma_f32_32x32x16_bf16 v[32:47], a[36:39], a[172:175], v[32:47]
    ds_read_b128 a[168:171], v221 offset:16384
    s_add_u32 m0, s93, 2048
    s_nop 0
    buffer_load_dwordx4 v190, s[28:31], s7 offen nt lds
    v_cvt_pk_bf16_f32 v84, v244, v245
    v_cvt_pk_bf16_f32 v85, v246, v247
    v_accvgpr_write_b32 a68, v84
    v_accvgpr_write_b32 a69, v85
    v_lshlrev_b32 v248, 16, v86
    v_and_b32 v249, s86, v86
    v_lshlrev_b32 v250, 16, v87
    v_and_b32 v251, s86, v87
    v_pk_fma_f32 v[248:249], v[248:249], v[252:253], v[254:255]
    v_pk_fma_f32 v[250:251], v[250:251], v[252:253], v[254:255]
    s_waitcnt lgkmcnt(3)
    v_mfma_f32_32x32x16_bf16 v[16:31], a[40:43], a[176:179], v[16:31]
    ds_read_b128 a[172:175], v221 offset:24576
    v_cvt_pk_bf16_f32 v86, v248, v249
    v_cvt_pk_bf16_f32 v87, v250, v251
    v_accvgpr_write_b32 a70, v86
    v_accvgpr_write_b32 a71, v87
    v_lshlrev_b32_e64 v244, 16, v88
    v_and_b32 v245, s86, v88
    v_lshlrev_b32 v246, 16, v89
    v_and_b32 v247, s86, v89
    v_pk_fma_f32 v[244:245], v[244:245], v[252:253], v[254:255]
    v_pk_fma_f32 v[246:247], v[246:247], v[252:253], v[254:255]
    v_mfma_f32_32x32x16_bf16 v[32:47], a[40:43], a[180:183], v[32:47]
    ds_read_b128 a[176:179], v222 offset:16384
    s_add_u32 m0, s93, 3072
    s_nop 0
    buffer_load_dwordx4 v191, s[28:31], s7 offen nt lds
    v_cvt_pk_bf16_f32 v88, v244, v245
    v_cvt_pk_bf16_f32 v89, v246, v247
    v_accvgpr_write_b32 a72, v88
    v_accvgpr_write_b32 a73, v89
    v_lshlrev_b32 v248, 16, v90
    v_and_b32 v249, s86, v90
    v_lshlrev_b32 v250, 16, v91
    v_and_b32 v251, s86, v91
    v_pk_fma_f32 v[248:249], v[248:249], v[252:253], v[254:255]
    v_pk_fma_f32 v[250:251], v[250:251], v[252:253], v[254:255]
    v_mfma_f32_32x32x16_bf16 v[16:31], a[44:47], a[184:187], v[16:31]
    ds_read_b128 a[180:183], v222 offset:24576
    v_cvt_pk_bf16_f32 v90, v248, v249
    v_cvt_pk_bf16_f32 v91, v250, v251
    v_accvgpr_write_b32 a74, v90
    v_accvgpr_write_b32 a75, v91
    v_lshlrev_b32 v244, 16, v92
    v_and_b32 v245, s86, v92
    v_lshlrev_b32 v246, 16, v93
    v_and_b32 v247, s86, v93
    v_pk_fma_f32 v[244:245], v[244:245], v[252:253], v[254:255]
    v_pk_fma_f32 v[246:247], v[246:247], v[252:253], v[254:255]
    v_mfma_f32_32x32x16_bf16 v[32:47], a[44:47], a[188:191], v[32:47]
    ds_read_b128 a[184:187], v223 offset:16384
    s_add_u32 m0, s93, 4096
    s_nop 0
    buffer_load_dwordx4 v192, s[28:31], s7 offen nt lds
    v_cvt_pk_bf16_f32 v92, v244, v245
    v_cvt_pk_bf16_f32 v93, v246, v247
    v_accvgpr_write_b32 a76, v92
    v_accvgpr_write_b32 a77, v93
    v_lshlrev_b32 v248, 16, v94
    v_and_b32 v249, s86, v94
    v_lshlrev_b32 v250, 16, v95
    v_and_b32 v251, s86, v95
    v_pk_fma_f32 v[248:249], v[248:249], v[252:253], v[254:255]
    v_pk_fma_f32 v[250:251], v[250:251], v[252:253], v[254:255]
    s_waitcnt lgkmcnt(3)
    v_mfma_f32_32x32x16_bf16 v[16:31], a[48:51], a[160:163], v[16:31]
    ds_read_b128 a[188:191], v223 offset:24576
    v_cvt_pk_bf16_f32 v94, v248, v249
    v_cvt_pk_bf16_f32 v95, v250, v251
    v_accvgpr_write_b32 a78, v94
    v_accvgpr_write_b32 a79, v95
    v_lshlrev_b32_e64 v244, 16, v96
    v_and_b32 v245, s86, v96
    v_lshlrev_b32 v246, 16, v97
    v_and_b32 v247, s86, v97
    v_pk_fma_f32 v[244:245], v[244:245], v[252:253], v[254:255]
    v_pk_fma_f32 v[246:247], v[246:247], v[252:253], v[254:255]
    v_mfma_f32_32x32x16_bf16 v[32:47], a[48:51], a[164:167], v[32:47]
    s_waitcnt vmcnt(17)
    s_barrier
    ds_read_b128 a[160:163], v216 offset:32768
    s_add_u32 m0, s78, 98304
    s_add_u32 s32, s82, s73
    s_add_u32 s32, s32, 221184
    buffer_load_dwordx4 v2, s[16:19], s32 offen offset:0 lds
    v_cvt_pk_bf16_f32 v96, v244, v245
    v_cvt_pk_bf16_f32 v97, v246, v247
    v_accvgpr_write_b32 a80, v96
    v_accvgpr_write_b32 a81, v97
    v_lshlrev_b32 v248, 16, v98
    v_and_b32 v249, s86, v98
    v_lshlrev_b32 v250, 16, v99
    v_and_b32 v251, s86, v99
    v_pk_fma_f32 v[248:249], v[248:249], v[252:253], v[254:255]
    v_pk_fma_f32 v[250:251], v[250:251], v[252:253], v[254:255]
    v_mfma_f32_32x32x16_bf16 v[16:31], a[52:55], a[168:171], v[16:31]
    ds_read_b128 a[164:167], v216 offset:40960
    v_cvt_pk_bf16_f32 v98, v248, v249
    v_cvt_pk_bf16_f32 v99, v250, v251
    v_accvgpr_write_b32 a82, v98
    v_accvgpr_write_b32 a83, v99
    v_lshlrev_b32 v244, 16, v100
    v_and_b32 v245, s86, v100
    v_lshlrev_b32 v246, 16, v101
    v_and_b32 v247, s86, v101
    v_pk_fma_f32 v[244:245], v[244:245], v[252:253], v[254:255]
    v_pk_fma_f32 v[246:247], v[246:247], v[252:253], v[254:255]
    v_mfma_f32_32x32x16_bf16 v[32:47], a[52:55], a[172:175], v[32:47]
    ds_read_b128 a[168:171], v217 offset:32768
    buffer_load_dwordx4 v3, s[16:19], s32 offen offset:1024 lds
    v_cvt_pk_bf16_f32 v100, v244, v245
    v_cvt_pk_bf16_f32 v101, v246, v247
    v_accvgpr_write_b32 a84, v100
    v_accvgpr_write_b32 a85, v101
    v_lshlrev_b32_e64 v248, 16, v102
    v_and_b32 v249, s86, v102
    v_lshlrev_b32 v250, 16, v103
    v_and_b32 v251, s86, v103
    v_pk_fma_f32 v[248:249], v[248:249], v[252:253], v[254:255]
    v_pk_fma_f32 v[250:251], v[250:251], v[252:253], v[254:255]
    s_waitcnt lgkmcnt(3)
    v_mfma_f32_32x32x16_bf16 v[16:31], a[56:59], a[176:179], v[16:31]
    ds_read_b128 a[172:175], v217 offset:40960
    v_cvt_pk_bf16_f32 v102, v248, v249
    v_cvt_pk_bf16_f32 v103, v250, v251
    v_accvgpr_write_b32 a86, v102
    v_accvgpr_write_b32 a87, v103
    v_lshlrev_b32 v244, 16, v104
    v_and_b32 v245, s86, v104
    v_lshlrev_b32 v246, 16, v105
    v_and_b32 v247, s86, v105
    v_pk_fma_f32 v[244:245], v[244:245], v[252:253], v[254:255]
    v_pk_fma_f32 v[246:247], v[246:247], v[252:253], v[254:255]
    v_mfma_f32_32x32x16_bf16 v[32:47], a[56:59], a[180:183], v[32:47]
    ds_read_b128 a[176:179], v218 offset:32768
    buffer_load_dwordx4 v4, s[16:19], s32 offen offset:2048 lds
    v_cvt_pk_bf16_f32 v104, v244, v245
    v_cvt_pk_bf16_f32 v105, v246, v247
    v_accvgpr_write_b32 a88, v104
    v_accvgpr_write_b32 a89, v105
    v_lshlrev_b32 v248, 16, v106
    v_and_b32 v249, s86, v106
    v_lshlrev_b32 v250, 16, v107
    v_and_b32 v251, s86, v107
    v_pk_fma_f32 v[248:249], v[248:249], v[252:253], v[254:255]
    v_pk_fma_f32 v[250:251], v[250:251], v[252:253], v[254:255]
    v_mfma_f32_32x32x16_bf16 v[16:31], a[60:63], a[184:187], v[16:31]
    ds_read_b128 a[180:183], v218 offset:40960
    v_cvt_pk_bf16_f32 v106, v248, v249
    v_cvt_pk_bf16_f32 v107, v250, v251
    v_accvgpr_write_b32 a90, v106
    v_accvgpr_write_b32 a91, v107
    v_lshlrev_b32 v244, 16, v108
    v_and_b32 v245, s86, v108
    v_lshlrev_b32 v246, 16, v109
    v_and_b32 v247, s86, v109
    v_pk_fma_f32 v[244:245], v[244:245], v[252:253], v[254:255]
    v_pk_fma_f32 v[246:247], v[246:247], v[252:253], v[254:255]
    v_mfma_f32_32x32x16_bf16 v[32:47], a[60:63], a[188:191], v[32:47]
    ds_read_b128 a[184:187], v219 offset:32768
    buffer_load_dwordx4 v5, s[16:19], s32 offen offset:3072 lds
    v_cvt_pk_bf16_f32 v108, v244, v245
    v_cvt_pk_bf16_f32 v109, v246, v247
    v_accvgpr_write_b32 a92, v108
    v_accvgpr_write_b32 a93, v109
    v_lshlrev_b32_e64 v248, 16, v110
    v_and_b32 v249, s86, v110
    v_lshlrev_b32 v250, 16, v111
    v_and_b32 v251, s86, v111
    v_pk_fma_f32 v[248:249], v[248:249], v[252:253], v[254:255]
    v_pk_fma_f32 v[250:251], v[250:251], v[252:253], v[254:255]
    s_waitcnt lgkmcnt(3)
    v_mfma_f32_32x32x16_bf16 v[16:31], a[64:67], a[160:163], v[16:31]
    ds_read_b128 a[188:191], v219 offset:40960
    v_cvt_pk_bf16_f32 v110, v248, v249
    v_cvt_pk_bf16_f32 v111, v250, v251
    v_accvgpr_write_b32 a94, v110
    v_accvgpr_write_b32 a95, v111
    v_lshlrev_b32_e64 v244, 16, v112
    v_and_b32 v245, s86, v112
    v_lshlrev_b32 v246, 16, v113
    v_and_b32 v247, s86, v113
    v_pk_fma_f32 v[244:245], v[244:245], v[252:253], v[254:255]
    v_pk_fma_f32 v[246:247], v[246:247], v[252:253], v[254:255]
    v_mfma_f32_32x32x16_bf16 v[32:47], a[64:67], a[164:167], v[32:47]
    ds_read_b128 a[160:163], v220 offset:32768
    s_add_u32 m0, s78, 114688
    s_add_u32 s32, s82, s74
    buffer_load_dwordx4 v2, s[16:19], s32 offen offset:0 lds
    v_cvt_pk_bf16_f32 v112, v244, v245
    v_cvt_pk_bf16_f32 v113, v246, v247
    v_accvgpr_write_b32 a96, v112
    v_accvgpr_write_b32 a97, v113
    v_lshlrev_b32 v248, 16, v114
    v_and_b32 v249, s86, v114
    v_lshlrev_b32 v250, 16, v115
    v_and_b32 v251, s86, v115
    v_pk_fma_f32 v[248:249], v[248:249], v[252:253], v[254:255]
    v_pk_fma_f32 v[250:251], v[250:251], v[252:253], v[254:255]
    v_mfma_f32_32x32x16_bf16 v[16:31], a[68:71], a[168:171], v[16:31]
    ds_read_b128 a[164:167], v220 offset:40960
    v_cvt_pk_bf16_f32 v114, v248, v249
    v_cvt_pk_bf16_f32 v115, v250, v251
    v_accvgpr_write_b32 a98, v114
    v_accvgpr_write_b32 a99, v115
    v_lshlrev_b32 v244, 16, v116
    v_and_b32 v245, s86, v116
    v_lshlrev_b32 v246, 16, v117
    v_and_b32 v247, s86, v117
    v_pk_fma_f32 v[244:245], v[244:245], v[252:253], v[254:255]
    v_pk_fma_f32 v[246:247], v[246:247], v[252:253], v[254:255]
    v_mfma_f32_32x32x16_bf16 v[32:47], a[68:71], a[172:175], v[32:47]
    ds_read_b128 a[168:171], v221 offset:32768
    buffer_load_dwordx4 v3, s[16:19], s32 offen offset:1024 lds
    v_cvt_pk_bf16_f32 v116, v244, v245
    v_cvt_pk_bf16_f32 v117, v246, v247
    v_accvgpr_write_b32 a100, v116
    v_accvgpr_write_b32 a101, v117
    v_lshlrev_b32_e64 v248, 16, v118
    v_and_b32 v249, s86, v118
    v_lshlrev_b32 v250, 16, v119
    v_and_b32 v251, s86, v119
    v_pk_fma_f32 v[248:249], v[248:249], v[252:253], v[254:255]
    v_pk_fma_f32 v[250:251], v[250:251], v[252:253], v[254:255]
    s_waitcnt lgkmcnt(3)
    v_mfma_f32_32x32x16_bf16 v[16:31], a[72:75], a[176:179], v[16:31]
    ds_read_b128 a[172:175], v221 offset:40960
    v_cvt_pk_bf16_f32 v118, v248, v249
    v_cvt_pk_bf16_f32 v119, v250, v251
    v_accvgpr_write_b32 a102, v118
    v_accvgpr_write_b32 a103, v119
    v_lshlrev_b32 v244, 16, v120
    v_and_b32 v245, s86, v120
    v_lshlrev_b32 v246, 16, v121
    v_and_b32 v247, s86, v121
    v_pk_fma_f32 v[244:245], v[244:245], v[252:253], v[254:255]
    v_pk_fma_f32 v[246:247], v[246:247], v[252:253], v[254:255]
    v_mfma_f32_32x32x16_bf16 v[32:47], a[72:75], a[180:183], v[32:47]
    ds_read_b128 a[176:179], v222 offset:32768
    buffer_load_dwordx4 v4, s[16:19], s32 offen offset:2048 lds
    v_cvt_pk_bf16_f32 v120, v244, v245
    v_cvt_pk_bf16_f32 v121, v246, v247
    v_accvgpr_write_b32 a104, v120
    v_accvgpr_write_b32 a105, v121
    v_lshlrev_b32 v248, 16, v122
    v_and_b32 v249, s86, v122
    v_lshlrev_b32 v250, 16, v123
    v_and_b32 v251, s86, v123
    v_pk_fma_f32 v[248:249], v[248:249], v[252:253], v[254:255]
    v_pk_fma_f32 v[250:251], v[250:251], v[252:253], v[254:255]
    v_mfma_f32_32x32x16_bf16 v[16:31], a[76:79], a[184:187], v[16:31]
    ds_read_b128 a[180:183], v222 offset:40960
    v_cvt_pk_bf16_f32 v122, v248, v249
    v_cvt_pk_bf16_f32 v123, v250, v251
    v_accvgpr_write_b32 a106, v122
    v_accvgpr_write_b32 a107, v123
    v_lshlrev_b32 v244, 16, v124
    v_and_b32 v245, s86, v124
    v_lshlrev_b32 v246, 16, v125
    v_and_b32 v247, s86, v125
    v_pk_fma_f32 v[244:245], v[244:245], v[252:253], v[254:255]
    v_pk_fma_f32 v[246:247], v[246:247], v[252:253], v[254:255]
    v_mfma_f32_32x32x16_bf16 v[32:47], a[76:79], a[188:191], v[32:47]
    ds_read_b128 a[184:187], v223 offset:32768
    buffer_load_dwordx4 v5, s[16:19], s32 offen offset:3072 lds
    v_cvt_pk_bf16_f32 v124, v244, v245
    v_cvt_pk_bf16_f32 v125, v246, v247
    v_accvgpr_write_b32 a108, v124
    v_accvgpr_write_b32 a109, v125
    v_lshlrev_b32_e64 v248, 16, v126
    v_and_b32 v249, s86, v126
    v_lshlrev_b32 v250, 16, v127
    v_and_b32 v251, s86, v127
    v_pk_fma_f32 v[248:249], v[248:249], v[252:253], v[254:255]
    v_pk_fma_f32 v[250:251], v[250:251], v[252:253], v[254:255]
    s_waitcnt lgkmcnt(3)
    v_mfma_f32_32x32x16_bf16 v[16:31], a[80:83], a[160:163], v[16:31]
    ds_read_b128 a[188:191], v223 offset:40960
    v_cvt_pk_bf16_f32 v126, v248, v249
    v_cvt_pk_bf16_f32 v127, v250, v251
    v_accvgpr_write_b32 a110, v126
    v_accvgpr_write_b32 a111, v127
    v_lshlrev_b32 v244, 16, v128
    v_and_b32 v245, s86, v128
    v_lshlrev_b32 v246, 16, v129
    v_and_b32 v247, s86, v129
    v_pk_fma_f32 v[244:245], v[244:245], v[252:253], v[254:255]
    v_pk_fma_f32 v[246:247], v[246:247], v[252:253], v[254:255]
    v_mfma_f32_32x32x16_bf16 v[32:47], a[80:83], a[164:167], v[32:47]
    s_waitcnt vmcnt(21)
    s_barrier
    ds_read_b128 a[160:163], v216 offset:49152
    s_add_u32 m0, s78, 0
    s_add_u32 s32, s82, s74
    s_add_u32 s32, s32, 221184
    buffer_load_dwordx4 v2, s[16:19], s32 offen offset:0 lds
    v_cvt_pk_bf16_f32 v128, v244, v245
    v_cvt_pk_bf16_f32 v129, v246, v247
    v_accvgpr_write_b32 a112, v128
    v_accvgpr_write_b32 a113, v129
    v_lshlrev_b32 v248, 16, v130
    v_and_b32 v249, s86, v130
    v_lshlrev_b32 v250, 16, v131
    v_and_b32 v251, s86, v131
    v_pk_fma_f32 v[248:249], v[248:249], v[252:253], v[254:255]
    v_pk_fma_f32 v[250:251], v[250:251], v[252:253], v[254:255]
    v_mfma_f32_32x32x16_bf16 v[16:31], a[84:87], a[168:171], v[16:31]
    ds_read_b128 a[164:167], v216 offset:57344
    v_cvt_pk_bf16_f32 v130, v248, v249
    v_cvt_pk_bf16_f32 v131, v250, v251
    v_accvgpr_write_b32 a114, v130
    v_accvgpr_write_b32 a115, v131
    v_lshlrev_b32 v244, 16, v132
    v_and_b32 v245, s86, v132
    v_lshlrev_b32 v246, 16, v133
    v_and_b32 v247, s86, v133
    v_pk_fma_f32 v[244:245], v[244:245], v[252:253], v[254:255]
    v_pk_fma_f32 v[246:247], v[246:247], v[252:253], v[254:255]
    v_mfma_f32_32x32x16_bf16 v[32:47], a[84:87], a[172:175], v[32:47]
    ds_read_b128 a[168:171], v217 offset:49152
    buffer_load_dwordx4 v3, s[16:19], s32 offen offset:1024 lds
    v_cvt_pk_bf16_f32 v132, v244, v245
    v_cvt_pk_bf16_f32 v133, v246, v247
    v_accvgpr_write_b32 a116, v132
    v_accvgpr_write_b32 a117, v133
    v_lshlrev_b32_e64 v248, 16, v134
    v_and_b32 v249, s86, v134
    v_lshlrev_b32 v250, 16, v135
    v_and_b32 v251, s86, v135
    v_pk_fma_f32 v[248:249], v[248:249], v[252:253], v[254:255]
    v_pk_fma_f32 v[250:251], v[250:251], v[252:253], v[254:255]
    s_waitcnt lgkmcnt(3)
    v_mfma_f32_32x32x16_bf16 v[16:31], a[88:91], a[176:179], v[16:31]
    ds_read_b128 a[172:175], v217 offset:57344
    v_cvt_pk_bf16_f32 v134, v248, v249
    v_cvt_pk_bf16_f32 v135, v250, v251
    v_accvgpr_write_b32 a118, v134
    v_accvgpr_write_b32 a119, v135
    v_lshlrev_b32 v244, 16, v136
    v_and_b32 v245, s86, v136
    v_lshlrev_b32 v246, 16, v137
    v_and_b32 v247, s86, v137
    v_pk_fma_f32 v[244:245], v[244:245], v[252:253], v[254:255]
    v_pk_fma_f32 v[246:247], v[246:247], v[252:253], v[254:255]
    v_mfma_f32_32x32x16_bf16 v[32:47], a[88:91], a[180:183], v[32:47]
    ds_read_b128 a[176:179], v218 offset:49152
    buffer_load_dwordx4 v4, s[16:19], s32 offen offset:2048 lds
    v_cvt_pk_bf16_f32 v136, v244, v245
    v_cvt_pk_bf16_f32 v137, v246, v247
    v_accvgpr_write_b32 a120, v136
    v_accvgpr_write_b32 a121, v137
    v_lshlrev_b32 v248, 16, v138
    v_and_b32 v249, s86, v138
    v_lshlrev_b32 v250, 16, v139
    v_and_b32 v251, s86, v139
    v_pk_fma_f32 v[248:249], v[248:249], v[252:253], v[254:255]
    v_pk_fma_f32 v[250:251], v[250:251], v[252:253], v[254:255]
    v_mfma_f32_32x32x16_bf16 v[16:31], a[92:95], a[184:187], v[16:31]
    ds_read_b128 a[180:183], v218 offset:57344
    v_cvt_pk_bf16_f32 v138, v248, v249
    v_cvt_pk_bf16_f32 v139, v250, v251
    v_accvgpr_write_b32 a122, v138
    v_accvgpr_write_b32 a123, v139
    v_lshlrev_b32 v244, 16, v140
    v_and_b32 v245, s86, v140
    v_lshlrev_b32 v246, 16, v141
    v_and_b32 v247, s86, v141
    v_pk_fma_f32 v[244:245], v[244:245], v[252:253], v[254:255]
    v_pk_fma_f32 v[246:247], v[246:247], v[252:253], v[254:255]
    v_mfma_f32_32x32x16_bf16 v[32:47], a[92:95], a[188:191], v[32:47]
    ds_read_b128 a[184:187], v219 offset:49152
    buffer_load_dwordx4 v5, s[16:19], s32 offen offset:3072 lds
    v_cvt_pk_bf16_f32 v140, v244, v245
    v_cvt_pk_bf16_f32 v141, v246, v247
    v_accvgpr_write_b32 a124, v140
    v_accvgpr_write_b32 a125, v141
    v_lshlrev_b32_e64 v248, 16, v142
    v_and_b32 v249, s86, v142
    v_lshlrev_b32 v250, 16, v143
    v_and_b32 v251, s86, v143
    v_pk_fma_f32 v[248:249], v[248:249], v[252:253], v[254:255]
    v_pk_fma_f32 v[250:251], v[250:251], v[252:253], v[254:255]
    s_waitcnt lgkmcnt(3)
    v_mfma_f32_32x32x16_bf16 v[16:31], a[96:99], a[160:163], v[16:31]
    ds_read_b128 a[188:191], v219 offset:57344
    v_cvt_pk_bf16_f32 v142, v248, v249
    v_cvt_pk_bf16_f32 v143, v250, v251
    v_accvgpr_write_b32 a126, v142
    v_accvgpr_write_b32 a127, v143
    v_lshlrev_b32_e64 v244, 16, v144
    v_and_b32 v245, s86, v144
    v_lshlrev_b32 v246, 16, v145
    v_and_b32 v247, s86, v145
    v_pk_fma_f32 v[244:245], v[244:245], v[252:253], v[254:255]
    v_pk_fma_f32 v[246:247], v[246:247], v[252:253], v[254:255]
    v_mfma_f32_32x32x16_bf16 v[32:47], a[96:99], a[164:167], v[32:47]
    ds_read_b128 a[160:163], v220 offset:49152
    s_add_u32 m0, s78, 16384
    s_add_u32 s32, s82, s75
    buffer_load_dwordx4 v2, s[16:19], s32 offen offset:0 lds
    v_cvt_pk_bf16_f32 v144, v244, v245
    v_cvt_pk_bf16_f32 v145, v246, v247
    v_accvgpr_write_b32 a128, v144
    v_accvgpr_write_b32 a129, v145
    v_lshlrev_b32 v248, 16, v146
    v_and_b32 v249, s86, v146
    v_lshlrev_b32 v250, 16, v147
    v_and_b32 v251, s86, v147
    v_pk_fma_f32 v[248:249], v[248:249], v[252:253], v[254:255]
    v_pk_fma_f32 v[250:251], v[250:251], v[252:253], v[254:255]
    v_mfma_f32_32x32x16_bf16 v[16:31], a[100:103], a[168:171], v[16:31]
    ds_read_b128 a[164:167], v220 offset:57344
    v_cvt_pk_bf16_f32 v146, v248, v249
    v_cvt_pk_bf16_f32 v147, v250, v251
    v_accvgpr_write_b32 a130, v146
    v_accvgpr_write_b32 a131, v147
    v_lshlrev_b32 v244, 16, v148
    v_and_b32 v245, s86, v148
    v_lshlrev_b32 v246, 16, v149
    v_and_b32 v247, s86, v149
    v_pk_fma_f32 v[244:245], v[244:245], v[252:253], v[254:255]
    v_pk_fma_f32 v[246:247], v[246:247], v[252:253], v[254:255]
    v_mfma_f32_32x32x16_bf16 v[32:47], a[100:103], a[172:175], v[32:47]
    ds_read_b128 a[168:171], v221 offset:49152
    v_cvt_pk_bf16_f32 v148, v244, v245
    v_cvt_pk_bf16_f32 v149, v246, v247
    v_accvgpr_write_b32 a132, v148
    v_accvgpr_write_b32 a133, v149
    v_lshlrev_b32_e64 v248, 16, v150
    v_and_b32 v249, s86, v150
    v_lshlrev_b32 v250, 16, v151
    v_and_b32 v251, s86, v151
    v_pk_fma_f32 v[248:249], v[248:249], v[252:253], v[254:255]
    v_pk_fma_f32 v[250:251], v[250:251], v[252:253], v[254:255]
    s_waitcnt lgkmcnt(3)
    v_mfma_f32_32x32x16_bf16 v[16:31], a[104:107], a[176:179], v[16:31]
    ds_read_b128 a[172:175], v221 offset:57344
    v_cvt_pk_bf16_f32 v150, v248, v249
    v_cvt_pk_bf16_f32 v151, v250, v251
    v_accvgpr_write_b32 a134, v150
    v_accvgpr_write_b32 a135, v151
    v_lshlrev_b32 v244, 16, v152
    v_and_b32 v245, s86, v152
    v_lshlrev_b32 v246, 16, v153
    v_and_b32 v247, s86, v153
    v_pk_fma_f32 v[244:245], v[244:245], v[252:253], v[254:255]
    v_pk_fma_f32 v[246:247], v[246:247], v[252:253], v[254:255]
    v_mfma_f32_32x32x16_bf16 v[32:47], a[104:107], a[180:183], v[32:47]
    ds_read_b128 a[176:179], v222 offset:49152
    buffer_load_dwordx4 v3, s[16:19], s32 offen offset:1024 lds
    v_cvt_pk_bf16_f32 v152, v244, v245
    v_cvt_pk_bf16_f32 v153, v246, v247
    v_accvgpr_write_b32 a136, v152
    v_accvgpr_write_b32 a137, v153
    v_lshlrev_b32 v248, 16, v154
    v_and_b32 v249, s86, v154
    v_lshlrev_b32 v250, 16, v155
    v_and_b32 v251, s86, v155
    v_pk_fma_f32 v[248:249], v[248:249], v[252:253], v[254:255]
    v_pk_fma_f32 v[250:251], v[250:251], v[252:253], v[254:255]
    v_mfma_f32_32x32x16_bf16 v[16:31], a[108:111], a[184:187], v[16:31]
    ds_read_b128 a[180:183], v222 offset:57344
    v_cvt_pk_bf16_f32 v154, v248, v249
    v_cvt_pk_bf16_f32 v155, v250, v251
    v_accvgpr_write_b32 a138, v154
    v_accvgpr_write_b32 a139, v155
    v_lshlrev_b32 v244, 16, v156
    v_and_b32 v245, s86, v156
    v_lshlrev_b32 v246, 16, v157
    v_and_b32 v247, s86, v157
    v_pk_fma_f32 v[244:245], v[244:245], v[252:253], v[254:255]
    v_pk_fma_f32 v[246:247], v[246:247], v[252:253], v[254:255]
    v_mfma_f32_32x32x16_bf16 v[32:47], a[108:111], a[188:191], v[32:47]
    ds_read_b128 a[184:187], v223 offset:49152
    v_cvt_pk_bf16_f32 v156, v244, v245
    v_cvt_pk_bf16_f32 v157, v246, v247
    v_accvgpr_write_b32 a140, v156
    v_accvgpr_write_b32 a141, v157
    v_lshlrev_b32_e64 v248, 16, v158
    v_and_b32 v249, s86, v158
    v_lshlrev_b32 v250, 16, v159
    v_and_b32 v251, s86, v159
    v_pk_fma_f32 v[248:249], v[248:249], v[252:253], v[254:255]
    v_pk_fma_f32 v[250:251], v[250:251], v[252:253], v[254:255]
    s_waitcnt lgkmcnt(3)
    v_mfma_f32_32x32x16_bf16 v[16:31], a[112:115], a[160:163], v[16:31]
    ds_read_b128 a[188:191], v223 offset:57344
    v_cvt_pk_bf16_f32 v158, v248, v249
    v_cvt_pk_bf16_f32 v159, v250, v251
    v_accvgpr_write_b32 a142, v158
    v_accvgpr_write_b32 a143, v159
    v_lshlrev_b32 v244, 16, v160
    v_and_b32 v245, s86, v160
    v_lshlrev_b32 v246, 16, v161
    v_and_b32 v247, s86, v161
    v_pk_fma_f32 v[244:245], v[244:245], v[252:253], v[254:255]
    v_pk_fma_f32 v[246:247], v[246:247], v[252:253], v[254:255]
    v_mfma_f32_32x32x16_bf16 v[32:47], a[112:115], a[164:167], v[32:47]
    s_waitcnt vmcnt(23)
    s_barrier
    ds_read_b128 a[160:163], v224 offset:0
    buffer_load_dwordx4 v4, s[16:19], s32 offen offset:2048 lds
    v_cvt_pk_bf16_f32 v160, v244, v245
    v_cvt_pk_bf16_f32 v161, v246, v247
    v_accvgpr_write_b32 a144, v160
    v_accvgpr_write_b32 a145, v161
    v_lshlrev_b32 v248, 16, v162
    v_and_b32 v249, s86, v162
    v_lshlrev_b32 v250, 16, v163
    v_and_b32 v251, s86, v163
    v_pk_fma_f32 v[248:249], v[248:249], v[252:253], v[254:255]
    v_pk_fma_f32 v[250:251], v[250:251], v[252:253], v[254:255]
    v_mfma_f32_32x32x16_bf16 v[16:31], a[116:119], a[168:171], v[16:31]
    ds_read_b128 a[164:167], v224 offset:8192
    v_cvt_pk_bf16_f32 v162, v248, v249
    v_cvt_pk_bf16_f32 v163, v250, v251
    v_accvgpr_write_b32 a146, v162
    v_accvgpr_write_b32 a147, v163
    v_lshlrev_b32 v244, 16, v164
    v_and_b32 v245, s86, v164
    v_lshlrev_b32 v246, 16, v165
    v_and_b32 v247, s86, v165
    v_pk_fma_f32 v[244:245], v[244:245], v[252:253], v[254:255]
    v_pk_fma_f32 v[246:247], v[246:247], v[252:253], v[254:255]
    v_mfma_f32_32x32x16_bf16 v[32:47], a[116:119], a[172:175], v[32:47]
    ds_read_b128 a[168:171], v225 offset:0
    buffer_load_dwordx4 v5, s[16:19], s32 offen offset:3072 lds
    v_cvt_pk_bf16_f32 v164, v244, v245
    v_cvt_pk_bf16_f32 v165, v246, v247
    v_accvgpr_write_b32 a148, v164
    v_accvgpr_write_b32 a149, v165
    v_lshlrev_b32_e64 v248, 16, v166
    v_and_b32 v249, s86, v166
    v_lshlrev_b32 v250, 16, v167
    v_and_b32 v251, s86, v167
    v_pk_fma_f32 v[248:249], v[248:249], v[252:253], v[254:255]
    v_pk_fma_f32 v[250:251], v[250:251], v[252:253], v[254:255]
    s_waitcnt lgkmcnt(3)
    v_mfma_f32_32x32x16_bf16 v[16:31], a[120:123], a[176:179], v[16:31]
    ds_read_b128 a[172:175], v225 offset:8192
    v_cvt_pk_bf16_f32 v166, v248, v249
    v_cvt_pk_bf16_f32 v167, v250, v251
    v_accvgpr_write_b32 a150, v166
    v_accvgpr_write_b32 a151, v167
    v_lshlrev_b32_e64 v244, 16, v168
    v_and_b32 v245, s86, v168
    v_lshlrev_b32 v246, 16, v169
    v_and_b32 v247, s86, v169
    v_pk_fma_f32 v[244:245], v[244:245], v[252:253], v[254:255]
    v_pk_fma_f32 v[246:247], v[246:247], v[252:253], v[254:255]
    v_mfma_f32_32x32x16_bf16 v[32:47], a[120:123], a[180:183], v[32:47]
    ds_read_b128 a[176:179], v226 offset:0
    s_add_u32 m0, s78, 32768
    s_add_u32 s32, s82, s75
    s_add_u32 s32, s32, 221184
    buffer_load_dwordx4 v2, s[16:19], s32 offen offset:0 lds
    v_cvt_pk_bf16_f32 v168, v244, v245
    v_cvt_pk_bf16_f32 v169, v246, v247
    v_accvgpr_write_b32 a152, v168
    v_accvgpr_write_b32 a153, v169
    v_lshlrev_b32 v248, 16, v170
    v_and_b32 v249, s86, v170
    v_lshlrev_b32 v250, 16, v171
    v_and_b32 v251, s86, v171
    v_pk_fma_f32 v[248:249], v[248:249], v[252:253], v[254:255]
    v_pk_fma_f32 v[250:251], v[250:251], v[252:253], v[254:255]
    v_mfma_f32_32x32x16_bf16 v[16:31], a[124:127], a[184:187], v[16:31]
    ds_read_b128 a[180:183], v226 offset:8192
    v_cvt_pk_bf16_f32 v170, v248, v249
    v_cvt_pk_bf16_f32 v171, v250, v251
    v_accvgpr_write_b32 a154, v170
    v_accvgpr_write_b32 a155, v171
    v_lshlrev_b32 v244, 16, v172
    v_and_b32 v245, s86, v172
    v_lshlrev_b32 v246, 16, v173
    v_and_b32 v247, s86, v173
    v_pk_fma_f32 v[244:245], v[244:245], v[252:253], v[254:255]
    v_pk_fma_f32 v[246:247], v[246:247], v[252:253], v[254:255]
    v_mfma_f32_32x32x16_bf16 v[32:47], a[124:127], a[188:191], v[32:47]
    ds_read_b128 a[184:187], v227 offset:0
    v_cvt_pk_bf16_f32 v172, v244, v245
    v_cvt_pk_bf16_f32 v173, v246, v247
    v_accvgpr_write_b32 a156, v172
    v_accvgpr_write_b32 a157, v173
    v_lshlrev_b32_e64 v248, 16, v174
    v_and_b32 v249, s86, v174
    v_lshlrev_b32 v250, 16, v175
    v_and_b32 v251, s86, v175
    v_pk_fma_f32 v[248:249], v[248:249], v[252:253], v[254:255]
    v_pk_fma_f32 v[250:251], v[250:251], v[252:253], v[254:255]
    s_waitcnt lgkmcnt(3)
    v_mfma_f32_32x32x16_bf16 v[16:31], a[128:131], a[160:163], v[16:31]
    ds_read_b128 a[188:191], v227 offset:8192
    v_cvt_pk_bf16_f32 v174, v248, v249
    v_cvt_pk_bf16_f32 v175, v250, v251
    v_accvgpr_write_b32 a158, v174
    v_accvgpr_write_b32 a159, v175
    s_cmp_eq_u32 s3, 1
    s_cbranch_scc1 FORK_ALT_B
    v_mfma_f32_32x32x16_bf16 v[32:47], a[128:131], a[164:167], v[32:47]
    ds_read_b128 a[160:163], v228 offset:0
    buffer_load_dwordx4 v3, s[16:19], s32 offen offset:1024 lds
    v_lshrrev_b32 v188, 5, v1
    v_lshlrev_b32 v188, 4, v188
    v_bfe_u32 v189, v1, 2, 3
    v_mfma_f32_32x32x16_bf16 v[16:31], a[132:135], a[168:171], v[16:31]
    ds_read_b128 a[164:167], v228 offset:8192
    v_add_u32_e64 v188, v188, v189
    v_mul_u32_u24 v188, 160, v188
    v_and_b32_e64 v189, 3, v1
    v_lshl_add_u32 v188, v189, 3, v188
    v_add_u32_e64 v188, s93, v188
    v_mfma_f32_32x32x16_bf16 v[32:47], a[132:135], a[172:175], v[32:47]
    ds_read_b128 a[168:171], v229 offset:0
    s_waitcnt vmcnt(18)
    ds_read_b64_tr_b16 v[190:191], v188 offset:0
    ds_read_b64_tr_b16 v[192:193], v188 offset:1280
    s_waitcnt lgkmcnt(5)
    v_mfma_f32_32x32x16_bf16 v[16:31], a[136:139], a[176:179], v[16:31]
    ds_read_b128 a[172:175], v229 offset:8192
    ds_read_b64_tr_b16 v[194:195], v188 offset:32
    ds_read_b64_tr_b16 v[196:197], v188 offset:1312
    ds_read_b64_tr_b16 v[198:199], v188 offset:64
    ds_read_b64_tr_b16 v[200:201], v188 offset:1344
    v_mfma_f32_32x32x16_bf16 v[32:47], a[136:139], a[180:183], v[32:47]
    ds_read_b128 a[176:179], v230 offset:0
    buffer_load_dwordx4 v4, s[16:19], s32 offen offset:2048 lds
    ds_read_b64_tr_b16 v[202:203], v188 offset:96
    ds_read_b64_tr_b16 v[204:205], v188 offset:1376
    v_mfma_f32_32x32x16_bf16 v[16:31], a[140:143], a[184:187], v[16:31]
    ds_read_b128 a[180:183], v230 offset:8192
    ds_read_b64_tr_b16 v[206:207], v188 offset:128
    ds_read_b64_tr_b16 v[208:209], v188 offset:1408
    v_mfma_f32_32x32x16_bf16 v[32:47], a[140:143], a[188:191], v[32:47]
    ds_read_b128 a[184:187], v231 offset:0
    s_waitcnt lgkmcnt(11)
    v_mfma_f32_32x32x16_bf16 v[16:31], a[144:147], a[160:163], v[16:31]
    ds_read_b128 a[188:191], v231 offset:8192
    s_waitcnt lgkmcnt(2)
    v_mfma_f32_32x32x16_bf16 v[32:47], a[144:147], a[164:167], v[32:47]
    s_barrier
    ds_read_b64_tr_b16 a[160:161], v8 offset:16384
    ds_read_b64_tr_b16 a[162:163], v8 offset:16896
    buffer_load_dwordx4 v5, s[16:19], s32 offen offset:3072 lds
    v_mfma_f32_32x32x16_bf16 v[16:31], a[148:151], a[168:171], v[16:31]
    ds_read_b64_tr_b16 a[164:165], v8 offset:24576
    ds_read_b64_tr_b16 a[166:167], v8 offset:25088
    buffer_store_dwordx4 v[190:193], v236, s[20:23], s89 offen sc1
    s_add_u32 s89, s89, 1024
    v_mfma_f32_32x32x16_bf16 v[32:47], a[148:151], a[172:175], v[32:47]
    ds_read_b64_tr_b16 a[168:169], v9 offset:16384
    ds_read_b64_tr_b16 a[170:171], v9 offset:16896
    s_waitcnt lgkmcnt(6)
    v_mfma_f32_32x32x16_bf16 v[16:31], a[152:155], a[176:179], v[16:31]
    ds_read_b64_tr_b16 a[172:173], v9 offset:24576
    ds_read_b64_tr_b16 a[174:175], v9 offset:25088
    buffer_store_dwordx4 v[194:197], v236, s[20:23], s89 offen sc1
    s_add_u32 s89, s89, 1024
    v_mfma_f32_32x32x16_bf16 v[32:47], a[152:155], a[180:183], v[32:47]
    ds_read_b64_tr_b16 a[176:177], v8 offset:18432
    ds_read_b64_tr_b16 a[178:179], v8 offset:18944
    s_add_u32 m0, s78, 49152
    s_add_u32 s32, s82, s76
    buffer_load_dwordx4 v2, s[16:19], s32 offen offset:0 lds
    v_mfma_f32_32x32x16_bf16 v[16:31], a[156:159], a[184:187], v[16:31]
    ds_read_b64_tr_b16 a[180:181], v8 offset:26624
    ds_read_b64_tr_b16 a[182:183], v8 offset:27136
    buffer_store_dwordx4 v[198:201], v236, s[20:23], s89 offen sc1
    s_add_u32 s89, s89, 1024
    v_mfma_f32_32x32x16_bf16 v[32:47], a[156:159], a[188:191], v[32:47]
    ds_read_b64_tr_b16 a[184:185], v9 offset:18432
    ds_read_b64_tr_b16 a[186:187], v9 offset:18944
    s_waitcnt lgkmcnt(6)
    v_mfma_f32_32x32x16_bf16 v[48:63], a[160:163], a[0:3], 0
    ds_read_b64_tr_b16 a[188:189], v9 offset:26624
    ds_read_b64_tr_b16 a[190:191], v9 offset:27136
    buffer_store_dwordx4 v[202:205], v236, s[20:23], s89 offen sc1
    s_add_u32 s89, s89, 1024
    v_mfma_f32_32x32x16_bf16 v[64:79], a[164:167], a[0:3], 0
    ds_read_b64_tr_b16 a[160:161], v8 offset:20480
    ds_read_b64_tr_b16 a[162:163], v8 offset:20992
    buffer_load_dwordx4 v3, s[16:19], s32 offen offset:1024 lds
    v_mfma_f32_32x32x16_bf16 v[80:95], a[168:171], a[0:3], 0
    ds_read_b64_tr_b16 a[164:165], v8 offset:28672
    ds_read_b64_tr_b16 a[166:167], v8 offset:29184
    buffer_store_dwordx4 v[206:209], v236, s[20:23], s89 offen sc1
    v_mfma_f32_32x32x16_bf16 v[96:111], a[172:175], a[0:3], 0
    ds_read_b64_tr_b16 a[168:169], v9 offset:20480
    ds_read_b64_tr_b16 a[170:171], v9 offset:20992
    s_waitcnt lgkmcnt(6)
    v_mfma_f32_32x32x16_bf16 v[48:63], a[176:179], a[4:7], v[48:63]
    ds_read_b64_tr_b16 a[172:173], v9 offset:28672
    ds_read_b64_tr_b16 a[174:175], v9 offset:29184
    s_branch FORK_JOIN_B
FORK_ALT_B:
    v_mfma_f32_32x32x16_bf16 v[32:47], a[128:131], a[164:167], v[32:47]
    ds_read_b128 a[160:163], v228 offset:0
    buffer_load_dwordx4 v3, s[16:19], s32 offen offset:1024 lds
    v_and_b32_e64 v188, 15, v1
    v_lshlrev_b32 v188, 7, v188
    v_lshrrev_b32 v189, 5, v1
    v_mfma_f32_32x32x16_bf16 v[16:31], a[132:135], a[168:171], v[16:31]
    ds_read_b128 a[164:167], v228 offset:8192
    v_xor_b32 v189, v189, v1
    v_and_b32 v189, 7, v189
    v_lshl_add_u32 v188, v189, 4, v188
    v_bfe_u32 v189, v1, 4, 1
    v_lshl_add_u32 v188, v189, 3, v188
    v_mfma_f32_32x32x16_bf16 v[32:47], a[132:135], a[172:175], v[32:47]
    ds_read_b128 a[168:171], v229 offset:0
    v_add_u32 v188, s93, v188
    s_waitcnt vmcnt(18)
    ds_read_b64 v[148:149], v188 offset:0
    ds_read_b64 v[150:151], v188 offset:2048
    s_waitcnt lgkmcnt(5)
    v_mfma_f32_32x32x16_bf16 v[16:31], a[136:139], a[176:179], v[16:31]
    ds_read_b128 a[172:175], v229 offset:8192
    v_xor_b32 v189, 32, v188
    ds_read_b64 v[152:153], v189 offset:0
    ds_read_b64 v[154:155], v189 offset:2048
    v_xor_b32_e64 v189, 64, v188
    ds_read_b64 v[156:157], v189 offset:0
    ds_read_b64 v[158:159], v189 offset:2048
    v_mfma_f32_32x32x16_bf16 v[32:47], a[136:139], a[180:183], v[32:47]
    ds_read_b128 a[176:179], v230 offset:0
    buffer_load_dwordx4 v4, s[16:19], s32 offen offset:2048 lds
    v_xor_b32 v189, 96, v188
    ds_read_b64 v[160:161], v189 offset:0
    ds_read_b64 v[162:163], v189 offset:2048
    v_mfma_f32_32x32x16_bf16 v[16:31], a[140:143], a[184:187], v[16:31]
    ds_read_b128 a[180:183], v230 offset:8192
    ds_read_b64 v[164:165], v188 offset:0
    ds_read_b64 v[166:167], v188 offset:2048
    s_mov_b32 s34, 0x05040100
    s_mov_b32 s35, 0x07060302
    v_mfma_f32_32x32x16_bf16 v[32:47], a[140:143], a[188:191], v[32:47]
    ds_read_b128 a[184:187], v231 offset:0
    s_waitcnt lgkmcnt(11)
    v_mfma_f32_32x32x16_bf16 v[16:31], a[144:147], a[160:163], v[16:31]
    ds_read_b128 a[188:191], v231 offset:8192
    s_waitcnt lgkmcnt(2)
    v_perm_b32 v190, v150, v148, s34
    v_perm_b32 v191, v150, v148, s35
    v_perm_b32 v192, v151, v149, s34
    v_perm_b32 v193, v151, v149, s35
    v_mfma_f32_32x32x16_bf16 v[32:47], a[144:147], a[164:167], v[32:47]
    s_barrier
    s_nop 0
    ds_read_b64_tr_b16 a[160:161], v8 offset:16384
    ds_read_b64_tr_b16 a[162:163], v8 offset:16896
    buffer_load_dwordx4 v5, s[16:19], s32 offen offset:3072 lds
    v_mfma_f32_32x32x16_bf16 v[16:31], a[148:151], a[168:171], v[16:31]
    ds_read_b64_tr_b16 a[164:165], v8 offset:24576
    ds_read_b64_tr_b16 a[166:167], v8 offset:25088
    buffer_store_dwordx4 v[190:193], v236, s[20:23], s89 offen sc1
    s_add_u32 s89, s89, 5120
    v_perm_b32 v194, v154, v152, s34
    v_mfma_f32_32x32x16_bf16 v[32:47], a[148:151], a[172:175], v[32:47]
    ds_read_b64_tr_b16 a[168:169], v9 offset:16384
    ds_read_b64_tr_b16 a[170:171], v9 offset:16896
    v_perm_b32 v195, v154, v152, s35
    v_perm_b32 v196, v155, v153, s34
    v_perm_b32 v197, v155, v153, s35
    s_waitcnt lgkmcnt(6)
    v_mfma_f32_32x32x16_bf16 v[16:31], a[152:155], a[176:179], v[16:31]
    ds_read_b64_tr_b16 a[172:173], v9 offset:24576
    ds_read_b64_tr_b16 a[174:175], v9 offset:25088
    buffer_store_dwordx4 v[194:197], v236, s[20:23], s89 offen sc1
    s_add_u32 s89, s89, 5120
    v_perm_b32 v198, v158, v156, s34
    v_mfma_f32_32x32x16_bf16 v[32:47], a[152:155], a[180:183], v[32:47]
    ds_read_b64_tr_b16 a[176:177], v8 offset:18432
    ds_read_b64_tr_b16 a[178:179], v8 offset:18944
    s_add_u32 m0, s78, 49152
    s_add_u32 s32, s82, s76
    buffer_load_dwordx4 v2, s[16:19], s32 offen offset:0 lds
    v_mfma_f32_32x32x16_bf16 v[16:31], a[156:159], a[184:187], v[16:31]
    ds_read_b64_tr_b16 a[180:181], v8 offset:26624
    ds_read_b64_tr_b16 a[182:183], v8 offset:27136
    v_perm_b32 v199, v158, v156, s35
    v_perm_b32 v200, v159, v157, s34
    v_perm_b32 v201, v159, v157, s35
    buffer_store_dwordx4 v[198:201], v236, s[20:23], s89 offen sc1
    v_mfma_f32_32x32x16_bf16 v[32:47], a[156:159], a[188:191], v[32:47]
    ds_read_b64_tr_b16 a[184:185], v9 offset:18432
    ds_read_b64_tr_b16 a[186:187], v9 offset:18944
    s_add_u32 s89, s89, 5120
    v_perm_b32 v202, v162, v160, s34
    v_perm_b32 v203, v162, v160, s35
    s_waitcnt lgkmcnt(6)
    s_nop 0
    v_mfma_f32_32x32x16_bf16 v[48:63], a[160:163], a[0:3], 0
    ds_read_b64_tr_b16 a[188:189], v9 offset:26624
    ds_read_b64_tr_b16 a[190:191], v9 offset:27136
    v_perm_b32 v204, v163, v161, s34
    v_perm_b32 v205, v163, v161, s35
    buffer_store_dwordx4 v[202:205], v236, s[20:23], s89 offen sc1
    v_mfma_f32_32x32x16_bf16 v[64:79], a[164:167], a[0:3], 0
    ds_read_b64_tr_b16 a[160:161], v8 offset:20480
    ds_read_b64_tr_b16 a[162:163], v8 offset:20992
    buffer_load_dwordx4 v3, s[16:19], s32 offen offset:1024 lds
    s_add_u32 s89, s89, 1073741824
    v_mfma_f32_32x32x16_bf16 v[80:95], a[168:171], a[0:3], 0
    ds_read_b64_tr_b16 a[164:165], v8 offset:28672
    ds_read_b64_tr_b16 a[166:167], v8 offset:29184
    buffer_store_dwordx4 v[206:209], v236, s[20:23], s89 offen sc1
    v_mfma_f32_32x32x16_bf16 v[96:111], a[172:175], a[0:3], 0
    ds_read_b64_tr_b16 a[168:169], v9 offset:20480
    ds_read_b64_tr_b16 a[170:171], v9 offset:20992
    s_waitcnt lgkmcnt(6)
    v_mfma_f32_32x32x16_bf16 v[48:63], a[176:179], a[4:7], v[48:63]
    ds_read_b64_tr_b16 a[172:173], v9 offset:28672
    ds_read_b64_tr_b16 a[174:175], v9 offset:29184
FORK_JOIN_B:
    ds_write2_b32 v0, v252, v254 offset1:1
    v_add_u32 v0, 0x1000, v236
    v_mov_b32_e64 v248, 0
    v_min_u32 v249, 6, v12
    v_sub_u32 v249, v249, v12
    v_lshl_add_u32 v249, v249, 3, v15
    ds_write2_b32 v249, v248, v248 offset1:1
    v_mfma_f32_32x32x16_bf16 v[64:79], a[180:183], a[4:7], v[64:79]
    ds_read_b64_tr_b16 a[176:177], v8 offset:22528
    ds_read_b64_tr_b16 a[178:179], v8 offset:23040
    buffer_load_dwordx4 v4, s[16:19], s32 offen offset:2048 lds
    v_fma_f32 v244, -v177, v32, v17
    v_fma_f32 v245, v177, v16, v33
    v_mfma_f32_32x32x16_bf16 v[80:95], a[184:187], a[4:7], v[80:95]
    ds_read_b64_tr_b16 a[180:181], v8 offset:30720
    ds_read_b64_tr_b16 a[182:183], v8 offset:31232
    v_fma_f32 v244, v176, v16, v244
    v_fma_f32 v245, v176, v32, v245
    v_fma_f32 v246, -v177, v245, v18
    v_fma_f32 v247, v177, v244, v34
    v_mfma_f32_32x32x16_bf16 v[96:111], a[188:191], a[4:7], v[96:111]
    ds_read_b64_tr_b16 a[184:185], v9 offset:22528
    ds_read_b64_tr_b16 a[186:187], v9 offset:23040
    v_fma_f32 v246, v176, v244, v246
    v_fmac_f32 v247, v176, v245
    v_fma_f32 v244, -v177, v247, v19
    s_waitcnt lgkmcnt(8)
    v_mfma_f32_32x32x16_bf16 v[48:63], a[160:163], a[8:11], v[48:63]
    ds_read_b64_tr_b16 a[188:189], v9 offset:30720
    ds_read_b64_tr_b16 a[190:191], v9 offset:31232
    v_fma_f32 v245, v177, v246, v35
    v_fma_f32 v244, v176, v246, v244
    v_fma_f32 v245, v176, v247, v245
    v_fma_f32 v246, -v177, v245, v20
    v_mfma_f32_32x32x16_bf16 v[64:79], a[164:167], a[8:11], v[64:79]
    s_waitcnt vmcnt(24)
    s_barrier
    ds_read_b64_tr_b16 a[160:161], v8 offset:32768
    ds_read_b64_tr_b16 a[162:163], v8 offset:33280
    buffer_load_dwordx4 v5, s[16:19], s32 offen offset:3072 lds
    v_mfma_f32_32x32x16_bf16 v[80:95], a[168:171], a[8:11], v[80:95]
    ds_read_b64_tr_b16 a[164:165], v8 offset:40960
    ds_read_b64_tr_b16 a[166:167], v8 offset:41472
    v_fma_f32 v247, v177, v244, v36
    v_fma_f32 v246, v176, v244, v246
    v_fma_f32 v247, v176, v245, v247
    v_fma_f32 v244, -v177, v247, v21
    v_mfma_f32_32x32x16_bf16 v[96:111], a[172:175], a[8:11], v[96:111]
    ds_read_b64_tr_b16 a[168:169], v9 offset:32768
    ds_read_b64_tr_b16 a[170:171], v9 offset:33280
    v_fma_f32 v245, v177, v246, v37
    v_fma_f32 v244, v176, v246, v244
    v_fmac_f32 v245, v176, v247
    s_waitcnt lgkmcnt(6)
    v_mfma_f32_32x32x16_bf16 v[48:63], a[176:179], a[12:15], v[48:63]
    ds_read_b64_tr_b16 a[172:173], v9 offset:40960
    ds_read_b64_tr_b16 a[174:175], v9 offset:41472
    v_fma_f32 v246, -v177, v245, v22
    v_fma_f32 v247, v177, v244, v38
    v_fma_f32 v246, v176, v244, v246
    v_fmac_f32 v247, v176, v245
    v_mfma_f32_32x32x16_bf16 v[64:79], a[180:183], a[12:15], v[64:79]
    ds_read_b64_tr_b16 a[176:177], v8 offset:34816
    ds_read_b64_tr_b16 a[178:179], v8 offset:35328
    s_add_u32 m0, s78, 65536
    s_add_u32 s32, s82, s76
    s_add_u32 s32, s32, 221184
    buffer_load_dwordx4 v2, s[16:19], s32 offen offset:0 lds
    v_mfma_f32_32x32x16_bf16 v[80:95], a[184:187], a[12:15], v[80:95]
    ds_read_b64_tr_b16 a[180:181], v8 offset:43008
    ds_read_b64_tr_b16 a[182:183], v8 offset:43520
    v_fma_f32 v244, -v177, v247, v23
    v_fma_f32 v245, v177, v246, v39
    v_fma_f32 v244, v176, v246, v244
    v_fma_f32 v245, v176, v247, v245
    v_mfma_f32_32x32x16_bf16 v[96:111], a[188:191], a[12:15], v[96:111]
    ds_read_b64_tr_b16 a[184:185], v9 offset:34816
    ds_read_b64_tr_b16 a[186:187], v9 offset:35328
    v_fma_f32 v246, -v177, v245, v24
    v_fma_f32 v247, v177, v244, v40
    v_fmac_f32 v246, v176, v244
    s_waitcnt lgkmcnt(6)
    v_mfma_f32_32x32x16_bf16 v[48:63], a[160:163], a[16:19], v[48:63]
    ds_read_b64_tr_b16 a[188:189], v9 offset:43008
    ds_read_b64_tr_b16 a[190:191], v9 offset:43520
    v_fma_f32 v247, v176, v245, v247
    v_fma_f32 v244, -v177, v247, v25
    v_fma_f32 v245, v177, v246, v41
    v_fma_f32 v244, v176, v246, v244
    v_mfma_f32_32x32x16_bf16 v[64:79], a[164:167], a[16:19], v[64:79]
    ds_read_b64_tr_b16 a[160:161], v8 offset:36864
    ds_read_b64_tr_b16 a[162:163], v8 offset:37376
    buffer_load_dwordx4 v3, s[16:19], s32 offen offset:1024 lds
    v_fma_f32 v245, v176, v247, v245
    v_fma_f32 v246, -v177, v245, v26
    v_mfma_f32_32x32x16_bf16 v[80:95], a[168:171], a[16:19], v[80:95]
    ds_read_b64_tr_b16 a[164:165], v8 offset:45056
    ds_read_b64_tr_b16 a[166:167], v8 offset:45568
    v_fma_f32 v247, v177, v244, v42
    v_fma_f32 v246, v176, v244, v246
    v_fma_f32 v247, v176, v245, v247
    v_fma_f32 v244, -v177, v247, v27
    v_mfma_f32_32x32x16_bf16 v[96:111], a[172:175], a[16:19], v[96:111]
    ds_read_b64_tr_b16 a[168:169], v9 offset:36864
    ds_read_b64_tr_b16 a[170:171], v9 offset:37376
    v_fma_f32 v245, v177, v246, v43
    v_fma_f32 v244, v176, v246, v244
    v_fmac_f32 v245, v176, v247
    s_waitcnt lgkmcnt(6)
    v_mfma_f32_32x32x16_bf16 v[48:63], a[176:179], a[20:23], v[48:63]
    ds_read_b64_tr_b16 a[172:173], v9 offset:45056
    ds_read_b64_tr_b16 a[174:175], v9 offset:45568
    v_fma_f32 v246, -v177, v245, v28
    v_fma_f32 v247, v177, v244, v44
    v_fma_f32 v246, v176, v244, v246
    v_fma_f32 v247, v176, v245, v247
    v_mfma_f32_32x32x16_bf16 v[64:79], a[180:183], a[20:23], v[64:79]
    ds_read_b64_tr_b16 a[176:177], v8 offset:38912
    ds_read_b64_tr_b16 a[178:179], v8 offset:39424
    buffer_load_dwordx4 v4, s[16:19], s32 offen offset:2048 lds
    v_fma_f32 v244, -v177, v247, v29
    v_fma_f32 v245, v177, v246, v45
    v_mfma_f32_32x32x16_bf16 v[80:95], a[184:187], a[20:23], v[80:95]
    ds_read_b64_tr_b16 a[180:181], v8 offset:47104
    ds_read_b64_tr_b16 a[182:183], v8 offset:47616
    v_fma_f32 v244, v176, v246, v244
    v_fma_f32 v245, v176, v247, v245
    v_fma_f32 v246, -v177, v245, v30
    v_fma_f32 v247, v177, v244, v46
    v_mfma_f32_32x32x16_bf16 v[96:111], a[188:191], a[20:23], v[96:111]
    ds_read_b64_tr_b16 a[184:185], v9 offset:38912
    ds_read_b64_tr_b16 a[186:187], v9 offset:39424
    v_fma_f32 v246, v176, v244, v246
    v_fmac_f32 v247, v176, v245
    v_fma_f32 v244, -v177, v247, v31
    s_waitcnt lgkmcnt(6)
    v_mfma_f32_32x32x16_bf16 v[48:63], a[160:163], a[24:27], v[48:63]
    ds_read_b64_tr_b16 a[188:189], v9 offset:47104
    ds_read_b64_tr_b16 a[190:191], v9 offset:47616
    v_fma_f32 v245, v177, v246, v47
    v_fma_f32 v244, v176, v246, v244
    v_fma_f32 v245, v176, v247, v245
    ds_write2_b32 v15, v244, v245 offset0:14 offset1:15
    v_mfma_f32_32x32x16_bf16 v[64:79], a[164:167], a[24:27], v[64:79]
    s_waitcnt vmcnt(24)
    s_barrier
    ds_read_b64_tr_b16 a[160:161], v8 offset:49152
    ds_read_b64_tr_b16 a[162:163], v8 offset:49664
    buffer_load_dwordx4 v5, s[16:19], s32 offen offset:3072 lds
    v_mfma_f32_32x32x16_bf16 v[80:95], a[168:171], a[24:27], v[80:95]
    ds_read_b64_tr_b16 a[164:165], v8 offset:57344
    ds_read_b64_tr_b16 a[166:167], v8 offset:57856
    v_mfma_f32_32x32x16_bf16 v[96:111], a[172:175], a[24:27], v[96:111]
    ds_read_b64_tr_b16 a[168:169], v9 offset:49152
    ds_read_b64_tr_b16 a[170:171], v9 offset:49664
    s_waitcnt lgkmcnt(7)
    s_nop 0
    v_mfma_f32_32x32x16_bf16 v[48:63], a[176:179], a[28:31], v[48:63]
    ds_read_b64_tr_b16 a[172:173], v9 offset:57344
    ds_read_b64_tr_b16 a[174:175], v9 offset:57856
    v_mfma_f32_32x32x16_bf16 v[64:79], a[180:183], a[28:31], v[64:79]
    ds_read_b64_tr_b16 a[176:177], v8 offset:51200
    ds_read_b64_tr_b16 a[178:179], v8 offset:51712
    s_add_u32 m0, s78, 81920
    s_add_u32 s32, s82, s77
    buffer_load_dwordx4 v2, s[16:19], s32 offen offset:0 lds
    v_mfma_f32_32x32x16_bf16 v[80:95], a[184:187], a[28:31], v[80:95]
    ds_read_b64_tr_b16 a[180:181], v8 offset:59392
    ds_read_b64_tr_b16 a[182:183], v8 offset:59904
    v_mfma_f32_32x32x16_bf16 v[96:111], a[188:191], a[28:31], v[96:111]
    ds_read_b64_tr_b16 a[184:185], v9 offset:51200
    ds_read_b64_tr_b16 a[186:187], v9 offset:51712
    s_waitcnt lgkmcnt(6)
    v_mfma_f32_32x32x16_bf16 v[48:63], a[160:163], a[32:35], v[48:63]
    ds_read_b64_tr_b16 a[188:189], v9 offset:59392
    ds_read_b64_tr_b16 a[190:191], v9 offset:59904
    v_mfma_f32_32x32x16_bf16 v[64:79], a[164:167], a[32:35], v[64:79]
    ds_read_b64_tr_b16 a[160:161], v8 offset:53248
    ds_read_b64_tr_b16 a[162:163], v8 offset:53760
    buffer_load_dwordx4 v3, s[16:19], s32 offen offset:1024 lds
    v_mfma_f32_32x32x16_bf16 v[80:95], a[168:171], a[32:35], v[80:95]
    ds_read_b64_tr_b16 a[164:165], v8 offset:61440
    ds_read_b64_tr_b16 a[166:167], v8 offset:61952
    v_mfma_f32_32x32x16_bf16 v[96:111], a[172:175], a[32:35], v[96:111]
    ds_read_b64_tr_b16 a[168:169], v9 offset:53248
    ds_read_b64_tr_b16 a[170:171], v9 offset:53760
    s_waitcnt lgkmcnt(6)
    v_mfma_f32_32x32x16_bf16 v[48:63], a[176:179], a[36:39], v[48:63]
    ds_read_b64_tr_b16 a[172:173], v9 offset:61440
    ds_read_b64_tr_b16 a[174:175], v9 offset:61952
    v_mfma_f32_32x32x16_bf16 v[64:79], a[180:183], a[36:39], v[64:79]
    ds_read_b64_tr_b16 a[176:177], v8 offset:55296
    ds_read_b64_tr_b16 a[178:179], v8 offset:55808
    buffer_load_dwordx4 v4, s[16:19], s32 offen offset:2048 lds
    v_mfma_f32_32x32x16_bf16 v[80:95], a[184:187], a[36:39], v[80:95]
    ds_read_b64_tr_b16 a[180:181], v8 offset:63488
    ds_read_b64_tr_b16 a[182:183], v8 offset:64000
    v_mfma_f32_32x32x16_bf16 v[96:111], a[188:191], a[36:39], v[96:111]
    ds_read_b64_tr_b16 a[184:185], v9 offset:55296
    ds_read_b64_tr_b16 a[186:187], v9 offset:55808
    s_waitcnt lgkmcnt(6)
    v_mfma_f32_32x32x16_bf16 v[48:63], a[160:163], a[40:43], v[48:63]
    ds_read_b64_tr_b16 a[188:189], v9 offset:63488
    ds_read_b64_tr_b16 a[190:191], v9 offset:64000
    v_mfma_f32_32x32x16_bf16 v[64:79], a[164:167], a[40:43], v[64:79]
    s_waitcnt vmcnt(24)
    s_barrier
    ds_read_b64_tr_b16 a[160:161], v6 offset:0
    ds_read_b64_tr_b16 a[162:163], v6 offset:512
    buffer_load_dwordx4 v5, s[16:19], s32 offen offset:3072 lds
    v_mfma_f32_32x32x16_bf16 v[80:95], a[168:171], a[40:43], v[80:95]
    ds_read_b64_tr_b16 a[164:165], v6 offset:8192
    ds_read_b64_tr_b16 a[166:167], v6 offset:8704
    ds_read2_b64 v[188:191], v15 offset0:0 offset1:1
    ds_read2_b64 v[192:195], v15 offset0:2 offset1:3
    ds_read2_b64 v[196:199], v15 offset0:4 offset1:5
    ds_read_b64 v[200:201], v15 offset:48
    v_mfma_f32_32x32x16_bf16 v[96:111], a[172:175], a[40:43], v[96:111]
    ds_read_b64_tr_b16 a[168:169], v7 offset:0
    ds_read_b64_tr_b16 a[170:171], v7 offset:512
    v_mov_b32 v249, s85
    v_mov_b32 v251, s85
    s_add_u32 s34, s80, 0
    s_waitcnt lgkmcnt(10)
    v_mfma_f32_32x32x16_bf16 v[48:63], a[176:179], a[44:47], v[48:63]
    ds_read_b64_tr_b16 a[172:173], v7 offset:8192
    ds_read_b64_tr_b16 a[174:175], v7 offset:8704
    s_mul_i32 s34, s34, 8704
    s_add_u32 s34, s34, 16842752
    v_mfma_f32_32x32x16_bf16 v[64:79], a[180:183], a[44:47], v[64:79]
    ds_read_b64_tr_b16 a[176:177], v6 offset:2048
    ds_read_b64_tr_b16 a[178:179], v6 offset:2560
    s_add_u32 m0, s78, 98304
    s_add_u32 s32, s82, s77
    s_add_u32 s32, s32, 221184
    buffer_load_dwordx4 v2, s[16:19], s32 offen offset:0 lds
    v_mfma_f32_32x32x16_bf16 v[80:95], a[184:187], a[44:47], v[80:95]
    ds_read_b64_tr_b16 a[180:181], v6 offset:10240
    ds_read_b64_tr_b16 a[182:183], v6 offset:10752
    v_mfma_f32_32x32x16_bf16 v[96:111], a[188:191], a[44:47], v[96:111]
    ds_read_b64_tr_b16 a[184:185], v7 offset:2048
    ds_read_b64_tr_b16 a[186:187], v7 offset:2560
    s_waitcnt lgkmcnt(6)
    v_mfma_f32_32x32x16_bf16 v[48:63], a[160:163], a[48:51], v[48:63]
    ds_read_b64_tr_b16 a[188:189], v7 offset:10240
    ds_read_b64_tr_b16 a[190:191], v7 offset:10752
    v_fma_f32 v190, -v181, v189, v190
    v_fma_f32 v191, v181, v188, v191
    v_fma_f32 v190, v180, v188, v190
    v_fma_f32 v191, v180, v189, v191
    v_mfma_f32_32x32x16_bf16 v[64:79], a[164:167], a[48:51], v[64:79]
    ds_read_b64_tr_b16 a[160:161], v6 offset:4096
    ds_read_b64_tr_b16 a[162:163], v6 offset:4608
    buffer_load_dwordx4 v3, s[16:19], s32 offen offset:1024 lds
    v_fma_f32 v192, -v181, v191, v192
    v_fma_f32 v193, v181, v190, v193
    v_mfma_f32_32x32x16_bf16 v[80:95], a[168:171], a[48:51], v[80:95]
    ds_read_b64_tr_b16 a[164:165], v6 offset:12288
    ds_read_b64_tr_b16 a[166:167], v6 offset:12800
    v_fma_f32 v192, v180, v190, v192
    v_fma_f32 v193, v180, v191, v193
    v_fma_f32 v194, -v181, v193, v194
    v_fma_f32 v195, v181, v192, v195
    v_mfma_f32_32x32x16_bf16 v[96:111], a[172:175], a[48:51], v[96:111]
    ds_read_b64_tr_b16 a[168:169], v7 offset:4096
    ds_read_b64_tr_b16 a[170:171], v7 offset:4608
    v_fma_f32 v194, v180, v192, v194
    v_fmac_f32 v195, v180, v193
    v_fma_f32 v196, -v181, v195, v196
    s_waitcnt lgkmcnt(6)
    v_mfma_f32_32x32x16_bf16 v[48:63], a[176:179], a[52:55], v[48:63]
    ds_read_b64_tr_b16 a[172:173], v7 offset:12288
    ds_read_b64_tr_b16 a[174:175], v7 offset:12800
    v_fma_f32 v197, v181, v194, v197
    v_fma_f32 v196, v180, v194, v196
    v_fma_f32 v197, v180, v195, v197
    v_fma_f32 v198, -v181, v197, v198
    v_mfma_f32_32x32x16_bf16 v[64:79], a[180:183], a[52:55], v[64:79]
    ds_read_b64_tr_b16 a[176:177], v6 offset:6144
    ds_read_b64_tr_b16 a[178:179], v6 offset:6656
    buffer_load_dwordx4 v4, s[16:19], s32 offen offset:2048 lds
    v_fma_f32 v199, v181, v196, v199
    v_fma_f32 v198, v180, v196, v198
    v_mfma_f32_32x32x16_bf16 v[80:95], a[184:187], a[52:55], v[80:95]
    ds_read_b64_tr_b16 a[180:181], v6 offset:14336
    ds_read_b64_tr_b16 a[182:183], v6 offset:14848
    v_fma_f32 v199, v180, v197, v199
    v_fma_f32 v200, -v181, v199, v200
    v_fma_f32 v201, v181, v198, v201
    v_fma_f32 v237, v180, v198, v200
    v_mfma_f32_32x32x16_bf16 v[96:111], a[188:191], a[52:55], v[96:111]
    ds_read_b64_tr_b16 a[184:185], v7 offset:6144
    ds_read_b64_tr_b16 a[186:187], v7 offset:6656
    v_fma_f32 v238, v180, v199, v201
    v_fma_f32 v248, -v181, v238, v244
    v_fma_f32 v250, v181, v237, v245
    s_waitcnt lgkmcnt(6)
    v_mfma_f32_32x32x16_bf16 v[48:63], a[160:163], a[56:59], v[48:63]
    ds_read_b64_tr_b16 a[188:189], v7 offset:14336
    ds_read_b64_tr_b16 a[190:191], v7 offset:14848
    v_fmac_f32 v248, v180, v237
    v_fma_f32 v250, v180, v238, v250
    buffer_store_dwordx4 v[248:251], v13, s[20:23], s34 offen sc1
    v_mfma_f32_32x32x16_bf16 v[64:79], a[164:167], a[56:59], v[64:79]
    s_waitcnt vmcnt(25)
    s_barrier
    ds_read_b64_tr_b16 a[160:161], v6 offset:16384
    ds_read_b64_tr_b16 a[162:163], v6 offset:16896
    buffer_load_dwordx4 v5, s[16:19], s32 offen offset:3072 lds
    v_mfma_f32_32x32x16_bf16 v[80:95], a[168:171], a[56:59], v[80:95]
    ds_read_b64_tr_b16 a[164:165], v6 offset:24576
    ds_read_b64_tr_b16 a[166:167], v6 offset:25088
    v_mfma_f32_32x32x16_bf16 v[96:111], a[172:175], a[56:59], v[96:111]
    ds_read_b64_tr_b16 a[168:169], v7 offset:16384
    ds_read_b64_tr_b16 a[170:171], v7 offset:16896
    s_waitcnt lgkmcnt(6)
    s_nop 0
    v_mfma_f32_32x32x16_bf16 v[48:63], a[176:179], a[60:63], v[48:63]
    ds_read_b64_tr_b16 a[172:173], v7 offset:24576
    ds_read_b64_tr_b16 a[174:175], v7 offset:25088
    v_mfma_f32_32x32x16_bf16 v[64:79], a[180:183], a[60:63], v[64:79]
    ds_read_b64_tr_b16 a[176:177], v6 offset:18432
    ds_read_b64_tr_b16 a[178:179], v6 offset:18944
    v_mfma_f32_32x32x16_bf16 v[80:95], a[184:187], a[60:63], v[80:95]
    ds_read_b64_tr_b16 a[180:181], v6 offset:26624
    ds_read_b64_tr_b16 a[182:183], v6 offset:27136
    v_mfma_f32_32x32x16_bf16 v[96:111], a[188:191], a[60:63], v[96:111]
    ds_read_b64_tr_b16 a[184:185], v7 offset:18432
    ds_read_b64_tr_b16 a[186:187], v7 offset:18944
    s_waitcnt lgkmcnt(6)
    v_mfma_f32_32x32x16_bf16 v[48:63], a[160:163], a[64:67], v[48:63]
    ds_read_b64_tr_b16 a[188:189], v7 offset:26624
    ds_read_b64_tr_b16 a[190:191], v7 offset:27136
    v_mfma_f32_32x32x16_bf16 v[64:79], a[164:167], a[64:67], v[64:79]
    ds_read_b64_tr_b16 a[160:161], v6 offset:20480
    ds_read_b64_tr_b16 a[162:163], v6 offset:20992
    v_mfma_f32_32x32x16_bf16 v[80:95], a[168:171], a[64:67], v[80:95]
    ds_read_b64_tr_b16 a[164:165], v6 offset:28672
    ds_read_b64_tr_b16 a[166:167], v6 offset:29184
    v_mfma_f32_32x32x16_bf16 v[96:111], a[172:175], a[64:67], v[96:111]
    ds_read_b64_tr_b16 a[168:169], v7 offset:20480
    ds_read_b64_tr_b16 a[170:171], v7 offset:20992
    s_waitcnt lgkmcnt(6)
    v_mfma_f32_32x32x16_bf16 v[48:63], a[176:179], a[68:71], v[48:63]
    ds_read_b64_tr_b16 a[172:173], v7 offset:28672
    ds_read_b64_tr_b16 a[174:175], v7 offset:29184
    v_mfma_f32_32x32x16_bf16 v[64:79], a[180:183], a[68:71], v[64:79]
    ds_read_b64_tr_b16 a[176:177], v6 offset:22528
    ds_read_b64_tr_b16 a[178:179], v6 offset:23040
    v_mfma_f32_32x32x16_bf16 v[80:95], a[184:187], a[68:71], v[80:95]
    ds_read_b64_tr_b16 a[180:181], v6 offset:30720
    ds_read_b64_tr_b16 a[182:183], v6 offset:31232
    v_mfma_f32_32x32x16_bf16 v[96:111], a[188:191], a[68:71], v[96:111]
    ds_read_b64_tr_b16 a[184:185], v7 offset:22528
    ds_read_b64_tr_b16 a[186:187], v7 offset:23040
    s_waitcnt lgkmcnt(6)
    v_mfma_f32_32x32x16_bf16 v[48:63], a[160:163], a[72:75], v[48:63]
    ds_read_b64_tr_b16 a[188:189], v7 offset:30720
    ds_read_b64_tr_b16 a[190:191], v7 offset:31232
    v_mfma_f32_32x32x16_bf16 v[64:79], a[164:167], a[72:75], v[64:79]
    s_waitcnt vmcnt(22)
    s_barrier
    ds_read_b64_tr_b16 a[160:161], v6 offset:32768
    ds_read_b64_tr_b16 a[162:163], v6 offset:33280
    v_mfma_f32_32x32x16_bf16 v[80:95], a[168:171], a[72:75], v[80:95]
    ds_read_b64_tr_b16 a[164:165], v6 offset:40960
    ds_read_b64_tr_b16 a[166:167], v6 offset:41472
    v_mfma_f32_32x32x16_bf16 v[96:111], a[172:175], a[72:75], v[96:111]
    ds_read_b64_tr_b16 a[168:169], v7 offset:32768
    ds_read_b64_tr_b16 a[170:171], v7 offset:33280
    s_waitcnt lgkmcnt(6)
    v_mfma_f32_32x32x16_bf16 v[48:63], a[176:179], a[76:79], v[48:63]
    ds_read_b64_tr_b16 a[172:173], v7 offset:40960
    ds_read_b64_tr_b16 a[174:175], v7 offset:41472
    v_mfma_f32_32x32x16_bf16 v[64:79], a[180:183], a[76:79], v[64:79]
    ds_read_b64_tr_b16 a[176:177], v6 offset:34816
    ds_read_b64_tr_b16 a[178:179], v6 offset:35328
    v_mfma_f32_32x32x16_bf16 v[80:95], a[184:187], a[76:79], v[80:95]
    ds_read_b64_tr_b16 a[180:181], v6 offset:43008
    ds_read_b64_tr_b16 a[182:183], v6 offset:43520
    v_mfma_f32_32x32x16_bf16 v[96:111], a[188:191], a[76:79], v[96:111]
    ds_read_b64_tr_b16 a[184:185], v7 offset:34816
    ds_read_b64_tr_b16 a[186:187], v7 offset:35328
    s_waitcnt lgkmcnt(6)
    v_mfma_f32_32x32x16_bf16 v[48:63], a[160:163], a[80:83], v[48:63]
    ds_read_b64_tr_b16 a[188:189], v7 offset:43008
    ds_read_b64_tr_b16 a[190:191], v7 offset:43520
    v_mfma_f32_32x32x16_bf16 v[64:79], a[164:167], a[80:83], v[64:79]
    ds_read_b64_tr_b16 a[160:161], v6 offset:36864
    ds_read_b64_tr_b16 a[162:163], v6 offset:37376
    v_mfma_f32_32x32x16_bf16 v[80:95], a[168:171], a[80:83], v[80:95]
    ds_read_b64_tr_b16 a[164:165], v6 offset:45056
    ds_read_b64_tr_b16 a[166:167], v6 offset:45568
    v_mfma_f32_32x32x16_bf16 v[96:111], a[172:175], a[80:83], v[96:111]
    ds_read_b64_tr_b16 a[168:169], v7 offset:36864
    ds_read_b64_tr_b16 a[170:171], v7 offset:37376
    s_waitcnt lgkmcnt(6)
    v_mfma_f32_32x32x16_bf16 v[48:63], a[176:179], a[84:87], v[48:63]
    ds_read_b64_tr_b16 a[172:173], v7 offset:45056
    ds_read_b64_tr_b16 a[174:175], v7 offset:45568
    v_mfma_f32_32x32x16_bf16 v[64:79], a[180:183], a[84:87], v[64:79]
    ds_read_b64_tr_b16 a[176:177], v6 offset:38912
    ds_read_b64_tr_b16 a[178:179], v6 offset:39424
    v_mfma_f32_32x32x16_bf16 v[80:95], a[184:187], a[84:87], v[80:95]
    ds_read_b64_tr_b16 a[180:181], v6 offset:47104
    ds_read_b64_tr_b16 a[182:183], v6 offset:47616
    v_mfma_f32_32x32x16_bf16 v[96:111], a[188:191], a[84:87], v[96:111]
    ds_read_b64_tr_b16 a[184:185], v7 offset:38912
    ds_read_b64_tr_b16 a[186:187], v7 offset:39424
    s_waitcnt lgkmcnt(6)
    v_mfma_f32_32x32x16_bf16 v[48:63], a[160:163], a[88:91], v[48:63]
    ds_read_b64_tr_b16 a[188:189], v7 offset:47104
    ds_read_b64_tr_b16 a[190:191], v7 offset:47616
    v_mfma_f32_32x32x16_bf16 v[64:79], a[164:167], a[88:91], v[64:79]
    s_waitcnt vmcnt(13)
    s_barrier
    s_lshl_b32 s33, s6, 4
    s_add_u32 s33, s33, s5
    s_lshl_b32 s33, s33, 7
    s_add_u32 s33, s33, 24117248
    s_cmp_eq_u32 s4, 0
    s_cselect_b32 s33, s33, 1073741824
    v_mov_b32 v224, s85
    s_mov_b64 exec, 1
    buffer_store_dword v224, off, s[20:23], s33 sc1
    s_mov_b64 exec, -1
    ds_read_b64_tr_b16 a[160:161], v6 offset:49152
    ds_read_b64_tr_b16 a[162:163], v6 offset:49664
    v_mfma_f32_32x32x16_bf16 v[80:95], a[168:171], a[88:91], v[80:95]
    ds_read_b64_tr_b16 a[164:165], v6 offset:57344
    ds_read_b64_tr_b16 a[166:167], v6 offset:57856
    v_mfma_f32_32x32x16_bf16 v[96:111], a[172:175], a[88:91], v[96:111]
    ds_read_b64_tr_b16 a[168:169], v7 offset:49152
    ds_read_b64_tr_b16 a[170:171], v7 offset:49664
    s_waitcnt lgkmcnt(6)
    v_mfma_f32_32x32x16_bf16 v[48:63], a[176:179], a[92:95], v[48:63]
    ds_read_b64_tr_b16 a[172:173], v7 offset:57344
    ds_read_b64_tr_b16 a[174:175], v7 offset:57856
    v_mfma_f32_32x32x16_bf16 v[64:79], a[180:183], a[92:95], v[64:79]
    ds_read_b64_tr_b16 a[176:177], v6 offset:51200
    ds_read_b64_tr_b16 a[178:179], v6 offset:51712
    v_mfma_f32_32x32x16_bf16 v[80:95], a[184:187], a[92:95], v[80:95]
    ds_read_b64_tr_b16 a[180:181], v6 offset:59392
    ds_read_b64_tr_b16 a[182:183], v6 offset:59904
    v_mfma_f32_32x32x16_bf16 v[96:111], a[188:191], a[92:95], v[96:111]
    ds_read_b64_tr_b16 a[184:185], v7 offset:51200
    ds_read_b64_tr_b16 a[186:187], v7 offset:51712
    s_waitcnt lgkmcnt(6)
    v_mfma_f32_32x32x16_bf16 v[48:63], a[160:163], a[96:99], v[48:63]
    ds_read_b64_tr_b16 a[188:189], v7 offset:59392
    ds_read_b64_tr_b16 a[190:191], v7 offset:59904
    v_mfma_f32_32x32x16_bf16 v[64:79], a[164:167], a[96:99], v[64:79]
    ds_read_b64_tr_b16 a[160:161], v6 offset:53248
    ds_read_b64_tr_b16 a[162:163], v6 offset:53760
    v_mfma_f32_32x32x16_bf16 v[80:95], a[168:171], a[96:99], v[80:95]
    ds_read_b64_tr_b16 a[164:165], v6 offset:61440
    ds_read_b64_tr_b16 a[166:167], v6 offset:61952
    v_mfma_f32_32x32x16_bf16 v[96:111], a[172:175], a[96:99], v[96:111]
    ds_read_b64_tr_b16 a[168:169], v7 offset:53248
    ds_read_b64_tr_b16 a[170:171], v7 offset:53760
    s_waitcnt lgkmcnt(6)
    v_mfma_f32_32x32x16_bf16 v[48:63], a[176:179], a[100:103], v[48:63]
    ds_read_b64_tr_b16 a[172:173], v7 offset:61440
    ds_read_b64_tr_b16 a[174:175], v7 offset:61952
    v_mfma_f32_32x32x16_bf16 v[64:79], a[180:183], a[100:103], v[64:79]
    ds_read_b64_tr_b16 a[176:177], v6 offset:55296
    ds_read_b64_tr_b16 a[178:179], v6 offset:55808
    v_mfma_f32_32x32x16_bf16 v[80:95], a[184:187], a[100:103], v[80:95]
    ds_read_b64_tr_b16 a[180:181], v6 offset:63488
    ds_read_b64_tr_b16 a[182:183], v6 offset:64000
    v_mfma_f32_32x32x16_bf16 v[96:111], a[188:191], a[100:103], v[96:111]
    ds_read_b64_tr_b16 a[184:185], v7 offset:55296
    ds_read_b64_tr_b16 a[186:187], v7 offset:55808
    s_waitcnt lgkmcnt(6)
    v_mfma_f32_32x32x16_bf16 v[48:63], a[160:163], a[104:107], v[48:63]
    ds_read_b64_tr_b16 a[188:189], v7 offset:63488
    ds_read_b64_tr_b16 a[190:191], v7 offset:64000
    v_mfma_f32_32x32x16_bf16 v[64:79], a[164:167], a[104:107], v[64:79]
    s_waitcnt vmcnt(10)
    s_barrier
    ds_read_b64_tr_b16 a[160:161], v8 offset:0
    ds_read_b64_tr_b16 a[162:163], v8 offset:512
    v_mfma_f32_32x32x16_bf16 v[80:95], a[168:171], a[104:107], v[80:95]
    ds_read_b64_tr_b16 a[164:165], v8 offset:8192
    ds_read_b64_tr_b16 a[166:167], v8 offset:8704
    v_mfma_f32_32x32x16_bf16 v[96:111], a[172:175], a[104:107], v[96:111]
    ds_read_b64_tr_b16 a[168:169], v9 offset:0
    ds_read_b64_tr_b16 a[170:171], v9 offset:512
    s_waitcnt lgkmcnt(6)
    v_mfma_f32_32x32x16_bf16 v[48:63], a[176:179], a[108:111], v[48:63]
    ds_read_b64_tr_b16 a[172:173], v9 offset:8192
    ds_read_b64_tr_b16 a[174:175], v9 offset:8704
    v_mfma_f32_32x32x16_bf16 v[64:79], a[180:183], a[108:111], v[64:79]
    ds_read_b64_tr_b16 a[176:177], v8 offset:2048
    ds_read_b64_tr_b16 a[178:179], v8 offset:2560
    v_mfma_f32_32x32x16_bf16 v[80:95], a[184:187], a[108:111], v[80:95]
    ds_read_b64_tr_b16 a[180:181], v8 offset:10240
    ds_read_b64_tr_b16 a[182:183], v8 offset:10752
    v_mfma_f32_32x32x16_bf16 v[96:111], a[188:191], a[108:111], v[96:111]
    ds_read_b64_tr_b16 a[184:185], v9 offset:2048
    ds_read_b64_tr_b16 a[186:187], v9 offset:2560
    s_waitcnt lgkmcnt(6)
    v_mfma_f32_32x32x16_bf16 v[48:63], a[160:163], a[112:115], v[48:63]
    ds_read_b64_tr_b16 a[188:189], v9 offset:10240
    ds_read_b64_tr_b16 a[190:191], v9 offset:10752
    v_mfma_f32_32x32x16_bf16 v[64:79], a[164:167], a[112:115], v[64:79]
    ds_read_b64_tr_b16 a[160:161], v8 offset:4096
    ds_read_b64_tr_b16 a[162:163], v8 offset:4608
    v_mfma_f32_32x32x16_bf16 v[80:95], a[168:171], a[112:115], v[80:95]
    ds_read_b64_tr_b16 a[164:165], v8 offset:12288
    ds_read_b64_tr_b16 a[166:167], v8 offset:12800
    v_mfma_f32_32x32x16_bf16 v[96:111], a[172:175], a[112:115], v[96:111]
    ds_read_b64_tr_b16 a[168:169], v9 offset:4096
    ds_read_b64_tr_b16 a[170:171], v9 offset:4608
    s_waitcnt lgkmcnt(6)
    v_mfma_f32_32x32x16_bf16 v[48:63], a[176:179], a[116:119], v[48:63]
    ds_read_b64_tr_b16 a[172:173], v9 offset:12288
    ds_read_b64_tr_b16 a[174:175], v9 offset:12800
    v_mfma_f32_32x32x16_bf16 v[64:79], a[180:183], a[116:119], v[64:79]
    ds_read_b64_tr_b16 a[176:177], v8 offset:6144
    ds_read_b64_tr_b16 a[178:179], v8 offset:6656
    v_mfma_f32_32x32x16_bf16 v[80:95], a[184:187], a[116:119], v[80:95]
    ds_read_b64_tr_b16 a[180:181], v8 offset:14336
    ds_read_b64_tr_b16 a[182:183], v8 offset:14848
    v_mfma_f32_32x32x16_bf16 v[96:111], a[188:191], a[116:119], v[96:111]
    ds_read_b64_tr_b16 a[184:185], v9 offset:6144
    ds_read_b64_tr_b16 a[186:187], v9 offset:6656
    s_add_u32 s35, s80, 0
    s_mul_i32 s35, s35, 8704
    s_add_u32 s35, s35, 16842752
    s_waitcnt lgkmcnt(6)
    v_mfma_f32_32x32x16_bf16 v[48:63], a[160:163], a[120:123], v[48:63]
    ds_read_b64_tr_b16 a[188:189], v9 offset:14336
    ds_read_b64_tr_b16 a[190:191], v9 offset:14848
    s_mov_b32 s92, 0
    v_mov_b32 v220, v232
    v_max_i32_e64 v220, v220, v233
    buffer_load_dwordx4 v[188:191], v220, s[20:23], s35 offen sc1
    v_mfma_f32_32x32x16_bf16 v[64:79], a[164:167], a[120:123], v[64:79]
    s_waitcnt vmcnt(7)
    s_barrier
    ds_read_b64_tr_b16 a[160:161], v8 offset:16384
    ds_read_b64_tr_b16 a[162:163], v8 offset:16896
    v_add_u32 v220, 0xfffffc00, v232
    v_max_i32_e64 v220, v220, v233
    buffer_load_dwordx4 v[192:195], v220, s[20:23], s35 offen sc1
    v_mfma_f32_32x32x16_bf16 v[80:95], a[168:171], a[120:123], v[80:95]
    ds_read_b64_tr_b16 a[164:165], v8 offset:24576
    ds_read_b64_tr_b16 a[166:167], v8 offset:25088
    v_add_u32 v220, 0xfffff800, v232
    v_max_i32_e64 v220, v220, v233
    buffer_load_dwordx4 v[196:199], v220, s[20:23], s35 offen sc1
    v_mfma_f32_32x32x16_bf16 v[96:111], a[172:175], a[120:123], v[96:111]
    ds_read_b64_tr_b16 a[168:169], v9 offset:16384
    ds_read_b64_tr_b16 a[170:171], v9 offset:16896
    v_add_u32 v220, 0xfffff400, v232
    v_max_i32 v220, v220, v233
    buffer_load_dwordx4 v[200:203], v220, s[20:23], s35 offen sc1
    s_waitcnt lgkmcnt(6)
    v_mfma_f32_32x32x16_bf16 v[48:63], a[176:179], a[124:127], v[48:63]
    ds_read_b64_tr_b16 a[172:173], v9 offset:24576
    ds_read_b64_tr_b16 a[174:175], v9 offset:25088
    v_add_u32 v220, 0xfffff000, v232
    v_max_i32_e64 v220, v220, v233
    buffer_load_dwordx4 v[204:207], v220, s[20:23], s35 offen sc1
    v_mfma_f32_32x32x16_bf16 v[64:79], a[180:183], a[124:127], v[64:79]
    ds_read_b64_tr_b16 a[176:177], v8 offset:18432
    ds_read_b64_tr_b16 a[178:179], v8 offset:18944
    v_add_u32 v220, 0xffffec00, v232
    v_max_i32_e64 v220, v220, v233
    buffer_load_dwordx4 v[208:211], v220, s[20:23], s35 offen sc1
    v_mfma_f32_32x32x16_bf16 v[80:95], a[184:187], a[124:127], v[80:95]
    ds_read_b64_tr_b16 a[180:181], v8 offset:26624
    ds_read_b64_tr_b16 a[182:183], v8 offset:27136
    v_add_u32 v220, 0xffffe800, v232
    v_max_i32_e64 v220, v220, v233
    buffer_load_dwordx4 v[212:215], v220, s[20:23], s35 offen sc1
    v_mfma_f32_32x32x16_bf16 v[96:111], a[188:191], a[124:127], v[96:111]
    ds_read_b64_tr_b16 a[184:185], v9 offset:18432
    ds_read_b64_tr_b16 a[186:187], v9 offset:18944
    v_add_u32 v220, 0xffffe400, v232
    v_max_i32 v220, v220, v233
    buffer_load_dwordx4 v[216:219], v220, s[20:23], s35 offen sc1
    s_waitcnt lgkmcnt(6)
    v_mfma_f32_32x32x16_bf16 v[48:63], a[160:163], a[128:131], v[48:63]
    ds_read_b64_tr_b16 a[188:189], v9 offset:26624
    ds_read_b64_tr_b16 a[190:191], v9 offset:27136
    v_mfma_f32_32x32x16_bf16 v[64:79], a[164:167], a[128:131], v[64:79]
    ds_read_b64_tr_b16 a[160:161], v8 offset:20480
    ds_read_b64_tr_b16 a[162:163], v8 offset:20992
    v_mfma_f32_32x32x16_bf16 v[80:95], a[168:171], a[128:131], v[80:95]
    ds_read_b64_tr_b16 a[164:165], v8 offset:28672
    ds_read_b64_tr_b16 a[166:167], v8 offset:29184
    v_mfma_f32_32x32x16_bf16 v[96:111], a[172:175], a[128:131], v[96:111]
    ds_read_b64_tr_b16 a[168:169], v9 offset:20480
    ds_read_b64_tr_b16 a[170:171], v9 offset:20992
    s_waitcnt lgkmcnt(6)
    s_nop 0
    v_mfma_f32_32x32x16_bf16 v[48:63], a[176:179], a[132:135], v[48:63]
    ds_read_b64_tr_b16 a[172:173], v9 offset:28672
    ds_read_b64_tr_b16 a[174:175], v9 offset:29184
    v_mfma_f32_32x32x16_bf16 v[64:79], a[180:183], a[132:135], v[64:79]
    ds_read_b64_tr_b16 a[176:177], v8 offset:22528
    ds_read_b64_tr_b16 a[178:179], v8 offset:23040
    v_mfma_f32_32x32x16_bf16 v[80:95], a[184:187], a[132:135], v[80:95]
    ds_read_b64_tr_b16 a[180:181], v8 offset:30720
    ds_read_b64_tr_b16 a[182:183], v8 offset:31232
    v_mfma_f32_32x32x16_bf16 v[96:111], a[188:191], a[132:135], v[96:111]
    ds_read_b64_tr_b16 a[184:185], v9 offset:22528
    ds_read_b64_tr_b16 a[186:187], v9 offset:23040
    s_waitcnt lgkmcnt(6)
    v_mfma_f32_32x32x16_bf16 v[48:63], a[160:163], a[136:139], v[48:63]
    ds_read_b64_tr_b16 a[188:189], v9 offset:30720
    ds_read_b64_tr_b16 a[190:191], v9 offset:31232
    v_mfma_f32_32x32x16_bf16 v[64:79], a[164:167], a[136:139], v[64:79]
    s_waitcnt vmcnt(9)
    s_barrier
    ds_read_b64_tr_b16 a[160:161], v8 offset:32768
    ds_read_b64_tr_b16 a[162:163], v8 offset:33280
    v_mfma_f32_32x32x16_bf16 v[80:95], a[168:171], a[136:139], v[80:95]
    ds_read_b64_tr_b16 a[164:165], v8 offset:40960
    ds_read_b64_tr_b16 a[166:167], v8 offset:41472
    v_mfma_f32_32x32x16_bf16 v[96:111], a[172:175], a[136:139], v[96:111]
    ds_read_b64_tr_b16 a[168:169], v9 offset:32768
    ds_read_b64_tr_b16 a[170:171], v9 offset:33280
    s_waitcnt lgkmcnt(6)
    v_mfma_f32_32x32x16_bf16 v[48:63], a[176:179], a[140:143], v[48:63]
    ds_read_b64_tr_b16 a[172:173], v9 offset:40960
    ds_read_b64_tr_b16 a[174:175], v9 offset:41472
    v_mfma_f32_32x32x16_bf16 v[64:79], a[180:183], a[140:143], v[64:79]
    ds_read_b64_tr_b16 a[176:177], v8 offset:34816
    ds_read_b64_tr_b16 a[178:179], v8 offset:35328
    v_mfma_f32_32x32x16_bf16 v[80:95], a[184:187], a[140:143], v[80:95]
    ds_read_b64_tr_b16 a[180:181], v8 offset:43008
    ds_read_b64_tr_b16 a[182:183], v8 offset:43520
    v_mfma_f32_32x32x16_bf16 v[96:111], a[188:191], a[140:143], v[96:111]
    ds_read_b64_tr_b16 a[184:185], v9 offset:34816
    ds_read_b64_tr_b16 a[186:187], v9 offset:35328
    s_waitcnt lgkmcnt(6)
    v_mfma_f32_32x32x16_bf16 v[48:63], a[160:163], a[144:147], v[48:63]
    ds_read_b64_tr_b16 a[188:189], v9 offset:43008
    ds_read_b64_tr_b16 a[190:191], v9 offset:43520
    s_waitcnt vmcnt(0)
    v_mov_b32_e64 v221, s85
    v_bitop3_b32 v220, v189, v191, v221 bitop3:0x7e
    v_bitop3_b32 v223, v193, v195, v221 bitop3:0x7e
    v_mfma_f32_32x32x16_bf16 v[64:79], a[164:167], a[144:147], v[64:79]
    ds_read_b64_tr_b16 a[160:161], v8 offset:36864
    ds_read_b64_tr_b16 a[162:163], v8 offset:37376
    v_bitop3_b32 v222, v197, v199, v221 bitop3:0x7e
    v_or3_b32 v220, v220, v222, v223
    v_bitop3_b32 v223, v201, v203, v221 bitop3:0x7e
    v_bitop3_b32 v222, v205, v207, v221 bitop3:0x7e
    v_mfma_f32_32x32x16_bf16 v[80:95], a[168:171], a[144:147], v[80:95]
    ds_read_b64_tr_b16 a[164:165], v8 offset:45056
    ds_read_b64_tr_b16 a[166:167], v8 offset:45568
    v_or3_b32 v220, v220, v222, v223
    v_bitop3_b32 v223, v209, v211, v221 bitop3:0x7e
    v_bitop3_b32 v222, v213, v215, v221 bitop3:0x7e
    v_or3_b32 v220, v220, v222, v223
    v_mfma_f32_32x32x16_bf16 v[96:111], a[172:175], a[144:147], v[96:111]
    ds_read_b64_tr_b16 a[168:169], v9 offset:36864
    ds_read_b64_tr_b16 a[170:171], v9 offset:37376
    v_bitop3_b32 v223, v217, v219, v221 bitop3:0x7e
    v_or_b32_e64 v220, v220, v223
    v_cmp_ne_u32 vcc, 0, v220
    s_nop 1
    s_cbranch_vccnz LB_SLOW_B
LB_OK_B:
    s_waitcnt lgkmcnt(6)
    v_mfma_f32_32x32x16_bf16 v[48:63], a[176:179], a[148:151], v[48:63]
    ds_read_b64_tr_b16 a[172:173], v9 offset:45056
    ds_read_b64_tr_b16 a[174:175], v9 offset:45568
    v_mov_b32 v220, v216
    v_mov_b32 v221, v218
    v_fma_f32 v212, -v187, v221, v212
    v_fma_f32 v214, v187, v220, v214
    v_mfma_f32_32x32x16_bf16 v[64:79], a[180:183], a[148:151], v[64:79]
    ds_read_b64_tr_b16 a[176:177], v8 offset:38912
    ds_read_b64_tr_b16 a[178:179], v8 offset:39424
    v_fma_f32 v220, v186, v220, v212
    v_fma_f32 v221, v186, v221, v214
    v_fma_f32 v208, -v187, v221, v208
    v_fma_f32 v210, v187, v220, v210
    v_mfma_f32_32x32x16_bf16 v[80:95], a[184:187], a[148:151], v[80:95]
    ds_read_b64_tr_b16 a[180:181], v8 offset:47104
    ds_read_b64_tr_b16 a[182:183], v8 offset:47616
    v_fma_f32 v220, v186, v220, v208
    v_fma_f32 v221, v186, v221, v210
    v_fma_f32 v204, -v187, v221, v204
    v_fma_f32 v206, v187, v220, v206
    v_mfma_f32_32x32x16_bf16 v[96:111], a[188:191], a[148:151], v[96:111]
    ds_read_b64_tr_b16 a[184:185], v9 offset:38912
    ds_read_b64_tr_b16 a[186:187], v9 offset:39424
    v_fma_f32 v220, v186, v220, v204
    v_fma_f32 v221, v186, v221, v206
    v_fma_f32 v200, -v187, v221, v200
    s_waitcnt lgkmcnt(6)
    v_mfma_f32_32x32x16_bf16 v[48:63], a[160:163], a[152:155], v[48:63]
    ds_read_b64_tr_b16 a[188:189], v9 offset:47104
    ds_read_b64_tr_b16 a[190:191], v9 offset:47616
    v_fmac_f32 v202, v187, v220
    v_fma_f32 v220, v186, v220, v200
    v_fma_f32 v221, v186, v221, v202
    v_fma_f32 v196, -v187, v221, v196
    v_mfma_f32_32x32x16_bf16 v[64:79], a[164:167], a[152:155], v[64:79]
    v_fma_f32 v198, v187, v220, v198
    v_fma_f32 v220, v186, v220, v196
    v_fma_f32 v221, v186, v221, v198
    v_fma_f32 v192, -v187, v221, v192
    v_fma_f32 v194, v187, v220, v194
    v_fma_f32 v220, v186, v220, v192
    v_mfma_f32_32x32x16_bf16 v[80:95], a[168:171], a[152:155], v[80:95]
    v_fma_f32 v221, v186, v221, v194
    v_fma_f32 v188, -v187, v221, v188
    v_fma_f32 v190, v187, v220, v190
    v_fma_f32 v220, v186, v220, v188
    v_fma_f32 v221, v186, v221, v190
    v_mov_b32_e64 v188, v220
    v_mfma_f32_32x32x16_bf16 v[96:111], a[172:175], a[152:155], v[96:111]
    v_mov_b32_e64 v190, v220
    v_mov_b32 v189, v221
    v_mov_b32 v191, v221
    v_permlane32_swap_b32 v188, v190
    s_nop 0
    v_permlane32_swap_b32 v189, v191
    s_waitcnt lgkmcnt(0)
    v_mfma_f32_32x32x16_bf16 v[48:63], a[176:179], a[156:159], v[48:63]
    v_fma_f32 v188, -v185, v191, v188
    v_fma_f32 v189, v185, v190, v189
    v_fma_f32 v188, v184, v190, v188
    v_fma_f32 v189, v184, v191, v189
    v_fma_f32 v237, -v183, v189, v237
    v_fma_f32 v238, v183, v188, v238
    v_mfma_f32_32x32x16_bf16 v[64:79], a[180:183], a[156:159], v[64:79]
    v_fma_f32 v237, v182, v188, v237
    v_fma_f32 v238, v182, v189, v238
    v_fma_f32 v16, -v177, v238, v16
    v_fma_f32 v32, v177, v237, v32
    v_fma_f32 v16, v176, v237, v16
    v_fma_f32 v32, v176, v238, v32
    v_mfma_f32_32x32x16_bf16 v[80:95], a[184:187], a[156:159], v[80:95]
    v_mul_f32 v192, v178, v16
    v_mul_f32 v193, v178, v32
    v_fma_f32 v192, -v179, v32, v192
    v_fma_f32 v193, v179, v16, v193
    v_cvt_pk_bf16_f32 v194, v192, -v193
    ds_write_b32 v234, v194 offset:0
    v_mfma_f32_32x32x16_bf16 v[96:111], a[188:191], a[156:159], v[96:111]
    v_fma_f32 v17, -v177, v32, v17
    v_fma_f32 v33, v177, v16, v33
    v_fma_f32 v17, v176, v16, v17
    v_fma_f32 v33, v176, v32, v33
    v_mul_f32 v196, v178, v17
    v_mul_f32 v197, v178, v33
    v_fma_f32 v196, -v179, v33, v196
    v_fma_f32 v197, v179, v17, v197
    v_cvt_pk_bf16_f32 v198, v196, -v197
    ds_write_b32 v234, v198 offset:144
    v_fma_f32 v18, -v177, v33, v18
    v_fma_f32 v34, v177, v17, v34
    v_fma_f32 v18, v176, v17, v18
    v_fma_f32 v34, v176, v33, v34
    v_mul_f32 v192, v178, v18
    v_mul_f32 v193, v178, v34
    v_fma_f32 v192, -v179, v34, v192
    v_fma_f32 v193, v179, v18, v193
    v_cvt_pk_bf16_f32 v194, v192, -v193
    ds_write_b32 v234, v194 offset:288
    v_fma_f32 v19, -v177, v34, v19
    v_fma_f32 v35, v177, v18, v35
    v_fma_f32 v19, v176, v18, v19
    v_fma_f32 v35, v176, v34, v35
    v_mul_f32 v196, v178, v19
    v_mul_f32 v197, v178, v35
    v_fma_f32 v196, -v179, v35, v196
    v_fma_f32 v197, v179, v19, v197
    v_cvt_pk_bf16_f32 v198, v196, -v197
    ds_write_b32 v234, v198 offset:432
    v_fma_f32 v20, -v177, v35, v20
    v_fma_f32 v36, v177, v19, v36
    v_fma_f32 v20, v176, v19, v20
    v_fma_f32 v36, v176, v35, v36
    v_mul_f32 v192, v178, v20
    v_mul_f32 v193, v178, v36
    v_fma_f32 v192, -v179, v36, v192
    v_fma_f32 v193, v179, v20, v193
    v_cvt_pk_bf16_f32 v194, v192, -v193
    ds_write_b32 v234, v194 offset:576
    v_fma_f32 v21, -v177, v36, v21
    v_fma_f32 v37, v177, v20, v37
    v_fma_f32 v21, v176, v20, v21
    v_fma_f32 v37, v176, v36, v37
    v_mul_f32 v196, v178, v21
    v_mul_f32 v197, v178, v37
    v_fma_f32 v196, -v179, v37, v196
    v_fma_f32 v197, v179, v21, v197
    v_cvt_pk_bf16_f32 v198, v196, -v197
    ds_write_b32 v234, v198 offset:720
    v_fma_f32 v22, -v177, v37, v22
    v_fma_f32 v38, v177, v21, v38
    v_fma_f32 v22, v176, v21, v22
    v_fma_f32 v38, v176, v37, v38
    v_mul_f32 v192, v178, v22
    v_mul_f32 v193, v178, v38
    v_fma_f32 v192, -v179, v38, v192
    v_fma_f32 v193, v179, v22, v193
    v_cvt_pk_bf16_f32 v194, v192, -v193
    ds_write_b32 v234, v194 offset:864
    v_fma_f32 v23, -v177, v38, v23
    v_fma_f32 v39, v177, v22, v39
    v_fma_f32 v23, v176, v22, v23
    v_fma_f32 v39, v176, v38, v39
    v_mul_f32 v196, v178, v23
    v_mul_f32 v197, v178, v39
    v_fma_f32 v196, -v179, v39, v196
    v_fma_f32 v197, v179, v23, v197
    v_cvt_pk_bf16_f32 v198, v196, -v197
    ds_write_b32 v234, v198 offset:1008
    v_fma_f32 v24, -v177, v39, v24
    v_fma_f32 v40, v177, v23, v40
    v_fma_f32 v24, v176, v23, v24
    v_fma_f32 v40, v176, v39, v40
    v_mul_f32 v192, v178, v24
    v_mul_f32 v193, v178, v40
    v_fma_f32 v192, -v179, v40, v192
    v_fma_f32 v193, v179, v24, v193
    v_cvt_pk_bf16_f32 v194, v192, -v193
    ds_write_b32 v234, v194 offset:1152
    v_fma_f32 v25, -v177, v40, v25
    v_fma_f32 v41, v177, v24, v41
    v_fma_f32 v25, v176, v24, v25
    v_fma_f32 v41, v176, v40, v41
    v_mul_f32 v196, v178, v25
    v_mul_f32 v197, v178, v41
    v_fma_f32 v196, -v179, v41, v196
    v_fma_f32 v197, v179, v25, v197
    v_cvt_pk_bf16_f32 v198, v196, -v197
    ds_write_b32 v234, v198 offset:1296
    v_fma_f32 v26, -v177, v41, v26
    v_fma_f32 v42, v177, v25, v42
    v_fma_f32 v26, v176, v25, v26
    v_fma_f32 v42, v176, v41, v42
    v_mul_f32 v192, v178, v26
    v_mul_f32 v193, v178, v42
    v_fma_f32 v192, -v179, v42, v192
    v_fma_f32 v193, v179, v26, v193
    v_cvt_pk_bf16_f32 v194, v192, -v193
    ds_write_b32 v234, v194 offset:1440
    v_fma_f32 v27, -v177, v42, v27
    v_fma_f32 v43, v177, v26, v43
    v_fma_f32 v27, v176, v26, v27
    v_fma_f32 v43, v176, v42, v43
    v_mul_f32 v196, v178, v27
    v_mul_f32 v197, v178, v43
    v_fma_f32 v196, -v179, v43, v196
    v_fma_f32 v197, v179, v27, v197
    v_cvt_pk_bf16_f32 v198, v196, -v197
    ds_write_b32 v234, v198 offset:1584
    v_fma_f32 v28, -v177, v43, v28
    v_fma_f32 v44, v177, v27, v44
    v_fma_f32 v28, v176, v27, v28
    v_fma_f32 v44, v176, v43, v44
    v_mul_f32 v192, v178, v28
    v_mul_f32 v193, v178, v44
    v_fma_f32 v192, -v179, v44, v192
    v_fma_f32 v193, v179, v28, v193
    v_cvt_pk_bf16_f32 v194, v192, -v193
    ds_write_b32 v234, v194 offset:1728
    v_fma_f32 v29, -v177, v44, v29
    v_fma_f32 v45, v177, v28, v45
    v_fma_f32 v29, v176, v28, v29
    v_fma_f32 v45, v176, v44, v45
    v_mul_f32 v196, v178, v29
    v_mul_f32 v197, v178, v45
    v_fma_f32 v196, -v179, v45, v196
    v_fma_f32 v197, v179, v29, v197
    v_cvt_pk_bf16_f32 v198, v196, -v197
    ds_write_b32 v234, v198 offset:1872
    v_fma_f32 v30, -v177, v45, v30
    v_fma_f32 v46, v177, v29, v46
    v_fma_f32 v30, v176, v29, v30
    v_fma_f32 v46, v176, v45, v46
    v_mul_f32 v192, v178, v30
    v_mul_f32 v193, v178, v46
    v_fma_f32 v192, -v179, v46, v192
    v_fma_f32 v193, v179, v30, v193
    v_cvt_pk_bf16_f32 v194, v192, -v193
    ds_write_b32 v234, v194 offset:2016
    v_fma_f32 v31, -v177, v46, v31
    v_fma_f32 v47, v177, v30, v47
    v_fma_f32 v31, v176, v30, v31
    v_fma_f32 v47, v176, v46, v47
    v_mul_f32 v196, v178, v31
    v_mul_f32 v197, v178, v47
    v_fma_f32 v196, -v179, v47, v196
    v_fmac_f32 v197, v179, v31
    v_cvt_pk_bf16_f32 v198, v196, -v197
    ds_write_b32 v234, v198 offset:2160
    s_waitcnt lgkmcnt(0)
    ds_read_b128 v[200:203], v235 offset:0
    ds_read_b128 v[204:207], v235 offset:64
    ds_read_b128 v[208:211], v235 offset:2304
    ds_read_b128 v[212:215], v235 offset:2368
    s_add_u32 s35, s80, 0
    s_lshl_b32 s35, s35, 13
    s_add_u32 s35, s35, s87
    s_add_u32 s35, s35, 221184
    s_add_u32 s34, s35, 4096
    s_waitcnt lgkmcnt(3)
    buffer_store_dwordx4 v[200:203], v236, s[20:23], s35 offen offset:0 sc1
    s_waitcnt lgkmcnt(2)
    buffer_store_dwordx4 v[204:207], v236, s[20:23], s34 offen offset:0 sc1
    s_waitcnt lgkmcnt(1)
    buffer_store_dwordx4 v[208:211], v236, s[20:23], s35 offen offset:1024 sc1
    s_waitcnt lgkmcnt(0)
    buffer_store_dwordx4 v[212:215], v236, s[20:23], s34 offen offset:1024 sc1
    s_lshl_b32 s29, s6, 11
    s_add_u32 s29, s29, 24117248
    v_and_b32_e64 v225, 15, v1
    v_lshlrev_b32 v225, 7, v225
    v_mov_b32 v224, s85
    s_mov_b64 exec, 0xffff
    buffer_load_dword v224, v225, s[20:23], s29 offen sc1
    s_mov_b64 exec, -1
    s_getpc_b64 s[100:101]
CT_K2B:
    s_add_u32 s100, s100, K2_START-CT_K2B
    s_addc_u32 s101, s101, 0
    s_mul_i32 s33, s4, 2048
    s_add_u32 s33, s33, 0
    v_lshl_add_u32 v230, v1, 7, s33
    v_min_u32 v230, TEXT_END-K2_START-4, v230
    s_mov_b64 exec, 0xffff
    global_load_dword v231, v230, s[100:101]
    s_mov_b64 exec, -1
    v_mov_b32 v16, v11
    v_mov_b32_e64 v17, v11
    v_mov_b32 v18, s88
    v_mov_b32 v19, s88
    v_mov_b32 v20, 1.0
    v_mov_b32 v21, 1.0
    v_pk_mul_f32 v[22:23], v[48:49], v[48:49]
    v_pk_mul_f32 v[24:25], v[50:51], v[50:51]
    v_pk_mul_f32 v[26:27], v[52:53], v[52:53]
    v_pk_mul_f32 v[28:29], v[54:55], v[54:55]
    v_pk_fma_f32 v[22:23], v[22:23], v[18:19], v[16:17]
    v_pk_fma_f32 v[24:25], v[24:25], v[18:19], v[16:17]
    v_pk_fma_f32 v[26:27], v[26:27], v[18:19], v[16:17]
    v_pk_fma_f32 v[28:29], v[28:29], v[18:19], v[16:17]
    v_pk_mul_f32 v[22:23], v[22:23], v[48:49]
    v_pk_mul_f32 v[24:25], v[24:25], v[50:51]
    v_pk_mul_f32 v[26:27], v[26:27], v[52:53]
    v_pk_mul_f32 v[28:29], v[28:29], v[54:55]
    v_exp_f32_e64 v22, v22
    v_pk_mul_f32 v[64:65], v[64:65], v[48:49]
    v_exp_f32 v23, v23
    v_exp_f32 v24, v24
    v_pk_mul_f32 v[66:67], v[66:67], v[50:51]
    v_exp_f32 v25, v25
    v_exp_f32 v26, v26
    v_pk_mul_f32 v[68:69], v[68:69], v[52:53]
    v_exp_f32 v27, v27
    v_exp_f32 v28, v28
    v_pk_mul_f32 v[70:71], v[70:71], v[54:55]
    v_exp_f32_e64 v29, v29
    v_pk_add_f32 v[22:23], v[22:23], v[20:21]
    v_pk_add_f32 v[24:25], v[24:25], v[20:21]
    v_pk_add_f32 v[26:27], v[26:27], v[20:21]
    v_pk_add_f32 v[28:29], v[28:29], v[20:21]
    v_rcp_f32_e64 v22, v22
    v_rcp_f32 v23, v23
    v_rcp_f32 v24, v24
    v_pk_mul_f32 v[64:65], v[64:65], v[22:23]
    v_rcp_f32_e64 v25, v25
    v_cvt_pk_bf16_f32 v248, v64, v65
    v_rcp_f32_e64 v26, v26
    v_pk_mul_f32 v[66:67], v[66:67], v[24:25]
    v_rcp_f32_e64 v27, v27
    v_cvt_pk_bf16_f32 v249, v66, v67
    v_rcp_f32_e64 v28, v28
    v_pk_mul_f32 v[68:69], v[68:69], v[26:27]
    v_rcp_f32_e64 v29, v29
    v_cvt_pk_bf16_f32 v250, v68, v69
    v_pk_mul_f32 v[70:71], v[70:71], v[28:29]
    v_cvt_pk_bf16_f32 v251, v70, v71
    buffer_store_dwordx4 v[248:251], v10, s[20:23], s90 offen offset:0 sc1
    v_pk_mul_f32 v[22:23], v[56:57], v[56:57]
    v_pk_mul_f32 v[24:25], v[58:59], v[58:59]
    v_pk_mul_f32 v[26:27], v[60:61], v[60:61]
    v_pk_mul_f32 v[28:29], v[62:63], v[62:63]
    v_pk_fma_f32 v[22:23], v[22:23], v[18:19], v[16:17]
    v_pk_fma_f32 v[24:25], v[24:25], v[18:19], v[16:17]
    v_pk_fma_f32 v[26:27], v[26:27], v[18:19], v[16:17]
    v_pk_fma_f32 v[28:29], v[28:29], v[18:19], v[16:17]
    v_pk_mul_f32 v[22:23], v[22:23], v[56:57]
    v_pk_mul_f32 v[24:25], v[24:25], v[58:59]
    v_pk_mul_f32 v[26:27], v[26:27], v[60:61]
    v_pk_mul_f32 v[28:29], v[28:29], v[62:63]
    v_exp_f32_e64 v22, v22
    v_pk_mul_f32 v[72:73], v[72:73], v[56:57]
    v_exp_f32 v23, v23
    v_exp_f32 v24, v24
    v_pk_mul_f32 v[74:75], v[74:75], v[58:59]
    v_exp_f32 v25, v25
    v_exp_f32 v26, v26
    v_pk_mul_f32 v[76:77], v[76:77], v[60:61]
    v_exp_f32 v27, v27
    v_exp_f32 v28, v28
    v_pk_mul_f32 v[78:79], v[78:79], v[62:63]
    v_exp_f32_e64 v29, v29
    v_pk_add_f32 v[22:23], v[22:23], v[20:21]
    v_pk_add_f32 v[24:25], v[24:25], v[20:21]
    v_pk_add_f32 v[26:27], v[26:27], v[20:21]
    v_pk_add_f32 v[28:29], v[28:29], v[20:21]
    v_rcp_f32_e64 v22, v22
    v_rcp_f32 v23, v23
    v_rcp_f32 v24, v24
    v_pk_mul_f32 v[72:73], v[72:73], v[22:23]
    v_rcp_f32_e64 v25, v25
    v_cvt_pk_bf16_f32 v252, v72, v73
    v_rcp_f32_e64 v26, v26
    v_pk_mul_f32 v[74:75], v[74:75], v[24:25]
    v_rcp_f32_e64 v27, v27
    v_cvt_pk_bf16_f32 v253, v74, v75
    v_rcp_f32_e64 v28, v28
    v_pk_mul_f32 v[76:77], v[76:77], v[26:27]
    v_rcp_f32_e64 v29, v29
    v_cvt_pk_bf16_f32 v254, v76, v77
    v_pk_mul_f32 v[78:79], v[78:79], v[28:29]
    v_cvt_pk_bf16_f32 v255, v78, v79
    buffer_store_dwordx4 v[252:255], v10, s[20:23], s90 offen offset:512 sc1
    v_pk_mul_f32 v[22:23], v[80:81], v[80:81]
    v_pk_mul_f32 v[24:25], v[82:83], v[82:83]
    v_pk_mul_f32 v[26:27], v[84:85], v[84:85]
    v_pk_mul_f32 v[28:29], v[86:87], v[86:87]
    v_pk_fma_f32 v[22:23], v[22:23], v[18:19], v[16:17]
    v_pk_fma_f32 v[24:25], v[24:25], v[18:19], v[16:17]
    v_pk_fma_f32 v[26:27], v[26:27], v[18:19], v[16:17]
    v_pk_fma_f32 v[28:29], v[28:29], v[18:19], v[16:17]
    v_pk_mul_f32 v[22:23], v[22:23], v[80:81]
    v_pk_mul_f32 v[24:25], v[24:25], v[82:83]
    v_pk_mul_f32 v[26:27], v[26:27], v[84:85]
    v_pk_mul_f32 v[28:29], v[28:29], v[86:87]
    v_exp_f32_e64 v22, v22
    v_pk_mul_f32 v[96:97], v[96:97], v[80:81]
    v_exp_f32 v23, v23
    v_exp_f32 v24, v24
    v_pk_mul_f32 v[98:99], v[98:99], v[82:83]
    v_exp_f32 v25, v25
    v_exp_f32 v26, v26
    v_pk_mul_f32 v[100:101], v[100:101], v[84:85]
    v_exp_f32 v27, v27
    v_exp_f32 v28, v28
    v_pk_mul_f32 v[102:103], v[102:103], v[86:87]
    v_exp_f32_e64 v29, v29
    v_pk_add_f32 v[22:23], v[22:23], v[20:21]
    v_pk_add_f32 v[24:25], v[24:25], v[20:21]
    v_pk_add_f32 v[26:27], v[26:27], v[20:21]
    v_pk_add_f32 v[28:29], v[28:29], v[20:21]
    v_rcp_f32_e64 v22, v22
    v_rcp_f32 v23, v23
    v_rcp_f32 v24, v24
    v_pk_mul_f32 v[96:97], v[96:97], v[22:23]
    v_rcp_f32_e64 v25, v25
    v_cvt_pk_bf16_f32 v248, v96, v97
    v_rcp_f32_e64 v26, v26
    v_pk_mul_f32 v[98:99], v[98:99], v[24:25]
    v_rcp_f32_e64 v27, v27
    v_cvt_pk_bf16_f32 v249, v98, v99
    v_rcp_f32_e64 v28, v28
    v_pk_mul_f32 v[100:101], v[100:101], v[26:27]
    v_rcp_f32_e64 v29, v29
    v_cvt_pk_bf16_f32 v250, v100, v101
    s_add_u32 s90, s90, 4096
    v_pk_mul_f32 v[102:103], v[102:103], v[28:29]
    v_cvt_pk_bf16_f32 v251, v102, v103
    buffer_store_dwordx4 v[248:251], v10, s[20:23], s90 offen offset:0 sc1
    v_pk_mul_f32 v[22:23], v[88:89], v[88:89]
    v_pk_mul_f32 v[24:25], v[90:91], v[90:91]
    v_pk_mul_f32 v[26:27], v[92:93], v[92:93]
    v_pk_mul_f32 v[28:29], v[94:95], v[94:95]
    v_pk_fma_f32 v[22:23], v[22:23], v[18:19], v[16:17]
    v_pk_fma_f32 v[24:25], v[24:25], v[18:19], v[16:17]
    v_pk_fma_f32 v[26:27], v[26:27], v[18:19], v[16:17]
    v_pk_fma_f32 v[28:29], v[28:29], v[18:19], v[16:17]
    v_pk_mul_f32 v[22:23], v[22:23], v[88:89]
    v_pk_mul_f32 v[24:25], v[24:25], v[90:91]
    v_pk_mul_f32 v[26:27], v[26:27], v[92:93]
    v_pk_mul_f32 v[28:29], v[28:29], v[94:95]
    v_exp_f32_e64 v22, v22
    v_pk_mul_f32 v[104:105], v[104:105], v[88:89]
    v_exp_f32 v23, v23
    v_exp_f32 v24, v24
    v_pk_mul_f32 v[106:107], v[106:107], v[90:91]
    v_exp_f32 v25, v25
    v_exp_f32 v26, v26
    v_pk_mul_f32 v[108:109], v[108:109], v[92:93]
    v_exp_f32 v27, v27
    v_exp_f32 v28, v28
    v_pk_mul_f32 v[110:111], v[110:111], v[94:95]
    v_exp_f32_e64 v29, v29
    v_pk_add_f32 v[22:23], v[22:23], v[20:21]
    v_pk_add_f32 v[24:25], v[24:25], v[20:21]
    v_pk_add_f32 v[26:27], v[26:27], v[20:21]
    v_pk_add_f32 v[28:29], v[28:29], v[20:21]
    v_rcp_f32_e64 v22, v22
    v_rcp_f32 v23, v23
    v_rcp_f32 v24, v24
    v_pk_mul_f32 v[104:105], v[104:105], v[22:23]
    v_rcp_f32_e64 v25, v25
    v_cvt_pk_bf16_f32 v252, v104, v105
    v_rcp_f32_e64 v26, v26
    v_pk_mul_f32 v[106:107], v[106:107], v[24:25]
    v_rcp_f32_e64 v27, v27
    v_cvt_pk_bf16_f32 v253, v106, v107
    v_rcp_f32_e64 v28, v28
    v_pk_mul_f32 v[108:109], v[108:109], v[26:27]
    v_rcp_f32_e64 v29, v29
    v_cvt_pk_bf16_f32 v254, v108, v109
    v_pk_mul_f32 v[110:111], v[110:111], v[28:29]
    v_cvt_pk_bf16_f32 v255, v110, v111
    buffer_store_dwordx4 v[252:255], v10, s[20:23], s90 offen offset:512 sc1
    s_mov_b32 s30, 0
    s_waitcnt vmcnt(5)
    v_cmp_ne_u32 vcc, s85, v224
    s_nop 1
    s_cbranch_vccnz JF_SLOW_B
JF_OK_B:
    s_lshr_b32 s28, s6, 3
    s_mul_i32 s28, s28, 47
    s_mul_i32 s29, s4, 12
    s_add_u32 s31, s28, s29
    s_and_b32 s28, s6, 7
    s_mul_i32 s28, s28, 94
    s_add_u32 s28, s28, s31
    s_mul_i32 s28, s28, 5120
    s_add_u32 s27, s28, 12582912
    s_mov_b32 s24, 0x76543210
    s_mov_b32 s25, 0xba98
    s_cmp_eq_u32 s4, 0
    s_cselect_b32 s24, 0xba98721, s24
    s_cselect_b32 s25, 0x6543, s25
    s_cmp_eq_u32 s4, 3
    s_cselect_b32 s24, 0x38765210, s24
    s_cselect_b32 s25, 0xba94, s25
    s_cmp_lt_u32 s6, 8
    s_cselect_b32 s24, 0x32985410, s24
    s_cselect_b32 s25, 0xba76, s25
    s_lshl_b32 s80, s5, 11
    s_add_u32 s80, s80, 17072128
    s_add_u32 s83, s80, 7077888
    v_and_b32 v2, 15, v1
    v_lshlrev_b32_e64 v2, 7, v2
    s_mov_b32 s92, 0
    s_bfe_u32 s28, s24, 0x40000
    s_mul_i32 s28, s28, 5120
    s_add_u32 s28, s28, s27
    buffer_load_dwordx4 a[192:195], v236, s[20:23], s28 offen offset:0 sc1
    buffer_load_dwordx4 a[196:199], v236, s[20:23], s28 offen offset:1024 sc1
    buffer_load_dwordx4 a[200:203], v236, s[20:23], s28 offen offset:2048 sc1
    buffer_load_dwordx4 a[204:207], v236, s[20:23], s28 offen offset:3072 sc1
    buffer_load_dwordx4 a[208:211], v0, s[20:23], s28 offen offset:0 sc1
    s_bfe_u32 s28, s24, 0x40004
    s_mul_i32 s28, s28, 5120
    s_add_u32 s28, s28, s27
    buffer_load_dwordx4 a[212:215], v236, s[20:23], s28 offen offset:0 sc1
    s_mov_b32 s12, s52
    s_mov_b32 s13, s53
    s_mov_b32 s14, 1280
    s_mov_b32 s15, 0x20000
    s_mov_b32 s16, s62
    s_mov_b32 s17, s63
    s_mov_b32 s18, 5242880
    s_mov_b32 s19, 0x20000
    v_mov_b32 v3, v236
    v_mov_b32 v4, v0
    s_mov_b32 s74, s31
    s_lshr_b32 s34, s6, 3
    s_lshl_b32 s35, s5, 1
    s_add_u32 s35, s35, s34
    s_mul_i32 s75, s35, 94
    s_add_u32 s75, s75, s74
    s_lshl_b32 s75, s75, 12
    s_xor_b32 s82, s35, 1
    s_mul_i32 s82, s82, 94
    s_add_u32 s82, s82, s74
    s_lshl_b32 s82, s82, 12
    s_lshl_b32 s35, s35, 6
    s_lshl_b32 s32, s4, 4
    s_add_u32 s35, s35, s32
    s_and_b32 s33, s6, 7
    s_mul_i32 s33, s33, 160
    s_mul_i32 s70, s35, 1280
    s_add_u32 s70, s70, s33
    s_lshl_b32 s71, s70, 1
    s_mov_b32 s81, 0xcccd
    s_mov_b32 m0, s93
    v_add_u32 v6, 0, v1
    v_mul_lo_u32 v7, v6, s81
    v_lshrrev_b32_e64 v7, 19, v7
    v_mul_u32_u24 v8, 1120, v7
    v_lshl_add_u32 v8, v6, 4, v8
    buffer_load_dwordx4 v8, s[8:11], s70 offen offset:0 lds
    v_add_u32_e64 v6, 64, v1
    v_mul_lo_u32 v7, v6, s81
    v_lshrrev_b32_e64 v7, 19, v7
    v_mul_u32_u24 v8, 1120, v7
    v_lshl_add_u32 v8, v6, 4, v8
    v_add_u32 v8, 0xfffffc00, v8
    buffer_load_dwordx4 v8, s[8:11], s70 offen offset:1024 lds
    v_add_u32 v6, 128, v1
    v_mul_lo_u32 v7, v6, s81
    v_lshrrev_b32 v7, 19, v7
    v_mul_u32_u24 v8, 1120, v7
    v_lshl_add_u32 v8, v6, 4, v8
    v_add_u32 v8, 0xfffff800, v8
    s_mov_b32 exec_hi, 0
    buffer_load_dwordx4 v8, s[8:11], s70 offen offset:2048 lds
    s_add_u32 m0, s93, 3072
    s_mov_b32 exec_lo, 0x3ff
    buffer_load_dwordx4 v3, s[12:15], s33 offen lds
    s_mov_b64 exec, -1
    s_mov_b32 s69, 1073741824
    s_lshl_b32 s32, s6, 7
    s_add_u32 s32, s32, s80
    s_cmp_eq_u32 s4, 0
    s_cselect_b32 s32, s32, 1073741824
    v_mov_b32_e64 v14, s85
    s_waitcnt vmcnt(10)
    s_barrier
    s_mov_b64 exec, 1
    buffer_store_dword v14, off, s[20:23], s32 sc1
    s_mov_b64 exec, -1
    buffer_load_dwordx4 a[216:219], v236, s[20:23], s28 offen offset:1024 sc1
    buffer_load_dwordx4 a[220:223], v236, s[20:23], s28 offen offset:2048 sc1
    buffer_load_dwordx4 a[224:227], v236, s[20:23], s28 offen offset:3072 sc1
    buffer_load_dwordx4 a[228:231], v0, s[20:23], s28 offen offset:0 sc1
    s_bfe_u32 s28, s24, 0x40008
    s_mul_i32 s28, s28, 5120
    s_add_u32 s28, s28, s27
    buffer_load_dwordx4 a[232:235], v236, s[20:23], s28 offen offset:0 sc1
    buffer_load_dwordx4 a[236:239], v236, s[20:23], s28 offen offset:1024 sc1
    buffer_load_dwordx4 a[240:243], v236, s[20:23], s28 offen offset:2048 sc1
    buffer_load_dwordx4 a[244:247], v236, s[20:23], s28 offen offset:3072 sc1
    buffer_load_dwordx4 a[248:251], v0, s[20:23], s28 offen offset:0 sc1
    s_bfe_u32 s28, s24, 0x4000c
    s_mul_i32 s28, s28, 5120
    s_add_u32 s28, s28, s27
    buffer_load_dwordx4 a[252:255], v236, s[20:23], s28 offen offset:0 sc1
    buffer_load_dwordx4 a[0:3], v236, s[20:23], s28 offen offset:1024 sc1
    buffer_load_dwordx4 a[4:7], v236, s[20:23], s28 offen offset:2048 sc1
    buffer_load_dwordx4 a[8:11], v236, s[20:23], s28 offen offset:3072 sc1
    buffer_load_dwordx4 a[12:15], v0, s[20:23], s28 offen offset:0 sc1
    s_bfe_u32 s28, s24, 0x40010
    s_mul_i32 s28, s28, 5120
    s_add_u32 s28, s28, s27
    buffer_load_dwordx4 a[16:19], v236, s[20:23], s28 offen offset:0 sc1
    buffer_load_dwordx4 a[20:23], v236, s[20:23], s28 offen offset:1024 sc1
    buffer_load_dwordx4 a[24:27], v236, s[20:23], s28 offen offset:2048 sc1
    buffer_load_dwordx4 a[28:31], v236, s[20:23], s28 offen offset:3072 sc1
    buffer_load_dwordx4 a[32:35], v0, s[20:23], s28 offen offset:0 sc1
    s_bfe_u32 s28, s24, 0x40014
    s_mul_i32 s28, s28, 5120
    s_add_u32 s28, s28, s27
    buffer_load_dwordx4 a[36:39], v236, s[20:23], s28 offen offset:0 sc1
    buffer_load_dwordx4 a[40:43], v236, s[20:23], s28 offen offset:1024 sc1
    buffer_load_dwordx4 a[44:47], v236, s[20:23], s28 offen offset:2048 sc1
    buffer_load_dwordx4 a[48:51], v236, s[20:23], s28 offen offset:3072 sc1
    buffer_load_dwordx4 a[52:55], v0, s[20:23], s28 offen offset:0 sc1
    s_bfe_u32 s28, s24, 0x40018
    s_mul_i32 s28, s28, 5120
    s_add_u32 s28, s28, s27
    buffer_load_dwordx4 a[56:59], v236, s[20:23], s28 offen offset:0 sc1
    buffer_load_dwordx4 a[60:63], v236, s[20:23], s28 offen offset:1024 sc1
    buffer_load_dwordx4 a[64:67], v236, s[20:23], s28 offen offset:2048 sc1
    buffer_load_dwordx4 a[68:71], v236, s[20:23], s28 offen offset:3072 sc1
    buffer_load_dwordx4 a[72:75], v0, s[20:23], s28 offen offset:0 sc1
    s_bfe_u32 s28, s24, 0x4001c
    s_mul_i32 s28, s28, 5120
    s_add_u32 s28, s28, s27
    buffer_load_dwordx4 a[76:79], v236, s[20:23], s28 offen offset:0 sc1
    buffer_load_dwordx4 a[80:83], v236, s[20:23], s28 offen offset:1024 sc1
    buffer_load_dwordx4 a[84:87], v236, s[20:23], s28 offen offset:2048 sc1
    buffer_load_dwordx4 a[88:91], v236, s[20:23], s28 offen offset:3072 sc1
    buffer_load_dwordx4 a[92:95], v0, s[20:23], s28 offen offset:0 sc1
    s_bfe_u32 s28, s25, 0x40000
    s_mul_i32 s28, s28, 5120
    s_add_u32 s28, s28, s27
    buffer_load_dwordx4 a[96:99], v236, s[20:23], s28 offen offset:0 sc1
    buffer_load_dwordx4 a[100:103], v236, s[20:23], s28 offen offset:1024 sc1
    buffer_load_dwordx4 a[104:107], v236, s[20:23], s28 offen offset:2048 sc1
    buffer_load_dwordx4 a[108:111], v236, s[20:23], s28 offen offset:3072 sc1
    buffer_load_dwordx4 a[112:115], v0, s[20:23], s28 offen offset:0 sc1
    s_bfe_u32 s28, s25, 0x40004
    s_mul_i32 s28, s28, 5120
    s_add_u32 s28, s28, s27
    buffer_load_dwordx4 a[116:119], v236, s[20:23], s28 offen offset:0 sc1
    buffer_load_dwordx4 a[120:123], v236, s[20:23], s28 offen offset:1024 sc1
    buffer_load_dwordx4 a[124:127], v236, s[20:23], s28 offen offset:2048 sc1
    s_and_b32 s35, s35, 127
    s_lshl_b32 s35, s35, 3
    s_add_u32 s35, s35, 161792
    s_mul_i32 s34, s4, 5376
    v_lshlrev_b32 v10, 3, v1
    v_add_u32 v10, s93, v10
    v_add_u32 v6, 0, v1
    v_mul_lo_u32 v7, v6, s81
    v_lshrrev_b32_e64 v7, 20, v7
    v_mul_u32_u24 v8, 20, v7
    v_sub_u32 v8, v6, v8
    v_mul_u32_u24 v9, 2560, v7
    v_lshl_add_u32 v240, v8, 4, v9
    v_mul_u32_u24 v12, 336, v7
    v_lshl_add_u32 v12, v8, 4, v12
    v_add_u32_e64 v245, s34, v12
    v_lshl_add_u32 v156, v8, 3, s93
    v_lshl_add_u32 v11, v7, 3, s35
    ds_read_b64 v[116:117], v11
    v_add_u32_e64 v6, 64, v1
    v_mul_lo_u32 v7, v6, s81
    v_lshrrev_b32_e64 v7, 20, v7
    v_mul_u32_u24 v8, 20, v7
    v_sub_u32 v8, v6, v8
    v_mul_u32_u24 v9, 2560, v7
    v_lshl_add_u32 v241, v8, 4, v9
    v_mul_u32_u24 v12, 336, v7
    v_lshl_add_u32 v12, v8, 4, v12
    v_add_u32_e64 v246, s34, v12
    v_lshl_add_u32 v157, v8, 3, s93
    v_lshl_add_u32 v11, v7, 3, s35
    ds_read_b64 v[118:119], v11
    v_add_u32 v6, 128, v1
    v_mul_lo_u32 v7, v6, s81
    v_lshrrev_b32_e64 v7, 20, v7
    v_mul_u32_u24 v8, 20, v7
    v_sub_u32 v8, v6, v8
    v_mul_u32_u24 v9, 2560, v7
    v_lshl_add_u32 v242, v8, 4, v9
    v_mul_u32_u24 v12, 336, v7
    v_lshl_add_u32 v12, v8, 4, v12
    v_add_u32_e64 v247, s34, v12
    v_lshl_add_u32 v158, v8, 3, s93
    v_lshl_add_u32 v11, v7, 3, s35
    ds_read_b64 v[120:121], v11
    v_add_u32 v6, 192, v1
    v_mul_lo_u32 v7, v6, s81
    v_lshrrev_b32_e64 v7, 20, v7
    v_mul_u32_u24 v8, 20, v7
    v_sub_u32 v8, v6, v8
    v_mul_u32_u24 v9, 2560, v7
    v_lshl_add_u32 v243, v8, 4, v9
    v_mul_u32_u24 v12, 336, v7
    v_lshl_add_u32 v12, v8, 4, v12
    v_add_u32_e64 v248, s34, v12
    v_lshl_add_u32 v159, v8, 3, s93
    v_lshl_add_u32 v11, v7, 3, s35
    ds_read_b64 v[122:123], v11
    v_add_u32 v6, 256, v1
    v_mul_lo_u32 v7, v6, s81
    v_lshrrev_b32_e64 v7, 20, v7
    v_mul_u32_u24 v8, 20, v7
    v_sub_u32 v8, v6, v8
    v_mul_u32_u24 v9, 2560, v7
    v_lshl_add_u32 v244, v8, 4, v9
    v_mul_u32_u24 v12, 336, v7
    v_lshl_add_u32 v12, v8, 4, v12
    v_add_u32_e64 v249, s34, v12
    v_lshl_add_u32 v160, v8, 3, s93
    v_lshl_add_u32 v11, v7, 3, s35
    ds_read_b64 v[124:125], v11
    v_and_b32_e64 v5, 15, v1
    v_mul_u32_u24 v5, 336, v5
    v_lshrrev_b32_e64 v6, 4, v1
    v_lshl_add_u32 v5, v6, 4, v5
    s_mul_i32 s34, s4, 21504
    v_add_u32_e64 v5, s34, v5
    v_add_u32 v13, s93, v3
    s_lshl_b32 s3, s2, 2
    s_add_u32 s3, s3, s4
    s_mul_i32 s72, s3, 5120
    s_add_u32 s72, s72, 17825792
    s_xor_b32 s3, s3, 4
    s_mul_i32 s73, s3, 5120
    s_add_u32 s73, s73, 17825792
    v_mov_b32 v250, 0xff
    s_mov_b32 s76, s85
    s_lshr_b32 s77, s76, 8
    s_add_u32 s77, s77, s76
    s_lshr_b32 s78, s76, 16
    s_add_u32 s78, s78, s76
    s_lshr_b32 s79, s76, 24
    s_add_u32 s79, s79, s76
    s_waitcnt vmcnt(43)
    ds_read_b64 v[96:97], v10 offset:0
    ds_read_b64 v[106:107], v156 offset:3072
    ds_read_b64 v[98:99], v10 offset:512
    ds_read_b64 v[108:109], v157 offset:3072
    ds_read_b64 v[100:101], v10 offset:1024
    ds_read_b64 v[110:111], v158 offset:3072
    ds_read_b64 v[102:103], v10 offset:1536
    ds_read_b64 v[112:113], v159 offset:3072
    ds_read_b64 v[104:105], v10 offset:2048
    ds_read_b64 v[114:115], v160 offset:3072
    s_waitcnt lgkmcnt(0)
    v_lshlrev_b32 v128, 16, v96
    v_and_b32_e64 v129, s86, v96
    v_lshlrev_b32 v130, 16, v97
    v_and_b32 v131, s86, v97
    v_lshlrev_b32 v132, 16, v106
    v_and_b32 v133, s86, v106
    v_lshlrev_b32 v134, 16, v107
    v_and_b32 v135, s86, v107
    v_fma_f32 v136, v128, v116, v117
    v_fma_f32 v137, v129, v116, v117
    v_fma_f32 v138, v130, v116, v117
    v_fma_f32 v139, v131, v116, v117
    v_cvt_pk_bf16_f32 v140, v136, v137
    v_cvt_pk_bf16_f32 v141, v138, v139
    v_lshlrev_b32 v136, 16, v140
    v_and_b32 v137, s86, v140
    v_lshlrev_b32 v138, 16, v141
    v_and_b32 v139, s86, v141
    v_pk_mul_f32 v[136:137], v[136:137], v[132:133]
    v_pk_mul_f32 v[138:139], v[138:139], v[134:135]
    v_cvt_pk_bf16_f32 v140, v136, v137
    v_cvt_pk_bf16_f32 v141, v138, v139
    v_lshlrev_b32 v136, 16, v140
    v_and_b32 v137, s86, v140
    v_lshlrev_b32 v138, 16, v141
    v_and_b32 v139, s86, v141
    v_pk_add_f32 v[144:145], v[128:129], v[136:137]
    v_pk_add_f32 v[146:147], v[130:131], v[138:139]
    ds_write_b128 v13, v[144:147] offset:0
    v_lshlrev_b32 v128, 16, v98
    v_and_b32 v129, s86, v98
    v_lshlrev_b32 v130, 16, v99
    v_and_b32 v131, s86, v99
    v_lshlrev_b32 v132, 16, v108
    v_and_b32 v133, s86, v108
    v_lshlrev_b32 v134, 16, v109
    v_and_b32 v135, s86, v109
    v_fma_f32 v136, v128, v118, v119
    v_fma_f32 v137, v129, v118, v119
    v_fma_f32 v138, v130, v118, v119
    v_fma_f32 v139, v131, v118, v119
    v_cvt_pk_bf16_f32 v140, v136, v137
    v_cvt_pk_bf16_f32 v141, v138, v139
    v_lshlrev_b32 v136, 16, v140
    v_and_b32 v137, s86, v140
    v_lshlrev_b32 v138, 16, v141
    v_and_b32 v139, s86, v141
    v_pk_mul_f32 v[136:137], v[136:137], v[132:133]
    v_pk_mul_f32 v[138:139], v[138:139], v[134:135]
    v_cvt_pk_bf16_f32 v140, v136, v137
    v_cvt_pk_bf16_f32 v141, v138, v139
    v_lshlrev_b32 v136, 16, v140
    v_and_b32 v137, s86, v140
    v_lshlrev_b32 v138, 16, v141
    v_and_b32 v139, s86, v141
    v_pk_add_f32 v[148:149], v[128:129], v[136:137]
    v_pk_add_f32 v[150:151], v[130:131], v[138:139]
    ds_write_b128 v13, v[148:151] offset:1024
    v_lshlrev_b32 v128, 16, v100
    v_and_b32 v129, s86, v100
    v_lshlrev_b32 v130, 16, v101
    v_and_b32 v131, s86, v101
    v_lshlrev_b32 v132, 16, v110
    v_and_b32 v133, s86, v110
    v_lshlrev_b32 v134, 16, v111
    v_and_b32 v135, s86, v111
    v_fma_f32 v136, v128, v120, v121
    v_fma_f32 v137, v129, v120, v121
    v_fma_f32 v138, v130, v120, v121
    v_fma_f32 v139, v131, v120, v121
    v_cvt_pk_bf16_f32 v140, v136, v137
    v_cvt_pk_bf16_f32 v141, v138, v139
    v_lshlrev_b32 v136, 16, v140
    v_and_b32 v137, s86, v140
    v_lshlrev_b32 v138, 16, v141
    v_and_b32 v139, s86, v141
    v_pk_mul_f32 v[136:137], v[136:137], v[132:133]
    v_pk_mul_f32 v[138:139], v[138:139], v[134:135]
    v_cvt_pk_bf16_f32 v140, v136, v137
    v_cvt_pk_bf16_f32 v141, v138, v139
    v_lshlrev_b32 v136, 16, v140
    v_and_b32 v137, s86, v140
    v_lshlrev_b32 v138, 16, v141
    v_and_b32 v139, s86, v141
    v_pk_add_f32 v[144:145], v[128:129], v[136:137]
    v_pk_add_f32 v[146:147], v[130:131], v[138:139]
    ds_write_b128 v13, v[144:147] offset:2048
    v_lshlrev_b32 v128, 16, v102
    v_and_b32 v129, s86, v102
    v_lshlrev_b32 v130, 16, v103
    v_and_b32 v131, s86, v103
    v_lshlrev_b32 v132, 16, v112
    v_and_b32 v133, s86, v112
    v_lshlrev_b32 v134, 16, v113
    v_and_b32 v135, s86, v113
    v_fma_f32 v136, v128, v122, v123
    v_fma_f32 v137, v129, v122, v123
    v_fma_f32 v138, v130, v122, v123
    v_fma_f32 v139, v131, v122, v123
    v_cvt_pk_bf16_f32 v140, v136, v137
    v_cvt_pk_bf16_f32 v141, v138, v139
    v_lshlrev_b32 v136, 16, v140
    v_and_b32 v137, s86, v140
    v_lshlrev_b32 v138, 16, v141
    v_and_b32 v139, s86, v141
    v_pk_mul_f32 v[136:137], v[136:137], v[132:133]
    v_pk_mul_f32 v[138:139], v[138:139], v[134:135]
    v_cvt_pk_bf16_f32 v140, v136, v137
    v_cvt_pk_bf16_f32 v141, v138, v139
    v_lshlrev_b32 v136, 16, v140
    v_and_b32 v137, s86, v140
    v_lshlrev_b32 v138, 16, v141
    v_and_b32 v139, s86, v141
    v_pk_add_f32 v[148:149], v[128:129], v[136:137]
    v_pk_add_f32 v[150:151], v[130:131], v[138:139]
    ds_write_b128 v13, v[148:151] offset:3072
    v_lshlrev_b32 v128, 16, v104
    v_and_b32 v129, s86, v104
    v_lshlrev_b32 v130, 16, v105
    v_and_b32 v131, s86, v105
    v_lshlrev_b32 v132, 16, v114
    v_and_b32 v133, s86, v114
    v_lshlrev_b32 v134, 16, v115
    v_and_b32 v135, s86, v115
    v_fma_f32 v136, v128, v124, v125
    v_fma_f32 v137, v129, v124, v125
    v_fma_f32 v138, v130, v124, v125
    v_fma_f32 v139, v131, v124, v125
    v_cvt_pk_bf16_f32 v140, v136, v137
    v_cvt_pk_bf16_f32 v141, v138, v139
    v_lshlrev_b32 v136, 16, v140
    v_and_b32 v137, s86, v140
    v_lshlrev_b32 v138, 16, v141
    v_and_b32 v139, s86, v141
    v_pk_mul_f32 v[136:137], v[136:137], v[132:133]
    v_pk_mul_f32 v[138:139], v[138:139], v[134:135]
    v_cvt_pk_bf16_f32 v140, v136, v137
    v_cvt_pk_bf16_f32 v141, v138, v139
    v_lshlrev_b32_e64 v136, 16, v140
    v_and_b32 v137, s86, v140
    v_lshlrev_b32 v138, 16, v141
    v_and_b32 v139, s86, v141
    v_pk_add_f32 v[144:145], v[128:129], v[136:137]
    v_pk_add_f32 v[146:147], v[130:131], v[138:139]
    ds_write_b128 v13, v[144:147] offset:4096
    s_branch K2_START
K1_TYPE_C:
    s_waitcnt vmcnt(13)
    s_barrier
    ds_read_b128 a[160:163], v216 offset:0
    ds_read_b128 a[164:167], v216 offset:8192
    ds_read_b128 a[168:171], v217 offset:0
    ds_read_b128 a[172:175], v217 offset:8192
    ds_read_b128 a[176:179], v218 offset:0
    ds_read_b128 a[180:183], v218 offset:8192
    ds_read_b128 a[184:187], v219 offset:0
    s_waitcnt lgkmcnt(3)
    v_mfma_f32_32x32x16_bf16 v[16:31], a[0:3], a[160:163], 0
    ds_read_b128 a[188:191], v219 offset:8192
    v_lshlrev_b32 v244, 16, v48
    v_and_b32_e64 v245, s86, v48
    v_lshlrev_b32 v246, 16, v49
    v_and_b32 v247, s86, v49
    v_pk_fma_f32 v[244:245], v[244:245], v[252:253], v[254:255]
    v_pk_fma_f32 v[246:247], v[246:247], v[252:253], v[254:255]
    v_mfma_f32_32x32x16_bf16 v[32:47], a[0:3], a[164:167], 0
    ds_read_b128 a[160:163], v220 offset:0
    buffer_load_dwordx4 v213, s[12:15], s32 offen offset:1024 lds
    v_cvt_pk_bf16_f32 v48, v244, v245
    v_cvt_pk_bf16_f32 v49, v246, v247
    v_accvgpr_write_b32 a32, v48
    v_accvgpr_write_b32 a33, v49
    v_lshlrev_b32 v248, 16, v50
    v_and_b32 v249, s86, v50
    v_lshlrev_b32 v250, 16, v51
    v_and_b32 v251, s86, v51
    v_pk_fma_f32 v[248:249], v[248:249], v[252:253], v[254:255]
    v_pk_fma_f32 v[250:251], v[250:251], v[252:253], v[254:255]
    v_mfma_f32_32x32x16_bf16 v[16:31], a[4:7], a[168:171], v[16:31]
    ds_read_b128 a[164:167], v220 offset:8192
    v_cvt_pk_bf16_f32 v50, v248, v249
    v_cvt_pk_bf16_f32 v51, v250, v251
    v_accvgpr_write_b32 a34, v50
    v_accvgpr_write_b32 a35, v51
    v_lshlrev_b32 v244, 16, v52
    v_and_b32 v245, s86, v52
    v_lshlrev_b32 v246, 16, v53
    v_and_b32 v247, s86, v53
    v_pk_fma_f32 v[244:245], v[244:245], v[252:253], v[254:255]
    v_pk_fma_f32 v[246:247], v[246:247], v[252:253], v[254:255]
    v_mfma_f32_32x32x16_bf16 v[32:47], a[4:7], a[172:175], v[32:47]
    ds_read_b128 a[168:171], v221 offset:0
    buffer_load_dwordx4 v214, s[12:15], s32 offen offset:2048 lds
    v_cvt_pk_bf16_f32 v52, v244, v245
    v_cvt_pk_bf16_f32 v53, v246, v247
    v_accvgpr_write_b32 a36, v52
    v_accvgpr_write_b32 a37, v53
    v_lshlrev_b32_e64 v248, 16, v54
    v_and_b32 v249, s86, v54
    v_lshlrev_b32 v250, 16, v55
    v_and_b32 v251, s86, v55
    v_pk_fma_f32 v[248:249], v[248:249], v[252:253], v[254:255]
    v_pk_fma_f32 v[250:251], v[250:251], v[252:253], v[254:255]
    s_waitcnt lgkmcnt(3)
    v_mfma_f32_32x32x16_bf16 v[16:31], a[8:11], a[176:179], v[16:31]
    ds_read_b128 a[172:175], v221 offset:8192
    v_cvt_pk_bf16_f32 v54, v248, v249
    v_cvt_pk_bf16_f32 v55, v250, v251
    v_accvgpr_write_b32 a38, v54
    v_accvgpr_write_b32 a39, v55
    v_lshlrev_b32 v244, 16, v56
    v_and_b32 v245, s86, v56
    v_lshlrev_b32 v246, 16, v57
    v_and_b32 v247, s86, v57
    v_pk_fma_f32 v[244:245], v[244:245], v[252:253], v[254:255]
    v_pk_fma_f32 v[246:247], v[246:247], v[252:253], v[254:255]
    v_mfma_f32_32x32x16_bf16 v[32:47], a[8:11], a[180:183], v[32:47]
    ds_read_b128 a[176:179], v222 offset:0
    buffer_load_dwordx4 v215, s[12:15], s32 offen offset:3072 lds
    v_cvt_pk_bf16_f32 v56, v244, v245
    v_cvt_pk_bf16_f32 v57, v246, v247
    v_accvgpr_write_b32 a40, v56
    v_accvgpr_write_b32 a41, v57
    v_lshlrev_b32 v248, 16, v58
    v_and_b32 v249, s86, v58
    v_lshlrev_b32 v250, 16, v59
    v_and_b32 v251, s86, v59
    v_pk_fma_f32 v[248:249], v[248:249], v[252:253], v[254:255]
    v_pk_fma_f32 v[250:251], v[250:251], v[252:253], v[254:255]
    v_mfma_f32_32x32x16_bf16 v[16:31], a[12:15], a[184:187], v[16:31]
    ds_read_b128 a[180:183], v222 offset:8192
    v_cvt_pk_bf16_f32 v58, v248, v249
    v_cvt_pk_bf16_f32 v59, v250, v251
    v_accvgpr_write_b32 a42, v58
    v_accvgpr_write_b32 a43, v59
    v_lshlrev_b32_e64 v244, 16, v60
    v_and_b32 v245, s86, v60
    v_lshlrev_b32 v246, 16, v61
    v_and_b32 v247, s86, v61
    v_pk_fma_f32 v[244:245], v[244:245], v[252:253], v[254:255]
    v_pk_fma_f32 v[246:247], v[246:247], v[252:253], v[254:255]
    v_mfma_f32_32x32x16_bf16 v[32:47], a[12:15], a[188:191], v[32:47]
    ds_read_b128 a[184:187], v223 offset:0
    s_add_u32 m0, s78, 81920
    s_add_u32 s32, s81, s68
    s_add_u32 s32, s32, 40960
    buffer_load_dwordx4 v212, s[12:15], s32 offen offset:0 lds
    v_cvt_pk_bf16_f32 v60, v244, v245
    v_cvt_pk_bf16_f32 v61, v246, v247
    v_accvgpr_write_b32 a44, v60
    v_accvgpr_write_b32 a45, v61
    v_lshlrev_b32_e64 v248, 16, v62
    v_and_b32 v249, s86, v62
    v_lshlrev_b32 v250, 16, v63
    v_and_b32 v251, s86, v63
    v_pk_fma_f32 v[248:249], v[248:249], v[252:253], v[254:255]
    v_pk_fma_f32 v[250:251], v[250:251], v[252:253], v[254:255]
    s_waitcnt lgkmcnt(3)
    v_mfma_f32_32x32x16_bf16 v[16:31], a[16:19], a[160:163], v[16:31]
    ds_read_b128 a[188:191], v223 offset:8192
    v_cvt_pk_bf16_f32 v62, v248, v249
    v_cvt_pk_bf16_f32 v63, v250, v251
    v_accvgpr_write_b32 a46, v62
    v_accvgpr_write_b32 a47, v63
    v_lshlrev_b32 v244, 16, v64
    v_and_b32 v245, s86, v64
    v_lshlrev_b32 v246, 16, v65
    v_and_b32 v247, s86, v65
    v_pk_fma_f32 v[244:245], v[244:245], v[252:253], v[254:255]
    v_pk_fma_f32 v[246:247], v[246:247], v[252:253], v[254:255]
    v_mfma_f32_32x32x16_bf16 v[32:47], a[16:19], a[164:167], v[32:47]
    s_waitcnt vmcnt(13)
    s_barrier
    ds_read_b128 a[160:163], v216 offset:16384
    buffer_load_dwordx4 v213, s[12:15], s32 offen offset:1024 lds
    v_cvt_pk_bf16_f32 v64, v244, v245
    v_cvt_pk_bf16_f32 v65, v246, v247
    v_accvgpr_write_b32 a48, v64
    v_accvgpr_write_b32 a49, v65
    v_lshlrev_b32 v248, 16, v66
    v_and_b32 v249, s86, v66
    v_lshlrev_b32 v250, 16, v67
    v_and_b32 v251, s86, v67
    v_pk_fma_f32 v[248:249], v[248:249], v[252:253], v[254:255]
    v_pk_fma_f32 v[250:251], v[250:251], v[252:253], v[254:255]
    v_mfma_f32_32x32x16_bf16 v[16:31], a[20:23], a[168:171], v[16:31]
    ds_read_b128 a[164:167], v216 offset:24576
    v_cvt_pk_bf16_f32 v66, v248, v249
    v_cvt_pk_bf16_f32 v67, v250, v251
    v_accvgpr_write_b32 a50, v66
    v_accvgpr_write_b32 a51, v67
    v_lshlrev_b32 v244, 16, v68
    v_and_b32 v245, s86, v68
    v_lshlrev_b32 v246, 16, v69
    v_and_b32 v247, s86, v69
    v_pk_fma_f32 v[244:245], v[244:245], v[252:253], v[254:255]
    v_pk_fma_f32 v[246:247], v[246:247], v[252:253], v[254:255]
    v_mfma_f32_32x32x16_bf16 v[32:47], a[20:23], a[172:175], v[32:47]
    ds_read_b128 a[168:171], v217 offset:16384
    buffer_load_dwordx4 v214, s[12:15], s32 offen offset:2048 lds
    v_cvt_pk_bf16_f32 v68, v244, v245
    v_cvt_pk_bf16_f32 v69, v246, v247
    v_accvgpr_write_b32 a52, v68
    v_accvgpr_write_b32 a53, v69
    v_lshlrev_b32_e64 v248, 16, v70
    v_and_b32 v249, s86, v70
    v_lshlrev_b32 v250, 16, v71
    v_and_b32 v251, s86, v71
    v_pk_fma_f32 v[248:249], v[248:249], v[252:253], v[254:255]
    v_pk_fma_f32 v[250:251], v[250:251], v[252:253], v[254:255]
    s_waitcnt lgkmcnt(3)
    v_mfma_f32_32x32x16_bf16 v[16:31], a[24:27], a[176:179], v[16:31]
    ds_read_b128 a[172:175], v217 offset:24576
    v_cvt_pk_bf16_f32 v70, v248, v249
    v_cvt_pk_bf16_f32 v71, v250, v251
    v_accvgpr_write_b32 a54, v70
    v_accvgpr_write_b32 a55, v71
    v_lshlrev_b32 v244, 16, v72
    v_and_b32 v245, s86, v72
    v_lshlrev_b32 v246, 16, v73
    v_and_b32 v247, s86, v73
    v_pk_fma_f32 v[244:245], v[244:245], v[252:253], v[254:255]
    v_pk_fma_f32 v[246:247], v[246:247], v[252:253], v[254:255]
    v_mfma_f32_32x32x16_bf16 v[32:47], a[24:27], a[180:183], v[32:47]
    ds_read_b128 a[176:179], v218 offset:16384
    buffer_load_dwordx4 v215, s[12:15], s32 offen offset:3072 lds
    v_cvt_pk_bf16_f32 v72, v244, v245
    v_cvt_pk_bf16_f32 v73, v246, v247
    v_accvgpr_write_b32 a56, v72
    v_accvgpr_write_b32 a57, v73
    v_lshlrev_b32 v248, 16, v74
    v_and_b32 v249, s86, v74
    v_lshlrev_b32 v250, 16, v75
    v_and_b32 v251, s86, v75
    v_pk_fma_f32 v[248:249], v[248:249], v[252:253], v[254:255]
    v_pk_fma_f32 v[250:251], v[250:251], v[252:253], v[254:255]
    v_mfma_f32_32x32x16_bf16 v[16:31], a[28:31], a[184:187], v[16:31]
    ds_read_b128 a[180:183], v218 offset:24576
    v_cvt_pk_bf16_f32 v74, v248, v249
    v_cvt_pk_bf16_f32 v75, v250, v251
    v_accvgpr_write_b32 a58, v74
    v_accvgpr_write_b32 a59, v75
    v_lshlrev_b32 v244, 16, v76
    v_and_b32 v245, s86, v76
    v_lshlrev_b32 v246, 16, v77
    v_and_b32 v247, s86, v77
    v_pk_fma_f32 v[244:245], v[244:245], v[252:253], v[254:255]
    v_pk_fma_f32 v[246:247], v[246:247], v[252:253], v[254:255]
    v_mfma_f32_32x32x16_bf16 v[32:47], a[28:31], a[188:191], v[32:47]
    ds_read_b128 a[184:187], v219 offset:16384
    s_add_u32 m0, s93, 0
    s_nop 0
    buffer_load_dwordx4 v188, s[24:27], s7 offen nt lds
    v_cvt_pk_bf16_f32 v76, v244, v245
    v_cvt_pk_bf16_f32 v77, v246, v247
    v_accvgpr_write_b32 a60, v76
    v_accvgpr_write_b32 a61, v77
    v_lshlrev_b32_e64 v248, 16, v78
    v_and_b32 v249, s86, v78
    v_lshlrev_b32 v250, 16, v79
    v_and_b32 v251, s86, v79
    v_pk_fma_f32 v[248:249], v[248:249], v[252:253], v[254:255]
    v_pk_fma_f32 v[250:251], v[250:251], v[252:253], v[254:255]
    s_waitcnt lgkmcnt(3)
    v_mfma_f32_32x32x16_bf16 v[16:31], a[32:35], a[160:163], v[16:31]
    ds_read_b128 a[188:191], v219 offset:24576
    v_cvt_pk_bf16_f32 v78, v248, v249
    v_cvt_pk_bf16_f32 v79, v250, v251
    v_accvgpr_write_b32 a62, v78
    v_accvgpr_write_b32 a63, v79
    v_lshlrev_b32_e64 v244, 16, v80
    v_and_b32 v245, s86, v80
    v_lshlrev_b32 v246, 16, v81
    v_and_b32 v247, s86, v81
    v_pk_fma_f32 v[244:245], v[244:245], v[252:253], v[254:255]
    v_pk_fma_f32 v[246:247], v[246:247], v[252:253], v[254:255]
    v_mfma_f32_32x32x16_bf16 v[32:47], a[32:35], a[164:167], v[32:47]
    ds_read_b128 a[160:163], v220 offset:16384
    s_add_u32 m0, s93, 1024
    s_nop 0
    buffer_load_dwordx4 v189, s[24:27], s7 offen nt lds
    v_cvt_pk_bf16_f32 v80, v244, v245
    v_cvt_pk_bf16_f32 v81, v246, v247
    v_accvgpr_write_b32 a64, v80
    v_accvgpr_write_b32 a65, v81
    v_lshlrev_b32 v248, 16, v82
    v_and_b32 v249, s86, v82
    v_lshlrev_b32 v250, 16, v83
    v_and_b32 v251, s86, v83
    v_pk_fma_f32 v[248:249], v[248:249], v[252:253], v[254:255]
    v_pk_fma_f32 v[250:251], v[250:251], v[252:253], v[254:255]
    v_mfma_f32_32x32x16_bf16 v[16:31], a[36:39], a[168:171], v[16:31]
    ds_read_b128 a[164:167], v220 offset:24576
    v_cvt_pk_bf16_f32 v82, v248, v249
    v_cvt_pk_bf16_f32 v83, v250, v251
    v_accvgpr_write_b32 a66, v82
    v_accvgpr_write_b32 a67, v83
    v_lshlrev_b32 v244, 16, v84
    v_and_b32 v245, s86, v84
    v_lshlrev_b32 v246, 16, v85
    v_and_b32 v247, s86, v85
    v_pk_fma_f32 v[244:245], v[244:245], v[252:253], v[254:255]
    v_pk_fma_f32 v[246:247], v[246:247], v[252:253], v[254:255]
    v_mfma_f32_32x32x16_bf16 v[32:47], a[36:39], a[172:175], v[32:47]
    ds_read_b128 a[168:171], v221 offset:16384
    s_add_u32 m0, s93, 2048
    s_nop 0
    buffer_load_dwordx4 v190, s[28:31], s7 offen nt lds
    v_cvt_pk_bf16_f32 v84, v244, v245
    v_cvt_pk_bf16_f32 v85, v246, v247
    v_accvgpr_write_b32 a68, v84
    v_accvgpr_write_b32 a69, v85
    v_lshlrev_b32 v248, 16, v86
    v_and_b32 v249, s86, v86
    v_lshlrev_b32 v250, 16, v87
    v_and_b32 v251, s86, v87
    v_pk_fma_f32 v[248:249], v[248:249], v[252:253], v[254:255]
    v_pk_fma_f32 v[250:251], v[250:251], v[252:253], v[254:255]
    s_waitcnt lgkmcnt(3)
    v_mfma_f32_32x32x16_bf16 v[16:31], a[40:43], a[176:179], v[16:31]
    ds_read_b128 a[172:175], v221 offset:24576
    v_cvt_pk_bf16_f32 v86, v248, v249
    v_cvt_pk_bf16_f32 v87, v250, v251
    v_accvgpr_write_b32 a70, v86
    v_accvgpr_write_b32 a71, v87
    v_lshlrev_b32_e64 v244, 16, v88
    v_and_b32 v245, s86, v88
    v_lshlrev_b32 v246, 16, v89
    v_and_b32 v247, s86, v89
    v_pk_fma_f32 v[244:245], v[244:245], v[252:253], v[254:255]
    v_pk_fma_f32 v[246:247], v[246:247], v[252:253], v[254:255]
    v_mfma_f32_32x32x16_bf16 v[32:47], a[40:43], a[180:183], v[32:47]
    ds_read_b128 a[176:179], v222 offset:16384
    s_add_u32 m0, s93, 3072
    s_nop 0
    buffer_load_dwordx4 v191, s[28:31], s7 offen nt lds
    v_cvt_pk_bf16_f32 v88, v244, v245
    v_cvt_pk_bf16_f32 v89, v246, v247
    v_accvgpr_write_b32 a72, v88
    v_accvgpr_write_b32 a73, v89
    v_lshlrev_b32 v248, 16, v90
    v_and_b32 v249, s86, v90
    v_lshlrev_b32 v250, 16, v91
    v_and_b32 v251, s86, v91
    v_pk_fma_f32 v[248:249], v[248:249], v[252:253], v[254:255]
    v_pk_fma_f32 v[250:251], v[250:251], v[252:253], v[254:255]
    v_mfma_f32_32x32x16_bf16 v[16:31], a[44:47], a[184:187], v[16:31]
    ds_read_b128 a[180:183], v222 offset:24576
    v_cvt_pk_bf16_f32 v90, v248, v249
    v_cvt_pk_bf16_f32 v91, v250, v251
    v_accvgpr_write_b32 a74, v90
    v_accvgpr_write_b32 a75, v91
    v_lshlrev_b32 v244, 16, v92
    v_and_b32 v245, s86, v92
    v_lshlrev_b32 v246, 16, v93
    v_and_b32 v247, s86, v93
    v_pk_fma_f32 v[244:245], v[244:245], v[252:253], v[254:255]
    v_pk_fma_f32 v[246:247], v[246:247], v[252:253], v[254:255]
    v_mfma_f32_32x32x16_bf16 v[32:47], a[44:47], a[188:191], v[32:47]
    ds_read_b128 a[184:187], v223 offset:16384
    s_add_u32 m0, s93, 4096
    s_nop 0
    buffer_load_dwordx4 v192, s[28:31], s7 offen nt lds
    v_cvt_pk_bf16_f32 v92, v244, v245
    v_cvt_pk_bf16_f32 v93, v246, v247
    v_accvgpr_write_b32 a76, v92
    v_accvgpr_write_b32 a77, v93
    v_lshlrev_b32 v248, 16, v94
    v_and_b32 v249, s86, v94
    v_lshlrev_b32 v250, 16, v95
    v_and_b32 v251, s86, v95
    v_pk_fma_f32 v[248:249], v[248:249], v[252:253], v[254:255]
    v_pk_fma_f32 v[250:251], v[250:251], v[252:253], v[254:255]
    s_waitcnt lgkmcnt(3)
    v_mfma_f32_32x32x16_bf16 v[16:31], a[48:51], a[160:163], v[16:31]
    ds_read_b128 a[188:191], v223 offset:24576
    v_cvt_pk_bf16_f32 v94, v248, v249
    v_cvt_pk_bf16_f32 v95, v250, v251
    v_accvgpr_write_b32 a78, v94
    v_accvgpr_write_b32 a79, v95
    v_lshlrev_b32_e64 v244, 16, v96
    v_and_b32 v245, s86, v96
    v_lshlrev_b32 v246, 16, v97
    v_and_b32 v247, s86, v97
    v_pk_fma_f32 v[244:245], v[244:245], v[252:253], v[254:255]
    v_pk_fma_f32 v[246:247], v[246:247], v[252:253], v[254:255]
    v_mfma_f32_32x32x16_bf16 v[32:47], a[48:51], a[164:167], v[32:47]
    s_waitcnt vmcnt(17)
    s_barrier
    ds_read_b128 a[160:163], v216 offset:32768
    s_add_u32 m0, s78, 98304
    s_add_u32 s32, s81, s69
    s_add_u32 s32, s32, 40960
    buffer_load_dwordx4 v212, s[12:15], s32 offen offset:0 lds
    v_cvt_pk_bf16_f32 v96, v244, v245
    v_cvt_pk_bf16_f32 v97, v246, v247
    v_accvgpr_write_b32 a80, v96
    v_accvgpr_write_b32 a81, v97
    v_lshlrev_b32 v248, 16, v98
    v_and_b32 v249, s86, v98
    v_lshlrev_b32 v250, 16, v99
    v_and_b32 v251, s86, v99
    v_pk_fma_f32 v[248:249], v[248:249], v[252:253], v[254:255]
    v_pk_fma_f32 v[250:251], v[250:251], v[252:253], v[254:255]
    v_mfma_f32_32x32x16_bf16 v[16:31], a[52:55], a[168:171], v[16:31]
    ds_read_b128 a[164:167], v216 offset:40960
    v_cvt_pk_bf16_f32 v98, v248, v249
    v_cvt_pk_bf16_f32 v99, v250, v251
    v_accvgpr_write_b32 a82, v98
    v_accvgpr_write_b32 a83, v99
    v_lshlrev_b32 v244, 16, v100
    v_and_b32 v245, s86, v100
    v_lshlrev_b32 v246, 16, v101
    v_and_b32 v247, s86, v101
    v_pk_fma_f32 v[244:245], v[244:245], v[252:253], v[254:255]
    v_pk_fma_f32 v[246:247], v[246:247], v[252:253], v[254:255]
    v_mfma_f32_32x32x16_bf16 v[32:47], a[52:55], a[172:175], v[32:47]
    ds_read_b128 a[168:171], v217 offset:32768
    buffer_load_dwordx4 v213, s[12:15], s32 offen offset:1024 lds
    v_cvt_pk_bf16_f32 v100, v244, v245
    v_cvt_pk_bf16_f32 v101, v246, v247
    v_accvgpr_write_b32 a84, v100
    v_accvgpr_write_b32 a85, v101
    v_lshlrev_b32_e64 v248, 16, v102
    v_and_b32 v249, s86, v102
    v_lshlrev_b32 v250, 16, v103
    v_and_b32 v251, s86, v103
    v_pk_fma_f32 v[248:249], v[248:249], v[252:253], v[254:255]
    v_pk_fma_f32 v[250:251], v[250:251], v[252:253], v[254:255]
    s_waitcnt lgkmcnt(3)
    v_mfma_f32_32x32x16_bf16 v[16:31], a[56:59], a[176:179], v[16:31]
    ds_read_b128 a[172:175], v217 offset:40960
    v_cvt_pk_bf16_f32 v102, v248, v249
    v_cvt_pk_bf16_f32 v103, v250, v251
    v_accvgpr_write_b32 a86, v102
    v_accvgpr_write_b32 a87, v103
    v_lshlrev_b32 v244, 16, v104
    v_and_b32 v245, s86, v104
    v_lshlrev_b32 v246, 16, v105
    v_and_b32 v247, s86, v105
    v_pk_fma_f32 v[244:245], v[244:245], v[252:253], v[254:255]
    v_pk_fma_f32 v[246:247], v[246:247], v[252:253], v[254:255]
    v_mfma_f32_32x32x16_bf16 v[32:47], a[56:59], a[180:183], v[32:47]
    ds_read_b128 a[176:179], v218 offset:32768
    buffer_load_dwordx4 v214, s[12:15], s32 offen offset:2048 lds
    v_cvt_pk_bf16_f32 v104, v244, v245
    v_cvt_pk_bf16_f32 v105, v246, v247
    v_accvgpr_write_b32 a88, v104
    v_accvgpr_write_b32 a89, v105
    v_lshlrev_b32 v248, 16, v106
    v_and_b32 v249, s86, v106
    v_lshlrev_b32 v250, 16, v107
    v_and_b32 v251, s86, v107
    v_pk_fma_f32 v[248:249], v[248:249], v[252:253], v[254:255]
    v_pk_fma_f32 v[250:251], v[250:251], v[252:253], v[254:255]
    v_mfma_f32_32x32x16_bf16 v[16:31], a[60:63], a[184:187], v[16:31]
    ds_read_b128 a[180:183], v218 offset:40960
    v_cvt_pk_bf16_f32 v106, v248, v249
    v_cvt_pk_bf16_f32 v107, v250, v251
    v_accvgpr_write_b32 a90, v106
    v_accvgpr_write_b32 a91, v107
    v_lshlrev_b32 v244, 16, v108
    v_and_b32 v245, s86, v108
    v_lshlrev_b32 v246, 16, v109
    v_and_b32 v247, s86, v109
    v_pk_fma_f32 v[244:245], v[244:245], v[252:253], v[254:255]
    v_pk_fma_f32 v[246:247], v[246:247], v[252:253], v[254:255]
    v_mfma_f32_32x32x16_bf16 v[32:47], a[60:63], a[188:191], v[32:47]
    ds_read_b128 a[184:187], v219 offset:32768
    buffer_load_dwordx4 v215, s[12:15], s32 offen offset:3072 lds
    v_cvt_pk_bf16_f32 v108, v244, v245
    v_cvt_pk_bf16_f32 v109, v246, v247
    v_accvgpr_write_b32 a92, v108
    v_accvgpr_write_b32 a93, v109
    v_lshlrev_b32_e64 v248, 16, v110
    v_and_b32 v249, s86, v110
    v_lshlrev_b32 v250, 16, v111
    v_and_b32 v251, s86, v111
    v_pk_fma_f32 v[248:249], v[248:249], v[252:253], v[254:255]
    v_pk_fma_f32 v[250:251], v[250:251], v[252:253], v[254:255]
    s_waitcnt lgkmcnt(3)
    v_mfma_f32_32x32x16_bf16 v[16:31], a[64:67], a[160:163], v[16:31]
    ds_read_b128 a[188:191], v219 offset:40960
    v_cvt_pk_bf16_f32 v110, v248, v249
    v_cvt_pk_bf16_f32 v111, v250, v251
    v_accvgpr_write_b32 a94, v110
    v_accvgpr_write_b32 a95, v111
    v_lshlrev_b32_e64 v244, 16, v112
    v_and_b32 v245, s86, v112
    v_lshlrev_b32 v246, 16, v113
    v_and_b32 v247, s86, v113
    v_pk_fma_f32 v[244:245], v[244:245], v[252:253], v[254:255]
    v_pk_fma_f32 v[246:247], v[246:247], v[252:253], v[254:255]
    v_mfma_f32_32x32x16_bf16 v[32:47], a[64:67], a[164:167], v[32:47]
    ds_read_b128 a[160:163], v220 offset:32768
    s_add_u32 m0, s78, 114688
    s_add_u32 s32, s81, s70
    s_add_u32 s32, s32, 40960
    buffer_load_dwordx4 v212, s[12:15], s32 offen offset:0 lds
    v_cvt_pk_bf16_f32 v112, v244, v245
    v_cvt_pk_bf16_f32 v113, v246, v247
    v_accvgpr_write_b32 a96, v112
    v_accvgpr_write_b32 a97, v113
    v_lshlrev_b32 v248, 16, v114
    v_and_b32 v249, s86, v114
    v_lshlrev_b32 v250, 16, v115
    v_and_b32 v251, s86, v115
    v_pk_fma_f32 v[248:249], v[248:249], v[252:253], v[254:255]
    v_pk_fma_f32 v[250:251], v[250:251], v[252:253], v[254:255]
    v_mfma_f32_32x32x16_bf16 v[16:31], a[68:71], a[168:171], v[16:31]
    ds_read_b128 a[164:167], v220 offset:40960
    v_cvt_pk_bf16_f32 v114, v248, v249
    v_cvt_pk_bf16_f32 v115, v250, v251
    v_accvgpr_write_b32 a98, v114
    v_accvgpr_write_b32 a99, v115
    v_lshlrev_b32 v244, 16, v116
    v_and_b32 v245, s86, v116
    v_lshlrev_b32 v246, 16, v117
    v_and_b32 v247, s86, v117
    v_pk_fma_f32 v[244:245], v[244:245], v[252:253], v[254:255]
    v_pk_fma_f32 v[246:247], v[246:247], v[252:253], v[254:255]
    v_mfma_f32_32x32x16_bf16 v[32:47], a[68:71], a[172:175], v[32:47]
    ds_read_b128 a[168:171], v221 offset:32768
    buffer_load_dwordx4 v213, s[12:15], s32 offen offset:1024 lds
    v_cvt_pk_bf16_f32 v116, v244, v245
    v_cvt_pk_bf16_f32 v117, v246, v247
    v_accvgpr_write_b32 a100, v116
    v_accvgpr_write_b32 a101, v117
    v_lshlrev_b32_e64 v248, 16, v118
    v_and_b32 v249, s86, v118
    v_lshlrev_b32 v250, 16, v119
    v_and_b32 v251, s86, v119
    v_pk_fma_f32 v[248:249], v[248:249], v[252:253], v[254:255]
    v_pk_fma_f32 v[250:251], v[250:251], v[252:253], v[254:255]
    s_waitcnt lgkmcnt(3)
    v_mfma_f32_32x32x16_bf16 v[16:31], a[72:75], a[176:179], v[16:31]
    ds_read_b128 a[172:175], v221 offset:40960
    v_cvt_pk_bf16_f32 v118, v248, v249
    v_cvt_pk_bf16_f32 v119, v250, v251
    v_accvgpr_write_b32 a102, v118
    v_accvgpr_write_b32 a103, v119
    v_lshlrev_b32 v244, 16, v120
    v_and_b32 v245, s86, v120
    v_lshlrev_b32 v246, 16, v121
    v_and_b32 v247, s86, v121
    v_pk_fma_f32 v[244:245], v[244:245], v[252:253], v[254:255]
    v_pk_fma_f32 v[246:247], v[246:247], v[252:253], v[254:255]
    v_mfma_f32_32x32x16_bf16 v[32:47], a[72:75], a[180:183], v[32:47]
    ds_read_b128 a[176:179], v222 offset:32768
    buffer_load_dwordx4 v214, s[12:15], s32 offen offset:2048 lds
    v_cvt_pk_bf16_f32 v120, v244, v245
    v_cvt_pk_bf16_f32 v121, v246, v247
    v_accvgpr_write_b32 a104, v120
    v_accvgpr_write_b32 a105, v121
    v_lshlrev_b32 v248, 16, v122
    v_and_b32 v249, s86, v122
    v_lshlrev_b32 v250, 16, v123
    v_and_b32 v251, s86, v123
    v_pk_fma_f32 v[248:249], v[248:249], v[252:253], v[254:255]
    v_pk_fma_f32 v[250:251], v[250:251], v[252:253], v[254:255]
    v_mfma_f32_32x32x16_bf16 v[16:31], a[76:79], a[184:187], v[16:31]
    ds_read_b128 a[180:183], v222 offset:40960
    v_cvt_pk_bf16_f32 v122, v248, v249
    v_cvt_pk_bf16_f32 v123, v250, v251
    v_accvgpr_write_b32 a106, v122
    v_accvgpr_write_b32 a107, v123
    v_lshlrev_b32 v244, 16, v124
    v_and_b32 v245, s86, v124
    v_lshlrev_b32 v246, 16, v125
    v_and_b32 v247, s86, v125
    v_pk_fma_f32 v[244:245], v[244:245], v[252:253], v[254:255]
    v_pk_fma_f32 v[246:247], v[246:247], v[252:253], v[254:255]
    v_mfma_f32_32x32x16_bf16 v[32:47], a[76:79], a[188:191], v[32:47]
    ds_read_b128 a[184:187], v223 offset:32768
    buffer_load_dwordx4 v215, s[12:15], s32 offen offset:3072 lds
    v_cvt_pk_bf16_f32 v124, v244, v245
    v_cvt_pk_bf16_f32 v125, v246, v247
    v_accvgpr_write_b32 a108, v124
    v_accvgpr_write_b32 a109, v125
    v_lshlrev_b32_e64 v248, 16, v126
    v_and_b32 v249, s86, v126
    v_lshlrev_b32 v250, 16, v127
    v_and_b32 v251, s86, v127
    v_pk_fma_f32 v[248:249], v[248:249], v[252:253], v[254:255]
    v_pk_fma_f32 v[250:251], v[250:251], v[252:253], v[254:255]
    s_waitcnt lgkmcnt(3)
    v_mfma_f32_32x32x16_bf16 v[16:31], a[80:83], a[160:163], v[16:31]
    ds_read_b128 a[188:191], v223 offset:40960
    v_cvt_pk_bf16_f32 v126, v248, v249
    v_cvt_pk_bf16_f32 v127, v250, v251
    v_accvgpr_write_b32 a110, v126
    v_accvgpr_write_b32 a111, v127
    v_lshlrev_b32 v244, 16, v128
    v_and_b32 v245, s86, v128
    v_lshlrev_b32 v246, 16, v129
    v_and_b32 v247, s86, v129
    v_pk_fma_f32 v[244:245], v[244:245], v[252:253], v[254:255]
    v_pk_fma_f32 v[246:247], v[246:247], v[252:253], v[254:255]
    v_mfma_f32_32x32x16_bf16 v[32:47], a[80:83], a[164:167], v[32:47]
    s_waitcnt vmcnt(21)
    s_barrier
    ds_read_b128 a[160:163], v216 offset:49152
    s_add_u32 m0, s78, 0
    s_add_u32 s32, s81, s71
    s_add_u32 s32, s32, 40960
    buffer_load_dwordx4 v212, s[12:15], s32 offen offset:0 lds
    v_cvt_pk_bf16_f32 v128, v244, v245
    v_cvt_pk_bf16_f32 v129, v246, v247
    v_accvgpr_write_b32 a112, v128
    v_accvgpr_write_b32 a113, v129
    v_lshlrev_b32 v248, 16, v130
    v_and_b32 v249, s86, v130
    v_lshlrev_b32 v250, 16, v131
    v_and_b32 v251, s86, v131
    v_pk_fma_f32 v[248:249], v[248:249], v[252:253], v[254:255]
    v_pk_fma_f32 v[250:251], v[250:251], v[252:253], v[254:255]
    v_mfma_f32_32x32x16_bf16 v[16:31], a[84:87], a[168:171], v[16:31]
    ds_read_b128 a[164:167], v216 offset:57344
    v_cvt_pk_bf16_f32 v130, v248, v249
    v_cvt_pk_bf16_f32 v131, v250, v251
    v_accvgpr_write_b32 a114, v130
    v_accvgpr_write_b32 a115, v131
    v_lshlrev_b32 v244, 16, v132
    v_and_b32 v245, s86, v132
    v_lshlrev_b32 v246, 16, v133
    v_and_b32 v247, s86, v133
    v_pk_fma_f32 v[244:245], v[244:245], v[252:253], v[254:255]
    v_pk_fma_f32 v[246:247], v[246:247], v[252:253], v[254:255]
    v_mfma_f32_32x32x16_bf16 v[32:47], a[84:87], a[172:175], v[32:47]
    ds_read_b128 a[168:171], v217 offset:49152
    buffer_load_dwordx4 v213, s[12:15], s32 offen offset:1024 lds
    v_cvt_pk_bf16_f32 v132, v244, v245
    v_cvt_pk_bf16_f32 v133, v246, v247
    v_accvgpr_write_b32 a116, v132
    v_accvgpr_write_b32 a117, v133
    v_lshlrev_b32_e64 v248, 16, v134
    v_and_b32 v249, s86, v134
    v_lshlrev_b32 v250, 16, v135
    v_and_b32 v251, s86, v135
    v_pk_fma_f32 v[248:249], v[248:249], v[252:253], v[254:255]
    v_pk_fma_f32 v[250:251], v[250:251], v[252:253], v[254:255]
    s_waitcnt lgkmcnt(3)
    v_mfma_f32_32x32x16_bf16 v[16:31], a[88:91], a[176:179], v[16:31]
    ds_read_b128 a[172:175], v217 offset:57344
    v_cvt_pk_bf16_f32 v134, v248, v249
    v_cvt_pk_bf16_f32 v135, v250, v251
    v_accvgpr_write_b32 a118, v134
    v_accvgpr_write_b32 a119, v135
    v_lshlrev_b32 v244, 16, v136
    v_and_b32 v245, s86, v136
    v_lshlrev_b32 v246, 16, v137
    v_and_b32 v247, s86, v137
    v_pk_fma_f32 v[244:245], v[244:245], v[252:253], v[254:255]
    v_pk_fma_f32 v[246:247], v[246:247], v[252:253], v[254:255]
    v_mfma_f32_32x32x16_bf16 v[32:47], a[88:91], a[180:183], v[32:47]
    ds_read_b128 a[176:179], v218 offset:49152
    buffer_load_dwordx4 v214, s[12:15], s32 offen offset:2048 lds
    v_cvt_pk_bf16_f32 v136, v244, v245
    v_cvt_pk_bf16_f32 v137, v246, v247
    v_accvgpr_write_b32 a120, v136
    v_accvgpr_write_b32 a121, v137
    v_lshlrev_b32 v248, 16, v138
    v_and_b32 v249, s86, v138
    v_lshlrev_b32 v250, 16, v139
    v_and_b32 v251, s86, v139
    v_pk_fma_f32 v[248:249], v[248:249], v[252:253], v[254:255]
    v_pk_fma_f32 v[250:251], v[250:251], v[252:253], v[254:255]
    v_mfma_f32_32x32x16_bf16 v[16:31], a[92:95], a[184:187], v[16:31]
    ds_read_b128 a[180:183], v218 offset:57344
    v_cvt_pk_bf16_f32 v138, v248, v249
    v_cvt_pk_bf16_f32 v139, v250, v251
    v_accvgpr_write_b32 a122, v138
    v_accvgpr_write_b32 a123, v139
    v_lshlrev_b32 v244, 16, v140
    v_and_b32 v245, s86, v140
    v_lshlrev_b32 v246, 16, v141
    v_and_b32 v247, s86, v141
    v_pk_fma_f32 v[244:245], v[244:245], v[252:253], v[254:255]
    v_pk_fma_f32 v[246:247], v[246:247], v[252:253], v[254:255]
    v_mfma_f32_32x32x16_bf16 v[32:47], a[92:95], a[188:191], v[32:47]
    ds_read_b128 a[184:187], v219 offset:49152
    buffer_load_dwordx4 v215, s[12:15], s32 offen offset:3072 lds
    v_cvt_pk_bf16_f32 v140, v244, v245
    v_cvt_pk_bf16_f32 v141, v246, v247
    v_accvgpr_write_b32 a124, v140
    v_accvgpr_write_b32 a125, v141
    v_lshlrev_b32_e64 v248, 16, v142
    v_and_b32 v249, s86, v142
    v_lshlrev_b32 v250, 16, v143
    v_and_b32 v251, s86, v143
    v_pk_fma_f32 v[248:249], v[248:249], v[252:253], v[254:255]
    v_pk_fma_f32 v[250:251], v[250:251], v[252:253], v[254:255]
    s_waitcnt lgkmcnt(3)
    v_mfma_f32_32x32x16_bf16 v[16:31], a[96:99], a[160:163], v[16:31]
    ds_read_b128 a[188:191], v219 offset:57344
    v_cvt_pk_bf16_f32 v142, v248, v249
    v_cvt_pk_bf16_f32 v143, v250, v251
    v_accvgpr_write_b32 a126, v142
    v_accvgpr_write_b32 a127, v143
    v_lshlrev_b32_e64 v244, 16, v144
    v_and_b32 v245, s86, v144
    v_lshlrev_b32 v246, 16, v145
    v_and_b32 v247, s86, v145
    v_pk_fma_f32 v[244:245], v[244:245], v[252:253], v[254:255]
    v_pk_fma_f32 v[246:247], v[246:247], v[252:253], v[254:255]
    v_mfma_f32_32x32x16_bf16 v[32:47], a[96:99], a[164:167], v[32:47]
    ds_read_b128 a[160:163], v220 offset:49152
    s_add_u32 m0, s78, 16384
    s_add_u32 s32, s81, s72
    s_add_u32 s32, s32, 40960
    buffer_load_dwordx4 v212, s[12:15], s32 offen offset:0 lds
    v_cvt_pk_bf16_f32 v144, v244, v245
    v_cvt_pk_bf16_f32 v145, v246, v247
    v_accvgpr_write_b32 a128, v144
    v_accvgpr_write_b32 a129, v145
    v_lshlrev_b32 v248, 16, v146
    v_and_b32 v249, s86, v146
    v_lshlrev_b32 v250, 16, v147
    v_and_b32 v251, s86, v147
    v_pk_fma_f32 v[248:249], v[248:249], v[252:253], v[254:255]
    v_pk_fma_f32 v[250:251], v[250:251], v[252:253], v[254:255]
    v_mfma_f32_32x32x16_bf16 v[16:31], a[100:103], a[168:171], v[16:31]
    ds_read_b128 a[164:167], v220 offset:57344
    v_cvt_pk_bf16_f32 v146, v248, v249
    v_cvt_pk_bf16_f32 v147, v250, v251
    v_accvgpr_write_b32 a130, v146
    v_accvgpr_write_b32 a131, v147
    v_lshlrev_b32 v244, 16, v148
    v_and_b32 v245, s86, v148
    v_lshlrev_b32 v246, 16, v149
    v_and_b32 v247, s86, v149
    v_pk_fma_f32 v[244:245], v[244:245], v[252:253], v[254:255]
    v_pk_fma_f32 v[246:247], v[246:247], v[252:253], v[254:255]
    v_mfma_f32_32x32x16_bf16 v[32:47], a[100:103], a[172:175], v[32:47]
    ds_read_b128 a[168:171], v221 offset:49152
    v_cvt_pk_bf16_f32 v148, v244, v245
    v_cvt_pk_bf16_f32 v149, v246, v247
    v_accvgpr_write_b32 a132, v148
    v_accvgpr_write_b32 a133, v149
    v_lshlrev_b32_e64 v248, 16, v150
    v_and_b32 v249, s86, v150
    v_lshlrev_b32 v250, 16, v151
    v_and_b32 v251, s86, v151
    v_pk_fma_f32 v[248:249], v[248:249], v[252:253], v[254:255]
    v_pk_fma_f32 v[250:251], v[250:251], v[252:253], v[254:255]
    s_waitcnt lgkmcnt(3)
    v_mfma_f32_32x32x16_bf16 v[16:31], a[104:107], a[176:179], v[16:31]
    ds_read_b128 a[172:175], v221 offset:57344
    v_cvt_pk_bf16_f32 v150, v248, v249
    v_cvt_pk_bf16_f32 v151, v250, v251
    v_accvgpr_write_b32 a134, v150
    v_accvgpr_write_b32 a135, v151
    v_lshlrev_b32 v244, 16, v152
    v_and_b32 v245, s86, v152
    v_lshlrev_b32 v246, 16, v153
    v_and_b32 v247, s86, v153
    v_pk_fma_f32 v[244:245], v[244:245], v[252:253], v[254:255]
    v_pk_fma_f32 v[246:247], v[246:247], v[252:253], v[254:255]
    v_mfma_f32_32x32x16_bf16 v[32:47], a[104:107], a[180:183], v[32:47]
    ds_read_b128 a[176:179], v222 offset:49152
    buffer_load_dwordx4 v213, s[12:15], s32 offen offset:1024 lds
    v_cvt_pk_bf16_f32 v152, v244, v245
    v_cvt_pk_bf16_f32 v153, v246, v247
    v_accvgpr_write_b32 a136, v152
    v_accvgpr_write_b32 a137, v153
    v_lshlrev_b32 v248, 16, v154
    v_and_b32 v249, s86, v154
    v_lshlrev_b32 v250, 16, v155
    v_and_b32 v251, s86, v155
    v_pk_fma_f32 v[248:249], v[248:249], v[252:253], v[254:255]
    v_pk_fma_f32 v[250:251], v[250:251], v[252:253], v[254:255]
    v_mfma_f32_32x32x16_bf16 v[16:31], a[108:111], a[184:187], v[16:31]
    ds_read_b128 a[180:183], v222 offset:57344
    v_cvt_pk_bf16_f32 v154, v248, v249
    v_cvt_pk_bf16_f32 v155, v250, v251
    v_accvgpr_write_b32 a138, v154
    v_accvgpr_write_b32 a139, v155
    v_lshlrev_b32 v244, 16, v156
    v_and_b32 v245, s86, v156
    v_lshlrev_b32 v246, 16, v157
    v_and_b32 v247, s86, v157
    v_pk_fma_f32 v[244:245], v[244:245], v[252:253], v[254:255]
    v_pk_fma_f32 v[246:247], v[246:247], v[252:253], v[254:255]
    v_mfma_f32_32x32x16_bf16 v[32:47], a[108:111], a[188:191], v[32:47]
    ds_read_b128 a[184:187], v223 offset:49152
    v_cvt_pk_bf16_f32 v156, v244, v245
    v_cvt_pk_bf16_f32 v157, v246, v247
    v_accvgpr_write_b32 a140, v156
    v_accvgpr_write_b32 a141, v157
    v_lshlrev_b32_e64 v248, 16, v158
    v_and_b32 v249, s86, v158
    v_lshlrev_b32 v250, 16, v159
    v_and_b32 v251, s86, v159
    v_pk_fma_f32 v[248:249], v[248:249], v[252:253], v[254:255]
    v_pk_fma_f32 v[250:251], v[250:251], v[252:253], v[254:255]
    s_waitcnt lgkmcnt(3)
    v_mfma_f32_32x32x16_bf16 v[16:31], a[112:115], a[160:163], v[16:31]
    ds_read_b128 a[188:191], v223 offset:57344
    v_cvt_pk_bf16_f32 v158, v248, v249
    v_cvt_pk_bf16_f32 v159, v250, v251
    v_accvgpr_write_b32 a142, v158
    v_accvgpr_write_b32 a143, v159
    v_lshlrev_b32 v244, 16, v160
    v_and_b32 v245, s86, v160
    v_lshlrev_b32 v246, 16, v161
    v_and_b32 v247, s86, v161
    v_pk_fma_f32 v[244:245], v[244:245], v[252:253], v[254:255]
    v_pk_fma_f32 v[246:247], v[246:247], v[252:253], v[254:255]
    v_mfma_f32_32x32x16_bf16 v[32:47], a[112:115], a[164:167], v[32:47]
    s_waitcnt vmcnt(23)
    s_barrier
    ds_read_b128 a[160:163], v224 offset:0
    buffer_load_dwordx4 v214, s[12:15], s32 offen offset:2048 lds
    v_cvt_pk_bf16_f32 v160, v244, v245
    v_cvt_pk_bf16_f32 v161, v246, v247
    v_accvgpr_write_b32 a144, v160
    v_accvgpr_write_b32 a145, v161
    v_lshlrev_b32 v248, 16, v162
    v_and_b32 v249, s86, v162
    v_lshlrev_b32 v250, 16, v163
    v_and_b32 v251, s86, v163
    v_pk_fma_f32 v[248:249], v[248:249], v[252:253], v[254:255]
    v_pk_fma_f32 v[250:251], v[250:251], v[252:253], v[254:255]
    v_mfma_f32_32x32x16_bf16 v[16:31], a[116:119], a[168:171], v[16:31]
    ds_read_b128 a[164:167], v224 offset:8192
    v_cvt_pk_bf16_f32 v162, v248, v249
    v_cvt_pk_bf16_f32 v163, v250, v251
    v_accvgpr_write_b32 a146, v162
    v_accvgpr_write_b32 a147, v163
    v_lshlrev_b32 v244, 16, v164
    v_and_b32 v245, s86, v164
    v_lshlrev_b32 v246, 16, v165
    v_and_b32 v247, s86, v165
    v_pk_fma_f32 v[244:245], v[244:245], v[252:253], v[254:255]
    v_pk_fma_f32 v[246:247], v[246:247], v[252:253], v[254:255]
    v_mfma_f32_32x32x16_bf16 v[32:47], a[116:119], a[172:175], v[32:47]
    ds_read_b128 a[168:171], v225 offset:0
    buffer_load_dwordx4 v215, s[12:15], s32 offen offset:3072 lds
    v_cvt_pk_bf16_f32 v164, v244, v245
    v_cvt_pk_bf16_f32 v165, v246, v247
    v_accvgpr_write_b32 a148, v164
    v_accvgpr_write_b32 a149, v165
    v_lshlrev_b32_e64 v248, 16, v166
    v_and_b32 v249, s86, v166
    v_lshlrev_b32 v250, 16, v167
    v_and_b32 v251, s86, v167
    v_pk_fma_f32 v[248:249], v[248:249], v[252:253], v[254:255]
    v_pk_fma_f32 v[250:251], v[250:251], v[252:253], v[254:255]
    s_waitcnt lgkmcnt(3)
    v_mfma_f32_32x32x16_bf16 v[16:31], a[120:123], a[176:179], v[16:31]
    ds_read_b128 a[172:175], v225 offset:8192
    v_cvt_pk_bf16_f32 v166, v248, v249
    v_cvt_pk_bf16_f32 v167, v250, v251
    v_accvgpr_write_b32 a150, v166
    v_accvgpr_write_b32 a151, v167
    v_lshlrev_b32_e64 v244, 16, v168
    v_and_b32 v245, s86, v168
    v_lshlrev_b32 v246, 16, v169
    v_and_b32 v247, s86, v169
    v_pk_fma_f32 v[244:245], v[244:245], v[252:253], v[254:255]
    v_pk_fma_f32 v[246:247], v[246:247], v[252:253], v[254:255]
    v_mfma_f32_32x32x16_bf16 v[32:47], a[120:123], a[180:183], v[32:47]
    ds_read_b128 a[176:179], v226 offset:0
    s_add_u32 m0, s78, 32768
    s_add_u32 s32, s81, s68
    s_add_u32 s32, s32, 81920
    buffer_load_dwordx4 v212, s[12:15], s32 offen offset:0 lds
    v_cvt_pk_bf16_f32 v168, v244, v245
    v_cvt_pk_bf16_f32 v169, v246, v247
    v_accvgpr_write_b32 a152, v168
    v_accvgpr_write_b32 a153, v169
    v_lshlrev_b32 v248, 16, v170
    v_and_b32 v249, s86, v170
    v_lshlrev_b32 v250, 16, v171
    v_and_b32 v251, s86, v171
    v_pk_fma_f32 v[248:249], v[248:249], v[252:253], v[254:255]
    v_pk_fma_f32 v[250:251], v[250:251], v[252:253], v[254:255]
    v_mfma_f32_32x32x16_bf16 v[16:31], a[124:127], a[184:187], v[16:31]
    ds_read_b128 a[180:183], v226 offset:8192
    v_cvt_pk_bf16_f32 v170, v248, v249
    v_cvt_pk_bf16_f32 v171, v250, v251
    v_accvgpr_write_b32 a154, v170
    v_accvgpr_write_b32 a155, v171
    v_lshlrev_b32 v244, 16, v172
    v_and_b32 v245, s86, v172
    v_lshlrev_b32 v246, 16, v173
    v_and_b32 v247, s86, v173
    v_pk_fma_f32 v[244:245], v[244:245], v[252:253], v[254:255]
    v_pk_fma_f32 v[246:247], v[246:247], v[252:253], v[254:255]
    v_mfma_f32_32x32x16_bf16 v[32:47], a[124:127], a[188:191], v[32:47]
    ds_read_b128 a[184:187], v227 offset:0
    v_cvt_pk_bf16_f32 v172, v244, v245
    v_cvt_pk_bf16_f32 v173, v246, v247
    v_accvgpr_write_b32 a156, v172
    v_accvgpr_write_b32 a157, v173
    v_lshlrev_b32_e64 v248, 16, v174
    v_and_b32 v249, s86, v174
    v_lshlrev_b32 v250, 16, v175
    v_and_b32 v251, s86, v175
    v_pk_fma_f32 v[248:249], v[248:249], v[252:253], v[254:255]
    v_pk_fma_f32 v[250:251], v[250:251], v[252:253], v[254:255]
    s_waitcnt lgkmcnt(3)
    v_mfma_f32_32x32x16_bf16 v[16:31], a[128:131], a[160:163], v[16:31]
    ds_read_b128 a[188:191], v227 offset:8192
    v_cvt_pk_bf16_f32 v174, v248, v249
    v_cvt_pk_bf16_f32 v175, v250, v251
    v_accvgpr_write_b32 a158, v174
    v_accvgpr_write_b32 a159, v175
    s_cmp_eq_u32 s3, 1
    s_cbranch_scc1 FORK_ALT_C
    v_mfma_f32_32x32x16_bf16 v[32:47], a[128:131], a[164:167], v[32:47]
    ds_read_b128 a[160:163], v228 offset:0
    buffer_load_dwordx4 v213, s[12:15], s32 offen offset:1024 lds
    v_lshrrev_b32 v112, 5, v1
    v_lshlrev_b32 v112, 4, v112
    v_bfe_u32 v113, v1, 2, 3
    v_mfma_f32_32x32x16_bf16 v[16:31], a[132:135], a[168:171], v[16:31]
    ds_read_b128 a[164:167], v228 offset:8192
    v_add_u32_e64 v112, v112, v113
    v_mul_u32_u24 v112, 160, v112
    v_and_b32_e64 v113, 3, v1
    v_lshl_add_u32 v112, v113, 3, v112
    v_add_u32_e64 v112, s93, v112
    v_mfma_f32_32x32x16_bf16 v[32:47], a[132:135], a[172:175], v[32:47]
    ds_read_b128 a[168:171], v229 offset:0
    s_waitcnt vmcnt(18)
    ds_read_b64_tr_b16 v[114:115], v112 offset:0
    ds_read_b64_tr_b16 v[116:117], v112 offset:1280
    s_waitcnt lgkmcnt(5)
    v_mfma_f32_32x32x16_bf16 v[16:31], a[136:139], a[176:179], v[16:31]
    ds_read_b128 a[172:175], v229 offset:8192
    ds_read_b64_tr_b16 v[118:119], v112 offset:32
    ds_read_b64_tr_b16 v[120:121], v112 offset:1312
    ds_read_b64_tr_b16 v[122:123], v112 offset:64
    ds_read_b64_tr_b16 v[124:125], v112 offset:1344
    v_mfma_f32_32x32x16_bf16 v[32:47], a[136:139], a[180:183], v[32:47]
    ds_read_b128 a[176:179], v230 offset:0
    buffer_load_dwordx4 v214, s[12:15], s32 offen offset:2048 lds
    ds_read_b64_tr_b16 v[126:127], v112 offset:96
    ds_read_b64_tr_b16 v[128:129], v112 offset:1376
    v_mfma_f32_32x32x16_bf16 v[16:31], a[140:143], a[184:187], v[16:31]
    ds_read_b128 a[180:183], v230 offset:8192
    ds_read_b64_tr_b16 v[130:131], v112 offset:128
    ds_read_b64_tr_b16 v[132:133], v112 offset:1408
    v_mfma_f32_32x32x16_bf16 v[32:47], a[140:143], a[188:191], v[32:47]
    ds_read_b128 a[184:187], v231 offset:0
    s_waitcnt lgkmcnt(11)
    v_mfma_f32_32x32x16_bf16 v[16:31], a[144:147], a[160:163], v[16:31]
    ds_read_b128 a[188:191], v231 offset:8192
    s_waitcnt lgkmcnt(2)
    v_mfma_f32_32x32x16_bf16 v[32:47], a[144:147], a[164:167], v[32:47]
    s_barrier
    ds_read_b128 a[160:163], v224 offset:16384
    buffer_load_dwordx4 v215, s[12:15], s32 offen offset:3072 lds
    v_mfma_f32_32x32x16_bf16 v[16:31], a[148:151], a[168:171], v[16:31]
    ds_read_b128 a[164:167], v224 offset:24576
    buffer_store_dwordx4 v[114:117], v236, s[20:23], s89 offen sc1
    s_add_u32 s89, s89, 1024
    v_mfma_f32_32x32x16_bf16 v[32:47], a[148:151], a[172:175], v[32:47]
    ds_read_b128 a[168:171], v225 offset:16384
    s_waitcnt lgkmcnt(3)
    v_mfma_f32_32x32x16_bf16 v[16:31], a[152:155], a[176:179], v[16:31]
    ds_read_b128 a[172:175], v225 offset:24576
    buffer_store_dwordx4 v[118:121], v236, s[20:23], s89 offen sc1
    s_add_u32 s89, s89, 1024
    v_mfma_f32_32x32x16_bf16 v[32:47], a[152:155], a[180:183], v[32:47]
    ds_read_b128 a[176:179], v226 offset:16384
    s_add_u32 m0, s78, 49152
    s_add_u32 s32, s81, s69
    s_add_u32 s32, s32, 81920
    buffer_load_dwordx4 v212, s[12:15], s32 offen offset:0 lds
    v_mfma_f32_32x32x16_bf16 v[16:31], a[156:159], a[184:187], v[16:31]
    ds_read_b128 a[180:183], v226 offset:24576
    buffer_store_dwordx4 v[122:125], v236, s[20:23], s89 offen sc1
    s_add_u32 s89, s89, 1024
    v_mfma_f32_32x32x16_bf16 v[32:47], a[156:159], a[188:191], v[32:47]
    ds_read_b128 a[184:187], v227 offset:16384
    s_waitcnt lgkmcnt(3)
    v_mfma_f32_32x32x16_bf16 v[48:63], a[0:3], a[160:163], 0
    ds_read_b128 a[188:191], v227 offset:24576
    buffer_store_dwordx4 v[126:129], v236, s[20:23], s89 offen sc1
    s_add_u32 s89, s89, 1024
    v_mfma_f32_32x32x16_bf16 v[64:79], a[0:3], a[164:167], 0
    ds_read_b128 a[160:163], v228 offset:16384
    buffer_load_dwordx4 v213, s[12:15], s32 offen offset:1024 lds
    v_mfma_f32_32x32x16_bf16 v[48:63], a[4:7], a[168:171], v[48:63]
    ds_read_b128 a[164:167], v228 offset:24576
    buffer_store_dwordx4 v[130:133], v236, s[20:23], s89 offen sc1
    v_mfma_f32_32x32x16_bf16 v[64:79], a[4:7], a[172:175], v[64:79]
    ds_read_b128 a[168:171], v229 offset:16384
    s_waitcnt lgkmcnt(3)
    v_mfma_f32_32x32x16_bf16 v[48:63], a[8:11], a[176:179], v[48:63]
    ds_read_b128 a[172:175], v229 offset:24576
    s_branch FORK_JOIN_C
FORK_ALT_C:
    v_mfma_f32_32x32x16_bf16 v[32:47], a[128:131], a[164:167], v[32:47]
    ds_read_b128 a[160:163], v228 offset:0
    buffer_load_dwordx4 v213, s[12:15], s32 offen offset:1024 lds
    v_and_b32_e64 v112, 15, v1
    v_lshlrev_b32 v112, 7, v112
    v_lshrrev_b32 v113, 5, v1
    v_mfma_f32_32x32x16_bf16 v[16:31], a[132:135], a[168:171], v[16:31]
    ds_read_b128 a[164:167], v228 offset:8192
    v_xor_b32 v113, v113, v1
    v_and_b32 v113, 7, v113
    v_lshl_add_u32 v112, v113, 4, v112
    v_bfe_u32 v113, v1, 4, 1
    v_lshl_add_u32 v112, v113, 3, v112
    v_mfma_f32_32x32x16_bf16 v[32:47], a[132:135], a[172:175], v[32:47]
    ds_read_b128 a[168:171], v229 offset:0
    v_add_u32 v112, s93, v112
    s_waitcnt vmcnt(18)
    ds_read_b64 v[136:137], v112 offset:0
    ds_read_b64 v[138:139], v112 offset:2048
    s_waitcnt lgkmcnt(5)
    v_mfma_f32_32x32x16_bf16 v[16:31], a[136:139], a[176:179], v[16:31]
    ds_read_b128 a[172:175], v229 offset:8192
    v_xor_b32 v113, 32, v112
    ds_read_b64 v[140:141], v113 offset:0
    ds_read_b64 v[142:143], v113 offset:2048
    v_xor_b32_e64 v113, 64, v112
    ds_read_b64 v[144:145], v113 offset:0
    ds_read_b64 v[146:147], v113 offset:2048
    v_mfma_f32_32x32x16_bf16 v[32:47], a[136:139], a[180:183], v[32:47]
    ds_read_b128 a[176:179], v230 offset:0
    buffer_load_dwordx4 v214, s[12:15], s32 offen offset:2048 lds
    v_xor_b32 v113, 96, v112
    ds_read_b64 v[148:149], v113 offset:0
    ds_read_b64 v[150:151], v113 offset:2048
    v_mfma_f32_32x32x16_bf16 v[16:31], a[140:143], a[184:187], v[16:31]
    ds_read_b128 a[180:183], v230 offset:8192
    ds_read_b64 v[152:153], v112 offset:0
    ds_read_b64 v[154:155], v112 offset:2048
    s_mov_b32 s34, 0x05040100
    s_mov_b32 s35, 0x07060302
    v_mfma_f32_32x32x16_bf16 v[32:47], a[140:143], a[188:191], v[32:47]
    ds_read_b128 a[184:187], v231 offset:0
    s_waitcnt lgkmcnt(11)
    v_mfma_f32_32x32x16_bf16 v[16:31], a[144:147], a[160:163], v[16:31]
    ds_read_b128 a[188:191], v231 offset:8192
    s_waitcnt lgkmcnt(2)
    v_perm_b32 v114, v138, v136, s34
    v_perm_b32 v115, v138, v136, s35
    v_perm_b32 v116, v139, v137, s34
    v_perm_b32 v117, v139, v137, s35
    v_mfma_f32_32x32x16_bf16 v[32:47], a[144:147], a[164:167], v[32:47]
    s_barrier
    s_nop 0
    ds_read_b128 a[160:163], v224 offset:16384
    buffer_load_dwordx4 v215, s[12:15], s32 offen offset:3072 lds
    v_mfma_f32_32x32x16_bf16 v[16:31], a[148:151], a[168:171], v[16:31]
    ds_read_b128 a[164:167], v224 offset:24576
    buffer_store_dwordx4 v[114:117], v236, s[20:23], s89 offen sc1
    s_add_u32 s89, s89, 5120
    v_perm_b32 v118, v142, v140, s34
    v_perm_b32 v119, v142, v140, s35
    v_mfma_f32_32x32x16_bf16 v[32:47], a[148:151], a[172:175], v[32:47]
    ds_read_b128 a[168:171], v225 offset:16384
    v_perm_b32 v120, v143, v141, s34
    v_perm_b32 v121, v143, v141, s35
    s_waitcnt lgkmcnt(3)
    v_mfma_f32_32x32x16_bf16 v[16:31], a[152:155], a[176:179], v[16:31]
    ds_read_b128 a[172:175], v225 offset:24576
    buffer_store_dwordx4 v[118:121], v236, s[20:23], s89 offen sc1
    s_add_u32 s89, s89, 5120
    v_perm_b32 v122, v146, v144, s34
    v_perm_b32 v123, v146, v144, s35
    v_mfma_f32_32x32x16_bf16 v[32:47], a[152:155], a[180:183], v[32:47]
    ds_read_b128 a[176:179], v226 offset:16384
    s_add_u32 m0, s78, 49152
    s_add_u32 s32, s81, s69
    s_add_u32 s32, s32, 81920
    buffer_load_dwordx4 v212, s[12:15], s32 offen offset:0 lds
    v_mfma_f32_32x32x16_bf16 v[16:31], a[156:159], a[184:187], v[16:31]
    ds_read_b128 a[180:183], v226 offset:24576
    v_perm_b32 v124, v147, v145, s34
    v_perm_b32 v125, v147, v145, s35
    buffer_store_dwordx4 v[122:125], v236, s[20:23], s89 offen sc1
    s_add_u32 s89, s89, 5120
    v_mfma_f32_32x32x16_bf16 v[32:47], a[156:159], a[188:191], v[32:47]
    ds_read_b128 a[184:187], v227 offset:16384
    v_perm_b32 v126, v150, v148, s34
    v_perm_b32 v127, v150, v148, s35
    v_perm_b32 v128, v151, v149, s34
    v_perm_b32 v129, v151, v149, s35
    s_waitcnt lgkmcnt(3)
    v_mfma_f32_32x32x16_bf16 v[48:63], a[0:3], a[160:163], 0
    ds_read_b128 a[188:191], v227 offset:24576
    buffer_store_dwordx4 v[126:129], v236, s[20:23], s89 offen sc1
    s_add_u32 s89, s89, 1073741824
    v_mfma_f32_32x32x16_bf16 v[64:79], a[0:3], a[164:167], 0
    ds_read_b128 a[160:163], v228 offset:16384
    buffer_load_dwordx4 v213, s[12:15], s32 offen offset:1024 lds
    v_mfma_f32_32x32x16_bf16 v[48:63], a[4:7], a[168:171], v[48:63]
    ds_read_b128 a[164:167], v228 offset:24576
    buffer_store_dwordx4 v[130:133], v236, s[20:23], s89 offen sc1
    v_mfma_f32_32x32x16_bf16 v[64:79], a[4:7], a[172:175], v[64:79]
    ds_read_b128 a[168:171], v229 offset:16384
    s_waitcnt lgkmcnt(3)
    v_mfma_f32_32x32x16_bf16 v[48:63], a[8:11], a[176:179], v[48:63]
    ds_read_b128 a[172:175], v229 offset:24576
FORK_JOIN_C:
    ds_write2_b32 v0, v252, v254 offset1:1
    v_add_u32 v0, 0x1000, v236
    v_mov_b32 v248, 0
    v_min_u32 v249, 6, v12
    v_sub_u32 v249, v249, v12
    v_lshl_add_u32 v249, v249, 3, v15
    ds_write2_b32 v249, v248, v248 offset1:1
    v_mfma_f32_32x32x16_bf16 v[64:79], a[8:11], a[180:183], v[64:79]
    ds_read_b128 a[176:179], v230 offset:16384
    buffer_load_dwordx4 v214, s[12:15], s32 offen offset:2048 lds
    v_fma_f32 v244, -v177, v32, v17
    v_fma_f32 v245, v177, v16, v33
    v_fma_f32 v244, v176, v16, v244
    v_mfma_f32_32x32x16_bf16 v[48:63], a[12:15], a[184:187], v[48:63]
    ds_read_b128 a[180:183], v230 offset:24576
    v_fma_f32 v245, v176, v32, v245
    v_fma_f32 v246, -v177, v245, v18
    v_fma_f32 v247, v177, v244, v34
    v_fma_f32 v246, v176, v244, v246
    v_fma_f32 v247, v176, v245, v247
    v_mfma_f32_32x32x16_bf16 v[64:79], a[12:15], a[188:191], v[64:79]
    ds_read_b128 a[184:187], v231 offset:16384
    v_fma_f32 v244, -v177, v247, v19
    v_fma_f32 v245, v177, v246, v35
    v_fma_f32 v244, v176, v246, v244
    v_fmac_f32 v245, v176, v247
    s_waitcnt lgkmcnt(5)
    v_mfma_f32_32x32x16_bf16 v[48:63], a[16:19], a[160:163], v[48:63]
    ds_read_b128 a[188:191], v231 offset:24576
    v_fma_f32 v246, -v177, v245, v20
    v_fma_f32 v247, v177, v244, v36
    v_fma_f32 v246, v176, v244, v246
    v_fma_f32 v247, v176, v245, v247
    v_fma_f32 v244, -v177, v247, v21
    v_mfma_f32_32x32x16_bf16 v[64:79], a[16:19], a[164:167], v[64:79]
    s_waitcnt vmcnt(24)
    s_barrier
    ds_read_b128 a[160:163], v224 offset:32768
    buffer_load_dwordx4 v215, s[12:15], s32 offen offset:3072 lds
    v_fma_f32 v245, v177, v246, v37
    v_mfma_f32_32x32x16_bf16 v[48:63], a[20:23], a[168:171], v[48:63]
    ds_read_b128 a[164:167], v224 offset:40960
    v_fma_f32 v244, v176, v246, v244
    v_fma_f32 v245, v176, v247, v245
    v_fma_f32 v246, -v177, v245, v22
    v_fma_f32 v247, v177, v244, v38
    v_fma_f32 v246, v176, v244, v246
    v_mfma_f32_32x32x16_bf16 v[64:79], a[20:23], a[172:175], v[64:79]
    ds_read_b128 a[168:171], v225 offset:32768
    v_fma_f32 v247, v176, v245, v247
    v_fma_f32 v244, -v177, v247, v23
    v_fma_f32 v245, v177, v246, v39
    v_fmac_f32 v244, v176, v246
    s_waitcnt lgkmcnt(3)
    v_mfma_f32_32x32x16_bf16 v[48:63], a[24:27], a[176:179], v[48:63]
    ds_read_b128 a[172:175], v225 offset:40960
    v_fma_f32 v245, v176, v247, v245
    v_fma_f32 v246, -v177, v245, v24
    v_fma_f32 v247, v177, v244, v40
    v_fma_f32 v246, v176, v244, v246
    v_fmac_f32 v247, v176, v245
    v_mfma_f32_32x32x16_bf16 v[64:79], a[24:27], a[180:183], v[64:79]
    ds_read_b128 a[176:179], v226 offset:32768
    s_add_u32 m0, s78, 65536
    s_add_u32 s32, s81, s70
    s_add_u32 s32, s32, 81920
    buffer_load_dwordx4 v212, s[12:15], s32 offen offset:0 lds
    v_mfma_f32_32x32x16_bf16 v[48:63], a[28:31], a[184:187], v[48:63]
    ds_read_b128 a[180:183], v226 offset:40960
    v_fma_f32 v244, -v177, v247, v25
    v_fma_f32 v245, v177, v246, v41
    v_fma_f32 v244, v176, v246, v244
    v_fma_f32 v245, v176, v247, v245
    v_fma_f32 v246, -v177, v245, v26
    v_mfma_f32_32x32x16_bf16 v[64:79], a[28:31], a[188:191], v[64:79]
    ds_read_b128 a[184:187], v227 offset:32768
    v_fma_f32 v247, v177, v244, v42
    v_fma_f32 v246, v176, v244, v246
    v_fmac_f32 v247, v176, v245
    v_fma_f32 v244, -v177, v247, v27
    s_waitcnt lgkmcnt(3)
    v_mfma_f32_32x32x16_bf16 v[48:63], a[32:35], a[160:163], v[48:63]
    ds_read_b128 a[188:191], v227 offset:40960
    v_fma_f32 v245, v177, v246, v43
    v_fma_f32 v244, v176, v246, v244
    v_fma_f32 v245, v176, v247, v245
    v_fma_f32 v246, -v177, v245, v28
    v_fma_f32 v247, v177, v244, v44
    v_mfma_f32_32x32x16_bf16 v[64:79], a[32:35], a[164:167], v[64:79]
    ds_read_b128 a[160:163], v228 offset:32768
    buffer_load_dwordx4 v213, s[12:15], s32 offen offset:1024 lds
    v_fma_f32 v246, v176, v244, v246
    v_fma_f32 v247, v176, v245, v247
    v_fma_f32 v244, -v177, v247, v29
    v_mfma_f32_32x32x16_bf16 v[48:63], a[36:39], a[168:171], v[48:63]
    ds_read_b128 a[164:167], v228 offset:40960
    v_fma_f32 v245, v177, v246, v45
    v_fma_f32 v244, v176, v246, v244
    v_fma_f32 v245, v176, v247, v245
    v_fma_f32 v246, -v177, v245, v30
    v_fma_f32 v247, v177, v244, v46
    v_mfma_f32_32x32x16_bf16 v[64:79], a[36:39], a[172:175], v[64:79]
    ds_read_b128 a[168:171], v229 offset:32768
    v_fma_f32 v246, v176, v244, v246
    v_fmac_f32 v247, v176, v245
    v_fma_f32 v244, -v177, v247, v31
    v_fma_f32 v245, v177, v246, v47
    s_waitcnt lgkmcnt(3)
    v_mfma_f32_32x32x16_bf16 v[48:63], a[40:43], a[176:179], v[48:63]
    ds_read_b128 a[172:175], v229 offset:40960
    v_fma_f32 v244, v176, v246, v244
    v_fma_f32 v245, v176, v247, v245
    ds_write2_b32 v15, v244, v245 offset0:14 offset1:15
    v_mfma_f32_32x32x16_bf16 v[64:79], a[40:43], a[180:183], v[64:79]
    ds_read_b128 a[176:179], v230 offset:32768
    buffer_load_dwordx4 v214, s[12:15], s32 offen offset:2048 lds
    v_mfma_f32_32x32x16_bf16 v[48:63], a[44:47], a[184:187], v[48:63]
    ds_read_b128 a[180:183], v230 offset:40960
    v_mfma_f32_32x32x16_bf16 v[64:79], a[44:47], a[188:191], v[64:79]
    ds_read_b128 a[184:187], v231 offset:32768
    s_waitcnt lgkmcnt(4)
    s_nop 0
    v_mfma_f32_32x32x16_bf16 v[48:63], a[48:51], a[160:163], v[48:63]
    ds_read_b128 a[188:191], v231 offset:40960
    v_mfma_f32_32x32x16_bf16 v[64:79], a[48:51], a[164:167], v[64:79]
    s_waitcnt vmcnt(24) lgkmcnt(4)
    s_barrier
    ds_read_b128 a[160:163], v224 offset:49152
    buffer_load_dwordx4 v215, s[12:15], s32 offen offset:3072 lds
    v_mfma_f32_32x32x16_bf16 v[48:63], a[52:55], a[168:171], v[48:63]
    ds_read_b128 a[164:167], v224 offset:57344
    ds_read2_b64 v[152:155], v15 offset0:0 offset1:1
    ds_read2_b64 v[156:159], v15 offset0:2 offset1:3
    ds_read2_b64 v[160:163], v15 offset0:4 offset1:5
    ds_read_b64 v[164:165], v15 offset:48
    v_mov_b32_e64 v249, s85
    v_mfma_f32_32x32x16_bf16 v[64:79], a[52:55], a[172:175], v[64:79]
    ds_read_b128 a[168:171], v225 offset:49152
    v_mov_b32_e64 v251, s85
    s_add_u32 s34, s80, 0
    s_mul_i32 s34, s34, 8704
    s_add_u32 s34, s34, 16842752
    s_waitcnt lgkmcnt(7)
    v_mfma_f32_32x32x16_bf16 v[48:63], a[56:59], a[176:179], v[48:63]
    ds_read_b128 a[172:175], v225 offset:57344
    v_mfma_f32_32x32x16_bf16 v[64:79], a[56:59], a[180:183], v[64:79]
    ds_read_b128 a[176:179], v226 offset:49152
    s_add_u32 m0, s78, 81920
    s_add_u32 s32, s81, s71
    s_add_u32 s32, s32, 81920
    buffer_load_dwordx4 v212, s[12:15], s32 offen offset:0 lds
    v_mfma_f32_32x32x16_bf16 v[48:63], a[60:63], a[184:187], v[48:63]
    ds_read_b128 a[180:183], v226 offset:57344
    v_mfma_f32_32x32x16_bf16 v[64:79], a[60:63], a[188:191], v[64:79]
    ds_read_b128 a[184:187], v227 offset:49152
    s_waitcnt lgkmcnt(3)
    v_mfma_f32_32x32x16_bf16 v[48:63], a[64:67], a[160:163], v[48:63]
    ds_read_b128 a[188:191], v227 offset:57344
    v_fma_f32 v154, -v181, v153, v154
    v_fma_f32 v155, v181, v152, v155
    v_fma_f32 v154, v180, v152, v154
    v_fma_f32 v155, v180, v153, v155
    v_fma_f32 v156, -v181, v155, v156
    v_mfma_f32_32x32x16_bf16 v[64:79], a[64:67], a[164:167], v[64:79]
    ds_read_b128 a[160:163], v228 offset:49152
    buffer_load_dwordx4 v213, s[12:15], s32 offen offset:1024 lds
    v_fma_f32 v157, v181, v154, v157
    v_fma_f32 v156, v180, v154, v156
    v_fma_f32 v157, v180, v155, v157
    v_mfma_f32_32x32x16_bf16 v[48:63], a[68:71], a[168:171], v[48:63]
    ds_read_b128 a[164:167], v228 offset:57344
    v_fma_f32 v158, -v181, v157, v158
    v_fma_f32 v159, v181, v156, v159
    v_fma_f32 v158, v180, v156, v158
    v_fma_f32 v159, v180, v157, v159
    v_fma_f32 v160, -v181, v159, v160
    v_mfma_f32_32x32x16_bf16 v[64:79], a[68:71], a[172:175], v[64:79]
    ds_read_b128 a[168:171], v229 offset:49152
    v_fma_f32 v161, v181, v158, v161
    v_fma_f32 v160, v180, v158, v160
    v_fmac_f32 v161, v180, v159
    v_fma_f32 v162, -v181, v161, v162
    s_waitcnt lgkmcnt(3)
    v_mfma_f32_32x32x16_bf16 v[48:63], a[72:75], a[176:179], v[48:63]
    ds_read_b128 a[172:175], v229 offset:57344
    v_fma_f32 v163, v181, v160, v163
    v_fma_f32 v162, v180, v160, v162
    v_fma_f32 v163, v180, v161, v163
    v_fma_f32 v164, -v181, v163, v164
    v_fma_f32 v165, v181, v162, v165
    v_mfma_f32_32x32x16_bf16 v[64:79], a[72:75], a[180:183], v[64:79]
    ds_read_b128 a[176:179], v230 offset:49152
    buffer_load_dwordx4 v214, s[12:15], s32 offen offset:2048 lds
    v_fma_f32 v237, v180, v162, v164
    v_fma_f32 v238, v180, v163, v165
    v_fma_f32 v248, -v181, v238, v244
    v_mfma_f32_32x32x16_bf16 v[48:63], a[76:79], a[184:187], v[48:63]
    ds_read_b128 a[180:183], v230 offset:57344
    v_fma_f32 v250, v181, v237, v245
    v_fma_f32 v248, v180, v237, v248
    v_fma_f32 v250, v180, v238, v250
    buffer_store_dwordx4 v[248:251], v13, s[20:23], s34 offen sc1
    v_mfma_f32_32x32x16_bf16 v[64:79], a[76:79], a[188:191], v[64:79]
    ds_read_b128 a[184:187], v231 offset:49152
    v_lshlrev_b32 v194, 16, v194
    v_lshlrev_b32 v195, 16, v195
    v_lshlrev_b32 v196, 16, v196
    v_mul_f32 v196, 0x3fb8aa3b, v196
    s_waitcnt lgkmcnt(3)
    v_mfma_f32_32x32x16_bf16 v[48:63], a[80:83], a[160:163], v[48:63]
    ds_read_b128 a[188:191], v231 offset:57344
    v_exp_f32 v196, v196
    s_nop 0
    v_cvt_pk_bf16_f32 v196, v196, v196
    v_lshlrev_b32 v196, 16, v196
    v_mul_f32 v112, v196, v194
    v_mfma_f32_32x32x16_bf16 v[64:79], a[80:83], a[164:167], v[64:79]
    s_waitcnt vmcnt(25)
    s_barrier
    ds_read_b128 a[160:163], v216 offset:0
    buffer_load_dwordx4 v215, s[12:15], s32 offen offset:3072 lds
    v_mul_f32_e64 v113, v196, v195
    v_mfma_f32_32x32x16_bf16 v[48:63], a[84:87], a[168:171], v[48:63]
    ds_read_b128 a[164:167], v216 offset:8192
    v_mul_f32 v112, 0x3fb8aa3b, v112
    v_mul_f32_e64 v113, 0.15915494, v113
    v_exp_f32 v112, v112
    v_fract_f32 v113, v113
    v_mfma_f32_32x32x16_bf16 v[64:79], a[84:87], a[172:175], v[64:79]
    ds_read_b128 a[168:171], v217 offset:0
    v_cos_f32_e64 v114, v113
    v_sin_f32 v115, v113
    s_waitcnt lgkmcnt(3)
    v_mfma_f32_32x32x16_bf16 v[48:63], a[88:91], a[176:179], v[48:63]
    ds_read_b128 a[172:175], v217 offset:8192
    v_mul_f32 v188, v112, v114
    v_mul_f32 v189, v112, v115
    v_add_f32 v112, -1.0, v188
    v_mul_f32 v113, v194, v194
    v_fmac_f32 v113, v195, v195
    v_mfma_f32_32x32x16_bf16 v[64:79], a[88:91], a[180:183], v[64:79]
    ds_read_b128 a[176:179], v218 offset:0
    s_add_u32 m0, s78, 98304
    s_add_u32 s32, s81, s72
    s_add_u32 s32, s32, 81920
    buffer_load_dwordx4 v212, s[12:15], s32 offen offset:0 lds
    v_mfma_f32_32x32x16_bf16 v[48:63], a[92:95], a[184:187], v[48:63]
    ds_read_b128 a[180:183], v218 offset:8192
    v_rcp_f32 v113, v113
    v_mul_f32 v114, v112, v194
    v_fmac_f32 v114, v189, v195
    v_mul_f32 v115, v189, v194
    v_mfma_f32_32x32x16_bf16 v[64:79], a[92:95], a[188:191], v[64:79]
    ds_read_b128 a[184:187], v219 offset:0
    v_fma_f32 v115, -v112, v195, v115
    v_add_f32 v113, v113, v113
    v_mul_f32 v190, v114, v113
    v_mul_f32 v191, v115, v113
    s_waitcnt lgkmcnt(3)
    v_mfma_f32_32x32x16_bf16 v[48:63], a[96:99], a[160:163], v[48:63]
    ds_read_b128 a[188:191], v219 offset:8192
    v_mul_f32 v112, v188, v188
    v_mul_f32 v113, v188, v189
    v_fma_f32 v112, -v189, v189, v112
    v_fmac_f32 v113, v189, v188
    v_mul_f32 v114, v112, v112
    v_mfma_f32_32x32x16_bf16 v[64:79], a[96:99], a[164:167], v[64:79]
    ds_read_b128 a[160:163], v220 offset:0
    buffer_load_dwordx4 v213, s[12:15], s32 offen offset:1024 lds
    v_mul_f32_e64 v115, v112, v113
    v_fma_f32 v114, -v113, v113, v114
    v_fma_f32 v115, v113, v112, v115
    v_mfma_f32_32x32x16_bf16 v[48:63], a[100:103], a[168:171], v[48:63]
    ds_read_b128 a[164:167], v220 offset:8192
    v_mul_f32 v112, v114, v114
    v_mul_f32 v113, v114, v115
    v_fma_f32 v112, -v115, v115, v112
    v_fmac_f32 v113, v115, v114
    v_mul_f32 v192, v112, v112
    v_mfma_f32_32x32x16_bf16 v[64:79], a[100:103], a[172:175], v[64:79]
    ds_read_b128 a[168:171], v221 offset:0
    v_mul_f32_e64 v193, v112, v113
    v_fma_f32 v192, -v113, v113, v192
    v_fma_f32 v193, v113, v112, v193
    v_mul_f32 v112, v192, v192
    s_waitcnt lgkmcnt(3)
    v_mfma_f32_32x32x16_bf16 v[48:63], a[104:107], a[176:179], v[48:63]
    ds_read_b128 a[172:175], v221 offset:8192
    v_mul_f32_e64 v113, v192, v193
    v_fma_f32 v112, -v193, v193, v112
    v_fma_f32 v113, v193, v192, v113
    v_mul_f32 v114, v112, v112
    v_mul_f32 v115, v112, v113
    v_mfma_f32_32x32x16_bf16 v[64:79], a[104:107], a[180:183], v[64:79]
    ds_read_b128 a[176:179], v222 offset:0
    buffer_load_dwordx4 v214, s[12:15], s32 offen offset:2048 lds
    v_fma_f32 v114, -v113, v113, v114
    v_fmac_f32 v115, v113, v112
    v_mul_f32 v196, v114, v114
    v_mfma_f32_32x32x16_bf16 v[48:63], a[108:111], a[184:187], v[48:63]
    ds_read_b128 a[180:183], v222 offset:8192
    v_mul_f32_e64 v197, v114, v115
    v_fma_f32 v196, -v115, v115, v196
    v_fma_f32 v197, v115, v114, v197
    v_mul_f32 v198, v196, v196
    v_mul_f32 v199, v196, v197
    v_mfma_f32_32x32x16_bf16 v[64:79], a[108:111], a[188:191], v[64:79]
    ds_read_b128 a[184:187], v223 offset:0
    v_fma_f32 v198, -v197, v197, v198
    v_fmac_f32 v199, v197, v196
    v_cndmask_b32 v116, 1.0, v192, s[98:99]
    v_cndmask_b32 v117, 0, v193, s[98:99]
    s_waitcnt lgkmcnt(3)
    v_mfma_f32_32x32x16_bf16 v[48:63], a[112:115], a[160:163], v[48:63]
    ds_read_b128 a[188:191], v223 offset:8192
    s_bitcmp1_b32 s4, 0
    s_cselect_b64 s[100:101], -1, 0
    v_cndmask_b32 v112, 1.0, v112, s[100:101]
    v_cndmask_b32 v113, 0, v113, s[100:101]
    v_mul_f32_e64 v118, v116, v112
    v_mfma_f32_32x32x16_bf16 v[64:79], a[112:115], a[164:167], v[64:79]
    s_waitcnt vmcnt(25)
    s_barrier
    ds_read_b128 a[160:163], v216 offset:16384
    buffer_load_dwordx4 v215, s[12:15], s32 offen offset:3072 lds
    v_mul_f32_e64 v119, v116, v113
    v_mfma_f32_32x32x16_bf16 v[48:63], a[116:119], a[168:171], v[48:63]
    ds_read_b128 a[164:167], v216 offset:24576
    v_fma_f32 v118, -v117, v113, v118
    v_fma_f32 v119, v117, v112, v119
    s_bitcmp1_b32 s4, 1
    s_cselect_b64 s[100:101], -1, 0
    v_cndmask_b32 v114, 1.0, v114, s[100:101]
    v_mfma_f32_32x32x16_bf16 v[64:79], a[116:119], a[172:175], v[64:79]
    ds_read_b128 a[168:171], v217 offset:16384
    v_cndmask_b32 v115, 0, v115, s[100:101]
    v_mul_f32_e64 v194, v118, v114
    v_mul_f32 v195, v118, v115
    v_fma_f32 v194, -v119, v115, v194
    s_waitcnt lgkmcnt(3)
    v_mfma_f32_32x32x16_bf16 v[48:63], a[120:123], a[176:179], v[48:63]
    ds_read_b128 a[172:175], v217 offset:24576
    v_fmac_f32 v195, v119, v114
    v_mov_b32 v112, 0
    v_mov_b32 v113, s85
    v_mov_b32 v114, 0
    v_mov_b32 v115, s85
    v_mfma_f32_32x32x16_bf16 v[64:79], a[120:123], a[180:183], v[64:79]
    ds_read_b128 a[176:179], v218 offset:16384
    s_add_u32 s34, s80, 1
    s_mul_i32 s34, s34, 8704
    s_add_u32 s34, s34, 16842752
    buffer_store_dwordx4 v[112:115], v233, s[20:23], s34 offen sc1
    v_mfma_f32_32x32x16_bf16 v[48:63], a[124:127], a[184:187], v[48:63]
    ds_read_b128 a[180:183], v218 offset:24576
    v_lshlrev_b32_e64 v206, 16, v206
    v_lshlrev_b32 v207, 16, v207
    v_lshlrev_b32 v208, 16, v208
    v_mul_f32 v208, 0x3fb8aa3b, v208
    v_mfma_f32_32x32x16_bf16 v[64:79], a[124:127], a[188:191], v[64:79]
    ds_read_b128 a[184:187], v219 offset:16384
    v_exp_f32 v208, v208
    s_nop 0
    v_cvt_pk_bf16_f32 v208, v208, v208
    v_lshlrev_b32 v208, 16, v208
    s_waitcnt lgkmcnt(3)
    v_mfma_f32_32x32x16_bf16 v[48:63], a[128:131], a[160:163], v[48:63]
    ds_read_b128 a[188:191], v219 offset:24576
    v_mul_f32 v112, v208, v206
    v_mul_f32 v113, v208, v207
    v_mul_f32 v112, 0x3fb8aa3b, v112
    v_mul_f32_e64 v113, 0.15915494, v113
    v_mfma_f32_32x32x16_bf16 v[64:79], a[128:131], a[164:167], v[64:79]
    ds_read_b128 a[160:163], v220 offset:16384
    v_exp_f32_e64 v112, v112
    v_fract_f32 v113, v113
    v_cos_f32 v114, v113
    v_mfma_f32_32x32x16_bf16 v[48:63], a[132:135], a[168:171], v[48:63]
    ds_read_b128 a[164:167], v220 offset:24576
    v_sin_f32 v115, v113
    v_mul_f32 v200, v112, v114
    v_mul_f32 v201, v112, v115
    v_add_f32 v112, -1.0, v200
    v_mfma_f32_32x32x16_bf16 v[64:79], a[132:135], a[172:175], v[64:79]
    ds_read_b128 a[168:171], v221 offset:16384
    v_mul_f32_e64 v113, v206, v206
    v_fma_f32 v113, v207, v207, v113
    v_rcp_f32 v113, v113
    s_waitcnt lgkmcnt(3)
    v_mfma_f32_32x32x16_bf16 v[48:63], a[136:139], a[176:179], v[48:63]
    ds_read_b128 a[172:175], v221 offset:24576
    v_mul_f32_e64 v114, v112, v206
    v_fmac_f32 v114, v201, v207
    v_mul_f32 v115, v201, v206
    v_fma_f32 v115, -v112, v207, v115
    v_add_f32_e64 v113, v113, v113
    v_mfma_f32_32x32x16_bf16 v[64:79], a[136:139], a[180:183], v[64:79]
    ds_read_b128 a[176:179], v222 offset:16384
    v_mul_f32 v202, v114, v113
    v_mul_f32 v203, v115, v113
    v_mul_f32 v112, v200, v200
    v_mul_f32 v113, v200, v201
    v_fma_f32 v112, -v201, v201, v112
    v_mfma_f32_32x32x16_bf16 v[48:63], a[140:143], a[184:187], v[48:63]
    ds_read_b128 a[180:183], v222 offset:24576
    v_fma_f32 v113, v201, v200, v113
    v_mul_f32 v114, v112, v112
    v_mul_f32 v115, v112, v113
    v_fma_f32 v114, -v113, v113, v114
    v_fma_f32 v115, v113, v112, v115
    v_mfma_f32_32x32x16_bf16 v[64:79], a[140:143], a[188:191], v[64:79]
    ds_read_b128 a[184:187], v223 offset:16384
    v_mul_f32 v112, v114, v114
    v_mul_f32 v113, v114, v115
    v_fma_f32 v112, -v115, v115, v112
    v_fmac_f32 v113, v115, v114
    s_waitcnt lgkmcnt(3)
    v_mfma_f32_32x32x16_bf16 v[48:63], a[144:147], a[160:163], v[48:63]
    ds_read_b128 a[188:191], v223 offset:24576
    v_mul_f32 v204, v112, v112
    v_mul_f32 v205, v112, v113
    v_fma_f32 v204, -v113, v113, v204
    v_fmac_f32 v205, v113, v112
    v_mul_f32 v112, v204, v204
    v_mfma_f32_32x32x16_bf16 v[64:79], a[144:147], a[164:167], v[64:79]
    s_waitcnt vmcnt(23)
    s_barrier
    ds_read_b128 a[160:163], v216 offset:32768
    v_mul_f32_e64 v113, v204, v205
    v_fma_f32 v112, -v205, v205, v112
    v_fma_f32 v113, v205, v204, v113
    v_mfma_f32_32x32x16_bf16 v[48:63], a[148:151], a[168:171], v[48:63]
    ds_read_b128 a[164:167], v216 offset:40960
    v_mul_f32 v114, v112, v112
    v_mul_f32 v115, v112, v113
    v_fma_f32 v114, -v113, v113, v114
    v_fmac_f32 v115, v113, v112
    v_mul_f32 v208, v114, v114
    v_mfma_f32_32x32x16_bf16 v[64:79], a[148:151], a[172:175], v[64:79]
    ds_read_b128 a[168:171], v217 offset:32768
    v_mul_f32_e64 v209, v114, v115
    v_fma_f32 v208, -v115, v115, v208
    v_fma_f32 v209, v115, v114, v209
    v_mul_f32 v210, v208, v208
    s_waitcnt lgkmcnt(3)
    v_mfma_f32_32x32x16_bf16 v[48:63], a[152:155], a[176:179], v[48:63]
    ds_read_b128 a[172:175], v217 offset:40960
    v_mul_f32_e64 v211, v208, v209
    v_fma_f32 v210, -v209, v209, v210
    v_fma_f32 v211, v209, v208, v211
    v_cndmask_b32 v116, 1.0, v204, s[98:99]
    v_cndmask_b32 v117, 0, v205, s[98:99]
    v_mfma_f32_32x32x16_bf16 v[64:79], a[152:155], a[180:183], v[64:79]
    ds_read_b128 a[176:179], v218 offset:32768
    s_bitcmp1_b32 s4, 0
    s_cselect_b64 s[100:101], -1, 0
    v_cndmask_b32 v112, 1.0, v112, s[100:101]
    v_cndmask_b32 v113, 0, v113, s[100:101]
    v_mul_f32_e64 v118, v116, v112
    v_mfma_f32_32x32x16_bf16 v[48:63], a[156:159], a[184:187], v[48:63]
    ds_read_b128 a[180:183], v218 offset:40960
    v_mul_f32_e64 v119, v116, v113
    v_fma_f32 v118, -v117, v113, v118
    v_fma_f32 v119, v117, v112, v119
    s_bitcmp1_b32 s4, 1
    s_cselect_b64 s[100:101], -1, 0
    v_mfma_f32_32x32x16_bf16 v[64:79], a[156:159], a[188:191], v[64:79]
    ds_read_b128 a[184:187], v219 offset:32768
    v_cndmask_b32 v114, 1.0, v114, s[100:101]
    v_cndmask_b32 v115, 0, v115, s[100:101]
    v_mul_f32_e64 v206, v118, v114
    v_mul_f32 v207, v118, v115
    s_waitcnt lgkmcnt(3)
    v_mfma_f32_32x32x16_bf16 v[80:95], a[0:3], a[160:163], 0
    ds_read_b128 a[188:191], v219 offset:40960
    v_fma_f32 v206, -v119, v115, v206
    v_fmac_f32 v207, v119, v114
    v_mov_b32 v112, 0
    v_mov_b32 v113, s85
    v_mov_b32 v114, 0
    v_mfma_f32_32x32x16_bf16 v[96:111], a[0:3], a[164:167], 0
    ds_read_b128 a[160:163], v220 offset:32768
    v_mov_b32 v115, s85
    s_add_u32 s34, s80, 2
    s_mul_i32 s34, s34, 8704
    s_add_u32 s34, s34, 16842752
    v_mfma_f32_32x32x16_bf16 v[80:95], a[4:7], a[168:171], v[80:95]
    ds_read_b128 a[164:167], v220 offset:40960
    buffer_store_dwordx4 v[112:115], v233, s[20:23], s34 offen sc1
    v_fma_f32 v244, -v189, v64, v49
    v_fma_f32 v245, v189, v48, v65
    v_fma_f32 v244, v188, v48, v244
    v_mfma_f32_32x32x16_bf16 v[96:111], a[4:7], a[172:175], v[96:111]
    ds_read_b128 a[168:171], v221 offset:32768
    v_fma_f32 v245, v188, v64, v245
    v_fma_f32 v246, -v189, v245, v50
    v_fma_f32 v247, v189, v244, v66
    v_fmac_f32 v246, v188, v244
    s_waitcnt lgkmcnt(3)
    v_mfma_f32_32x32x16_bf16 v[80:95], a[8:11], a[176:179], v[80:95]
    ds_read_b128 a[172:175], v221 offset:40960
    v_fma_f32 v247, v188, v245, v247
    v_fma_f32 v244, -v189, v247, v51
    v_fma_f32 v245, v189, v246, v67
    v_fma_f32 v244, v188, v246, v244
    v_fma_f32 v245, v188, v247, v245
    v_mfma_f32_32x32x16_bf16 v[96:111], a[8:11], a[180:183], v[96:111]
    ds_read_b128 a[176:179], v222 offset:32768
    v_fma_f32 v246, -v189, v245, v52
    v_fma_f32 v247, v189, v244, v68
    v_fma_f32 v246, v188, v244, v246
    v_fma_f32 v247, v188, v245, v247
    v_fma_f32 v244, -v189, v247, v53
    v_mfma_f32_32x32x16_bf16 v[80:95], a[12:15], a[184:187], v[80:95]
    ds_read_b128 a[180:183], v222 offset:40960
    v_fma_f32 v245, v189, v246, v69
    v_fma_f32 v244, v188, v246, v244
    v_fma_f32 v245, v188, v247, v245
    v_fma_f32 v246, -v189, v245, v54
    v_fma_f32 v247, v189, v244, v70
    v_mfma_f32_32x32x16_bf16 v[96:111], a[12:15], a[188:191], v[96:111]
    ds_read_b128 a[184:187], v223 offset:32768
    v_fma_f32 v246, v188, v244, v246
    v_fmac_f32 v247, v188, v245
    v_fma_f32 v244, -v189, v247, v55
    v_fma_f32 v245, v189, v246, v71
    s_waitcnt lgkmcnt(3)
    v_mfma_f32_32x32x16_bf16 v[80:95], a[16:19], a[160:163], v[80:95]
    ds_read_b128 a[188:191], v223 offset:40960
    v_fma_f32 v244, v188, v246, v244
    v_fma_f32 v245, v188, v247, v245
    v_fma_f32 v246, -v189, v245, v56
    v_fma_f32 v247, v189, v244, v72
    v_fma_f32 v246, v188, v244, v246
    v_mfma_f32_32x32x16_bf16 v[96:111], a[16:19], a[164:167], v[96:111]
    s_waitcnt vmcnt(15)
    s_barrier
    s_lshl_b32 s33, s6, 4
    s_add_u32 s33, s33, s5
    s_lshl_b32 s33, s33, 7
    s_add_u32 s33, s33, 24117248
    s_cmp_eq_u32 s4, 0
    s_cselect_b32 s33, s33, 1073741824
    v_mov_b32 v168, s85
    s_mov_b64 exec, 1
    buffer_store_dword v168, off, s[20:23], s33 sc1
    s_mov_b64 exec, -1
    ds_read_b128 a[160:163], v216 offset:49152
    v_mfma_f32_32x32x16_bf16 v[80:95], a[20:23], a[168:171], v[80:95]
    ds_read_b128 a[164:167], v216 offset:57344
    v_fma_f32 v247, v188, v245, v247
    v_fma_f32 v244, -v189, v247, v57
    v_fma_f32 v245, v189, v246, v73
    v_fma_f32 v244, v188, v246, v244
    v_fma_f32 v245, v188, v247, v245
    v_mfma_f32_32x32x16_bf16 v[96:111], a[20:23], a[172:175], v[96:111]
    ds_read_b128 a[168:171], v217 offset:49152
    v_fma_f32 v246, -v189, v245, v58
    v_fma_f32 v247, v189, v244, v74
    v_fma_f32 v246, v188, v244, v246
    v_fmac_f32 v247, v188, v245
    s_waitcnt lgkmcnt(3)
    v_mfma_f32_32x32x16_bf16 v[80:95], a[24:27], a[176:179], v[80:95]
    ds_read_b128 a[172:175], v217 offset:57344
    v_fma_f32 v244, -v189, v247, v59
    v_fma_f32 v245, v189, v246, v75
    v_fma_f32 v244, v188, v246, v244
    v_fma_f32 v245, v188, v247, v245
    v_fma_f32 v246, -v189, v245, v60
    v_mfma_f32_32x32x16_bf16 v[96:111], a[24:27], a[180:183], v[96:111]
    ds_read_b128 a[176:179], v218 offset:49152
    v_fma_f32 v247, v189, v244, v76
    v_fma_f32 v246, v188, v244, v246
    v_fma_f32 v247, v188, v245, v247
    v_fma_f32 v244, -v189, v247, v61
    v_fma_f32 v245, v189, v246, v77
    v_mfma_f32_32x32x16_bf16 v[80:95], a[28:31], a[184:187], v[80:95]
    ds_read_b128 a[180:183], v218 offset:57344
    v_fma_f32 v244, v188, v246, v244
    v_fma_f32 v245, v188, v247, v245
    v_fma_f32 v246, -v189, v245, v62
    v_fma_f32 v247, v189, v244, v78
    v_fma_f32 v246, v188, v244, v246
    v_mfma_f32_32x32x16_bf16 v[96:111], a[28:31], a[188:191], v[96:111]
    ds_read_b128 a[184:187], v219 offset:49152
    v_fma_f32 v247, v188, v245, v247
    v_fma_f32 v244, -v189, v247, v63
    v_fma_f32 v245, v189, v246, v79
    v_fmac_f32 v244, v188, v246
    s_waitcnt lgkmcnt(3)
    v_mfma_f32_32x32x16_bf16 v[80:95], a[32:35], a[160:163], v[80:95]
    ds_read_b128 a[188:191], v219 offset:57344
    v_fma_f32 v245, v188, v247, v245
    ds_write2_b32 v15, v244, v245 offset0:14 offset1:15
    v_mfma_f32_32x32x16_bf16 v[96:111], a[32:35], a[164:167], v[96:111]
    ds_read_b128 a[160:163], v220 offset:49152
    v_mfma_f32_32x32x16_bf16 v[80:95], a[36:39], a[168:171], v[80:95]
    ds_read_b128 a[164:167], v220 offset:57344
    v_mfma_f32_32x32x16_bf16 v[96:111], a[36:39], a[172:175], v[96:111]
    ds_read_b128 a[168:171], v221 offset:49152
    s_waitcnt lgkmcnt(4)
    v_mfma_f32_32x32x16_bf16 v[80:95], a[40:43], a[176:179], v[80:95]
    ds_read_b128 a[172:175], v221 offset:57344
    v_mfma_f32_32x32x16_bf16 v[96:111], a[40:43], a[180:183], v[96:111]
    ds_read_b128 a[176:179], v222 offset:49152
    v_mfma_f32_32x32x16_bf16 v[80:95], a[44:47], a[184:187], v[80:95]
    ds_read_b128 a[180:183], v222 offset:57344
    v_mfma_f32_32x32x16_bf16 v[96:111], a[44:47], a[188:191], v[96:111]
    ds_read_b128 a[184:187], v223 offset:49152
    s_waitcnt lgkmcnt(3)
    v_mfma_f32_32x32x16_bf16 v[80:95], a[48:51], a[160:163], v[80:95]
    ds_read_b128 a[188:191], v223 offset:57344
    v_mfma_f32_32x32x16_bf16 v[96:111], a[48:51], a[164:167], v[96:111]
    s_waitcnt vmcnt(12)
    s_barrier
    ds_read_b128 a[160:163], v224 offset:0
    v_mfma_f32_32x32x16_bf16 v[80:95], a[52:55], a[168:171], v[80:95]
    ds_read_b128 a[164:167], v224 offset:8192
    ds_read2_b64 v[152:155], v15 offset0:0 offset1:1
    ds_read2_b64 v[156:159], v15 offset0:2 offset1:3
    ds_read2_b64 v[160:163], v15 offset0:4 offset1:5
    ds_read_b64 v[164:165], v15 offset:48
    v_mov_b32_e64 v249, s85
    v_mfma_f32_32x32x16_bf16 v[96:111], a[52:55], a[172:175], v[96:111]
    ds_read_b128 a[168:171], v225 offset:0
    v_mov_b32_e64 v251, s85
    s_add_u32 s34, s80, 1
    s_mul_i32 s34, s34, 8704
    s_add_u32 s34, s34, 16842752
    s_waitcnt lgkmcnt(7)
    v_mfma_f32_32x32x16_bf16 v[80:95], a[56:59], a[176:179], v[80:95]
    ds_read_b128 a[172:175], v225 offset:8192
    v_mfma_f32_32x32x16_bf16 v[96:111], a[56:59], a[180:183], v[96:111]
    ds_read_b128 a[176:179], v226 offset:0
    v_mfma_f32_32x32x16_bf16 v[80:95], a[60:63], a[184:187], v[80:95]
    ds_read_b128 a[180:183], v226 offset:8192
    v_mfma_f32_32x32x16_bf16 v[96:111], a[60:63], a[188:191], v[96:111]
    ds_read_b128 a[184:187], v227 offset:0
    s_waitcnt lgkmcnt(3)
    v_mfma_f32_32x32x16_bf16 v[80:95], a[64:67], a[160:163], v[80:95]
    ds_read_b128 a[188:191], v227 offset:8192
    v_fma_f32 v154, -v193, v153, v154
    v_fmac_f32 v155, v193, v152
    v_fma_f32 v154, v192, v152, v154
    v_fma_f32 v155, v192, v153, v155
    v_fma_f32 v156, -v193, v155, v156
    v_mfma_f32_32x32x16_bf16 v[96:111], a[64:67], a[164:167], v[96:111]
    ds_read_b128 a[160:163], v228 offset:0
    v_fma_f32 v157, v193, v154, v157
    v_fma_f32 v156, v192, v154, v156
    v_fma_f32 v157, v192, v155, v157
    v_fma_f32 v158, -v193, v157, v158
    v_fma_f32 v159, v193, v156, v159
    v_mfma_f32_32x32x16_bf16 v[80:95], a[68:71], a[168:171], v[80:95]
    ds_read_b128 a[164:167], v228 offset:8192
    v_fma_f32 v158, v192, v156, v158
    v_fma_f32 v159, v192, v157, v159
    v_fma_f32 v160, -v193, v159, v160
    v_fma_f32 v161, v193, v158, v161
    v_fma_f32 v160, v192, v158, v160
    v_mfma_f32_32x32x16_bf16 v[96:111], a[68:71], a[172:175], v[96:111]
    ds_read_b128 a[168:171], v229 offset:0
    v_fma_f32 v161, v192, v159, v161
    v_fma_f32 v162, -v193, v161, v162
    v_fma_f32 v163, v193, v160, v163
    v_fmac_f32 v162, v192, v160
    s_waitcnt lgkmcnt(3)
    v_mfma_f32_32x32x16_bf16 v[80:95], a[72:75], a[176:179], v[80:95]
    ds_read_b128 a[172:175], v229 offset:8192
    v_fma_f32 v163, v192, v161, v163
    v_fma_f32 v164, -v193, v163, v164
    v_fma_f32 v165, v193, v162, v165
    v_fma_f32 v239, v192, v162, v164
    v_fma_f32 v240, v192, v163, v165
    v_mfma_f32_32x32x16_bf16 v[96:111], a[72:75], a[180:183], v[96:111]
    ds_read_b128 a[176:179], v230 offset:0
    v_fma_f32 v248, -v193, v240, v244
    v_fma_f32 v250, v193, v239, v245
    v_fma_f32 v248, v192, v239, v248
    v_fmac_f32 v250, v192, v240
    v_mfma_f32_32x32x16_bf16 v[80:95], a[76:79], a[184:187], v[80:95]
    ds_read_b128 a[180:183], v230 offset:8192
    buffer_store_dwordx4 v[248:251], v13, s[20:23], s34 offen sc1
    s_add_u32 s35, s80, 0
    s_mul_i32 s35, s35, 8704
    s_add_u32 s35, s35, 16842752
    v_mfma_f32_32x32x16_bf16 v[96:111], a[76:79], a[188:191], v[96:111]
    ds_read_b128 a[184:187], v231 offset:0
    s_mov_b32 s92, 0
    v_mov_b32 v144, v232
    v_max_i32 v144, v144, v233
    buffer_load_dwordx4 v[112:115], v144, s[20:23], s35 offen sc1
    s_waitcnt lgkmcnt(3)
    v_mfma_f32_32x32x16_bf16 v[80:95], a[80:83], a[160:163], v[80:95]
    ds_read_b128 a[188:191], v231 offset:8192
    v_add_u32 v144, 0xfffffc00, v232
    v_max_i32_e64 v144, v144, v233
    buffer_load_dwordx4 v[116:119], v144, s[20:23], s35 offen sc1
    v_add_u32 v144, 0xfffff800, v232
    v_max_i32_e64 v144, v144, v233
    buffer_load_dwordx4 v[120:123], v144, s[20:23], s35 offen sc1
    v_mfma_f32_32x32x16_bf16 v[96:111], a[80:83], a[164:167], v[96:111]
    s_waitcnt vmcnt(11)
    s_barrier
    ds_read_b128 a[160:163], v224 offset:16384
    v_add_u32 v144, 0xfffff400, v232
    v_max_i32_e64 v144, v144, v233
    buffer_load_dwordx4 v[124:127], v144, s[20:23], s35 offen sc1
    v_mfma_f32_32x32x16_bf16 v[80:95], a[84:87], a[168:171], v[80:95]
    ds_read_b128 a[164:167], v224 offset:24576
    v_add_u32 v144, 0xfffff000, v232
    v_max_i32_e64 v144, v144, v233
    buffer_load_dwordx4 v[128:131], v144, s[20:23], s35 offen sc1
    v_add_u32 v144, 0xffffec00, v232
    v_max_i32_e64 v144, v144, v233
    buffer_load_dwordx4 v[132:135], v144, s[20:23], s35 offen sc1
    v_mfma_f32_32x32x16_bf16 v[96:111], a[84:87], a[172:175], v[96:111]
    ds_read_b128 a[168:171], v225 offset:16384
    v_add_u32 v144, 0xffffe800, v232
    v_max_i32 v144, v144, v233
    buffer_load_dwordx4 v[136:139], v144, s[20:23], s35 offen sc1
    s_waitcnt lgkmcnt(3)
    v_mfma_f32_32x32x16_bf16 v[80:95], a[88:91], a[176:179], v[80:95]
    ds_read_b128 a[172:175], v225 offset:24576
    v_add_u32 v144, 0xffffe400, v232
    v_max_i32_e64 v144, v144, v233
    buffer_load_dwordx4 v[140:143], v144, s[20:23], s35 offen sc1
    v_mfma_f32_32x32x16_bf16 v[96:111], a[88:91], a[180:183], v[96:111]
    ds_read_b128 a[176:179], v226 offset:16384
    v_mfma_f32_32x32x16_bf16 v[80:95], a[92:95], a[184:187], v[80:95]
    ds_read_b128 a[180:183], v226 offset:24576
    v_mfma_f32_32x32x16_bf16 v[96:111], a[92:95], a[188:191], v[96:111]
    ds_read_b128 a[184:187], v227 offset:16384
    s_waitcnt lgkmcnt(3)
    v_mfma_f32_32x32x16_bf16 v[80:95], a[96:99], a[160:163], v[80:95]
    ds_read_b128 a[188:191], v227 offset:24576
    v_mfma_f32_32x32x16_bf16 v[96:111], a[96:99], a[164:167], v[96:111]
    ds_read_b128 a[160:163], v228 offset:16384
    v_mfma_f32_32x32x16_bf16 v[80:95], a[100:103], a[168:171], v[80:95]
    ds_read_b128 a[164:167], v228 offset:24576
    v_mfma_f32_32x32x16_bf16 v[96:111], a[100:103], a[172:175], v[96:111]
    ds_read_b128 a[168:171], v229 offset:16384
    s_waitcnt lgkmcnt(3)
    v_mfma_f32_32x32x16_bf16 v[80:95], a[104:107], a[176:179], v[80:95]
    ds_read_b128 a[172:175], v229 offset:24576
    v_mfma_f32_32x32x16_bf16 v[96:111], a[104:107], a[180:183], v[96:111]
    ds_read_b128 a[176:179], v230 offset:16384
    v_mfma_f32_32x32x16_bf16 v[80:95], a[108:111], a[184:187], v[80:95]
    ds_read_b128 a[180:183], v230 offset:24576
    s_waitcnt vmcnt(0)
    v_mov_b32 v145, s85
    v_bitop3_b32 v144, v113, v115, v145 bitop3:0x7e
    v_bitop3_b32 v147, v117, v119, v145 bitop3:0x7e
    v_bitop3_b32 v146, v121, v123, v145 bitop3:0x7e
    s_lshl_b32 s29, s6, 11
    s_add_u32 s29, s29, 24117248
    v_and_b32 v169, 15, v1
    v_lshlrev_b32 v169, 7, v169
    v_mov_b32 v168, s85
    s_mov_b64 exec, 0xffff
    buffer_load_dword v168, v169, s[20:23], s29 offen sc1
    s_mov_b64 exec, -1
    v_mfma_f32_32x32x16_bf16 v[96:111], a[108:111], a[188:191], v[96:111]
    ds_read_b128 a[184:187], v231 offset:16384
    v_or3_b32 v144, v144, v146, v147
    v_bitop3_b32 v147, v125, v127, v145 bitop3:0x7e
    v_bitop3_b32 v146, v129, v131, v145 bitop3:0x7e
    v_or3_b32 v144, v144, v146, v147
    s_waitcnt lgkmcnt(3)
    v_mfma_f32_32x32x16_bf16 v[80:95], a[112:115], a[160:163], v[80:95]
    ds_read_b128 a[188:191], v231 offset:24576
    v_bitop3_b32 v147, v133, v135, v145 bitop3:0x7e
    v_bitop3_b32 v146, v137, v139, v145 bitop3:0x7e
    v_or3_b32 v144, v144, v146, v147
    v_bitop3_b32 v147, v141, v143, v145 bitop3:0x7e
    v_or_b32_e64 v144, v144, v147
    v_mfma_f32_32x32x16_bf16 v[96:111], a[112:115], a[164:167], v[96:111]
    s_barrier
    ds_read_b128 a[160:163], v224 offset:32768
    v_cmp_ne_u32 vcc, 0, v144
    s_nop 1
    s_cbranch_vccnz LB_SLOW_C0
LB_OK_C0:
    v_mov_b32 v144, v140
    v_mov_b32 v145, v142
    v_mfma_f32_32x32x16_bf16 v[80:95], a[116:119], a[168:171], v[80:95]
    ds_read_b128 a[164:167], v224 offset:40960
    v_fma_f32 v136, -v187, v145, v136
    v_fma_f32 v138, v187, v144, v138
    v_fma_f32 v144, v186, v144, v136
    v_fma_f32 v145, v186, v145, v138
    v_fma_f32 v132, -v187, v145, v132
    v_mfma_f32_32x32x16_bf16 v[96:111], a[116:119], a[172:175], v[96:111]
    ds_read_b128 a[168:171], v225 offset:32768
    v_fma_f32 v134, v187, v144, v134
    v_fma_f32 v144, v186, v144, v132
    v_fma_f32 v145, v186, v145, v134
    v_fma_f32 v128, -v187, v145, v128
    s_waitcnt lgkmcnt(3)
    v_mfma_f32_32x32x16_bf16 v[80:95], a[120:123], a[176:179], v[80:95]
    ds_read_b128 a[172:175], v225 offset:40960
    v_fmac_f32 v130, v187, v144
    v_fma_f32 v144, v186, v144, v128
    v_fma_f32 v145, v186, v145, v130
    v_fma_f32 v124, -v187, v145, v124
    v_fma_f32 v126, v187, v144, v126
    v_mfma_f32_32x32x16_bf16 v[96:111], a[120:123], a[180:183], v[96:111]
    ds_read_b128 a[176:179], v226 offset:32768
    v_fma_f32 v144, v186, v144, v124
    v_fma_f32 v145, v186, v145, v126
    v_fma_f32 v120, -v187, v145, v120
    v_fma_f32 v122, v187, v144, v122
    v_fma_f32 v144, v186, v144, v120
    v_mfma_f32_32x32x16_bf16 v[80:95], a[124:127], a[184:187], v[80:95]
    ds_read_b128 a[180:183], v226 offset:40960
    v_fma_f32 v145, v186, v145, v122
    v_fma_f32 v116, -v187, v145, v116
    v_fma_f32 v118, v187, v144, v118
    v_fma_f32 v144, v186, v144, v116
    v_fma_f32 v145, v186, v145, v118
    v_mfma_f32_32x32x16_bf16 v[96:111], a[124:127], a[188:191], v[96:111]
    ds_read_b128 a[184:187], v227 offset:32768
    v_fma_f32 v112, -v187, v145, v112
    v_fma_f32 v114, v187, v144, v114
    v_fma_f32 v144, v186, v144, v112
    v_fma_f32 v145, v186, v145, v114
    s_waitcnt lgkmcnt(3)
    v_mfma_f32_32x32x16_bf16 v[80:95], a[128:131], a[160:163], v[80:95]
    ds_read_b128 a[188:191], v227 offset:40960
    v_mov_b32 v112, v144
    v_mov_b32 v114, v144
    v_mov_b32 v113, v145
    v_mov_b32 v115, v145
    v_permlane32_swap_b32 v112, v114
    v_mfma_f32_32x32x16_bf16 v[96:111], a[128:131], a[164:167], v[96:111]
    ds_read_b128 a[160:163], v228 offset:32768
    v_permlane32_swap_b32 v113, v115
    v_fma_f32 v112, -v185, v115, v112
    v_fmac_f32 v113, v185, v114
    v_fma_f32 v112, v184, v114, v112
    v_fma_f32 v113, v184, v115, v113
    v_mfma_f32_32x32x16_bf16 v[80:95], a[132:135], a[168:171], v[80:95]
    ds_read_b128 a[164:167], v228 offset:40960
    v_fma_f32 v237, -v183, v113, v237
    v_fma_f32 v238, v183, v112, v238
    v_fma_f32 v237, v182, v112, v237
    v_fma_f32 v238, v182, v113, v238
    v_fma_f32 v16, -v177, v238, v16
    v_mfma_f32_32x32x16_bf16 v[96:111], a[132:135], a[172:175], v[96:111]
    ds_read_b128 a[168:171], v229 offset:32768
    v_fma_f32 v32, v177, v237, v32
    v_fma_f32 v16, v176, v237, v16
    v_fma_f32 v32, v176, v238, v32
    v_mul_f32 v116, v178, v16
    s_waitcnt lgkmcnt(3)
    v_mfma_f32_32x32x16_bf16 v[80:95], a[136:139], a[176:179], v[80:95]
    ds_read_b128 a[172:175], v229 offset:40960
    v_mul_f32_e64 v117, v178, v32
    v_fma_f32 v116, -v179, v32, v116
    v_fma_f32 v117, v179, v16, v117
    v_cvt_pk_bf16_f32 v118, v116, -v117
    ds_write_b32 v234, v118 offset:0
    v_mfma_f32_32x32x16_bf16 v[96:111], a[136:139], a[180:183], v[96:111]
    ds_read_b128 a[176:179], v230 offset:32768
    v_fma_f32 v17, -v177, v32, v17
    v_fma_f32 v33, v177, v16, v33
    v_fma_f32 v17, v176, v16, v17
    v_fmac_f32 v33, v176, v32
    v_mul_f32 v120, v178, v17
    v_mfma_f32_32x32x16_bf16 v[80:95], a[140:143], a[184:187], v[80:95]
    ds_read_b128 a[180:183], v230 offset:40960
    v_mul_f32_e64 v121, v178, v33
    v_fma_f32 v120, -v179, v33, v120
    v_fma_f32 v121, v179, v17, v121
    v_cvt_pk_bf16_f32 v122, v120, -v121
    ds_write_b32 v234, v122 offset:144
    v_mfma_f32_32x32x16_bf16 v[96:111], a[140:143], a[188:191], v[96:111]
    ds_read_b128 a[184:187], v231 offset:32768
    v_fma_f32 v18, -v177, v33, v18
    v_fma_f32 v34, v177, v17, v34
    v_fma_f32 v18, v176, v17, v18
    v_fmac_f32 v34, v176, v33
    s_waitcnt lgkmcnt(5)
    v_mfma_f32_32x32x16_bf16 v[80:95], a[144:147], a[160:163], v[80:95]
    ds_read_b128 a[188:191], v231 offset:40960
    v_mul_f32 v116, v178, v18
    v_mul_f32 v117, v178, v34
    v_fma_f32 v116, -v179, v34, v116
    v_fma_f32 v117, v179, v18, v117
    v_cvt_pk_bf16_f32 v118, v116, -v117
    v_mfma_f32_32x32x16_bf16 v[96:111], a[144:147], a[164:167], v[96:111]
    ds_write_b32 v234, v118 offset:288
    v_fma_f32 v19, -v177, v34, v19
    v_fma_f32 v35, v177, v18, v35
    v_fma_f32 v19, v176, v18, v19
    v_fmac_f32 v35, v176, v34
    v_mul_f32 v120, v178, v19
    v_mfma_f32_32x32x16_bf16 v[80:95], a[148:151], a[168:171], v[80:95]
    v_mul_f32_e64 v121, v178, v35
    v_fma_f32 v120, -v179, v35, v120
    v_fma_f32 v121, v179, v19, v121
    v_cvt_pk_bf16_f32 v122, v120, -v121
    ds_write_b32 v234, v122 offset:432
    v_fma_f32 v20, -v177, v35, v20
    v_mfma_f32_32x32x16_bf16 v[96:111], a[148:151], a[172:175], v[96:111]
    v_fma_f32 v36, v177, v19, v36
    v_fma_f32 v20, v176, v19, v20
    v_fmac_f32 v36, v176, v35
    v_mul_f32 v116, v178, v20
    v_mul_f32 v117, v178, v36
    s_waitcnt lgkmcnt(2)
    v_mfma_f32_32x32x16_bf16 v[80:95], a[152:155], a[176:179], v[80:95]
    v_fma_f32 v116, -v179, v36, v116
    v_fma_f32 v117, v179, v20, v117
    v_cvt_pk_bf16_f32 v118, v116, -v117
    ds_write_b32 v234, v118 offset:576
    v_fma_f32 v21, -v177, v36, v21
    v_fma_f32 v37, v177, v20, v37
    v_mfma_f32_32x32x16_bf16 v[96:111], a[152:155], a[180:183], v[96:111]
    v_fma_f32 v21, v176, v20, v21
    v_fma_f32 v37, v176, v36, v37
    v_mul_f32 v120, v178, v21
    v_mul_f32 v121, v178, v37
    v_fma_f32 v120, -v179, v37, v120
    v_fma_f32 v121, v179, v21, v121
    v_mfma_f32_32x32x16_bf16 v[80:95], a[156:159], a[184:187], v[80:95]
    v_cvt_pk_bf16_f32 v122, v120, -v121
    ds_write_b32 v234, v122 offset:720
    v_fma_f32 v22, -v177, v37, v22
    v_fma_f32 v38, v177, v21, v38
    v_fma_f32 v22, v176, v21, v22
    v_fma_f32 v38, v176, v37, v38
    v_mfma_f32_32x32x16_bf16 v[96:111], a[156:159], a[188:191], v[96:111]
    v_mul_f32 v116, v178, v22
    v_mul_f32 v117, v178, v38
    v_fma_f32 v116, -v179, v38, v116
    v_fma_f32 v117, v179, v22, v117
    v_cvt_pk_bf16_f32 v118, v116, -v117
    s_mov_b32 s30, 0
    s_waitcnt vmcnt(0)
    v_cmp_ne_u32 vcc, s85, v168
    s_nop 1
    s_cbranch_vccnz JF_SLOW_C
JF_OK_C:
    s_lshr_b32 s28, s6, 3
    s_mul_i32 s28, s28, 47
    s_mul_i32 s29, s4, 12
    s_add_u32 s31, s28, s29
    s_and_b32 s28, s6, 7
    s_mul_i32 s28, s28, 94
    s_add_u32 s28, s28, s31
    s_mul_i32 s28, s28, 5120
    s_add_u32 s27, s28, 12582912
    s_mov_b32 s24, 0x76543210
    s_mov_b32 s25, 0xba98
    s_cmp_eq_u32 s4, 0
    s_cselect_b32 s24, 0xba98721, s24
    s_cselect_b32 s25, 0x6543, s25
    s_cmp_eq_u32 s4, 3
    s_cselect_b32 s24, 0x38765210, s24
    s_cselect_b32 s25, 0xba94, s25
    s_cmp_lt_u32 s6, 8
    s_cselect_b32 s24, 0x32985410, s24
    s_cselect_b32 s25, 0xba76, s25
    ds_write_b32 v234, v118 offset:864
    v_fma_f32 v23, -v177, v38, v23
    v_fma_f32 v39, v177, v22, v39
    v_fma_f32 v23, v176, v22, v23
    v_fma_f32 v39, v176, v38, v39
    v_mul_f32 v120, v178, v23
    v_mul_f32 v121, v178, v39
    v_fma_f32 v120, -v179, v39, v120
    v_fma_f32 v121, v179, v23, v121
    v_cvt_pk_bf16_f32 v122, v120, -v121
    ds_write_b32 v234, v122 offset:1008
    v_fma_f32 v24, -v177, v39, v24
    v_fma_f32 v40, v177, v23, v40
    v_fma_f32 v24, v176, v23, v24
    v_fmac_f32 v40, v176, v39
    v_mul_f32 v116, v178, v24
    s_bfe_u32 s28, s24, 0x40000
    s_mul_i32 s28, s28, 5120
    s_add_u32 s28, s28, s27
    buffer_load_dwordx4 a[192:195], v236, s[20:23], s28 offen offset:0 sc1
    v_mul_f32 v117, v178, v40
    v_fma_f32 v116, -v179, v40, v116
    v_fma_f32 v117, v179, v24, v117
    v_cvt_pk_bf16_f32 v118, v116, -v117
    ds_write_b32 v234, v118 offset:1152
    v_fma_f32 v25, -v177, v40, v25
    v_fma_f32 v41, v177, v24, v41
    v_fma_f32 v25, v176, v24, v25
    v_fma_f32 v41, v176, v40, v41
    v_mul_f32 v120, v178, v25
    v_mul_f32 v121, v178, v41
    v_fma_f32 v120, -v179, v41, v120
    v_fma_f32 v121, v179, v25, v121
    v_cvt_pk_bf16_f32 v122, v120, -v121
    ds_write_b32 v234, v122 offset:1296
    v_fma_f32 v26, -v177, v41, v26
    buffer_load_dwordx4 a[196:199], v236, s[20:23], s28 offen offset:1024 sc1
    v_fma_f32 v42, v177, v25, v42
    v_fma_f32 v26, v176, v25, v26
    v_fma_f32 v42, v176, v41, v42
    v_mul_f32 v116, v178, v26
    v_mul_f32 v117, v178, v42
    v_fma_f32 v116, -v179, v42, v116
    v_fma_f32 v117, v179, v26, v117
    v_cvt_pk_bf16_f32 v118, v116, -v117
    ds_write_b32 v234, v118 offset:1440
    v_fma_f32 v27, -v177, v42, v27
    v_fma_f32 v43, v177, v26, v43
    v_fma_f32 v27, v176, v26, v27
    v_fma_f32 v43, v176, v42, v43
    v_mul_f32 v120, v178, v27
    v_mul_f32 v121, v178, v43
    v_fma_f32 v120, -v179, v43, v120
    buffer_load_dwordx4 a[200:203], v236, s[20:23], s28 offen offset:2048 sc1
    v_fma_f32 v121, v179, v27, v121
    v_cvt_pk_bf16_f32 v122, v120, -v121
    ds_write_b32 v234, v122 offset:1584
    v_fma_f32 v28, -v177, v43, v28
    v_fma_f32 v44, v177, v27, v44
    v_fma_f32 v28, v176, v27, v28
    v_fma_f32 v44, v176, v43, v44
    v_mul_f32 v116, v178, v28
    v_mul_f32 v117, v178, v44
    v_fma_f32 v116, -v179, v44, v116
    v_fma_f32 v117, v179, v28, v117
    v_cvt_pk_bf16_f32 v118, v116, -v117
    ds_write_b32 v234, v118 offset:1728
    v_fma_f32 v29, -v177, v44, v29
    v_fma_f32 v45, v177, v28, v45
    v_fma_f32 v29, v176, v28, v29
    buffer_load_dwordx4 a[204:207], v236, s[20:23], s28 offen offset:3072 sc1
    v_fma_f32 v45, v176, v44, v45
    v_mul_f32 v120, v178, v29
    v_mul_f32 v121, v178, v45
    v_fma_f32 v120, -v179, v45, v120
    v_fma_f32 v121, v179, v29, v121
    v_cvt_pk_bf16_f32 v122, v120, -v121
    ds_write_b32 v234, v122 offset:1872
    v_fma_f32 v30, -v177, v45, v30
    v_fma_f32 v46, v177, v29, v46
    v_fma_f32 v30, v176, v29, v30
    v_fma_f32 v46, v176, v45, v46
    v_mul_f32 v116, v178, v30
    v_mul_f32 v117, v178, v46
    v_fma_f32 v116, -v179, v46, v116
    v_fma_f32 v117, v179, v30, v117
    v_cvt_pk_bf16_f32 v118, v116, -v117
    buffer_load_dwordx4 a[208:211], v0, s[20:23], s28 offen offset:0 sc1
    ds_write_b32 v234, v118 offset:2016
    v_fma_f32 v31, -v177, v46, v31
    v_fma_f32 v47, v177, v30, v47
    v_fma_f32 v31, v176, v30, v31
    v_fma_f32 v47, v176, v46, v47
    v_mul_f32 v120, v178, v31
    v_mul_f32 v121, v178, v47
    v_fma_f32 v120, -v179, v47, v120
    v_fmac_f32 v121, v179, v31
    v_cvt_pk_bf16_f32 v122, v120, -v121
    ds_write_b32 v234, v122 offset:2160
    s_waitcnt lgkmcnt(0)
    ds_read_b128 v[124:127], v235 offset:0
    ds_read_b128 v[128:131], v235 offset:64
    ds_read_b128 v[132:135], v235 offset:2304
    ds_read_b128 v[136:139], v235 offset:2368
    s_bfe_u32 s28, s24, 0x40004
    s_mul_i32 s28, s28, 5120
    s_add_u32 s28, s28, s27
    buffer_load_dwordx4 a[212:215], v236, s[20:23], s28 offen offset:0 sc1
    s_add_u32 s35, s80, 0
    s_lshl_b32 s35, s35, 13
    s_add_u32 s35, s35, s87
    s_add_u32 s35, s35, 221184
    s_add_u32 s34, s35, 4096
    s_waitcnt lgkmcnt(3)
    buffer_store_dwordx4 v[124:127], v236, s[20:23], s35 offen offset:0 sc1
    s_waitcnt lgkmcnt(2)
    buffer_store_dwordx4 v[128:131], v236, s[20:23], s34 offen offset:0 sc1
    s_waitcnt lgkmcnt(1)
    buffer_store_dwordx4 v[132:135], v236, s[20:23], s35 offen offset:1024 sc1
    s_waitcnt lgkmcnt(0)
    buffer_store_dwordx4 v[136:139], v236, s[20:23], s34 offen offset:1024 sc1
    v_fma_f32 v244, -v201, v96, v81
    v_fma_f32 v245, v201, v80, v97
    v_fma_f32 v244, v200, v80, v244
    v_fma_f32 v245, v200, v96, v245
    v_fma_f32 v246, -v201, v245, v82
    v_fma_f32 v247, v201, v244, v98
    v_fma_f32 v246, v200, v244, v246
    v_fma_f32 v247, v200, v245, v247
    v_fma_f32 v244, -v201, v247, v83
    v_fma_f32 v245, v201, v246, v99
    v_fma_f32 v244, v200, v246, v244
    v_fma_f32 v245, v200, v247, v245
    v_fma_f32 v246, -v201, v245, v84
    v_fma_f32 v247, v201, v244, v100
    v_fma_f32 v246, v200, v244, v246
    v_fma_f32 v247, v200, v245, v247
    buffer_load_dwordx4 a[216:219], v236, s[20:23], s28 offen offset:1024 sc1
    v_fma_f32 v244, -v201, v247, v85
    v_fma_f32 v245, v201, v246, v101
    v_fma_f32 v244, v200, v246, v244
    v_fma_f32 v245, v200, v247, v245
    v_fma_f32 v246, -v201, v245, v86
    v_fma_f32 v247, v201, v244, v102
    v_fma_f32 v246, v200, v244, v246
    v_fma_f32 v247, v200, v245, v247
    v_fma_f32 v244, -v201, v247, v87
    v_fma_f32 v245, v201, v246, v103
    v_fma_f32 v244, v200, v246, v244
    v_fma_f32 v245, v200, v247, v245
    v_fma_f32 v246, -v201, v245, v88
    v_fma_f32 v247, v201, v244, v104
    v_fma_f32 v246, v200, v244, v246
    v_fma_f32 v247, v200, v245, v247
    buffer_load_dwordx4 a[220:223], v236, s[20:23], s28 offen offset:2048 sc1
    v_fma_f32 v244, -v201, v247, v89
    v_fma_f32 v245, v201, v246, v105
    v_fma_f32 v244, v200, v246, v244
    v_fma_f32 v245, v200, v247, v245
    v_fma_f32 v246, -v201, v245, v90
    v_fma_f32 v247, v201, v244, v106
    v_fma_f32 v246, v200, v244, v246
    v_fma_f32 v247, v200, v245, v247
    v_fma_f32 v244, -v201, v247, v91
    v_fma_f32 v245, v201, v246, v107
    v_fma_f32 v244, v200, v246, v244
    v_fma_f32 v245, v200, v247, v245
    v_fma_f32 v246, -v201, v245, v92
    v_fma_f32 v247, v201, v244, v108
    v_fma_f32 v246, v200, v244, v246
    v_fma_f32 v247, v200, v245, v247
    buffer_load_dwordx4 a[224:227], v236, s[20:23], s28 offen offset:3072 sc1
    v_fma_f32 v244, -v201, v247, v93
    v_fma_f32 v245, v201, v246, v109
    v_fma_f32 v244, v200, v246, v244
    v_fma_f32 v245, v200, v247, v245
    v_fma_f32 v246, -v201, v245, v94
    v_fma_f32 v247, v201, v244, v110
    v_fma_f32 v246, v200, v244, v246
    v_fma_f32 v247, v200, v245, v247
    v_fma_f32 v244, -v201, v247, v95
    v_fma_f32 v245, v201, v246, v111
    v_fma_f32 v244, v200, v246, v244
    v_fma_f32 v245, v200, v247, v245
    ds_write2_b32 v15, v244, v245 offset0:14 offset1:15
    s_waitcnt lgkmcnt(0)
    s_barrier
    ds_read2_b64 v[152:155], v15 offset0:0 offset1:1
    ds_read2_b64 v[156:159], v15 offset0:2 offset1:3
    ds_read2_b64 v[160:163], v15 offset0:4 offset1:5
    ds_read_b64 v[164:165], v15 offset:48
    buffer_load_dwordx4 a[228:231], v0, s[20:23], s28 offen offset:0 sc1
    v_mov_b32_e64 v249, s85
    v_mov_b32 v251, s85
    s_add_u32 s34, s80, 2
    s_mul_i32 s34, s34, 8704
    s_add_u32 s34, s34, 16842752
    s_waitcnt lgkmcnt(0)
    v_fma_f32 v154, -v205, v153, v154
    v_fmac_f32 v155, v205, v152
    v_fma_f32 v154, v204, v152, v154
    v_fma_f32 v155, v204, v153, v155
    v_fma_f32 v156, -v205, v155, v156
    v_fma_f32 v157, v205, v154, v157
    v_fma_f32 v156, v204, v154, v156
    v_fma_f32 v157, v204, v155, v157
    v_fma_f32 v158, -v205, v157, v158
    v_fma_f32 v159, v205, v156, v159
    s_bfe_u32 s28, s24, 0x40008
    s_mul_i32 s28, s28, 5120
    s_add_u32 s28, s28, s27
    buffer_load_dwordx4 a[232:235], v236, s[20:23], s28 offen offset:0 sc1
    v_fmac_f32 v158, v204, v156
    v_fma_f32 v159, v204, v157, v159
    v_fma_f32 v160, -v205, v159, v160
    v_fma_f32 v161, v205, v158, v161
    v_fma_f32 v160, v204, v158, v160
    v_fma_f32 v161, v204, v159, v161
    v_fma_f32 v162, -v205, v161, v162
    v_fma_f32 v163, v205, v160, v163
    v_fma_f32 v162, v204, v160, v162
    v_fma_f32 v163, v204, v161, v163
    v_fma_f32 v164, -v205, v163, v164
    v_fma_f32 v165, v205, v162, v165
    v_fma_f32 v241, v204, v162, v164
    v_fma_f32 v242, v204, v163, v165
    v_fma_f32 v248, -v205, v242, v244
    v_fma_f32 v250, v205, v241, v245
    buffer_load_dwordx4 a[236:239], v236, s[20:23], s28 offen offset:1024 sc1
    v_fma_f32 v248, v204, v241, v248
    v_fmac_f32 v250, v204, v242
    buffer_store_dwordx4 v[248:251], v13, s[20:23], s34 offen sc1
    s_add_u32 s35, s80, 1
    s_mul_i32 s35, s35, 8704
    s_add_u32 s35, s35, 16842752
    s_mov_b32 s92, 0
    v_mov_b32 v144, v232
    v_max_i32_e64 v144, v144, v233
    buffer_load_dwordx4 v[112:115], v144, s[20:23], s35 offen sc1
    v_add_u32 v144, 0xfffffc00, v232
    v_max_i32_e64 v144, v144, v233
    buffer_load_dwordx4 v[116:119], v144, s[20:23], s35 offen sc1
    buffer_load_dwordx4 a[240:243], v236, s[20:23], s28 offen offset:2048 sc1
    v_add_u32 v144, 0xfffff800, v232
    v_max_i32_e64 v144, v144, v233
    buffer_load_dwordx4 v[120:123], v144, s[20:23], s35 offen sc1
    v_add_u32 v144, 0xfffff400, v232
    v_max_i32_e64 v144, v144, v233
    buffer_load_dwordx4 v[124:127], v144, s[20:23], s35 offen sc1
    v_add_u32 v144, 0xfffff000, v232
    v_max_i32_e64 v144, v144, v233
    buffer_load_dwordx4 v[128:131], v144, s[20:23], s35 offen sc1
    v_add_u32 v144, 0xffffec00, v232
    v_max_i32_e64 v144, v144, v233
    buffer_load_dwordx4 v[132:135], v144, s[20:23], s35 offen sc1
    buffer_load_dwordx4 a[244:247], v236, s[20:23], s28 offen offset:3072 sc1
    v_add_u32 v144, 0xffffe800, v232
    v_max_i32_e64 v144, v144, v233
    buffer_load_dwordx4 v[136:139], v144, s[20:23], s35 offen sc1
    v_add_u32 v144, 0xffffe400, v232
    v_max_i32_e64 v144, v144, v233
    buffer_load_dwordx4 v[140:143], v144, s[20:23], s35 offen sc1
    s_waitcnt vmcnt(0)
    v_mov_b32 v145, s85
    v_bitop3_b32 v144, v113, v115, v145 bitop3:0x7e
    v_bitop3_b32 v147, v117, v119, v145 bitop3:0x7e
    v_bitop3_b32 v146, v121, v123, v145 bitop3:0x7e
    v_or3_b32 v144, v144, v146, v147
    v_bitop3_b32 v147, v125, v127, v145 bitop3:0x7e
    v_bitop3_b32 v146, v129, v131, v145 bitop3:0x7e
    buffer_load_dwordx4 a[248:251], v0, s[20:23], s28 offen offset:0 sc1
    v_or3_b32 v144, v144, v146, v147
    v_bitop3_b32 v147, v133, v135, v145 bitop3:0x7e
    v_bitop3_b32 v146, v137, v139, v145 bitop3:0x7e
    v_or3_b32 v144, v144, v146, v147
    v_bitop3_b32 v147, v141, v143, v145 bitop3:0x7e
    v_or_b32 v144, v144, v147
    v_cmp_ne_u32 vcc, 0, v144
    s_nop 1
    s_cbranch_vccnz LB_SLOW_C1
LB_OK_C1:
    v_mov_b32 v144, v140
    v_mov_b32 v145, v142
    v_fma_f32 v136, -v199, v145, v136
    v_fma_f32 v138, v199, v144, v138
    v_fma_f32 v144, v198, v144, v136
    v_fma_f32 v145, v198, v145, v138
    v_fma_f32 v132, -v199, v145, v132
    v_fmac_f32 v134, v199, v144
    s_bfe_u32 s28, s24, 0x4000c
    s_mul_i32 s28, s28, 5120
    s_add_u32 s28, s28, s27
    buffer_load_dwordx4 a[252:255], v236, s[20:23], s28 offen offset:0 sc1
    v_fma_f32 v144, v198, v144, v132
    v_fma_f32 v145, v198, v145, v134
    v_fma_f32 v128, -v199, v145, v128
    v_fma_f32 v130, v199, v144, v130
    v_fma_f32 v144, v198, v144, v128
    v_fma_f32 v145, v198, v145, v130
    v_fma_f32 v124, -v199, v145, v124
    v_fma_f32 v126, v199, v144, v126
    v_fma_f32 v144, v198, v144, v124
    v_fma_f32 v145, v198, v145, v126
    v_fma_f32 v120, -v199, v145, v120
    v_fma_f32 v122, v199, v144, v122
    v_fma_f32 v144, v198, v144, v120
    v_fma_f32 v145, v198, v145, v122
    v_fma_f32 v116, -v199, v145, v116
    v_fma_f32 v118, v199, v144, v118
    buffer_load_dwordx4 a[0:3], v236, s[20:23], s28 offen offset:1024 sc1
    v_fma_f32 v144, v198, v144, v116
    v_fma_f32 v145, v198, v145, v118
    v_fma_f32 v112, -v199, v145, v112
    v_fma_f32 v114, v199, v144, v114
    v_fma_f32 v144, v198, v144, v112
    v_fma_f32 v145, v198, v145, v114
    v_mov_b32_e64 v112, v144
    v_mov_b32 v114, v144
    v_mov_b32 v113, v145
    v_mov_b32 v115, v145
    v_permlane32_swap_b32 v112, v114
    s_nop 0
    v_permlane32_swap_b32 v113, v115
    v_fma_f32 v112, -v197, v115, v112
    v_fma_f32 v113, v197, v114, v113
    v_fma_f32 v112, v196, v114, v112
    v_fma_f32 v113, v196, v115, v113
    buffer_load_dwordx4 a[4:7], v236, s[20:23], s28 offen offset:2048 sc1
    v_fma_f32 v239, -v195, v113, v239
    v_fma_f32 v240, v195, v112, v240
    v_fma_f32 v239, v194, v112, v239
    v_fma_f32 v240, v194, v113, v240
    v_fma_f32 v48, -v189, v240, v48
    v_fma_f32 v64, v189, v239, v64
    v_fma_f32 v48, v188, v239, v48
    v_fma_f32 v64, v188, v240, v64
    v_fma_f32 v49, -v189, v64, v49
    v_fma_f32 v65, v189, v48, v65
    v_fma_f32 v49, v188, v48, v49
    v_fma_f32 v65, v188, v64, v65
    v_pk_mul_f32 v[116:117], v[64:65], v[190:191] op_sel:[0,1] op_sel_hi:[1,1]
    v_pk_mul_f32 v[118:119], v[48:49], v[190:191] op_sel:[0,1] op_sel_hi:[1,1]
    v_pk_fma_f32 v[116:117], v[48:49], v[190:191], v[116:117] op_sel_hi:[1,0,1] neg_lo:[0,0,1] neg_hi:[0,0,1]
    v_pk_fma_f32 v[118:119], v[64:65], v[190:191], v[118:119] op_sel_hi:[1,0,1]
    buffer_load_dwordx4 a[8:11], v236, s[20:23], s28 offen offset:3072 sc1
    v_cvt_pk_bf16_f32 v120, v116, -v118
    v_cvt_pk_bf16_f32 v122, v117, -v119
    ds_write_b32 v234, v120 offset:0
    ds_write_b32 v234, v122 offset:144
    v_fma_f32 v50, -v189, v65, v50
    v_fma_f32 v66, v189, v49, v66
    v_fma_f32 v50, v188, v49, v50
    v_fma_f32 v66, v188, v65, v66
    v_fma_f32 v51, -v189, v66, v51
    v_fma_f32 v67, v189, v50, v67
    v_fma_f32 v51, v188, v50, v51
    v_fma_f32 v67, v188, v66, v67
    v_pk_mul_f32 v[116:117], v[66:67], v[190:191] op_sel:[0,1] op_sel_hi:[1,1]
    v_pk_mul_f32 v[118:119], v[50:51], v[190:191] op_sel:[0,1] op_sel_hi:[1,1]
    v_pk_fma_f32 v[116:117], v[50:51], v[190:191], v[116:117] op_sel_hi:[1,0,1] neg_lo:[0,0,1] neg_hi:[0,0,1]
    v_pk_fma_f32 v[118:119], v[66:67], v[190:191], v[118:119] op_sel_hi:[1,0,1]
    buffer_load_dwordx4 a[12:15], v0, s[20:23], s28 offen offset:0 sc1
    v_cvt_pk_bf16_f32 v120, v116, -v118
    v_cvt_pk_bf16_f32 v122, v117, -v119
    ds_write_b32 v234, v120 offset:288
    ds_write_b32 v234, v122 offset:432
    v_fma_f32 v52, -v189, v67, v52
    v_fma_f32 v68, v189, v51, v68
    v_fma_f32 v52, v188, v51, v52
    v_fma_f32 v68, v188, v67, v68
    v_fma_f32 v53, -v189, v68, v53
    v_fma_f32 v69, v189, v52, v69
    v_fma_f32 v53, v188, v52, v53
    v_fmac_f32 v69, v188, v68
    v_pk_mul_f32 v[116:117], v[68:69], v[190:191] op_sel:[0,1] op_sel_hi:[1,1]
    v_pk_mul_f32 v[118:119], v[52:53], v[190:191] op_sel:[0,1] op_sel_hi:[1,1]
    v_pk_fma_f32 v[116:117], v[52:53], v[190:191], v[116:117] op_sel_hi:[1,0,1] neg_lo:[0,0,1] neg_hi:[0,0,1]
    v_pk_fma_f32 v[118:119], v[68:69], v[190:191], v[118:119] op_sel_hi:[1,0,1]
    s_bfe_u32 s28, s24, 0x40010
    s_mul_i32 s28, s28, 5120
    s_add_u32 s28, s28, s27
    buffer_load_dwordx4 a[16:19], v236, s[20:23], s28 offen offset:0 sc1
    v_cvt_pk_bf16_f32 v120, v116, -v118
    v_cvt_pk_bf16_f32 v122, v117, -v119
    ds_write_b32 v234, v120 offset:576
    ds_write_b32 v234, v122 offset:720
    v_fma_f32 v54, -v189, v69, v54
    v_fma_f32 v70, v189, v53, v70
    v_fma_f32 v54, v188, v53, v54
    v_fma_f32 v70, v188, v69, v70
    v_fma_f32 v55, -v189, v70, v55
    v_fma_f32 v71, v189, v54, v71
    v_fma_f32 v55, v188, v54, v55
    v_fma_f32 v71, v188, v70, v71
    v_pk_mul_f32 v[116:117], v[70:71], v[190:191] op_sel:[0,1] op_sel_hi:[1,1]
    v_pk_mul_f32 v[118:119], v[54:55], v[190:191] op_sel:[0,1] op_sel_hi:[1,1]
    v_pk_fma_f32 v[116:117], v[54:55], v[190:191], v[116:117] op_sel_hi:[1,0,1] neg_lo:[0,0,1] neg_hi:[0,0,1]
    v_pk_fma_f32 v[118:119], v[70:71], v[190:191], v[118:119] op_sel_hi:[1,0,1]
    buffer_load_dwordx4 a[20:23], v236, s[20:23], s28 offen offset:1024 sc1
    v_cvt_pk_bf16_f32 v120, v116, -v118
    v_cvt_pk_bf16_f32 v122, v117, -v119
    ds_write_b32 v234, v120 offset:864
    ds_write_b32 v234, v122 offset:1008
    v_fma_f32 v56, -v189, v71, v56
    v_fma_f32 v72, v189, v55, v72
    v_fma_f32 v56, v188, v55, v56
    v_fma_f32 v72, v188, v71, v72
    v_fma_f32 v57, -v189, v72, v57
    v_fma_f32 v73, v189, v56, v73
    v_fma_f32 v57, v188, v56, v57
    v_fma_f32 v73, v188, v72, v73
    v_pk_mul_f32 v[116:117], v[72:73], v[190:191] op_sel:[0,1] op_sel_hi:[1,1]
    v_pk_mul_f32 v[118:119], v[56:57], v[190:191] op_sel:[0,1] op_sel_hi:[1,1]
    v_pk_fma_f32 v[116:117], v[56:57], v[190:191], v[116:117] op_sel_hi:[1,0,1] neg_lo:[0,0,1] neg_hi:[0,0,1]
    v_pk_fma_f32 v[118:119], v[72:73], v[190:191], v[118:119] op_sel_hi:[1,0,1]
    buffer_load_dwordx4 a[24:27], v236, s[20:23], s28 offen offset:2048 sc1
    v_cvt_pk_bf16_f32 v120, v116, -v118
    v_cvt_pk_bf16_f32 v122, v117, -v119
    ds_write_b32 v234, v120 offset:1152
    ds_write_b32 v234, v122 offset:1296
    v_fma_f32 v58, -v189, v73, v58
    v_fma_f32 v74, v189, v57, v74
    v_fma_f32 v58, v188, v57, v58
    v_fma_f32 v74, v188, v73, v74
    v_fma_f32 v59, -v189, v74, v59
    v_fma_f32 v75, v189, v58, v75
    v_fma_f32 v59, v188, v58, v59
    v_fma_f32 v75, v188, v74, v75
    v_pk_mul_f32 v[116:117], v[74:75], v[190:191] op_sel:[0,1] op_sel_hi:[1,1]
    v_pk_mul_f32 v[118:119], v[58:59], v[190:191] op_sel:[0,1] op_sel_hi:[1,1]
    v_pk_fma_f32 v[116:117], v[58:59], v[190:191], v[116:117] op_sel_hi:[1,0,1] neg_lo:[0,0,1] neg_hi:[0,0,1]
    v_pk_fma_f32 v[118:119], v[74:75], v[190:191], v[118:119] op_sel_hi:[1,0,1]
    buffer_load_dwordx4 a[28:31], v236, s[20:23], s28 offen offset:3072 sc1
    v_cvt_pk_bf16_f32 v120, v116, -v118
    v_cvt_pk_bf16_f32 v122, v117, -v119
    ds_write_b32 v234, v120 offset:1440
    ds_write_b32 v234, v122 offset:1584
    v_fma_f32 v60, -v189, v75, v60
    v_fma_f32 v76, v189, v59, v76
    v_fma_f32 v60, v188, v59, v60
    v_fma_f32 v76, v188, v75, v76
    v_fma_f32 v61, -v189, v76, v61
    v_fma_f32 v77, v189, v60, v77
    v_fma_f32 v61, v188, v60, v61
    v_fma_f32 v77, v188, v76, v77
    v_pk_mul_f32 v[116:117], v[76:77], v[190:191] op_sel:[0,1] op_sel_hi:[1,1]
    v_pk_mul_f32 v[118:119], v[60:61], v[190:191] op_sel:[0,1] op_sel_hi:[1,1]
    v_pk_fma_f32 v[116:117], v[60:61], v[190:191], v[116:117] op_sel_hi:[1,0,1] neg_lo:[0,0,1] neg_hi:[0,0,1]
    v_pk_fma_f32 v[118:119], v[76:77], v[190:191], v[118:119] op_sel_hi:[1,0,1]
    buffer_load_dwordx4 a[32:35], v0, s[20:23], s28 offen offset:0 sc1
    v_cvt_pk_bf16_f32 v120, v116, -v118
    v_cvt_pk_bf16_f32 v122, v117, -v119
    ds_write_b32 v234, v120 offset:1728
    ds_write_b32 v234, v122 offset:1872
    v_fma_f32 v62, -v189, v77, v62
    v_fma_f32 v78, v189, v61, v78
    v_fma_f32 v62, v188, v61, v62
    v_fma_f32 v78, v188, v77, v78
    v_fma_f32 v63, -v189, v78, v63
    v_fma_f32 v79, v189, v62, v79
    v_fma_f32 v63, v188, v62, v63
    v_fma_f32 v79, v188, v78, v79
    v_pk_mul_f32 v[116:117], v[78:79], v[190:191] op_sel:[0,1] op_sel_hi:[1,1]
    v_pk_mul_f32 v[118:119], v[62:63], v[190:191] op_sel:[0,1] op_sel_hi:[1,1]
    v_pk_fma_f32 v[116:117], v[62:63], v[190:191], v[116:117] op_sel_hi:[1,0,1] neg_lo:[0,0,1] neg_hi:[0,0,1]
    v_pk_fma_f32 v[118:119], v[78:79], v[190:191], v[118:119] op_sel_hi:[1,0,1]
    s_bfe_u32 s28, s24, 0x40014
    s_mul_i32 s28, s28, 5120
    s_add_u32 s28, s28, s27
    buffer_load_dwordx4 a[36:39], v236, s[20:23], s28 offen offset:0 sc1
    v_cvt_pk_bf16_f32 v120, v116, -v118
    v_cvt_pk_bf16_f32 v122, v117, -v119
    ds_write_b32 v234, v120 offset:2016
    ds_write_b32 v234, v122 offset:2160
    s_waitcnt lgkmcnt(0)
    ds_read_b128 v[124:127], v235 offset:0
    ds_read_b128 v[128:131], v235 offset:64
    ds_read_b128 v[132:135], v235 offset:2304
    ds_read_b128 v[136:139], v235 offset:2368
    s_add_u32 s35, s80, 1
    s_lshl_b32 s35, s35, 13
    s_add_u32 s35, s35, s87
    s_add_u32 s35, s35, 221184
    s_add_u32 s34, s35, 4096
    s_waitcnt lgkmcnt(3)
    buffer_store_dwordx4 v[124:127], v236, s[20:23], s35 offen offset:0 sc1
    buffer_load_dwordx4 a[40:43], v236, s[20:23], s28 offen offset:1024 sc1
    s_waitcnt lgkmcnt(2)
    buffer_store_dwordx4 v[128:131], v236, s[20:23], s34 offen offset:0 sc1
    s_waitcnt lgkmcnt(1)
    buffer_store_dwordx4 v[132:135], v236, s[20:23], s35 offen offset:1024 sc1
    s_waitcnt lgkmcnt(0)
    buffer_store_dwordx4 v[136:139], v236, s[20:23], s34 offen offset:1024 sc1
    s_getpc_b64 s[100:101]
CT_K2C:
    s_add_u32 s100, s100, K2_START-CT_K2C
    s_addc_u32 s101, s101, 0
    s_mul_i32 s33, s4, 2048
    s_add_u32 s33, s33, 0
    v_lshl_add_u32 v170, v1, 7, s33
    v_min_u32 v170, TEXT_END-K2_START-4, v170
    s_mov_b64 exec, 0xffff
    global_load_dword v171, v170, s[100:101]
    s_mov_b64 exec, -1
    s_add_u32 s35, s80, 2
    s_mul_i32 s35, s35, 8704
    s_add_u32 s35, s35, 16842752
    s_mov_b32 s92, 0
    v_mov_b32 v144, v232
    v_max_i32_e64 v144, v144, v233
    buffer_load_dwordx4 v[112:115], v144, s[20:23], s35 offen sc1
    v_add_u32 v144, 0xfffffc00, v232
    v_max_i32_e64 v144, v144, v233
    buffer_load_dwordx4 v[116:119], v144, s[20:23], s35 offen sc1
    v_add_u32 v144, 0xfffff800, v232
    v_max_i32_e64 v144, v144, v233
    buffer_load_dwordx4 v[120:123], v144, s[20:23], s35 offen sc1
    v_add_u32 v144, 0xfffff400, v232
    v_max_i32_e64 v144, v144, v233
    buffer_load_dwordx4 v[124:127], v144, s[20:23], s35 offen sc1
    v_add_u32 v144, 0xfffff000, v232
    v_max_i32_e64 v144, v144, v233
    buffer_load_dwordx4 v[128:131], v144, s[20:23], s35 offen sc1
    v_add_u32 v144, 0xffffec00, v232
    v_max_i32_e64 v144, v144, v233
    buffer_load_dwordx4 v[132:135], v144, s[20:23], s35 offen sc1
    v_add_u32 v144, 0xffffe800, v232
    v_max_i32_e64 v144, v144, v233
    buffer_load_dwordx4 v[136:139], v144, s[20:23], s35 offen sc1
    v_add_u32 v144, 0xffffe400, v232
    v_max_i32_e64 v144, v144, v233
    buffer_load_dwordx4 v[140:143], v144, s[20:23], s35 offen sc1
    s_waitcnt vmcnt(0)
    v_mov_b32 v145, s85
    v_bitop3_b32 v144, v113, v115, v145 bitop3:0x7e
    v_bitop3_b32 v147, v117, v119, v145 bitop3:0x7e
    v_bitop3_b32 v146, v121, v123, v145 bitop3:0x7e
    v_or3_b32 v144, v144, v146, v147
    v_bitop3_b32 v147, v125, v127, v145 bitop3:0x7e
    v_bitop3_b32 v146, v129, v131, v145 bitop3:0x7e
    v_or3_b32 v144, v144, v146, v147
    v_bitop3_b32 v147, v133, v135, v145 bitop3:0x7e
    v_bitop3_b32 v146, v137, v139, v145 bitop3:0x7e
    v_or3_b32 v144, v144, v146, v147
    v_bitop3_b32 v147, v141, v143, v145 bitop3:0x7e
    v_or_b32 v144, v144, v147
    v_cmp_ne_u32 vcc, 0, v144
    s_nop 1
    s_cbranch_vccnz LB_SLOW_C2
LB_OK_C2:
    v_mov_b32 v144, v140
    v_mov_b32 v145, v142
    v_fma_f32 v136, -v211, v145, v136
    v_fma_f32 v138, v211, v144, v138
    v_fma_f32 v144, v210, v144, v136
    v_fma_f32 v145, v210, v145, v138
    v_fma_f32 v132, -v211, v145, v132
    v_fma_f32 v134, v211, v144, v134
    v_fma_f32 v144, v210, v144, v132
    v_fma_f32 v145, v210, v145, v134
    v_fma_f32 v128, -v211, v145, v128
    v_fma_f32 v130, v211, v144, v130
    v_fma_f32 v144, v210, v144, v128
    v_fma_f32 v145, v210, v145, v130
    v_fma_f32 v124, -v211, v145, v124
    v_fma_f32 v126, v211, v144, v126
    v_fma_f32 v144, v210, v144, v124
    v_fma_f32 v145, v210, v145, v126
    v_fma_f32 v120, -v211, v145, v120
    v_fma_f32 v122, v211, v144, v122
    v_fma_f32 v144, v210, v144, v120
    v_fma_f32 v145, v210, v145, v122
    v_fma_f32 v116, -v211, v145, v116
    v_fma_f32 v118, v211, v144, v118
    v_fma_f32 v144, v210, v144, v116
    v_fma_f32 v145, v210, v145, v118
    v_fma_f32 v112, -v211, v145, v112
    v_fma_f32 v114, v211, v144, v114
    v_fma_f32 v144, v210, v144, v112
    v_fma_f32 v145, v210, v145, v114
    v_mov_b32_e64 v112, v144
    v_mov_b32 v114, v144
    v_mov_b32 v113, v145
    v_mov_b32 v115, v145
    v_permlane32_swap_b32 v112, v114
    s_nop 0
    v_permlane32_swap_b32 v113, v115
    v_fma_f32 v112, -v209, v115, v112
    v_fma_f32 v113, v209, v114, v113
    v_fma_f32 v112, v208, v114, v112
    v_fma_f32 v113, v208, v115, v113
    v_fma_f32 v241, -v207, v113, v241
    v_fma_f32 v242, v207, v112, v242
    v_fma_f32 v241, v206, v112, v241
    v_fma_f32 v242, v206, v113, v242
    v_fma_f32 v80, -v201, v242, v80
    v_fma_f32 v96, v201, v241, v96
    v_fma_f32 v80, v200, v241, v80
    v_fma_f32 v96, v200, v242, v96
    v_fma_f32 v81, -v201, v96, v81
    v_fma_f32 v97, v201, v80, v97
    v_fma_f32 v81, v200, v80, v81
    v_fma_f32 v97, v200, v96, v97
    v_pk_mul_f32 v[116:117], v[96:97], v[202:203] op_sel:[0,1] op_sel_hi:[1,1]
    v_pk_mul_f32 v[118:119], v[80:81], v[202:203] op_sel:[0,1] op_sel_hi:[1,1]
    v_pk_fma_f32 v[116:117], v[80:81], v[202:203], v[116:117] op_sel_hi:[1,0,1] neg_lo:[0,0,1] neg_hi:[0,0,1]
    v_pk_fma_f32 v[118:119], v[96:97], v[202:203], v[118:119] op_sel_hi:[1,0,1]
    v_cvt_pk_bf16_f32 v120, v116, -v118
    v_cvt_pk_bf16_f32 v122, v117, -v119
    ds_write_b32 v234, v120 offset:0
    ds_write_b32 v234, v122 offset:144
    v_fma_f32 v82, -v201, v97, v82
    v_fma_f32 v98, v201, v81, v98
    v_fma_f32 v82, v200, v81, v82
    v_fma_f32 v98, v200, v97, v98
    v_fma_f32 v83, -v201, v98, v83
    v_fma_f32 v99, v201, v82, v99
    v_fma_f32 v83, v200, v82, v83
    v_fma_f32 v99, v200, v98, v99
    v_pk_mul_f32 v[116:117], v[98:99], v[202:203] op_sel:[0,1] op_sel_hi:[1,1]
    v_pk_mul_f32 v[118:119], v[82:83], v[202:203] op_sel:[0,1] op_sel_hi:[1,1]
    v_pk_fma_f32 v[116:117], v[82:83], v[202:203], v[116:117] op_sel_hi:[1,0,1] neg_lo:[0,0,1] neg_hi:[0,0,1]
    v_pk_fma_f32 v[118:119], v[98:99], v[202:203], v[118:119] op_sel_hi:[1,0,1]
    v_cvt_pk_bf16_f32 v120, v116, -v118
    v_cvt_pk_bf16_f32 v122, v117, -v119
    ds_write_b32 v234, v120 offset:288
    ds_write_b32 v234, v122 offset:432
    v_fma_f32 v84, -v201, v99, v84
    v_fma_f32 v100, v201, v83, v100
    v_fma_f32 v84, v200, v83, v84
    v_fma_f32 v100, v200, v99, v100
    v_fma_f32 v85, -v201, v100, v85
    v_fma_f32 v101, v201, v84, v101
    v_fma_f32 v85, v200, v84, v85
    v_fma_f32 v101, v200, v100, v101
    v_pk_mul_f32 v[116:117], v[100:101], v[202:203] op_sel:[0,1] op_sel_hi:[1,1]
    v_pk_mul_f32 v[118:119], v[84:85], v[202:203] op_sel:[0,1] op_sel_hi:[1,1]
    v_pk_fma_f32 v[116:117], v[84:85], v[202:203], v[116:117] op_sel_hi:[1,0,1] neg_lo:[0,0,1] neg_hi:[0,0,1]
    v_pk_fma_f32 v[118:119], v[100:101], v[202:203], v[118:119] op_sel_hi:[1,0,1]
    v_cvt_pk_bf16_f32 v120, v116, -v118
    v_cvt_pk_bf16_f32 v122, v117, -v119
    ds_write_b32 v234, v120 offset:576
    ds_write_b32 v234, v122 offset:720
    v_fma_f32 v86, -v201, v101, v86
    v_fma_f32 v102, v201, v85, v102
    v_fma_f32 v86, v200, v85, v86
    v_fma_f32 v102, v200, v101, v102
    v_fma_f32 v87, -v201, v102, v87
    v_fma_f32 v103, v201, v86, v103
    v_fma_f32 v87, v200, v86, v87
    v_fma_f32 v103, v200, v102, v103
    v_pk_mul_f32 v[116:117], v[102:103], v[202:203] op_sel:[0,1] op_sel_hi:[1,1]
    v_pk_mul_f32 v[118:119], v[86:87], v[202:203] op_sel:[0,1] op_sel_hi:[1,1]
    v_pk_fma_f32 v[116:117], v[86:87], v[202:203], v[116:117] op_sel_hi:[1,0,1] neg_lo:[0,0,1] neg_hi:[0,0,1]
    v_pk_fma_f32 v[118:119], v[102:103], v[202:203], v[118:119] op_sel_hi:[1,0,1]
    v_cvt_pk_bf16_f32 v120, v116, -v118
    v_cvt_pk_bf16_f32 v122, v117, -v119
    ds_write_b32 v234, v120 offset:864
    ds_write_b32 v234, v122 offset:1008
    v_fma_f32 v88, -v201, v103, v88
    v_fma_f32 v104, v201, v87, v104
    v_fma_f32 v88, v200, v87, v88
    v_fma_f32 v104, v200, v103, v104
    v_fma_f32 v89, -v201, v104, v89
    v_fma_f32 v105, v201, v88, v105
    v_fma_f32 v89, v200, v88, v89
    v_fma_f32 v105, v200, v104, v105
    v_pk_mul_f32 v[116:117], v[104:105], v[202:203] op_sel:[0,1] op_sel_hi:[1,1]
    v_pk_mul_f32 v[118:119], v[88:89], v[202:203] op_sel:[0,1] op_sel_hi:[1,1]
    v_pk_fma_f32 v[116:117], v[88:89], v[202:203], v[116:117] op_sel_hi:[1,0,1] neg_lo:[0,0,1] neg_hi:[0,0,1]
    v_pk_fma_f32 v[118:119], v[104:105], v[202:203], v[118:119] op_sel_hi:[1,0,1]
    v_cvt_pk_bf16_f32 v120, v116, -v118
    v_cvt_pk_bf16_f32 v122, v117, -v119
    ds_write_b32 v234, v120 offset:1152
    ds_write_b32 v234, v122 offset:1296
    v_fma_f32 v90, -v201, v105, v90
    v_fma_f32 v106, v201, v89, v106
    v_fma_f32 v90, v200, v89, v90
    v_fma_f32 v106, v200, v105, v106
    v_fma_f32 v91, -v201, v106, v91
    v_fma_f32 v107, v201, v90, v107
    v_fma_f32 v91, v200, v90, v91
    v_fma_f32 v107, v200, v106, v107
    v_pk_mul_f32 v[116:117], v[106:107], v[202:203] op_sel:[0,1] op_sel_hi:[1,1]
    v_pk_mul_f32 v[118:119], v[90:91], v[202:203] op_sel:[0,1] op_sel_hi:[1,1]
    v_pk_fma_f32 v[116:117], v[90:91], v[202:203], v[116:117] op_sel_hi:[1,0,1] neg_lo:[0,0,1] neg_hi:[0,0,1]
    v_pk_fma_f32 v[118:119], v[106:107], v[202:203], v[118:119] op_sel_hi:[1,0,1]
    v_cvt_pk_bf16_f32 v120, v116, -v118
    v_cvt_pk_bf16_f32 v122, v117, -v119
    ds_write_b32 v234, v120 offset:1440
    ds_write_b32 v234, v122 offset:1584
    v_fma_f32 v92, -v201, v107, v92
    v_fma_f32 v108, v201, v91, v108
    v_fma_f32 v92, v200, v91, v92
    v_fma_f32 v108, v200, v107, v108
    v_fma_f32 v93, -v201, v108, v93
    v_fma_f32 v109, v201, v92, v109
    v_fma_f32 v93, v200, v92, v93
    v_fma_f32 v109, v200, v108, v109
    v_pk_mul_f32 v[116:117], v[108:109], v[202:203] op_sel:[0,1] op_sel_hi:[1,1]
    v_pk_mul_f32 v[118:119], v[92:93], v[202:203] op_sel:[0,1] op_sel_hi:[1,1]
    v_pk_fma_f32 v[116:117], v[92:93], v[202:203], v[116:117] op_sel_hi:[1,0,1] neg_lo:[0,0,1] neg_hi:[0,0,1]
    v_pk_fma_f32 v[118:119], v[108:109], v[202:203], v[118:119] op_sel_hi:[1,0,1]
    v_cvt_pk_bf16_f32 v120, v116, -v118
    v_cvt_pk_bf16_f32 v122, v117, -v119
    ds_write_b32 v234, v120 offset:1728
    ds_write_b32 v234, v122 offset:1872
    v_fma_f32 v94, -v201, v109, v94
    v_fma_f32 v110, v201, v93, v110
    v_fma_f32 v94, v200, v93, v94
    v_fma_f32 v110, v200, v109, v110
    v_fma_f32 v95, -v201, v110, v95
    v_fma_f32 v111, v201, v94, v111
    v_fma_f32 v95, v200, v94, v95
    v_fma_f32 v111, v200, v110, v111
    v_pk_mul_f32 v[116:117], v[110:111], v[202:203] op_sel:[0,1] op_sel_hi:[1,1]
    v_pk_mul_f32 v[118:119], v[94:95], v[202:203] op_sel:[0,1] op_sel_hi:[1,1]
    v_pk_fma_f32 v[116:117], v[94:95], v[202:203], v[116:117] op_sel_hi:[1,0,1] neg_lo:[0,0,1] neg_hi:[0,0,1]
    v_pk_fma_f32 v[118:119], v[110:111], v[202:203], v[118:119] op_sel_hi:[1,0,1]
    v_cvt_pk_bf16_f32 v120, v116, -v118
    v_cvt_pk_bf16_f32 v122, v117, -v119
    ds_write_b32 v234, v120 offset:2016
    ds_write_b32 v234, v122 offset:2160
    s_waitcnt lgkmcnt(0)
    ds_read_b128 v[124:127], v235 offset:0
    ds_read_b128 v[128:131], v235 offset:64
    ds_read_b128 v[132:135], v235 offset:2304
    ds_read_b128 v[136:139], v235 offset:2368
    s_add_u32 s35, s80, 2
    s_lshl_b32 s35, s35, 13
    s_add_u32 s35, s35, s87
    s_add_u32 s35, s35, 221184
    s_add_u32 s34, s35, 4096
    s_waitcnt lgkmcnt(3)
    buffer_store_dwordx4 v[124:127], v236, s[20:23], s35 offen offset:0 sc1
    s_waitcnt lgkmcnt(2)
    buffer_store_dwordx4 v[128:131], v236, s[20:23], s34 offen offset:0 sc1
    s_waitcnt lgkmcnt(1)
    buffer_store_dwordx4 v[132:135], v236, s[20:23], s35 offen offset:1024 sc1
    s_waitcnt lgkmcnt(0)
    buffer_store_dwordx4 v[136:139], v236, s[20:23], s34 offen offset:1024 sc1
    s_lshl_b32 s80, s5, 11
    s_add_u32 s80, s80, 17072128
    s_add_u32 s83, s80, 7077888
    v_and_b32 v2, 15, v1
    v_lshlrev_b32_e64 v2, 7, v2
    s_mov_b32 s92, 0
    buffer_load_dwordx4 a[44:47], v236, s[20:23], s28 offen offset:2048 sc1
    buffer_load_dwordx4 a[48:51], v236, s[20:23], s28 offen offset:3072 sc1
    buffer_load_dwordx4 a[52:55], v0, s[20:23], s28 offen offset:0 sc1
    s_bfe_u32 s28, s24, 0x40018
    s_mul_i32 s28, s28, 5120
    s_add_u32 s28, s28, s27
    buffer_load_dwordx4 a[56:59], v236, s[20:23], s28 offen offset:0 sc1
    buffer_load_dwordx4 a[60:63], v236, s[20:23], s28 offen offset:1024 sc1
    buffer_load_dwordx4 a[64:67], v236, s[20:23], s28 offen offset:2048 sc1
    s_mov_b32 s12, s52
    s_mov_b32 s13, s53
    s_mov_b32 s14, 1280
    s_mov_b32 s15, 0x20000
    s_mov_b32 s16, s62
    s_mov_b32 s17, s63
    s_mov_b32 s18, 5242880
    s_mov_b32 s19, 0x20000
    v_mov_b32_e64 v3, v236
    v_mov_b32 v4, v0
    s_mov_b32 s74, s31
    s_lshr_b32 s34, s6, 3
    s_lshl_b32 s35, s5, 1
    s_add_u32 s35, s35, s34
    s_mul_i32 s75, s35, 94
    s_add_u32 s75, s75, s74
    s_lshl_b32 s75, s75, 12
    s_xor_b32 s82, s35, 1
    s_mul_i32 s82, s82, 94
    s_add_u32 s82, s82, s74
    s_lshl_b32 s82, s82, 12
    s_lshl_b32 s35, s35, 6
    s_lshl_b32 s32, s4, 4
    s_add_u32 s35, s35, s32
    s_and_b32 s33, s6, 7
    s_mul_i32 s33, s33, 160
    s_mul_i32 s70, s35, 1280
    s_add_u32 s70, s70, s33
    s_lshl_b32 s71, s70, 1
    s_mov_b32 s81, 0xcccd
    s_mov_b32 m0, s93
    v_add_u32 v6, 0, v1
    v_mul_lo_u32 v7, v6, s81
    v_lshrrev_b32_e64 v7, 19, v7
    v_mul_u32_u24 v8, 1120, v7
    v_lshl_add_u32 v8, v6, 4, v8
    buffer_load_dwordx4 v8, s[8:11], s70 offen offset:0 lds
    v_add_u32_e64 v6, 64, v1
    v_mul_lo_u32 v7, v6, s81
    v_lshrrev_b32_e64 v7, 19, v7
    v_mul_u32_u24 v8, 1120, v7
    v_lshl_add_u32 v8, v6, 4, v8
    v_add_u32 v8, 0xfffffc00, v8
    buffer_load_dwordx4 v8, s[8:11], s70 offen offset:1024 lds
    v_add_u32 v6, 128, v1
    v_mul_lo_u32 v7, v6, s81
    v_lshrrev_b32 v7, 19, v7
    v_mul_u32_u24 v8, 1120, v7
    v_lshl_add_u32 v8, v6, 4, v8
    v_add_u32 v8, 0xfffff800, v8
    s_mov_b32 exec_hi, 0
    buffer_load_dwordx4 v8, s[8:11], s70 offen offset:2048 lds
    s_add_u32 m0, s93, 3072
    s_mov_b32 exec_lo, 0x3ff
    buffer_load_dwordx4 v3, s[12:15], s33 offen lds
    s_mov_b64 exec, -1
    s_mov_b32 s69, 1073741824
    s_lshl_b32 s32, s6, 7
    s_add_u32 s32, s32, s80
    s_cmp_eq_u32 s4, 0
    s_cselect_b32 s32, s32, 1073741824
    v_mov_b32_e64 v14, s85
    s_waitcnt vmcnt(10)
    s_barrier
    s_mov_b64 exec, 1
    buffer_store_dword v14, off, s[20:23], s32 sc1
    s_mov_b64 exec, -1
    buffer_load_dwordx4 a[68:71], v236, s[20:23], s28 offen offset:3072 sc1
    buffer_load_dwordx4 a[72:75], v0, s[20:23], s28 offen offset:0 sc1
    s_bfe_u32 s28, s24, 0x4001c
    s_mul_i32 s28, s28, 5120
    s_add_u32 s28, s28, s27
    buffer_load_dwordx4 a[76:79], v236, s[20:23], s28 offen offset:0 sc1
    buffer_load_dwordx4 a[80:83], v236, s[20:23], s28 offen offset:1024 sc1
    buffer_load_dwordx4 a[84:87], v236, s[20:23], s28 offen offset:2048 sc1
    buffer_load_dwordx4 a[88:91], v236, s[20:23], s28 offen offset:3072 sc1
    buffer_load_dwordx4 a[92:95], v0, s[20:23], s28 offen offset:0 sc1
    s_bfe_u32 s28, s25, 0x40000
    s_mul_i32 s28, s28, 5120
    s_add_u32 s28, s28, s27
    buffer_load_dwordx4 a[96:99], v236, s[20:23], s28 offen offset:0 sc1
    buffer_load_dwordx4 a[100:103], v236, s[20:23], s28 offen offset:1024 sc1
    buffer_load_dwordx4 a[104:107], v236, s[20:23], s28 offen offset:2048 sc1
    buffer_load_dwordx4 a[108:111], v236, s[20:23], s28 offen offset:3072 sc1
    buffer_load_dwordx4 a[112:115], v0, s[20:23], s28 offen offset:0 sc1
    s_bfe_u32 s28, s25, 0x40004
    s_mul_i32 s28, s28, 5120
    s_add_u32 s28, s28, s27
    buffer_load_dwordx4 a[116:119], v236, s[20:23], s28 offen offset:0 sc1
    buffer_load_dwordx4 a[120:123], v236, s[20:23], s28 offen offset:1024 sc1
    buffer_load_dwordx4 a[124:127], v236, s[20:23], s28 offen offset:2048 sc1
    s_and_b32 s35, s35, 127
    s_lshl_b32 s35, s35, 3
    s_add_u32 s35, s35, 161792
    s_mul_i32 s34, s4, 5376
    v_lshlrev_b32_e64 v10, 3, v1
    v_add_u32 v10, s93, v10
    v_add_u32 v6, 0, v1
    v_mul_lo_u32 v7, v6, s81
    v_lshrrev_b32_e64 v7, 20, v7
    v_mul_u32_u24 v8, 20, v7
    v_sub_u32 v8, v6, v8
    v_mul_u32_u24 v9, 2560, v7
    v_lshl_add_u32 v240, v8, 4, v9
    v_mul_u32_u24 v12, 336, v7
    v_lshl_add_u32 v12, v8, 4, v12
    v_add_u32_e64 v245, s34, v12
    v_lshl_add_u32 v156, v8, 3, s93
    v_lshl_add_u32 v11, v7, 3, s35
    ds_read_b64 v[116:117], v11
    v_add_u32_e64 v6, 64, v1
    v_mul_lo_u32 v7, v6, s81
    v_lshrrev_b32_e64 v7, 20, v7
    v_mul_u32_u24 v8, 20, v7
    v_sub_u32 v8, v6, v8
    v_mul_u32_u24 v9, 2560, v7
    v_lshl_add_u32 v241, v8, 4, v9
    v_mul_u32_u24 v12, 336, v7
    v_lshl_add_u32 v12, v8, 4, v12
    v_add_u32_e64 v246, s34, v12
    v_lshl_add_u32 v157, v8, 3, s93
    v_lshl_add_u32 v11, v7, 3, s35
    ds_read_b64 v[118:119], v11
    v_add_u32 v6, 128, v1
    v_mul_lo_u32 v7, v6, s81
    v_lshrrev_b32_e64 v7, 20, v7
    v_mul_u32_u24 v8, 20, v7
    v_sub_u32 v8, v6, v8
    v_mul_u32_u24 v9, 2560, v7
    v_lshl_add_u32 v242, v8, 4, v9
    v_mul_u32_u24 v12, 336, v7
    v_lshl_add_u32 v12, v8, 4, v12
    v_add_u32_e64 v247, s34, v12
    v_lshl_add_u32 v158, v8, 3, s93
    v_lshl_add_u32 v11, v7, 3, s35
    ds_read_b64 v[120:121], v11
    v_add_u32 v6, 192, v1
    v_mul_lo_u32 v7, v6, s81
    v_lshrrev_b32_e64 v7, 20, v7
    v_mul_u32_u24 v8, 20, v7
    v_sub_u32 v8, v6, v8
    v_mul_u32_u24 v9, 2560, v7
    v_lshl_add_u32 v243, v8, 4, v9
    v_mul_u32_u24 v12, 336, v7
    v_lshl_add_u32 v12, v8, 4, v12
    v_add_u32_e64 v248, s34, v12
    v_lshl_add_u32 v159, v8, 3, s93
    v_lshl_add_u32 v11, v7, 3, s35
    ds_read_b64 v[122:123], v11
    v_add_u32 v6, 256, v1
    v_mul_lo_u32 v7, v6, s81
    v_lshrrev_b32_e64 v7, 20, v7
    v_mul_u32_u24 v8, 20, v7
    v_sub_u32 v8, v6, v8
    v_mul_u32_u24 v9, 2560, v7
    v_lshl_add_u32 v244, v8, 4, v9
    v_mul_u32_u24 v12, 336, v7
    v_lshl_add_u32 v12, v8, 4, v12
    v_add_u32_e64 v249, s34, v12
    v_lshl_add_u32 v160, v8, 3, s93
    v_lshl_add_u32 v11, v7, 3, s35
    ds_read_b64 v[124:125], v11
    v_and_b32_e64 v5, 15, v1
    v_mul_u32_u24 v5, 336, v5
    v_lshrrev_b32_e64 v6, 4, v1
    v_lshl_add_u32 v5, v6, 4, v5
    s_mul_i32 s34, s4, 21504
    v_add_u32_e64 v5, s34, v5
    v_add_u32 v13, s93, v3
    s_lshl_b32 s3, s2, 2
    s_add_u32 s3, s3, s4
    s_mul_i32 s72, s3, 5120
    s_add_u32 s72, s72, 17825792
    s_xor_b32 s3, s3, 4
    s_mul_i32 s73, s3, 5120
    s_add_u32 s73, s73, 17825792
    v_mov_b32 v250, 0xff
    s_mov_b32 s76, s85
    s_lshr_b32 s77, s76, 8
    s_add_u32 s77, s77, s76
    s_lshr_b32 s78, s76, 16
    s_add_u32 s78, s78, s76
    s_lshr_b32 s79, s76, 24
    s_add_u32 s79, s79, s76
    s_waitcnt vmcnt(16)
    ds_read_b64 v[96:97], v10 offset:0
    ds_read_b64 v[106:107], v156 offset:3072
    ds_read_b64 v[98:99], v10 offset:512
    ds_read_b64 v[108:109], v157 offset:3072
    ds_read_b64 v[100:101], v10 offset:1024
    ds_read_b64 v[110:111], v158 offset:3072
    ds_read_b64 v[102:103], v10 offset:1536
    ds_read_b64 v[112:113], v159 offset:3072
    ds_read_b64 v[104:105], v10 offset:2048
    ds_read_b64 v[114:115], v160 offset:3072
    s_waitcnt lgkmcnt(0)
    v_lshlrev_b32 v128, 16, v96
    v_and_b32_e64 v129, s86, v96
    v_lshlrev_b32 v130, 16, v97
    v_and_b32 v131, s86, v97
    v_lshlrev_b32 v132, 16, v106
    v_and_b32 v133, s86, v106
    v_lshlrev_b32 v134, 16, v107
    v_and_b32 v135, s86, v107
    v_fma_f32 v136, v128, v116, v117
    v_fma_f32 v137, v129, v116, v117
    v_fma_f32 v138, v130, v116, v117
    v_fma_f32 v139, v131, v116, v117
    v_cvt_pk_bf16_f32 v140, v136, v137
    v_cvt_pk_bf16_f32 v141, v138, v139
    v_lshlrev_b32 v136, 16, v140
    v_and_b32 v137, s86, v140
    v_lshlrev_b32 v138, 16, v141
    v_and_b32 v139, s86, v141
    v_pk_mul_f32 v[136:137], v[136:137], v[132:133]
    v_pk_mul_f32 v[138:139], v[138:139], v[134:135]
    v_cvt_pk_bf16_f32 v140, v136, v137
    v_cvt_pk_bf16_f32 v141, v138, v139
    v_lshlrev_b32 v136, 16, v140
    v_and_b32 v137, s86, v140
    v_lshlrev_b32 v138, 16, v141
    v_and_b32 v139, s86, v141
    v_pk_add_f32 v[144:145], v[128:129], v[136:137]
    v_pk_add_f32 v[146:147], v[130:131], v[138:139]
    ds_write_b128 v13, v[144:147] offset:0
    v_lshlrev_b32 v128, 16, v98
    v_and_b32 v129, s86, v98
    v_lshlrev_b32 v130, 16, v99
    v_and_b32 v131, s86, v99
    v_lshlrev_b32 v132, 16, v108
    v_and_b32 v133, s86, v108
    v_lshlrev_b32 v134, 16, v109
    v_and_b32 v135, s86, v109
    v_fma_f32 v136, v128, v118, v119
    v_fma_f32 v137, v129, v118, v119
    v_fma_f32 v138, v130, v118, v119
    v_fma_f32 v139, v131, v118, v119
    v_cvt_pk_bf16_f32 v140, v136, v137
    v_cvt_pk_bf16_f32 v141, v138, v139
    v_lshlrev_b32 v136, 16, v140
    v_and_b32 v137, s86, v140
    v_lshlrev_b32 v138, 16, v141
    v_and_b32 v139, s86, v141
    v_pk_mul_f32 v[136:137], v[136:137], v[132:133]
    v_pk_mul_f32 v[138:139], v[138:139], v[134:135]
    v_cvt_pk_bf16_f32 v140, v136, v137
    v_cvt_pk_bf16_f32 v141, v138, v139
    v_lshlrev_b32 v136, 16, v140
    v_and_b32 v137, s86, v140
    v_lshlrev_b32 v138, 16, v141
    v_and_b32 v139, s86, v141
    v_pk_add_f32 v[148:149], v[128:129], v[136:137]
    v_pk_add_f32 v[150:151], v[130:131], v[138:139]
    ds_write_b128 v13, v[148:151] offset:1024
    v_lshlrev_b32 v128, 16, v100
    v_and_b32 v129, s86, v100
    v_lshlrev_b32 v130, 16, v101
    v_and_b32 v131, s86, v101
    v_lshlrev_b32 v132, 16, v110
    v_and_b32 v133, s86, v110
    v_lshlrev_b32 v134, 16, v111
    v_and_b32 v135, s86, v111
    v_fma_f32 v136, v128, v120, v121
    v_fma_f32 v137, v129, v120, v121
    v_fma_f32 v138, v130, v120, v121
    v_fma_f32 v139, v131, v120, v121
    v_cvt_pk_bf16_f32 v140, v136, v137
    v_cvt_pk_bf16_f32 v141, v138, v139
    v_lshlrev_b32 v136, 16, v140
    v_and_b32 v137, s86, v140
    v_lshlrev_b32 v138, 16, v141
    v_and_b32 v139, s86, v141
    v_pk_mul_f32 v[136:137], v[136:137], v[132:133]
    v_pk_mul_f32 v[138:139], v[138:139], v[134:135]
    v_cvt_pk_bf16_f32 v140, v136, v137
    v_cvt_pk_bf16_f32 v141, v138, v139
    v_lshlrev_b32 v136, 16, v140
    v_and_b32 v137, s86, v140
    v_lshlrev_b32 v138, 16, v141
    v_and_b32 v139, s86, v141
    v_pk_add_f32 v[144:145], v[128:129], v[136:137]
    v_pk_add_f32 v[146:147], v[130:131], v[138:139]
    ds_write_b128 v13, v[144:147] offset:2048
    v_lshlrev_b32 v128, 16, v102
    v_and_b32 v129, s86, v102
    v_lshlrev_b32 v130, 16, v103
    v_and_b32 v131, s86, v103
    v_lshlrev_b32 v132, 16, v112
    v_and_b32 v133, s86, v112
    v_lshlrev_b32 v134, 16, v113
    v_and_b32 v135, s86, v113
    v_fma_f32 v136, v128, v122, v123
    v_fma_f32 v137, v129, v122, v123
    v_fma_f32 v138, v130, v122, v123
    v_fma_f32 v139, v131, v122, v123
    v_cvt_pk_bf16_f32 v140, v136, v137
    v_cvt_pk_bf16_f32 v141, v138, v139
    v_lshlrev_b32 v136, 16, v140
    v_and_b32 v137, s86, v140
    v_lshlrev_b32 v138, 16, v141
    v_and_b32 v139, s86, v141
    v_pk_mul_f32 v[136:137], v[136:137], v[132:133]
    v_pk_mul_f32 v[138:139], v[138:139], v[134:135]
    v_cvt_pk_bf16_f32 v140, v136, v137
    v_cvt_pk_bf16_f32 v141, v138, v139
    v_lshlrev_b32 v136, 16, v140
    v_and_b32 v137, s86, v140
    v_lshlrev_b32 v138, 16, v141
    v_and_b32 v139, s86, v141
    v_pk_add_f32 v[148:149], v[128:129], v[136:137]
    v_pk_add_f32 v[150:151], v[130:131], v[138:139]
    ds_write_b128 v13, v[148:151] offset:3072
    v_lshlrev_b32 v128, 16, v104
    v_and_b32 v129, s86, v104
    v_lshlrev_b32 v130, 16, v105
    v_and_b32 v131, s86, v105
    v_lshlrev_b32 v132, 16, v114
    v_and_b32 v133, s86, v114
    v_lshlrev_b32 v134, 16, v115
    v_and_b32 v135, s86, v115
    v_fma_f32 v136, v128, v124, v125
    v_fma_f32 v137, v129, v124, v125
    v_fma_f32 v138, v130, v124, v125
    v_fma_f32 v139, v131, v124, v125
    v_cvt_pk_bf16_f32 v140, v136, v137
    v_cvt_pk_bf16_f32 v141, v138, v139
    v_lshlrev_b32 v136, 16, v140
    v_and_b32 v137, s86, v140
    v_lshlrev_b32 v138, 16, v141
    v_and_b32 v139, s86, v141
    v_pk_mul_f32 v[136:137], v[136:137], v[132:133]
    v_pk_mul_f32 v[138:139], v[138:139], v[134:135]
    v_cvt_pk_bf16_f32 v140, v136, v137
    v_cvt_pk_bf16_f32 v141, v138, v139
    v_lshlrev_b32 v136, 16, v140
    v_and_b32 v137, s86, v140
    v_lshlrev_b32 v138, 16, v141
    v_and_b32 v139, s86, v141
    v_pk_add_f32 v[144:145], v[128:129], v[136:137]
    v_pk_add_f32 v[146:147], v[130:131], v[138:139]
    ds_write_b128 v13, v[144:147] offset:4096
    s_branch K2_START
LB_SLOW_A:
    s_sleep 2
    s_add_u32 s92, s92, 1
    s_cmp_gt_u32 s92, 100000
    s_cbranch_scc1 LB_OK_A
    v_mov_b32 v220, v232
    v_max_i32 v220, v220, v233
    buffer_load_dwordx4 v[188:191], v220, s[20:23], s35 offen sc1
    v_add_u32 v220, 0xfffffc00, v232
    v_max_i32_e64 v220, v220, v233
    buffer_load_dwordx4 v[192:195], v220, s[20:23], s35 offen sc1
    v_add_u32 v220, 0xfffff800, v232
    v_max_i32_e64 v220, v220, v233
    buffer_load_dwordx4 v[196:199], v220, s[20:23], s35 offen sc1
    v_add_u32 v220, 0xfffff400, v232
    v_max_i32_e64 v220, v220, v233
    buffer_load_dwordx4 v[200:203], v220, s[20:23], s35 offen sc1
    v_add_u32 v220, 0xfffff000, v232
    v_max_i32_e64 v220, v220, v233
    buffer_load_dwordx4 v[204:207], v220, s[20:23], s35 offen sc1
    v_add_u32 v220, 0xffffec00, v232
    v_max_i32_e64 v220, v220, v233
    buffer_load_dwordx4 v[208:211], v220, s[20:23], s35 offen sc1
    v_add_u32 v220, 0xffffe800, v232
    v_max_i32_e64 v220, v220, v233
    buffer_load_dwordx4 v[212:215], v220, s[20:23], s35 offen sc1
    v_add_u32 v220, 0xffffe400, v232
    v_max_i32_e64 v220, v220, v233
    buffer_load_dwordx4 v[216:219], v220, s[20:23], s35 offen sc1
    s_waitcnt vmcnt(0)
    v_mov_b32 v221, s85
    v_bitop3_b32 v220, v189, v191, v221 bitop3:0x7e
    v_bitop3_b32 v223, v193, v195, v221 bitop3:0x7e
    v_bitop3_b32 v222, v197, v199, v221 bitop3:0x7e
    v_or3_b32 v220, v220, v222, v223
    v_bitop3_b32 v223, v201, v203, v221 bitop3:0x7e
    v_bitop3_b32 v222, v205, v207, v221 bitop3:0x7e
    v_or3_b32 v220, v220, v222, v223
    v_bitop3_b32 v223, v209, v211, v221 bitop3:0x7e
    v_bitop3_b32 v222, v213, v215, v221 bitop3:0x7e
    v_or3_b32 v220, v220, v222, v223
    v_bitop3_b32 v223, v217, v219, v221 bitop3:0x7e
    v_or_b32_e64 v220, v220, v223
    v_cmp_ne_u32 vcc, 0, v220
    s_nop 1
    s_cbranch_vccnz LB_SLOW_A
    s_branch LB_OK_A
LB_SLOW_B:
    s_sleep 2
    s_add_u32 s92, s92, 1
    s_cmp_gt_u32 s92, 100000
    s_cbranch_scc1 LB_OK_B
    v_mov_b32 v220, v232
    v_max_i32_e64 v220, v220, v233
    buffer_load_dwordx4 v[188:191], v220, s[20:23], s35 offen sc1
    v_add_u32 v220, 0xfffffc00, v232
    v_max_i32_e64 v220, v220, v233
    buffer_load_dwordx4 v[192:195], v220, s[20:23], s35 offen sc1
    v_add_u32 v220, 0xfffff800, v232
    v_max_i32_e64 v220, v220, v233
    buffer_load_dwordx4 v[196:199], v220, s[20:23], s35 offen sc1
    v_add_u32 v220, 0xfffff400, v232
    v_max_i32_e64 v220, v220, v233
    buffer_load_dwordx4 v[200:203], v220, s[20:23], s35 offen sc1
    v_add_u32 v220, 0xfffff000, v232
    v_max_i32_e64 v220, v220, v233
    buffer_load_dwordx4 v[204:207], v220, s[20:23], s35 offen sc1
    v_add_u32 v220, 0xffffec00, v232
    v_max_i32_e64 v220, v220, v233
    buffer_load_dwordx4 v[208:211], v220, s[20:23], s35 offen sc1
    v_add_u32 v220, 0xffffe800, v232
    v_max_i32_e64 v220, v220, v233
    buffer_load_dwordx4 v[212:215], v220, s[20:23], s35 offen sc1
    v_add_u32 v220, 0xffffe400, v232
    v_max_i32_e64 v220, v220, v233
    buffer_load_dwordx4 v[216:219], v220, s[20:23], s35 offen sc1
    s_waitcnt vmcnt(0)
    v_mov_b32 v221, s85
    v_bitop3_b32 v220, v189, v191, v221 bitop3:0x7e
    v_bitop3_b32 v223, v193, v195, v221 bitop3:0x7e
    v_bitop3_b32 v222, v197, v199, v221 bitop3:0x7e
    v_or3_b32 v220, v220, v222, v223
    v_bitop3_b32 v223, v201, v203, v221 bitop3:0x7e
    v_bitop3_b32 v222, v205, v207, v221 bitop3:0x7e
    v_or3_b32 v220, v220, v222, v223
    v_bitop3_b32 v223, v209, v211, v221 bitop3:0x7e
    v_bitop3_b32 v222, v213, v215, v221 bitop3:0x7e
    v_or3_b32 v220, v220, v222, v223
    v_bitop3_b32 v223, v217, v219, v221 bitop3:0x7e
    v_or_b32_e64 v220, v220, v223
    v_cmp_ne_u32 vcc, 0, v220
    s_nop 1
    s_cbranch_vccnz LB_SLOW_B
    s_branch LB_OK_B
LB_SLOW_C0:
    s_sleep 2
    s_add_u32 s92, s92, 1
    s_cmp_gt_u32 s92, 100000
    s_cbranch_scc1 LB_OK_C0
    v_mov_b32 v144, v232
    v_max_i32_e64 v144, v144, v233
    buffer_load_dwordx4 v[112:115], v144, s[20:23], s35 offen sc1
    v_add_u32 v144, 0xfffffc00, v232
    v_max_i32_e64 v144, v144, v233
    buffer_load_dwordx4 v[116:119], v144, s[20:23], s35 offen sc1
    v_add_u32 v144, 0xfffff800, v232
    v_max_i32_e64 v144, v144, v233
    buffer_load_dwordx4 v[120:123], v144, s[20:23], s35 offen sc1
    v_add_u32 v144, 0xfffff400, v232
    v_max_i32_e64 v144, v144, v233
    buffer_load_dwordx4 v[124:127], v144, s[20:23], s35 offen sc1
    v_add_u32 v144, 0xfffff000, v232
    v_max_i32_e64 v144, v144, v233
    buffer_load_dwordx4 v[128:131], v144, s[20:23], s35 offen sc1
    v_add_u32 v144, 0xffffec00, v232
    v_max_i32_e64 v144, v144, v233
    buffer_load_dwordx4 v[132:135], v144, s[20:23], s35 offen sc1
    v_add_u32 v144, 0xffffe800, v232
    v_max_i32_e64 v144, v144, v233
    buffer_load_dwordx4 v[136:139], v144, s[20:23], s35 offen sc1
    v_add_u32 v144, 0xffffe400, v232
    v_max_i32_e64 v144, v144, v233
    buffer_load_dwordx4 v[140:143], v144, s[20:23], s35 offen sc1
    s_waitcnt vmcnt(0)
    v_mov_b32 v145, s85
    v_bitop3_b32 v144, v113, v115, v145 bitop3:0x7e
    v_bitop3_b32 v147, v117, v119, v145 bitop3:0x7e
    v_bitop3_b32 v146, v121, v123, v145 bitop3:0x7e
    v_or3_b32 v144, v144, v146, v147
    v_bitop3_b32 v147, v125, v127, v145 bitop3:0x7e
    v_bitop3_b32 v146, v129, v131, v145 bitop3:0x7e
    v_or3_b32 v144, v144, v146, v147
    v_bitop3_b32 v147, v133, v135, v145 bitop3:0x7e
    v_bitop3_b32 v146, v137, v139, v145 bitop3:0x7e
    v_or3_b32 v144, v144, v146, v147
    v_bitop3_b32 v147, v141, v143, v145 bitop3:0x7e
    v_or_b32_e64 v144, v144, v147
    v_cmp_ne_u32 vcc, 0, v144
    s_nop 1
    s_cbranch_vccnz LB_SLOW_C0
    s_branch LB_OK_C0
LB_SLOW_C1:
    s_sleep 2
    s_add_u32 s92, s92, 1
    s_cmp_gt_u32 s92, 100000
    s_cbranch_scc1 LB_OK_C1
    v_mov_b32 v144, v232
    v_max_i32_e64 v144, v144, v233
    buffer_load_dwordx4 v[112:115], v144, s[20:23], s35 offen sc1
    v_add_u32 v144, 0xfffffc00, v232
    v_max_i32_e64 v144, v144, v233
    buffer_load_dwordx4 v[116:119], v144, s[20:23], s35 offen sc1
    v_add_u32 v144, 0xfffff800, v232
    v_max_i32_e64 v144, v144, v233
    buffer_load_dwordx4 v[120:123], v144, s[20:23], s35 offen sc1
    v_add_u32 v144, 0xfffff400, v232
    v_max_i32_e64 v144, v144, v233
    buffer_load_dwordx4 v[124:127], v144, s[20:23], s35 offen sc1
    v_add_u32 v144, 0xfffff000, v232
    v_max_i32_e64 v144, v144, v233
    buffer_load_dwordx4 v[128:131], v144, s[20:23], s35 offen sc1
    v_add_u32 v144, 0xffffec00, v232
    v_max_i32_e64 v144, v144, v233
    buffer_load_dwordx4 v[132:135], v144, s[20:23], s35 offen sc1
    v_add_u32 v144, 0xffffe800, v232
    v_max_i32_e64 v144, v144, v233
    buffer_load_dwordx4 v[136:139], v144, s[20:23], s35 offen sc1
    v_add_u32 v144, 0xffffe400, v232
    v_max_i32_e64 v144, v144, v233
    buffer_load_dwordx4 v[140:143], v144, s[20:23], s35 offen sc1
    s_waitcnt vmcnt(0)
    v_mov_b32 v145, s85
    v_bitop3_b32 v144, v113, v115, v145 bitop3:0x7e
    v_bitop3_b32 v147, v117, v119, v145 bitop3:0x7e
    v_bitop3_b32 v146, v121, v123, v145 bitop3:0x7e
    v_or3_b32 v144, v144, v146, v147
    v_bitop3_b32 v147, v125, v127, v145 bitop3:0x7e
    v_bitop3_b32 v146, v129, v131, v145 bitop3:0x7e
    v_or3_b32 v144, v144, v146, v147
    v_bitop3_b32 v147, v133, v135, v145 bitop3:0x7e
    v_bitop3_b32 v146, v137, v139, v145 bitop3:0x7e
    v_or3_b32 v144, v144, v146, v147
    v_bitop3_b32 v147, v141, v143, v145 bitop3:0x7e
    v_or_b32_e64 v144, v144, v147
    v_cmp_ne_u32 vcc, 0, v144
    s_nop 1
    s_cbranch_vccnz LB_SLOW_C1
    s_branch LB_OK_C1
LB_SLOW_C2:
    s_sleep 2
    s_add_u32 s92, s92, 1
    s_cmp_gt_u32 s92, 100000
    s_cbranch_scc1 LB_OK_C2
    v_mov_b32 v144, v232
    v_max_i32_e64 v144, v144, v233
    buffer_load_dwordx4 v[112:115], v144, s[20:23], s35 offen sc1
    v_add_u32 v144, 0xfffffc00, v232
    v_max_i32_e64 v144, v144, v233
    buffer_load_dwordx4 v[116:119], v144, s[20:23], s35 offen sc1
    v_add_u32 v144, 0xfffff800, v232
    v_max_i32_e64 v144, v144, v233
    buffer_load_dwordx4 v[120:123], v144, s[20:23], s35 offen sc1
    v_add_u32 v144, 0xfffff400, v232
    v_max_i32_e64 v144, v144, v233
    buffer_load_dwordx4 v[124:127], v144, s[20:23], s35 offen sc1
    v_add_u32 v144, 0xfffff000, v232
    v_max_i32_e64 v144, v144, v233
    buffer_load_dwordx4 v[128:131], v144, s[20:23], s35 offen sc1
    v_add_u32 v144, 0xffffec00, v232
    v_max_i32_e64 v144, v144, v233
    buffer_load_dwordx4 v[132:135], v144, s[20:23], s35 offen sc1
    v_add_u32 v144, 0xffffe800, v232
    v_max_i32_e64 v144, v144, v233
    buffer_load_dwordx4 v[136:139], v144, s[20:23], s35 offen sc1
    v_add_u32 v144, 0xffffe400, v232
    v_max_i32_e64 v144, v144, v233
    buffer_load_dwordx4 v[140:143], v144, s[20:23], s35 offen sc1
    s_waitcnt vmcnt(0)
    v_mov_b32 v145, s85
    v_bitop3_b32 v144, v113, v115, v145 bitop3:0x7e
    v_bitop3_b32 v147, v117, v119, v145 bitop3:0x7e
    v_bitop3_b32 v146, v121, v123, v145 bitop3:0x7e
    v_or3_b32 v144, v144, v146, v147
    v_bitop3_b32 v147, v125, v127, v145 bitop3:0x7e
    v_bitop3_b32 v146, v129, v131, v145 bitop3:0x7e
    v_or3_b32 v144, v144, v146, v147
    v_bitop3_b32 v147, v133, v135, v145 bitop3:0x7e
    v_bitop3_b32 v146, v137, v139, v145 bitop3:0x7e
    v_or3_b32 v144, v144, v146, v147
    v_bitop3_b32 v147, v141, v143, v145 bitop3:0x7e
    v_or_b32_e64 v144, v144, v147
    v_cmp_ne_u32 vcc, 0, v144
    s_nop 1
    s_cbranch_vccnz LB_SLOW_C2
    s_branch LB_OK_C2
JF_SLOW_A:
    s_sleep 6
    s_add_u32 s30, s30, 1
    s_cmp_gt_u32 s30, 20000
    s_cbranch_scc1 JF_OK_A
    v_mov_b32 v224, s85
    s_mov_b64 exec, 0xffff
    buffer_load_dword v224, v225, s[20:23], s29 offen sc1
    s_mov_b64 exec, -1
    s_waitcnt vmcnt(0)
    v_cmp_ne_u32 vcc, s85, v224
    s_nop 1
    s_cbranch_vccnz JF_SLOW_A
    s_branch JF_OK_A
JF_SLOW_B:
    s_sleep 6
    s_add_u32 s30, s30, 1
    s_cmp_gt_u32 s30, 20000
    s_cbranch_scc1 JF_OK_B
    v_mov_b32 v224, s85
    s_mov_b64 exec, 0xffff
    buffer_load_dword v224, v225, s[20:23], s29 offen sc1
    s_mov_b64 exec, -1
    s_waitcnt vmcnt(0)
    v_cmp_ne_u32 vcc, s85, v224
    s_nop 1
    s_cbranch_vccnz JF_SLOW_B
    s_branch JF_OK_B
JF_SLOW_C:
    s_sleep 6
    s_add_u32 s30, s30, 1
    s_cmp_gt_u32 s30, 20000
    s_cbranch_scc1 JF_OK_C
    v_mov_b32_e64 v168, s85
    s_mov_b64 exec, 0xffff
    buffer_load_dword v168, v169, s[20:23], s29 offen sc1
    s_mov_b64 exec, -1
    s_waitcnt vmcnt(0)
    v_cmp_ne_u32 vcc, s85, v168
    s_nop 1
    s_cbranch_vccnz JF_SLOW_C
    s_branch JF_OK_C
K2_START:
    s_cmp_lg_u32 s4, 0
    s_cbranch_scc1 K2_GO
    s_mov_b64 exec, 0xffff
K2_RETRY:
    buffer_load_dword v15, v2, s[20:23], s80 offen sc1
    s_add_u32 s92, s92, 1
    s_waitcnt vmcnt(0)
    v_cmp_ne_u32 vcc, s85, v15
    s_nop 1
    s_cbranch_vccz K2_SEEN
    s_sleep 3
    s_cmp_lt_u32 s92, 100000
    s_cbranch_scc1 K2_RETRY
K2_SEEN:
    s_mov_b64 exec, -1
K2_GO:
    s_barrier
    s_bfe_u32 s68, s24, 0x40000
    s_lshl_b32 s68, s68, 12
    s_add_u32 s68, s68, s82
    buffer_load_dwordx4 v[176:179], v3, s[20:23], s68 offen offset:0 sc1
    buffer_load_dwordx4 v[180:183], v3, s[20:23], s68 offen offset:1024 sc1
    buffer_load_dwordx4 v[184:187], v3, s[20:23], s68 offen offset:2048 sc1
    buffer_load_dwordx4 v[188:191], v3, s[20:23], s68 offen offset:3072 sc1
    s_bfe_u32 s68, s24, 0x40004
    s_lshl_b32 s68, s68, 12
    s_add_u32 s68, s68, s82
    buffer_load_dwordx4 v[192:195], v3, s[20:23], s68 offen offset:0 sc1
    buffer_load_dwordx4 v[196:199], v3, s[20:23], s68 offen offset:1024 sc1
    buffer_load_dwordx4 v[200:203], v3, s[20:23], s68 offen offset:2048 sc1
    buffer_load_dwordx4 v[204:207], v3, s[20:23], s68 offen offset:3072 sc1
    s_bfe_u32 s68, s24, 0x40008
    s_lshl_b32 s68, s68, 12
    s_add_u32 s68, s68, s82
    buffer_load_dwordx4 v[208:211], v3, s[20:23], s68 offen offset:0 sc1
    buffer_load_dwordx4 v[212:215], v3, s[20:23], s68 offen offset:1024 sc1
    buffer_load_dwordx4 v[216:219], v3, s[20:23], s68 offen offset:2048 sc1
    buffer_load_dwordx4 v[220:223], v3, s[20:23], s68 offen offset:3072 sc1
    s_bfe_u32 s68, s24, 0x4000c
    s_lshl_b32 s68, s68, 12
    s_add_u32 s68, s68, s82
    buffer_load_dwordx4 v[224:227], v3, s[20:23], s68 offen offset:0 sc1
    buffer_load_dwordx4 v[228:231], v3, s[20:23], s68 offen offset:1024 sc1
    buffer_load_dwordx4 v[232:235], v3, s[20:23], s68 offen offset:2048 sc1
    buffer_load_dwordx4 v[236:239], v3, s[20:23], s68 offen offset:3072 sc1
    s_mov_b32 s92, 0
    s_nop 0
    s_mov_b32 s29, 0
    s_waitcnt vmcnt(12)
    v_mfma_f32_16x16x32_bf16 v[16:19], a[192:195], v[176:179], 0
    v_mfma_f32_16x16x32_bf16 v[20:23], a[192:195], v[180:183], 0
    s_bfe_u32 s68, s24, 0x40010
    s_lshl_b32 s68, s68, 12
    s_add_u32 s68, s68, s82
    buffer_load_dwordx4 a[176:179], v3, s[20:23], s68 offen offset:0 sc1
    v_mfma_f32_16x16x32_bf16 v[24:27], a[192:195], v[184:187], 0
    v_mfma_f32_16x16x32_bf16 v[28:31], a[192:195], v[188:191], 0
    buffer_load_dwordx4 a[128:131], v3, s[20:23], s28 offen offset:3072 sc1
    v_mfma_f32_16x16x32_bf16 v[32:35], a[196:199], v[176:179], 0
    v_mfma_f32_16x16x32_bf16 v[36:39], a[196:199], v[180:183], 0
    buffer_load_dwordx4 a[180:183], v3, s[20:23], s68 offen offset:1024 sc1
    v_mfma_f32_16x16x32_bf16 v[40:43], a[196:199], v[184:187], 0
    v_mfma_f32_16x16x32_bf16 v[44:47], a[196:199], v[188:191], 0
    buffer_load_dwordx4 a[132:135], v0, s[20:23], s28 offen offset:0 sc1
    v_mfma_f32_16x16x32_bf16 v[48:51], a[200:203], v[176:179], 0
    v_mfma_f32_16x16x32_bf16 v[52:55], a[200:203], v[180:183], 0
    buffer_load_dwordx4 a[184:187], v3, s[20:23], s68 offen offset:2048 sc1
    v_mfma_f32_16x16x32_bf16 v[56:59], a[200:203], v[184:187], 0
    v_mfma_f32_16x16x32_bf16 v[60:63], a[200:203], v[188:191], 0
    s_bfe_u32 s28, s25, 0x40008
    s_mul_i32 s28, s28, 5120
    s_add_u32 s28, s28, s27
    buffer_load_dwordx4 a[136:139], v3, s[20:23], s28 offen offset:0 sc1
    v_mfma_f32_16x16x32_bf16 v[64:67], a[204:207], v[176:179], 0
    v_mfma_f32_16x16x32_bf16 v[68:71], a[204:207], v[180:183], 0
    buffer_load_dwordx4 a[188:191], v3, s[20:23], s68 offen offset:3072 sc1
    v_mfma_f32_16x16x32_bf16 v[72:75], a[204:207], v[184:187], 0
    v_mfma_f32_16x16x32_bf16 v[76:79], a[204:207], v[188:191], 0
    buffer_load_dwordx4 a[140:143], v3, s[20:23], s28 offen offset:1024 sc1
    v_mfma_f32_16x16x32_bf16 v[80:83], a[208:211], v[176:179], 0
    v_mfma_f32_16x16x32_bf16 v[84:87], a[208:211], v[180:183], 0
    v_mfma_f32_16x16x32_bf16 v[88:91], a[208:211], v[184:187], 0
    v_mfma_f32_16x16x32_bf16 v[92:95], a[208:211], v[188:191], 0
    buffer_load_dwordx4 a[144:147], v3, s[20:23], s28 offen offset:2048 sc1
    s_waitcnt vmcnt(17)
    v_mfma_f32_16x16x32_bf16 v[16:19], a[212:215], v[192:195], v[16:19]
    v_mfma_f32_16x16x32_bf16 v[20:23], a[212:215], v[196:199], v[20:23]
    s_bfe_u32 s68, s24, 0x40014
    s_lshl_b32 s68, s68, 12
    s_add_u32 s68, s68, s82
    buffer_load_dwordx4 v[176:179], v3, s[20:23], s68 offen offset:0 sc1
    v_mfma_f32_16x16x32_bf16 v[24:27], a[212:215], v[200:203], v[24:27]
    v_mfma_f32_16x16x32_bf16 v[28:31], a[212:215], v[204:207], v[28:31]
    buffer_load_dwordx4 a[148:151], v3, s[20:23], s28 offen offset:3072 sc1
    v_mfma_f32_16x16x32_bf16 v[32:35], a[216:219], v[192:195], v[32:35]
    v_mfma_f32_16x16x32_bf16 v[36:39], a[216:219], v[196:199], v[36:39]
    buffer_load_dwordx4 v[180:183], v3, s[20:23], s68 offen offset:1024 sc1
    v_mfma_f32_16x16x32_bf16 v[40:43], a[216:219], v[200:203], v[40:43]
    v_mfma_f32_16x16x32_bf16 v[44:47], a[216:219], v[204:207], v[44:47]
    buffer_load_dwordx4 a[152:155], v0, s[20:23], s28 offen offset:0 sc1
    v_mfma_f32_16x16x32_bf16 v[48:51], a[220:223], v[192:195], v[48:51]
    v_mfma_f32_16x16x32_bf16 v[52:55], a[220:223], v[196:199], v[52:55]
    buffer_load_dwordx4 v[184:187], v3, s[20:23], s68 offen offset:2048 sc1
    v_mfma_f32_16x16x32_bf16 v[56:59], a[220:223], v[200:203], v[56:59]
    v_mfma_f32_16x16x32_bf16 v[60:63], a[220:223], v[204:207], v[60:63]
    s_bfe_u32 s28, s25, 0x4000c
    s_mul_i32 s28, s28, 5120
    s_add_u32 s28, s28, s27
    s_cmp_eq_u32 s4, 3
    s_cselect_b32 s28, 1073741824, s28
    buffer_load_dwordx4 a[156:159], v3, s[20:23], s28 offen offset:0 sc1
    v_mfma_f32_16x16x32_bf16 v[64:67], a[224:227], v[192:195], v[64:67]
    v_mfma_f32_16x16x32_bf16 v[68:71], a[224:227], v[196:199], v[68:71]
    buffer_load_dwordx4 v[188:191], v3, s[20:23], s68 offen offset:3072 sc1
    v_mfma_f32_16x16x32_bf16 v[72:75], a[224:227], v[200:203], v[72:75]
    v_mfma_f32_16x16x32_bf16 v[76:79], a[224:227], v[204:207], v[76:79]
    buffer_load_dwordx4 a[160:163], v3, s[20:23], s28 offen offset:1024 sc1
    v_mfma_f32_16x16x32_bf16 v[80:83], a[228:231], v[192:195], v[80:83]
    v_mfma_f32_16x16x32_bf16 v[84:87], a[228:231], v[196:199], v[84:87]
    v_mfma_f32_16x16x32_bf16 v[88:91], a[228:231], v[200:203], v[88:91]
    v_mfma_f32_16x16x32_bf16 v[92:95], a[228:231], v[204:207], v[92:95]
    buffer_load_dwordx4 a[164:167], v3, s[20:23], s28 offen offset:2048 sc1
    s_waitcnt vmcnt(22)
    v_mfma_f32_16x16x32_bf16 v[16:19], a[232:235], v[208:211], v[16:19]
    v_mfma_f32_16x16x32_bf16 v[20:23], a[232:235], v[212:215], v[20:23]
    s_bfe_u32 s68, s24, 0x40018
    s_lshl_b32 s68, s68, 12
    s_add_u32 s68, s68, s82
    buffer_load_dwordx4 v[192:195], v3, s[20:23], s68 offen offset:0 sc1
    v_mfma_f32_16x16x32_bf16 v[24:27], a[232:235], v[216:219], v[24:27]
    v_mfma_f32_16x16x32_bf16 v[28:31], a[232:235], v[220:223], v[28:31]
    buffer_load_dwordx4 a[168:171], v3, s[20:23], s28 offen offset:3072 sc1
    v_mfma_f32_16x16x32_bf16 v[32:35], a[236:239], v[208:211], v[32:35]
    v_mfma_f32_16x16x32_bf16 v[36:39], a[236:239], v[212:215], v[36:39]
    buffer_load_dwordx4 v[196:199], v3, s[20:23], s68 offen offset:1024 sc1
    v_mfma_f32_16x16x32_bf16 v[40:43], a[236:239], v[216:219], v[40:43]
    v_mfma_f32_16x16x32_bf16 v[44:47], a[236:239], v[220:223], v[44:47]
    buffer_load_dwordx4 a[172:175], v0, s[20:23], s28 offen offset:0 sc1
    v_mfma_f32_16x16x32_bf16 v[48:51], a[240:243], v[208:211], v[48:51]
    v_mfma_f32_16x16x32_bf16 v[52:55], a[240:243], v[212:215], v[52:55]
    buffer_load_dwordx4 v[200:203], v3, s[20:23], s68 offen offset:2048 sc1
    v_mfma_f32_16x16x32_bf16 v[56:59], a[240:243], v[216:219], v[56:59]
    v_mfma_f32_16x16x32_bf16 v[60:63], a[240:243], v[220:223], v[60:63]
    v_mfma_f32_16x16x32_bf16 v[64:67], a[244:247], v[208:211], v[64:67]
    v_mfma_f32_16x16x32_bf16 v[68:71], a[244:247], v[212:215], v[68:71]
    buffer_load_dwordx4 v[204:207], v3, s[20:23], s68 offen offset:3072 sc1
    v_mfma_f32_16x16x32_bf16 v[72:75], a[244:247], v[216:219], v[72:75]
    v_mfma_f32_16x16x32_bf16 v[76:79], a[244:247], v[220:223], v[76:79]
    v_mfma_f32_16x16x32_bf16 v[80:83], a[248:251], v[208:211], v[80:83]
    v_mfma_f32_16x16x32_bf16 v[84:87], a[248:251], v[212:215], v[84:87]
    v_mfma_f32_16x16x32_bf16 v[88:91], a[248:251], v[216:219], v[88:91]
    v_mfma_f32_16x16x32_bf16 v[92:95], a[248:251], v[220:223], v[92:95]
    s_waitcnt vmcnt(24)
    s_nop 0
    v_mfma_f32_16x16x32_bf16 v[16:19], a[252:255], v[224:227], v[16:19]
    v_mfma_f32_16x16x32_bf16 v[20:23], a[252:255], v[228:231], v[20:23]
    s_bfe_u32 s68, s24, 0x4001c
    s_lshl_b32 s68, s68, 12
    s_add_u32 s68, s68, s82
    buffer_load_dwordx4 v[208:211], v3, s[20:23], s68 offen offset:0 sc1
    v_mfma_f32_16x16x32_bf16 v[24:27], a[252:255], v[232:235], v[24:27]
    v_mfma_f32_16x16x32_bf16 v[28:31], a[252:255], v[236:239], v[28:31]
    v_mfma_f32_16x16x32_bf16 v[32:35], a[0:3], v[224:227], v[32:35]
    v_mfma_f32_16x16x32_bf16 v[36:39], a[0:3], v[228:231], v[36:39]
    buffer_load_dwordx4 v[212:215], v3, s[20:23], s68 offen offset:1024 sc1
    v_mfma_f32_16x16x32_bf16 v[40:43], a[0:3], v[232:235], v[40:43]
    v_mfma_f32_16x16x32_bf16 v[44:47], a[0:3], v[236:239], v[44:47]
    v_mfma_f32_16x16x32_bf16 v[48:51], a[4:7], v[224:227], v[48:51]
    v_mfma_f32_16x16x32_bf16 v[52:55], a[4:7], v[228:231], v[52:55]
    buffer_load_dwordx4 v[216:219], v3, s[20:23], s68 offen offset:2048 sc1
    v_mfma_f32_16x16x32_bf16 v[56:59], a[4:7], v[232:235], v[56:59]
    v_mfma_f32_16x16x32_bf16 v[60:63], a[4:7], v[236:239], v[60:63]
    v_mfma_f32_16x16x32_bf16 v[64:67], a[8:11], v[224:227], v[64:67]
    v_mfma_f32_16x16x32_bf16 v[68:71], a[8:11], v[228:231], v[68:71]
    buffer_load_dwordx4 v[220:223], v3, s[20:23], s68 offen offset:3072 sc1
    v_mfma_f32_16x16x32_bf16 v[72:75], a[8:11], v[232:235], v[72:75]
    v_mfma_f32_16x16x32_bf16 v[76:79], a[8:11], v[236:239], v[76:79]
    v_mfma_f32_16x16x32_bf16 v[80:83], a[12:15], v[224:227], v[80:83]
    v_mfma_f32_16x16x32_bf16 v[84:87], a[12:15], v[228:231], v[84:87]
    v_mfma_f32_16x16x32_bf16 v[88:91], a[12:15], v[232:235], v[88:91]
    v_mfma_f32_16x16x32_bf16 v[92:95], a[12:15], v[236:239], v[92:95]
    s_waitcnt vmcnt(21)
    s_nop 0
    v_mfma_f32_16x16x32_bf16 v[16:19], a[16:19], a[176:179], v[16:19]
    v_mfma_f32_16x16x32_bf16 v[20:23], a[16:19], a[180:183], v[20:23]
    s_bfe_u32 s68, s25, 0x40000
    s_lshl_b32 s68, s68, 12
    s_add_u32 s68, s68, s82
    buffer_load_dwordx4 v[224:227], v3, s[20:23], s68 offen offset:0 sc1
    v_mfma_f32_16x16x32_bf16 v[24:27], a[16:19], a[184:187], v[24:27]
    v_mfma_f32_16x16x32_bf16 v[28:31], a[16:19], a[188:191], v[28:31]
    v_mfma_f32_16x16x32_bf16 v[32:35], a[20:23], a[176:179], v[32:35]
    v_mfma_f32_16x16x32_bf16 v[36:39], a[20:23], a[180:183], v[36:39]
    buffer_load_dwordx4 v[228:231], v3, s[20:23], s68 offen offset:1024 sc1
    v_mfma_f32_16x16x32_bf16 v[40:43], a[20:23], a[184:187], v[40:43]
    v_mfma_f32_16x16x32_bf16 v[44:47], a[20:23], a[188:191], v[44:47]
    v_mfma_f32_16x16x32_bf16 v[48:51], a[24:27], a[176:179], v[48:51]
    v_mfma_f32_16x16x32_bf16 v[52:55], a[24:27], a[180:183], v[52:55]
    buffer_load_dwordx4 v[232:235], v3, s[20:23], s68 offen offset:2048 sc1
    v_mfma_f32_16x16x32_bf16 v[56:59], a[24:27], a[184:187], v[56:59]
    v_mfma_f32_16x16x32_bf16 v[60:63], a[24:27], a[188:191], v[60:63]
    v_mfma_f32_16x16x32_bf16 v[64:67], a[28:31], a[176:179], v[64:67]
    v_mfma_f32_16x16x32_bf16 v[68:71], a[28:31], a[180:183], v[68:71]
    buffer_load_dwordx4 v[236:239], v3, s[20:23], s68 offen offset:3072 sc1
    v_mfma_f32_16x16x32_bf16 v[72:75], a[28:31], a[184:187], v[72:75]
    v_mfma_f32_16x16x32_bf16 v[76:79], a[28:31], a[188:191], v[76:79]
    v_mfma_f32_16x16x32_bf16 v[80:83], a[32:35], a[176:179], v[80:83]
    v_mfma_f32_16x16x32_bf16 v[84:87], a[32:35], a[180:183], v[84:87]
    v_mfma_f32_16x16x32_bf16 v[88:91], a[32:35], a[184:187], v[88:91]
    v_mfma_f32_16x16x32_bf16 v[92:95], a[32:35], a[188:191], v[92:95]
    s_waitcnt vmcnt(16)
    s_nop 0
    v_mfma_f32_16x16x32_bf16 v[16:19], a[36:39], v[176:179], v[16:19]
    v_mfma_f32_16x16x32_bf16 v[20:23], a[36:39], v[180:183], v[20:23]
    s_bfe_u32 s68, s25, 0x40004
    s_lshl_b32 s68, s68, 12
    s_add_u32 s68, s68, s82
    buffer_load_dwordx4 a[176:179], v3, s[20:23], s68 offen offset:0 sc1
    v_mfma_f32_16x16x32_bf16 v[24:27], a[36:39], v[184:187], v[24:27]
    v_mfma_f32_16x16x32_bf16 v[28:31], a[36:39], v[188:191], v[28:31]
    v_mfma_f32_16x16x32_bf16 v[32:35], a[40:43], v[176:179], v[32:35]
    v_mfma_f32_16x16x32_bf16 v[36:39], a[40:43], v[180:183], v[36:39]
    buffer_load_dwordx4 a[180:183], v3, s[20:23], s68 offen offset:1024 sc1
    v_mfma_f32_16x16x32_bf16 v[40:43], a[40:43], v[184:187], v[40:43]
    v_mfma_f32_16x16x32_bf16 v[44:47], a[40:43], v[188:191], v[44:47]
    v_mfma_f32_16x16x32_bf16 v[48:51], a[44:47], v[176:179], v[48:51]
    v_mfma_f32_16x16x32_bf16 v[52:55], a[44:47], v[180:183], v[52:55]
    buffer_load_dwordx4 a[184:187], v3, s[20:23], s68 offen offset:2048 sc1
    v_mfma_f32_16x16x32_bf16 v[56:59], a[44:47], v[184:187], v[56:59]
    v_mfma_f32_16x16x32_bf16 v[60:63], a[44:47], v[188:191], v[60:63]
    v_mfma_f32_16x16x32_bf16 v[64:67], a[48:51], v[176:179], v[64:67]
    v_mfma_f32_16x16x32_bf16 v[68:71], a[48:51], v[180:183], v[68:71]
    buffer_load_dwordx4 a[188:191], v3, s[20:23], s68 offen offset:3072 sc1
    v_mfma_f32_16x16x32_bf16 v[72:75], a[48:51], v[184:187], v[72:75]
    v_mfma_f32_16x16x32_bf16 v[76:79], a[48:51], v[188:191], v[76:79]
    v_mfma_f32_16x16x32_bf16 v[80:83], a[52:55], v[176:179], v[80:83]
    v_mfma_f32_16x16x32_bf16 v[84:87], a[52:55], v[180:183], v[84:87]
    v_mfma_f32_16x16x32_bf16 v[88:91], a[52:55], v[184:187], v[88:91]
    v_mfma_f32_16x16x32_bf16 v[92:95], a[52:55], v[188:191], v[92:95]
    s_waitcnt vmcnt(12)
    s_nop 0
    v_mfma_f32_16x16x32_bf16 v[16:19], a[56:59], v[192:195], v[16:19]
    v_mfma_f32_16x16x32_bf16 v[20:23], a[56:59], v[196:199], v[20:23]
    s_bfe_u32 s68, s25, 0x40008
    s_lshl_b32 s68, s68, 12
    s_add_u32 s68, s68, s82
    buffer_load_dwordx4 v[176:179], v3, s[20:23], s68 offen offset:0 sc1
    v_mfma_f32_16x16x32_bf16 v[24:27], a[56:59], v[200:203], v[24:27]
    v_mfma_f32_16x16x32_bf16 v[28:31], a[56:59], v[204:207], v[28:31]
    v_mfma_f32_16x16x32_bf16 v[32:35], a[60:63], v[192:195], v[32:35]
    v_mfma_f32_16x16x32_bf16 v[36:39], a[60:63], v[196:199], v[36:39]
    buffer_load_dwordx4 v[180:183], v3, s[20:23], s68 offen offset:1024 sc1
    v_mfma_f32_16x16x32_bf16 v[40:43], a[60:63], v[200:203], v[40:43]
    v_mfma_f32_16x16x32_bf16 v[44:47], a[60:63], v[204:207], v[44:47]
    v_mfma_f32_16x16x32_bf16 v[48:51], a[64:67], v[192:195], v[48:51]
    v_mfma_f32_16x16x32_bf16 v[52:55], a[64:67], v[196:199], v[52:55]
    buffer_load_dwordx4 v[184:187], v3, s[20:23], s68 offen offset:2048 sc1
    v_mfma_f32_16x16x32_bf16 v[56:59], a[64:67], v[200:203], v[56:59]
    v_mfma_f32_16x16x32_bf16 v[60:63], a[64:67], v[204:207], v[60:63]
    v_mfma_f32_16x16x32_bf16 v[64:67], a[68:71], v[192:195], v[64:67]
    v_mfma_f32_16x16x32_bf16 v[68:71], a[68:71], v[196:199], v[68:71]
    buffer_load_dwordx4 v[188:191], v3, s[20:23], s68 offen offset:3072 sc1
    v_mfma_f32_16x16x32_bf16 v[72:75], a[68:71], v[200:203], v[72:75]
    v_mfma_f32_16x16x32_bf16 v[76:79], a[68:71], v[204:207], v[76:79]
    v_mfma_f32_16x16x32_bf16 v[80:83], a[72:75], v[192:195], v[80:83]
    v_mfma_f32_16x16x32_bf16 v[84:87], a[72:75], v[196:199], v[84:87]
    v_mfma_f32_16x16x32_bf16 v[88:91], a[72:75], v[200:203], v[88:91]
    v_mfma_f32_16x16x32_bf16 v[92:95], a[72:75], v[204:207], v[92:95]
    s_waitcnt vmcnt(12)
    s_nop 0
    v_mfma_f32_16x16x32_bf16 v[16:19], a[76:79], v[208:211], v[16:19]
    v_mfma_f32_16x16x32_bf16 v[20:23], a[76:79], v[212:215], v[20:23]
    s_bfe_u32 s68, s25, 0x4000c
    s_lshl_b32 s68, s68, 12
    s_add_u32 s68, s68, s82
    s_cmp_eq_u32 s4, 3
    s_cselect_b32 s68, s69, s68
    buffer_load_dwordx4 v[192:195], v3, s[20:23], s68 offen offset:0 sc1
    v_mfma_f32_16x16x32_bf16 v[24:27], a[76:79], v[216:219], v[24:27]
    v_mfma_f32_16x16x32_bf16 v[28:31], a[76:79], v[220:223], v[28:31]
    v_mfma_f32_16x16x32_bf16 v[32:35], a[80:83], v[208:211], v[32:35]
    v_mfma_f32_16x16x32_bf16 v[36:39], a[80:83], v[212:215], v[36:39]
    buffer_load_dwordx4 v[196:199], v3, s[20:23], s68 offen offset:1024 sc1
    v_mfma_f32_16x16x32_bf16 v[40:43], a[80:83], v[216:219], v[40:43]
    v_mfma_f32_16x16x32_bf16 v[44:47], a[80:83], v[220:223], v[44:47]
    v_mfma_f32_16x16x32_bf16 v[48:51], a[84:87], v[208:211], v[48:51]
    v_mfma_f32_16x16x32_bf16 v[52:55], a[84:87], v[212:215], v[52:55]
    buffer_load_dwordx4 v[200:203], v3, s[20:23], s68 offen offset:2048 sc1
    v_mfma_f32_16x16x32_bf16 v[56:59], a[84:87], v[216:219], v[56:59]
    v_mfma_f32_16x16x32_bf16 v[60:63], a[84:87], v[220:223], v[60:63]
    v_mfma_f32_16x16x32_bf16 v[64:67], a[88:91], v[208:211], v[64:67]
    v_mfma_f32_16x16x32_bf16 v[68:71], a[88:91], v[212:215], v[68:71]
    buffer_load_dwordx4 v[204:207], v3, s[20:23], s68 offen offset:3072 sc1
    v_mfma_f32_16x16x32_bf16 v[72:75], a[88:91], v[216:219], v[72:75]
    v_mfma_f32_16x16x32_bf16 v[76:79], a[88:91], v[220:223], v[76:79]
    v_mfma_f32_16x16x32_bf16 v[80:83], a[92:95], v[208:211], v[80:83]
    v_mfma_f32_16x16x32_bf16 v[84:87], a[92:95], v[212:215], v[84:87]
    v_mfma_f32_16x16x32_bf16 v[88:91], a[92:95], v[216:219], v[88:91]
    v_mfma_f32_16x16x32_bf16 v[92:95], a[92:95], v[220:223], v[92:95]
    s_waitcnt vmcnt(12)
    s_nop 0
    v_mfma_f32_16x16x32_bf16 v[16:19], a[96:99], v[224:227], v[16:19]
    v_mfma_f32_16x16x32_bf16 v[20:23], a[96:99], v[228:231], v[20:23]
    s_bfe_u32 s68, s24, 0x40000
    s_lshl_b32 s68, s68, 12
    s_add_u32 s68, s68, s75
    buffer_load_dwordx4 v[208:211], v3, s[20:23], s68 offen offset:0 sc1
    v_mfma_f32_16x16x32_bf16 v[24:27], a[96:99], v[232:235], v[24:27]
    v_mfma_f32_16x16x32_bf16 v[28:31], a[96:99], v[236:239], v[28:31]
    v_mfma_f32_16x16x32_bf16 v[32:35], a[100:103], v[224:227], v[32:35]
    v_mfma_f32_16x16x32_bf16 v[36:39], a[100:103], v[228:231], v[36:39]
    buffer_load_dwordx4 v[212:215], v3, s[20:23], s68 offen offset:1024 sc1
    v_mfma_f32_16x16x32_bf16 v[40:43], a[100:103], v[232:235], v[40:43]
    v_mfma_f32_16x16x32_bf16 v[44:47], a[100:103], v[236:239], v[44:47]
    v_mfma_f32_16x16x32_bf16 v[48:51], a[104:107], v[224:227], v[48:51]
    v_mfma_f32_16x16x32_bf16 v[52:55], a[104:107], v[228:231], v[52:55]
    buffer_load_dwordx4 v[216:219], v3, s[20:23], s68 offen offset:2048 sc1
    v_mfma_f32_16x16x32_bf16 v[56:59], a[104:107], v[232:235], v[56:59]
    v_mfma_f32_16x16x32_bf16 v[60:63], a[104:107], v[236:239], v[60:63]
    v_mfma_f32_16x16x32_bf16 v[64:67], a[108:111], v[224:227], v[64:67]
    v_mfma_f32_16x16x32_bf16 v[68:71], a[108:111], v[228:231], v[68:71]
    buffer_load_dwordx4 v[220:223], v3, s[20:23], s68 offen offset:3072 sc1
    v_mfma_f32_16x16x32_bf16 v[72:75], a[108:111], v[232:235], v[72:75]
    v_mfma_f32_16x16x32_bf16 v[76:79], a[108:111], v[236:239], v[76:79]
    v_mfma_f32_16x16x32_bf16 v[80:83], a[112:115], v[224:227], v[80:83]
    v_mfma_f32_16x16x32_bf16 v[84:87], a[112:115], v[228:231], v[84:87]
    v_mfma_f32_16x16x32_bf16 v[88:91], a[112:115], v[232:235], v[88:91]
    v_mfma_f32_16x16x32_bf16 v[92:95], a[112:115], v[236:239], v[92:95]
    s_waitcnt vmcnt(12)
    s_nop 0
    v_mfma_f32_16x16x32_bf16 v[16:19], a[116:119], a[176:179], v[16:19]
    v_mfma_f32_16x16x32_bf16 v[20:23], a[116:119], a[180:183], v[20:23]
    s_bfe_u32 s68, s24, 0x40004
    s_lshl_b32 s68, s68, 12
    s_add_u32 s68, s68, s75
    buffer_load_dwordx4 v[224:227], v3, s[20:23], s68 offen offset:0 sc1
    v_mfma_f32_16x16x32_bf16 v[24:27], a[116:119], a[184:187], v[24:27]
    v_mfma_f32_16x16x32_bf16 v[28:31], a[116:119], a[188:191], v[28:31]
    v_mfma_f32_16x16x32_bf16 v[32:35], a[120:123], a[176:179], v[32:35]
    v_mfma_f32_16x16x32_bf16 v[36:39], a[120:123], a[180:183], v[36:39]
    buffer_load_dwordx4 v[228:231], v3, s[20:23], s68 offen offset:1024 sc1
    v_mfma_f32_16x16x32_bf16 v[40:43], a[120:123], a[184:187], v[40:43]
    v_mfma_f32_16x16x32_bf16 v[44:47], a[120:123], a[188:191], v[44:47]
    v_mfma_f32_16x16x32_bf16 v[48:51], a[124:127], a[176:179], v[48:51]
    v_mfma_f32_16x16x32_bf16 v[52:55], a[124:127], a[180:183], v[52:55]
    buffer_load_dwordx4 v[232:235], v3, s[20:23], s68 offen offset:2048 sc1
    v_mfma_f32_16x16x32_bf16 v[56:59], a[124:127], a[184:187], v[56:59]
    v_mfma_f32_16x16x32_bf16 v[60:63], a[124:127], a[188:191], v[60:63]
    v_mfma_f32_16x16x32_bf16 v[64:67], a[128:131], a[176:179], v[64:67]
    v_mfma_f32_16x16x32_bf16 v[68:71], a[128:131], a[180:183], v[68:71]
    buffer_load_dwordx4 v[236:239], v3, s[20:23], s68 offen offset:3072 sc1
    v_mfma_f32_16x16x32_bf16 v[72:75], a[128:131], a[184:187], v[72:75]
    v_mfma_f32_16x16x32_bf16 v[76:79], a[128:131], a[188:191], v[76:79]
    v_mfma_f32_16x16x32_bf16 v[80:83], a[132:135], a[176:179], v[80:83]
    v_mfma_f32_16x16x32_bf16 v[84:87], a[132:135], a[180:183], v[84:87]
    v_mfma_f32_16x16x32_bf16 v[88:91], a[132:135], a[184:187], v[88:91]
    v_mfma_f32_16x16x32_bf16 v[92:95], a[132:135], a[188:191], v[92:95]
    s_waitcnt vmcnt(12)
    s_nop 0
    v_mfma_f32_16x16x32_bf16 v[16:19], a[136:139], v[176:179], v[16:19]
    v_mfma_f32_16x16x32_bf16 v[20:23], a[136:139], v[180:183], v[20:23]
    s_bfe_u32 s68, s24, 0x40008
    s_lshl_b32 s68, s68, 12
    s_add_u32 s68, s68, s75
    buffer_load_dwordx4 a[176:179], v3, s[20:23], s68 offen offset:0 sc1
    v_mfma_f32_16x16x32_bf16 v[24:27], a[136:139], v[184:187], v[24:27]
    v_mfma_f32_16x16x32_bf16 v[28:31], a[136:139], v[188:191], v[28:31]
    v_mfma_f32_16x16x32_bf16 v[32:35], a[140:143], v[176:179], v[32:35]
    v_mfma_f32_16x16x32_bf16 v[36:39], a[140:143], v[180:183], v[36:39]
    buffer_load_dwordx4 a[180:183], v3, s[20:23], s68 offen offset:1024 sc1
    v_mfma_f32_16x16x32_bf16 v[40:43], a[140:143], v[184:187], v[40:43]
    v_mfma_f32_16x16x32_bf16 v[44:47], a[140:143], v[188:191], v[44:47]
    v_mfma_f32_16x16x32_bf16 v[48:51], a[144:147], v[176:179], v[48:51]
    v_mfma_f32_16x16x32_bf16 v[52:55], a[144:147], v[180:183], v[52:55]
    buffer_load_dwordx4 a[184:187], v3, s[20:23], s68 offen offset:2048 sc1
    v_mfma_f32_16x16x32_bf16 v[56:59], a[144:147], v[184:187], v[56:59]
    v_mfma_f32_16x16x32_bf16 v[60:63], a[144:147], v[188:191], v[60:63]
    v_mfma_f32_16x16x32_bf16 v[64:67], a[148:151], v[176:179], v[64:67]
    v_mfma_f32_16x16x32_bf16 v[68:71], a[148:151], v[180:183], v[68:71]
    buffer_load_dwordx4 a[188:191], v3, s[20:23], s68 offen offset:3072 sc1
    v_mfma_f32_16x16x32_bf16 v[72:75], a[148:151], v[184:187], v[72:75]
    v_mfma_f32_16x16x32_bf16 v[76:79], a[148:151], v[188:191], v[76:79]
    v_mfma_f32_16x16x32_bf16 v[80:83], a[152:155], v[176:179], v[80:83]
    v_mfma_f32_16x16x32_bf16 v[84:87], a[152:155], v[180:183], v[84:87]
    v_mfma_f32_16x16x32_bf16 v[88:91], a[152:155], v[184:187], v[88:91]
    v_mfma_f32_16x16x32_bf16 v[92:95], a[152:155], v[188:191], v[92:95]
    s_waitcnt vmcnt(12)
    s_nop 0
    v_mfma_f32_16x16x32_bf16 v[16:19], a[156:159], v[192:195], v[16:19]
    v_mfma_f32_16x16x32_bf16 v[20:23], a[156:159], v[196:199], v[20:23]
    s_bfe_u32 s68, s24, 0x4000c
    s_lshl_b32 s68, s68, 12
    s_add_u32 s68, s68, s75
    buffer_load_dwordx4 v[176:179], v3, s[20:23], s68 offen offset:0 sc1
    v_mfma_f32_16x16x32_bf16 v[24:27], a[156:159], v[200:203], v[24:27]
    v_mfma_f32_16x16x32_bf16 v[28:31], a[156:159], v[204:207], v[28:31]
    v_mfma_f32_16x16x32_bf16 v[32:35], a[160:163], v[192:195], v[32:35]
    v_mfma_f32_16x16x32_bf16 v[36:39], a[160:163], v[196:199], v[36:39]
    buffer_load_dwordx4 v[180:183], v3, s[20:23], s68 offen offset:1024 sc1
    v_mfma_f32_16x16x32_bf16 v[40:43], a[160:163], v[200:203], v[40:43]
    v_mfma_f32_16x16x32_bf16 v[44:47], a[160:163], v[204:207], v[44:47]
    v_mfma_f32_16x16x32_bf16 v[48:51], a[164:167], v[192:195], v[48:51]
    v_mfma_f32_16x16x32_bf16 v[52:55], a[164:167], v[196:199], v[52:55]
    buffer_load_dwordx4 v[184:187], v3, s[20:23], s68 offen offset:2048 sc1
    v_mfma_f32_16x16x32_bf16 v[56:59], a[164:167], v[200:203], v[56:59]
    v_mfma_f32_16x16x32_bf16 v[60:63], a[164:167], v[204:207], v[60:63]
    v_mfma_f32_16x16x32_bf16 v[64:67], a[168:171], v[192:195], v[64:67]
    v_mfma_f32_16x16x32_bf16 v[68:71], a[168:171], v[196:199], v[68:71]
    buffer_load_dwordx4 v[188:191], v3, s[20:23], s68 offen offset:3072 sc1
    v_mfma_f32_16x16x32_bf16 v[72:75], a[168:171], v[200:203], v[72:75]
    v_mfma_f32_16x16x32_bf16 v[76:79], a[168:171], v[204:207], v[76:79]
    v_mfma_f32_16x16x32_bf16 v[80:83], a[172:175], v[192:195], v[80:83]
    v_mfma_f32_16x16x32_bf16 v[84:87], a[172:175], v[196:199], v[84:87]
    v_mfma_f32_16x16x32_bf16 v[88:91], a[172:175], v[200:203], v[88:91]
    v_mfma_f32_16x16x32_bf16 v[92:95], a[172:175], v[204:207], v[92:95]
    s_waitcnt vmcnt(12)
    s_nop 0
    v_mfma_f32_16x16x32_bf16 v[96:99], a[192:195], v[208:211], 0
    ds_write_b128 v5, v[16:19] offset:0
    v_mfma_f32_16x16x32_bf16 v[100:103], a[192:195], v[212:215], 0
    s_bfe_u32 s68, s24, 0x40010
    s_lshl_b32 s68, s68, 12
    s_add_u32 s68, s68, s75
    buffer_load_dwordx4 v[192:195], v3, s[20:23], s68 offen offset:0 sc1
    v_mfma_f32_16x16x32_bf16 v[104:107], a[192:195], v[216:219], 0
    ds_write_b128 v5, v[20:23] offset:5376
    v_mfma_f32_16x16x32_bf16 v[108:111], a[192:195], v[220:223], 0
    v_mfma_f32_16x16x32_bf16 v[112:115], a[196:199], v[208:211], 0
    ds_write_b128 v5, v[24:27] offset:10752
    v_mfma_f32_16x16x32_bf16 v[116:119], a[196:199], v[212:215], 0
    buffer_load_dwordx4 v[196:199], v3, s[20:23], s68 offen offset:1024 sc1
    v_mfma_f32_16x16x32_bf16 v[120:123], a[196:199], v[216:219], 0
    ds_write_b128 v5, v[28:31] offset:16128
    v_mfma_f32_16x16x32_bf16 v[124:127], a[196:199], v[220:223], 0
    v_mfma_f32_16x16x32_bf16 v[128:131], a[200:203], v[208:211], 0
    ds_write_b128 v5, v[32:35] offset:64
    v_mfma_f32_16x16x32_bf16 v[132:135], a[200:203], v[212:215], 0
    buffer_load_dwordx4 v[200:203], v3, s[20:23], s68 offen offset:2048 sc1
    v_mfma_f32_16x16x32_bf16 v[136:139], a[200:203], v[216:219], 0
    ds_write_b128 v5, v[36:39] offset:5440
    v_mfma_f32_16x16x32_bf16 v[140:143], a[200:203], v[220:223], 0
    v_mfma_f32_16x16x32_bf16 v[144:147], a[204:207], v[208:211], 0
    ds_write_b128 v5, v[40:43] offset:10816
    v_mfma_f32_16x16x32_bf16 v[148:151], a[204:207], v[212:215], 0
    buffer_load_dwordx4 v[204:207], v3, s[20:23], s68 offen offset:3072 sc1
    v_mfma_f32_16x16x32_bf16 v[152:155], a[204:207], v[216:219], 0
    ds_write_b128 v5, v[44:47] offset:16192
    v_mfma_f32_16x16x32_bf16 v[156:159], a[204:207], v[220:223], 0
    v_mfma_f32_16x16x32_bf16 v[160:163], a[208:211], v[208:211], 0
    ds_write_b128 v5, v[48:51] offset:128
    v_mfma_f32_16x16x32_bf16 v[164:167], a[208:211], v[212:215], 0
    v_mfma_f32_16x16x32_bf16 v[168:171], a[208:211], v[216:219], 0
    ds_write_b128 v5, v[52:55] offset:5504
    v_mfma_f32_16x16x32_bf16 v[172:175], a[208:211], v[220:223], 0
    s_waitcnt vmcnt(12)
    s_nop 0
    v_mfma_f32_16x16x32_bf16 v[96:99], a[212:215], v[224:227], v[96:99]
    ds_write_b128 v5, v[56:59] offset:10880
    v_mfma_f32_16x16x32_bf16 v[100:103], a[212:215], v[228:231], v[100:103]
    s_bfe_u32 s68, s24, 0x40014
    s_lshl_b32 s68, s68, 12
    s_add_u32 s68, s68, s75
    buffer_load_dwordx4 v[208:211], v3, s[20:23], s68 offen offset:0 sc1
    v_mfma_f32_16x16x32_bf16 v[104:107], a[212:215], v[232:235], v[104:107]
    ds_write_b128 v5, v[60:63] offset:16256
    v_mfma_f32_16x16x32_bf16 v[108:111], a[212:215], v[236:239], v[108:111]
    v_mfma_f32_16x16x32_bf16 v[112:115], a[216:219], v[224:227], v[112:115]
    ds_write_b128 v5, v[64:67] offset:192
    v_mfma_f32_16x16x32_bf16 v[116:119], a[216:219], v[228:231], v[116:119]
    buffer_load_dwordx4 v[212:215], v3, s[20:23], s68 offen offset:1024 sc1
    v_mfma_f32_16x16x32_bf16 v[120:123], a[216:219], v[232:235], v[120:123]
    ds_write_b128 v5, v[68:71] offset:5568
    v_mfma_f32_16x16x32_bf16 v[124:127], a[216:219], v[236:239], v[124:127]
    v_mfma_f32_16x16x32_bf16 v[128:131], a[220:223], v[224:227], v[128:131]
    ds_write_b128 v5, v[72:75] offset:10944
    v_mfma_f32_16x16x32_bf16 v[132:135], a[220:223], v[228:231], v[132:135]
    buffer_load_dwordx4 v[216:219], v3, s[20:23], s68 offen offset:2048 sc1
    v_mfma_f32_16x16x32_bf16 v[136:139], a[220:223], v[232:235], v[136:139]
    ds_write_b128 v5, v[76:79] offset:16320
    v_mfma_f32_16x16x32_bf16 v[140:143], a[220:223], v[236:239], v[140:143]
    v_mfma_f32_16x16x32_bf16 v[144:147], a[224:227], v[224:227], v[144:147]
    ds_write_b128 v5, v[80:83] offset:256
    v_mfma_f32_16x16x32_bf16 v[148:151], a[224:227], v[228:231], v[148:151]
    buffer_load_dwordx4 v[220:223], v3, s[20:23], s68 offen offset:3072 sc1
    v_mfma_f32_16x16x32_bf16 v[152:155], a[224:227], v[232:235], v[152:155]
    ds_write_b128 v5, v[84:87] offset:5632
    v_mfma_f32_16x16x32_bf16 v[156:159], a[224:227], v[236:239], v[156:159]
    v_mfma_f32_16x16x32_bf16 v[160:163], a[228:231], v[224:227], v[160:163]
    ds_write_b128 v5, v[88:91] offset:11008
    v_mfma_f32_16x16x32_bf16 v[164:167], a[228:231], v[228:231], v[164:167]
    v_mfma_f32_16x16x32_bf16 v[168:171], a[228:231], v[232:235], v[168:171]
    ds_write_b128 v5, v[92:95] offset:16384
    v_mfma_f32_16x16x32_bf16 v[172:175], a[228:231], v[236:239], v[172:175]
    s_waitcnt vmcnt(12)
    s_nop 0
    v_mfma_f32_16x16x32_bf16 v[96:99], a[232:235], a[176:179], v[96:99]
    v_mfma_f32_16x16x32_bf16 v[100:103], a[232:235], a[180:183], v[100:103]
    s_bfe_u32 s68, s24, 0x40018
    s_lshl_b32 s68, s68, 12
    s_add_u32 s68, s68, s75
    buffer_load_dwordx4 v[224:227], v3, s[20:23], s68 offen offset:0 sc1
    v_mfma_f32_16x16x32_bf16 v[104:107], a[232:235], a[184:187], v[104:107]
    v_mfma_f32_16x16x32_bf16 v[108:111], a[232:235], a[188:191], v[108:111]
    v_mfma_f32_16x16x32_bf16 v[112:115], a[236:239], a[176:179], v[112:115]
    s_waitcnt lgkmcnt(0)
    s_barrier
    v_mfma_f32_16x16x32_bf16 v[116:119], a[236:239], a[180:183], v[116:119]
    buffer_load_dwordx4 v[228:231], v3, s[20:23], s68 offen offset:1024 sc1
    v_mfma_f32_16x16x32_bf16 v[120:123], a[236:239], a[184:187], v[120:123]
    ds_read_b128 v[16:19], v245 offset:0
    ds_read_b128 v[20:23], v245 offset:21504
    v_mfma_f32_16x16x32_bf16 v[124:127], a[236:239], a[188:191], v[124:127]
    ds_read_b128 v[24:27], v245 offset:43008
    ds_read_b128 v[28:31], v245 offset:64512
    v_mfma_f32_16x16x32_bf16 v[128:131], a[240:243], a[176:179], v[128:131]
    ds_read_b128 v[32:35], v246 offset:0
    ds_read_b128 v[36:39], v246 offset:21504
    v_mfma_f32_16x16x32_bf16 v[132:135], a[240:243], a[180:183], v[132:135]
    buffer_load_dwordx4 v[232:235], v3, s[20:23], s68 offen offset:2048 sc1
    v_mfma_f32_16x16x32_bf16 v[136:139], a[240:243], a[184:187], v[136:139]
    ds_read_b128 v[40:43], v246 offset:43008
    ds_read_b128 v[44:47], v246 offset:64512
    v_mfma_f32_16x16x32_bf16 v[140:143], a[240:243], a[188:191], v[140:143]
    ds_read_b128 v[48:51], v247 offset:0
    ds_read_b128 v[52:55], v247 offset:21504
    v_mfma_f32_16x16x32_bf16 v[144:147], a[244:247], a[176:179], v[144:147]
    ds_read_b128 v[56:59], v247 offset:43008
    ds_read_b128 v[60:63], v247 offset:64512
    v_mfma_f32_16x16x32_bf16 v[148:151], a[244:247], a[180:183], v[148:151]
    buffer_load_dwordx4 v[236:239], v3, s[20:23], s68 offen offset:3072 sc1
    v_mfma_f32_16x16x32_bf16 v[152:155], a[244:247], a[184:187], v[152:155]
    ds_read_b128 v[64:67], v248 offset:0
    ds_read_b128 v[68:71], v248 offset:21504
    v_mfma_f32_16x16x32_bf16 v[156:159], a[244:247], a[188:191], v[156:159]
    ds_read_b128 v[72:75], v248 offset:43008
    ds_read_b128 v[76:79], v248 offset:64512
    v_mfma_f32_16x16x32_bf16 v[160:163], a[248:251], a[176:179], v[160:163]
    ds_read_b128 v[80:83], v249 offset:0
    ds_read_b128 v[84:87], v249 offset:21504
    v_mfma_f32_16x16x32_bf16 v[164:167], a[248:251], a[180:183], v[164:167]
    ds_read_b128 v[88:91], v249 offset:43008
    ds_read_b128 v[92:95], v249 offset:64512
    v_mfma_f32_16x16x32_bf16 v[168:171], a[248:251], a[184:187], v[168:171]
    s_waitcnt lgkmcnt(15)
    v_add_f32 v16, v16, v20
    v_mfma_f32_16x16x32_bf16 v[172:175], a[248:251], a[188:191], v[172:175]
    v_add_f32_e64 v24, v24, v28
    v_add_f32 v17, v17, v21
    s_waitcnt vmcnt(12)
    v_mfma_f32_16x16x32_bf16 v[96:99], a[252:255], v[176:179], v[96:99]
    v_add_f32 v25, v25, v29
    v_add_f32 v18, v18, v22
    v_mfma_f32_16x16x32_bf16 v[100:103], a[252:255], v[180:183], v[100:103]
    s_bfe_u32 s68, s24, 0x4001c
    s_lshl_b32 s68, s68, 12
    s_add_u32 s68, s68, s75
    buffer_load_dwordx4 a[176:179], v3, s[20:23], s68 offen offset:0 sc1
    v_mfma_f32_16x16x32_bf16 v[104:107], a[252:255], v[184:187], v[104:107]
    v_add_f32 v26, v26, v30
    v_add_f32 v19, v19, v23
    v_mfma_f32_16x16x32_bf16 v[108:111], a[252:255], v[188:191], v[108:111]
    v_add_f32 v27, v27, v31
    v_add_f32 v16, v16, v24
    v_mfma_f32_16x16x32_bf16 v[112:115], a[0:3], v[176:179], v[112:115]
    v_add_f32 v17, v17, v25
    v_add_f32 v18, v18, v26
    v_mfma_f32_16x16x32_bf16 v[116:119], a[0:3], v[180:183], v[116:119]
    buffer_load_dwordx4 a[180:183], v3, s[20:23], s68 offen offset:1024 sc1
    v_mfma_f32_16x16x32_bf16 v[120:123], a[0:3], v[184:187], v[120:123]
    v_add_f32_e64 v19, v19, v27
    v_bfi_b32 v16, v250, s76, v16
    v_mfma_f32_16x16x32_bf16 v[124:127], a[0:3], v[188:191], v[124:127]
    v_bfi_b32 v17, v250, s77, v17
    v_bfi_b32 v18, v250, s78, v18
    v_mfma_f32_16x16x32_bf16 v[128:131], a[4:7], v[176:179], v[128:131]
    v_bfi_b32 v19, v250, s79, v19
    buffer_store_dwordx4 v[16:19], v3, s[20:23], s72 offen offset:0 sc1
    v_mfma_f32_16x16x32_bf16 v[132:135], a[4:7], v[180:183], v[132:135]
    buffer_load_dwordx4 a[184:187], v3, s[20:23], s68 offen offset:2048 sc1
    v_mfma_f32_16x16x32_bf16 v[136:139], a[4:7], v[184:187], v[136:139]
    s_waitcnt lgkmcnt(12)
    v_add_f32 v32, v32, v36
    v_mfma_f32_16x16x32_bf16 v[140:143], a[4:7], v[188:191], v[140:143]
    v_add_f32 v40, v40, v44
    v_add_f32 v33, v33, v37
    v_mfma_f32_16x16x32_bf16 v[144:147], a[8:11], v[176:179], v[144:147]
    v_add_f32 v41, v41, v45
    v_add_f32 v34, v34, v38
    v_mfma_f32_16x16x32_bf16 v[148:151], a[8:11], v[180:183], v[148:151]
    buffer_load_dwordx4 a[188:191], v3, s[20:23], s68 offen offset:3072 sc1
    v_mfma_f32_16x16x32_bf16 v[152:155], a[8:11], v[184:187], v[152:155]
    v_add_f32 v42, v42, v46
    v_add_f32 v35, v35, v39
    v_mfma_f32_16x16x32_bf16 v[156:159], a[8:11], v[188:191], v[156:159]
    v_add_f32 v43, v43, v47
    v_add_f32 v32, v32, v40
    v_mfma_f32_16x16x32_bf16 v[160:163], a[12:15], v[176:179], v[160:163]
    v_add_f32 v33, v33, v41
    v_add_f32 v34, v34, v42
    v_mfma_f32_16x16x32_bf16 v[164:167], a[12:15], v[180:183], v[164:167]
    v_add_f32_e64 v35, v35, v43
    v_bfi_b32 v32, v250, s76, v32
    v_mfma_f32_16x16x32_bf16 v[168:171], a[12:15], v[184:187], v[168:171]
    v_bfi_b32 v33, v250, s77, v33
    v_bfi_b32 v34, v250, s78, v34
    v_mfma_f32_16x16x32_bf16 v[172:175], a[12:15], v[188:191], v[172:175]
    v_bfi_b32 v35, v250, s79, v35
    buffer_store_dwordx4 v[32:35], v3, s[20:23], s72 offen offset:1024 sc1
    s_waitcnt vmcnt(14)
    v_mfma_f32_16x16x32_bf16 v[96:99], a[16:19], v[192:195], v[96:99]
    s_waitcnt lgkmcnt(8)
    v_add_f32_e64 v48, v48, v52
    v_mfma_f32_16x16x32_bf16 v[100:103], a[16:19], v[196:199], v[100:103]
    s_bfe_u32 s68, s25, 0x40000
    s_lshl_b32 s68, s68, 12
    s_add_u32 s68, s68, s75
    buffer_load_dwordx4 v[176:179], v3, s[20:23], s68 offen offset:0 sc1
    v_mfma_f32_16x16x32_bf16 v[104:107], a[16:19], v[200:203], v[104:107]
    v_add_f32 v56, v56, v60
    v_add_f32 v49, v49, v53
    v_mfma_f32_16x16x32_bf16 v[108:111], a[16:19], v[204:207], v[108:111]
    v_add_f32 v57, v57, v61
    v_add_f32 v50, v50, v54
    v_mfma_f32_16x16x32_bf16 v[112:115], a[20:23], v[192:195], v[112:115]
    v_add_f32 v58, v58, v62
    v_add_f32 v51, v51, v55
    v_mfma_f32_16x16x32_bf16 v[116:119], a[20:23], v[196:199], v[116:119]
    buffer_load_dwordx4 v[180:183], v3, s[20:23], s68 offen offset:1024 sc1
    v_mfma_f32_16x16x32_bf16 v[120:123], a[20:23], v[200:203], v[120:123]
    v_add_f32 v59, v59, v63
    v_add_f32 v48, v48, v56
    v_mfma_f32_16x16x32_bf16 v[124:127], a[20:23], v[204:207], v[124:127]
    v_add_f32 v49, v49, v57
    v_add_f32 v50, v50, v58
    v_mfma_f32_16x16x32_bf16 v[128:131], a[24:27], v[192:195], v[128:131]
    v_add_f32_e64 v51, v51, v59
    v_bfi_b32 v48, v250, s76, v48
    v_mfma_f32_16x16x32_bf16 v[132:135], a[24:27], v[196:199], v[132:135]
    buffer_load_dwordx4 v[184:187], v3, s[20:23], s68 offen offset:2048 sc1
    v_mfma_f32_16x16x32_bf16 v[136:139], a[24:27], v[200:203], v[136:139]
    v_bfi_b32 v49, v250, s77, v49
    v_bfi_b32 v50, v250, s78, v50
    v_mfma_f32_16x16x32_bf16 v[140:143], a[24:27], v[204:207], v[140:143]
    v_bfi_b32 v51, v250, s79, v51
    buffer_store_dwordx4 v[48:51], v3, s[20:23], s72 offen offset:2048 sc1
    v_mfma_f32_16x16x32_bf16 v[144:147], a[28:31], v[192:195], v[144:147]
    s_waitcnt lgkmcnt(4)
    v_add_f32 v64, v64, v68
    v_mfma_f32_16x16x32_bf16 v[148:151], a[28:31], v[196:199], v[148:151]
    buffer_load_dwordx4 v[188:191], v3, s[20:23], s68 offen offset:3072 sc1
    v_mfma_f32_16x16x32_bf16 v[152:155], a[28:31], v[200:203], v[152:155]
    v_add_f32 v72, v72, v76
    v_add_f32 v65, v65, v69
    v_mfma_f32_16x16x32_bf16 v[156:159], a[28:31], v[204:207], v[156:159]
    v_add_f32 v73, v73, v77
    v_add_f32 v66, v66, v70
    v_mfma_f32_16x16x32_bf16 v[160:163], a[32:35], v[192:195], v[160:163]
    v_add_f32 v74, v74, v78
    v_add_f32 v67, v67, v71
    v_mfma_f32_16x16x32_bf16 v[164:167], a[32:35], v[196:199], v[164:167]
    v_add_f32 v75, v75, v79
    v_add_f32 v64, v64, v72
    v_mfma_f32_16x16x32_bf16 v[168:171], a[32:35], v[200:203], v[168:171]
    v_add_f32 v65, v65, v73
    v_add_f32 v66, v66, v74
    v_mfma_f32_16x16x32_bf16 v[172:175], a[32:35], v[204:207], v[172:175]
    v_add_f32 v67, v67, v75
    v_bfi_b32 v64, v250, s76, v64
    s_waitcnt vmcnt(15)
    v_mfma_f32_16x16x32_bf16 v[96:99], a[36:39], v[208:211], v[96:99]
    v_bfi_b32 v65, v250, s77, v65
    v_bfi_b32 v66, v250, s78, v66
    v_mfma_f32_16x16x32_bf16 v[100:103], a[36:39], v[212:215], v[100:103]
    s_bfe_u32 s68, s25, 0x40004
    s_lshl_b32 s68, s68, 12
    s_add_u32 s68, s68, s75
    buffer_load_dwordx4 v[192:195], v3, s[20:23], s68 offen offset:0 sc1
    v_mfma_f32_16x16x32_bf16 v[104:107], a[36:39], v[216:219], v[104:107]
    v_bfi_b32 v67, v250, s79, v67
    buffer_store_dwordx4 v[64:67], v3, s[20:23], s72 offen offset:3072 sc1
    v_mfma_f32_16x16x32_bf16 v[108:111], a[36:39], v[220:223], v[108:111]
    s_waitcnt lgkmcnt(0)
    v_add_f32 v80, v80, v84
    v_mfma_f32_16x16x32_bf16 v[112:115], a[40:43], v[208:211], v[112:115]
    v_add_f32 v88, v88, v92
    v_add_f32 v81, v81, v85
    v_mfma_f32_16x16x32_bf16 v[116:119], a[40:43], v[212:215], v[116:119]
    buffer_load_dwordx4 v[196:199], v3, s[20:23], s68 offen offset:1024 sc1
    v_mfma_f32_16x16x32_bf16 v[120:123], a[40:43], v[216:219], v[120:123]
    v_add_f32 v89, v89, v93
    v_add_f32 v82, v82, v86
    v_mfma_f32_16x16x32_bf16 v[124:127], a[40:43], v[220:223], v[124:127]
    v_add_f32 v90, v90, v94
    v_add_f32 v83, v83, v87
    v_mfma_f32_16x16x32_bf16 v[128:131], a[44:47], v[208:211], v[128:131]
    v_add_f32 v91, v91, v95
    v_add_f32 v80, v80, v88
    v_mfma_f32_16x16x32_bf16 v[132:135], a[44:47], v[212:215], v[132:135]
    buffer_load_dwordx4 v[200:203], v3, s[20:23], s68 offen offset:2048 sc1
    v_mfma_f32_16x16x32_bf16 v[136:139], a[44:47], v[216:219], v[136:139]
    v_add_f32 v81, v81, v89
    v_add_f32 v82, v82, v90
    v_mfma_f32_16x16x32_bf16 v[140:143], a[44:47], v[220:223], v[140:143]
    v_add_f32_e64 v83, v83, v91
    v_bfi_b32 v80, v250, s76, v80
    v_mfma_f32_16x16x32_bf16 v[144:147], a[48:51], v[208:211], v[144:147]
    v_bfi_b32 v81, v250, s77, v81
    v_bfi_b32 v82, v250, s78, v82
    v_mfma_f32_16x16x32_bf16 v[148:151], a[48:51], v[212:215], v[148:151]
    buffer_load_dwordx4 v[204:207], v3, s[20:23], s68 offen offset:3072 sc1
    v_mfma_f32_16x16x32_bf16 v[152:155], a[48:51], v[216:219], v[152:155]
    v_bfi_b32 v83, v250, s79, v83
    buffer_store_dwordx4 v[80:83], v4, s[20:23], s72 offen offset:0 sc1
    v_mfma_f32_16x16x32_bf16 v[156:159], a[48:51], v[220:223], v[156:159]
    s_barrier
    ds_read_b128 v[20:23], v13 offset:0
    v_mfma_f32_16x16x32_bf16 v[160:163], a[52:55], v[208:211], v[160:163]
    ds_read_b128 v[36:39], v13 offset:1024
    ds_read_b128 v[52:55], v13 offset:2048
    v_mfma_f32_16x16x32_bf16 v[164:167], a[52:55], v[212:215], v[164:167]
    ds_read_b128 v[68:71], v13 offset:3072
    ds_read_b128 v[84:87], v13 offset:4096
    v_mfma_f32_16x16x32_bf16 v[168:171], a[52:55], v[216:219], v[168:171]
    v_mfma_f32_16x16x32_bf16 v[172:175], a[52:55], v[220:223], v[172:175]
    s_waitcnt vmcnt(17)
    v_mfma_f32_16x16x32_bf16 v[96:99], a[56:59], v[224:227], v[96:99]
    v_mfma_f32_16x16x32_bf16 v[100:103], a[56:59], v[228:231], v[100:103]
    s_bfe_u32 s68, s25, 0x40008
    s_lshl_b32 s68, s68, 12
    s_add_u32 s68, s68, s75
    buffer_load_dwordx4 v[208:211], v3, s[20:23], s68 offen offset:0 sc1
    v_mfma_f32_16x16x32_bf16 v[104:107], a[56:59], v[232:235], v[104:107]
    v_mfma_f32_16x16x32_bf16 v[108:111], a[56:59], v[236:239], v[108:111]
    v_mfma_f32_16x16x32_bf16 v[112:115], a[60:63], v[224:227], v[112:115]
    v_mfma_f32_16x16x32_bf16 v[116:119], a[60:63], v[228:231], v[116:119]
    buffer_load_dwordx4 v[212:215], v3, s[20:23], s68 offen offset:1024 sc1
    v_mfma_f32_16x16x32_bf16 v[120:123], a[60:63], v[232:235], v[120:123]
    v_mfma_f32_16x16x32_bf16 v[124:127], a[60:63], v[236:239], v[124:127]
    v_mfma_f32_16x16x32_bf16 v[128:131], a[64:67], v[224:227], v[128:131]
    v_mfma_f32_16x16x32_bf16 v[132:135], a[64:67], v[228:231], v[132:135]
    buffer_load_dwordx4 v[216:219], v3, s[20:23], s68 offen offset:2048 sc1
    v_mfma_f32_16x16x32_bf16 v[136:139], a[64:67], v[232:235], v[136:139]
    v_mfma_f32_16x16x32_bf16 v[140:143], a[64:67], v[236:239], v[140:143]
    v_mfma_f32_16x16x32_bf16 v[144:147], a[68:71], v[224:227], v[144:147]
    v_mfma_f32_16x16x32_bf16 v[148:151], a[68:71], v[228:231], v[148:151]
    buffer_load_dwordx4 v[220:223], v3, s[20:23], s68 offen offset:3072 sc1
    v_mfma_f32_16x16x32_bf16 v[152:155], a[68:71], v[232:235], v[152:155]
    v_mfma_f32_16x16x32_bf16 v[156:159], a[68:71], v[236:239], v[156:159]
    v_mfma_f32_16x16x32_bf16 v[160:163], a[72:75], v[224:227], v[160:163]
    v_mfma_f32_16x16x32_bf16 v[164:167], a[72:75], v[228:231], v[164:167]
    v_mfma_f32_16x16x32_bf16 v[168:171], a[72:75], v[232:235], v[168:171]
    v_mfma_f32_16x16x32_bf16 v[172:175], a[72:75], v[236:239], v[172:175]
    s_waitcnt vmcnt(16)
    s_nop 0
    v_mfma_f32_16x16x32_bf16 v[96:99], a[76:79], a[176:179], v[96:99]
    v_mfma_f32_16x16x32_bf16 v[100:103], a[76:79], a[180:183], v[100:103]
    s_bfe_u32 s68, s25, 0x4000c
    s_lshl_b32 s68, s68, 12
    s_add_u32 s68, s68, s75
    s_cmp_eq_u32 s4, 3
    s_cselect_b32 s68, s69, s68
    buffer_load_dwordx4 v[224:227], v3, s[20:23], s68 offen offset:0 sc1
    v_mfma_f32_16x16x32_bf16 v[104:107], a[76:79], a[184:187], v[104:107]
    v_mfma_f32_16x16x32_bf16 v[108:111], a[76:79], a[188:191], v[108:111]
    v_mfma_f32_16x16x32_bf16 v[112:115], a[80:83], a[176:179], v[112:115]
    v_mfma_f32_16x16x32_bf16 v[116:119], a[80:83], a[180:183], v[116:119]
    buffer_load_dwordx4 v[228:231], v3, s[20:23], s68 offen offset:1024 sc1
    v_mfma_f32_16x16x32_bf16 v[120:123], a[80:83], a[184:187], v[120:123]
    v_mfma_f32_16x16x32_bf16 v[124:127], a[80:83], a[188:191], v[124:127]
    v_mfma_f32_16x16x32_bf16 v[128:131], a[84:87], a[176:179], v[128:131]
    v_mfma_f32_16x16x32_bf16 v[132:135], a[84:87], a[180:183], v[132:135]
    buffer_load_dwordx4 v[232:235], v3, s[20:23], s68 offen offset:2048 sc1
    v_mfma_f32_16x16x32_bf16 v[136:139], a[84:87], a[184:187], v[136:139]
    v_mfma_f32_16x16x32_bf16 v[140:143], a[84:87], a[188:191], v[140:143]
    v_mfma_f32_16x16x32_bf16 v[144:147], a[88:91], a[176:179], v[144:147]
    v_mfma_f32_16x16x32_bf16 v[148:151], a[88:91], a[180:183], v[148:151]
    buffer_load_dwordx4 v[236:239], v3, s[20:23], s68 offen offset:3072 sc1
    v_mfma_f32_16x16x32_bf16 v[152:155], a[88:91], a[184:187], v[152:155]
    v_mfma_f32_16x16x32_bf16 v[156:159], a[88:91], a[188:191], v[156:159]
    v_mfma_f32_16x16x32_bf16 v[160:163], a[92:95], a[176:179], v[160:163]
    v_mfma_f32_16x16x32_bf16 v[164:167], a[92:95], a[180:183], v[164:167]
    v_mfma_f32_16x16x32_bf16 v[168:171], a[92:95], a[184:187], v[168:171]
    v_mfma_f32_16x16x32_bf16 v[172:175], a[92:95], a[188:191], v[172:175]
    s_waitcnt vmcnt(14)
    s_nop 0
    v_mfma_f32_16x16x32_bf16 v[96:99], a[96:99], v[176:179], v[96:99]
    v_mfma_f32_16x16x32_bf16 v[100:103], a[96:99], v[180:183], v[100:103]
    v_mfma_f32_16x16x32_bf16 v[104:107], a[96:99], v[184:187], v[104:107]
    v_mfma_f32_16x16x32_bf16 v[108:111], a[96:99], v[188:191], v[108:111]
    v_mfma_f32_16x16x32_bf16 v[112:115], a[100:103], v[176:179], v[112:115]
    v_mfma_f32_16x16x32_bf16 v[116:119], a[100:103], v[180:183], v[116:119]
    v_mfma_f32_16x16x32_bf16 v[120:123], a[100:103], v[184:187], v[120:123]
    v_mfma_f32_16x16x32_bf16 v[124:127], a[100:103], v[188:191], v[124:127]
    v_mfma_f32_16x16x32_bf16 v[128:131], a[104:107], v[176:179], v[128:131]
    v_mfma_f32_16x16x32_bf16 v[132:135], a[104:107], v[180:183], v[132:135]
    v_mfma_f32_16x16x32_bf16 v[136:139], a[104:107], v[184:187], v[136:139]
    v_mfma_f32_16x16x32_bf16 v[140:143], a[104:107], v[188:191], v[140:143]
    v_mfma_f32_16x16x32_bf16 v[144:147], a[108:111], v[176:179], v[144:147]
    v_mfma_f32_16x16x32_bf16 v[148:151], a[108:111], v[180:183], v[148:151]
    v_mfma_f32_16x16x32_bf16 v[152:155], a[108:111], v[184:187], v[152:155]
    v_mfma_f32_16x16x32_bf16 v[156:159], a[108:111], v[188:191], v[156:159]
    v_mfma_f32_16x16x32_bf16 v[160:163], a[112:115], v[176:179], v[160:163]
    v_mfma_f32_16x16x32_bf16 v[164:167], a[112:115], v[180:183], v[164:167]
    v_mfma_f32_16x16x32_bf16 v[168:171], a[112:115], v[184:187], v[168:171]
    v_mfma_f32_16x16x32_bf16 v[172:175], a[112:115], v[188:191], v[172:175]
    s_waitcnt vmcnt(9)
    v_mfma_f32_16x16x32_bf16 v[96:99], a[116:119], v[192:195], v[96:99]
    v_mfma_f32_16x16x32_bf16 v[100:103], a[116:119], v[196:199], v[100:103]
    v_mfma_f32_16x16x32_bf16 v[104:107], a[116:119], v[200:203], v[104:107]
    v_mfma_f32_16x16x32_bf16 v[108:111], a[116:119], v[204:207], v[108:111]
    s_waitcnt vmcnt(4)
    v_mfma_f32_16x16x32_bf16 v[96:99], a[136:139], v[208:211], v[96:99]
    v_mfma_f32_16x16x32_bf16 v[100:103], a[136:139], v[212:215], v[100:103]
    v_mfma_f32_16x16x32_bf16 v[104:107], a[136:139], v[216:219], v[104:107]
    v_mfma_f32_16x16x32_bf16 v[108:111], a[136:139], v[220:223], v[108:111]
    s_waitcnt vmcnt(0)
    v_mfma_f32_16x16x32_bf16 v[96:99], a[156:159], v[224:227], v[96:99]
    v_mfma_f32_16x16x32_bf16 v[100:103], a[156:159], v[228:231], v[100:103]
    v_mfma_f32_16x16x32_bf16 v[104:107], a[156:159], v[232:235], v[104:107]
    v_mfma_f32_16x16x32_bf16 v[108:111], a[156:159], v[236:239], v[108:111]
    v_mfma_f32_16x16x32_bf16 v[112:115], a[120:123], v[192:195], v[112:115]
    v_mfma_f32_16x16x32_bf16 v[116:119], a[120:123], v[196:199], v[116:119]
    v_mfma_f32_16x16x32_bf16 v[120:123], a[120:123], v[200:203], v[120:123]
    s_nop 1
    ds_write_b128 v5, v[96:99] offset:0
    v_mfma_f32_16x16x32_bf16 v[124:127], a[120:123], v[204:207], v[124:127]
    v_mfma_f32_16x16x32_bf16 v[112:115], a[140:143], v[208:211], v[112:115]
    ds_write_b128 v5, v[100:103] offset:5376
    v_mfma_f32_16x16x32_bf16 v[116:119], a[140:143], v[212:215], v[116:119]
    v_mfma_f32_16x16x32_bf16 v[120:123], a[140:143], v[216:219], v[120:123]
    ds_write_b128 v5, v[104:107] offset:10752
    v_mfma_f32_16x16x32_bf16 v[124:127], a[140:143], v[220:223], v[124:127]
    buffer_load_dwordx4 v[24:27], v3, s[20:23], s73 offen offset:0 sc1
    buffer_load_dwordx4 v[40:43], v3, s[20:23], s73 offen offset:1024 sc1
    buffer_load_dwordx4 v[56:59], v3, s[20:23], s73 offen offset:2048 sc1
    buffer_load_dwordx4 v[72:75], v3, s[20:23], s73 offen offset:3072 sc1
    buffer_load_dwordx4 v[88:91], v4, s[20:23], s73 offen offset:0 sc1
    v_mfma_f32_16x16x32_bf16 v[112:115], a[160:163], v[224:227], v[112:115]
    ds_write_b128 v5, v[108:111] offset:16128
    v_mfma_f32_16x16x32_bf16 v[116:119], a[160:163], v[228:231], v[116:119]
    v_mfma_f32_16x16x32_bf16 v[120:123], a[160:163], v[232:235], v[120:123]
    v_mfma_f32_16x16x32_bf16 v[124:127], a[160:163], v[236:239], v[124:127]
    v_mfma_f32_16x16x32_bf16 v[128:131], a[124:127], v[192:195], v[128:131]
    v_mfma_f32_16x16x32_bf16 v[132:135], a[124:127], v[196:199], v[132:135]
    v_mfma_f32_16x16x32_bf16 v[136:139], a[124:127], v[200:203], v[136:139]
    s_nop 0
    s_nop 0
    ds_write_b128 v5, v[112:115] offset:64
    v_mfma_f32_16x16x32_bf16 v[140:143], a[124:127], v[204:207], v[140:143]
    v_mfma_f32_16x16x32_bf16 v[128:131], a[144:147], v[208:211], v[128:131]
    ds_write_b128 v5, v[116:119] offset:5440
    v_mfma_f32_16x16x32_bf16 v[132:135], a[144:147], v[212:215], v[132:135]
    v_mfma_f32_16x16x32_bf16 v[136:139], a[144:147], v[216:219], v[136:139]
    ds_write_b128 v5, v[120:123] offset:10816
    v_mfma_f32_16x16x32_bf16 v[140:143], a[144:147], v[220:223], v[140:143]
    v_mfma_f32_16x16x32_bf16 v[128:131], a[164:167], v[224:227], v[128:131]
    ds_write_b128 v5, v[124:127] offset:16192
    v_mfma_f32_16x16x32_bf16 v[132:135], a[164:167], v[228:231], v[132:135]
    v_mfma_f32_16x16x32_bf16 v[136:139], a[164:167], v[232:235], v[136:139]
    v_mfma_f32_16x16x32_bf16 v[140:143], a[164:167], v[236:239], v[140:143]
    v_mfma_f32_16x16x32_bf16 v[144:147], a[128:131], v[192:195], v[144:147]
    v_mfma_f32_16x16x32_bf16 v[148:151], a[128:131], v[196:199], v[148:151]
    v_mfma_f32_16x16x32_bf16 v[152:155], a[128:131], v[200:203], v[152:155]
    s_nop 0
    s_nop 0
    ds_write_b128 v5, v[128:131] offset:128
    v_mfma_f32_16x16x32_bf16 v[156:159], a[128:131], v[204:207], v[156:159]
    v_mfma_f32_16x16x32_bf16 v[144:147], a[148:151], v[208:211], v[144:147]
    ds_write_b128 v5, v[132:135] offset:5504
    v_mfma_f32_16x16x32_bf16 v[148:151], a[148:151], v[212:215], v[148:151]
    v_mfma_f32_16x16x32_bf16 v[152:155], a[148:151], v[216:219], v[152:155]
    ds_write_b128 v5, v[136:139] offset:10880
    v_mfma_f32_16x16x32_bf16 v[156:159], a[148:151], v[220:223], v[156:159]
    v_mfma_f32_16x16x32_bf16 v[144:147], a[168:171], v[224:227], v[144:147]
    ds_write_b128 v5, v[140:143] offset:16256
    v_mfma_f32_16x16x32_bf16 v[148:151], a[168:171], v[228:231], v[148:151]
    v_mfma_f32_16x16x32_bf16 v[152:155], a[168:171], v[232:235], v[152:155]
    v_mfma_f32_16x16x32_bf16 v[156:159], a[168:171], v[236:239], v[156:159]
    v_mfma_f32_16x16x32_bf16 v[160:163], a[132:135], v[192:195], v[160:163]
    v_mfma_f32_16x16x32_bf16 v[164:167], a[132:135], v[196:199], v[164:167]
    v_mfma_f32_16x16x32_bf16 v[168:171], a[132:135], v[200:203], v[168:171]
    s_nop 0
    s_nop 0
    ds_write_b128 v5, v[144:147] offset:192
    v_mfma_f32_16x16x32_bf16 v[172:175], a[132:135], v[204:207], v[172:175]
    v_mfma_f32_16x16x32_bf16 v[160:163], a[152:155], v[208:211], v[160:163]
    ds_write_b128 v5, v[148:151] offset:5568
    v_mfma_f32_16x16x32_bf16 v[164:167], a[152:155], v[212:215], v[164:167]
    v_mfma_f32_16x16x32_bf16 v[168:171], a[152:155], v[216:219], v[168:171]
    ds_write_b128 v5, v[152:155] offset:10944
    v_mfma_f32_16x16x32_bf16 v[172:175], a[152:155], v[220:223], v[172:175]
    v_mfma_f32_16x16x32_bf16 v[160:163], a[172:175], v[224:227], v[160:163]
    ds_write_b128 v5, v[156:159] offset:16320
    v_mfma_f32_16x16x32_bf16 v[164:167], a[172:175], v[228:231], v[164:167]
    v_mfma_f32_16x16x32_bf16 v[168:171], a[172:175], v[232:235], v[168:171]
    v_mfma_f32_16x16x32_bf16 v[172:175], a[172:175], v[236:239], v[172:175]
    s_nop 3
    ds_write_b128 v5, v[160:163] offset:256
    s_nop 0
    ds_write_b128 v5, v[164:167] offset:5632
    ds_write_b128 v5, v[168:171] offset:11008
    ds_write_b128 v5, v[172:175] offset:16384
    s_waitcnt vmcnt(0) lgkmcnt(15)
    v_xor_b32 v251, s76, v24
    v_bitop3_b32 v251, v251, v25, s77 bitop3:0xf6
    v_bitop3_b32 v251, v251, v26, s78 bitop3:0xf6
    v_bitop3_b32 v251, v251, v27, s79 bitop3:0xf6
    v_bitop3_b32 v251, v251, v40, s76 bitop3:0xf6
    v_bitop3_b32 v251, v251, v41, s77 bitop3:0xf6
    v_bitop3_b32 v251, v251, v42, s78 bitop3:0xf6
    v_bitop3_b32 v251, v251, v43, s79 bitop3:0xf6
    v_bitop3_b32 v251, v251, v56, s76 bitop3:0xf6
    v_bitop3_b32 v251, v251, v57, s77 bitop3:0xf6
    v_bitop3_b32 v251, v251, v58, s78 bitop3:0xf6
    v_bitop3_b32 v251, v251, v59, s79 bitop3:0xf6
    v_bitop3_b32 v251, v251, v72, s76 bitop3:0xf6
    v_bitop3_b32 v251, v251, v73, s77 bitop3:0xf6
    v_bitop3_b32 v251, v251, v74, s78 bitop3:0xf6
    v_bitop3_b32 v251, v251, v75, s79 bitop3:0xf6
    v_bitop3_b32 v251, v251, v88, s76 bitop3:0xf6
    v_bitop3_b32 v251, v251, v89, s77 bitop3:0xf6
    v_bitop3_b32 v251, v251, v90, s78 bitop3:0xf6
    v_bitop3_b32 v251, v251, v91, s79 bitop3:0xf6
    v_and_b32 v251, v250, v251
    v_cmp_ne_u32 vcc, 0, v251
    s_nop 1
    s_cbranch_vccnz K2_SLOW
K2_OK:
    s_mov_b32 s81, 0xffffff00
    v_and_b32 v24, s81, v24
    v_and_b32 v25, s81, v25
    v_and_b32 v26, s81, v26
    v_and_b32 v27, s81, v27
    v_pk_add_f32 v[16:17], v[20:21], v[24:25]
    v_pk_add_f32 v[18:19], v[22:23], v[26:27]
    v_and_b32 v40, s81, v40
    v_and_b32 v41, s81, v41
    v_and_b32 v42, s81, v42
    v_and_b32 v43, s81, v43
    v_pk_add_f32 v[32:33], v[36:37], v[40:41]
    v_pk_add_f32 v[34:35], v[38:39], v[42:43]
    v_and_b32 v56, s81, v56
    v_and_b32 v57, s81, v57
    v_and_b32 v58, s81, v58
    v_and_b32 v59, s81, v59
    v_pk_add_f32 v[48:49], v[52:53], v[56:57]
    v_pk_add_f32 v[50:51], v[54:55], v[58:59]
    v_and_b32 v72, s81, v72
    v_and_b32 v73, s81, v73
    v_and_b32 v74, s81, v74
    v_and_b32 v75, s81, v75
    v_pk_add_f32 v[64:65], v[68:69], v[72:73]
    v_pk_add_f32 v[66:67], v[70:71], v[74:75]
    v_and_b32 v88, s81, v88
    v_and_b32 v89, s81, v89
    v_and_b32 v90, s81, v90
    v_and_b32 v91, s81, v91
    v_pk_add_f32 v[80:81], v[84:85], v[88:89]
    v_pk_add_f32 v[82:83], v[86:87], v[90:91]
    s_waitcnt lgkmcnt(0)
    s_barrier
    ds_read_b128 v[96:99], v245 offset:0
    ds_read_b128 v[100:103], v245 offset:21504
    ds_read_b128 v[104:107], v245 offset:43008
    ds_read_b128 v[108:111], v245 offset:64512
    ds_read_b128 v[112:115], v246 offset:0
    ds_read_b128 v[116:119], v246 offset:21504
    ds_read_b128 v[120:123], v246 offset:43008
    ds_read_b128 v[124:127], v246 offset:64512
    ds_read_b128 v[128:131], v247 offset:0
    ds_read_b128 v[132:135], v247 offset:21504
    ds_read_b128 v[136:139], v247 offset:43008
    ds_read_b128 v[140:143], v247 offset:64512
    ds_read_b128 v[144:147], v248 offset:0
    ds_read_b128 v[148:151], v248 offset:21504
    ds_read_b128 v[152:155], v248 offset:43008
    ds_read_b128 v[156:159], v248 offset:64512
    ds_read_b128 v[160:163], v249 offset:0
    ds_read_b128 v[164:167], v249 offset:21504
    ds_read_b128 v[168:171], v249 offset:43008
    ds_read_b128 v[172:175], v249 offset:64512
    s_waitcnt lgkmcnt(15)
    s_nop 0
    v_pk_add_f32 v[96:97], v[96:97], v[100:101]
    v_pk_add_f32 v[104:105], v[104:105], v[108:109]
    v_pk_add_f32 v[16:17], v[16:17], v[96:97]
    v_pk_add_f32 v[98:99], v[98:99], v[102:103]
    v_pk_add_f32 v[106:107], v[106:107], v[110:111]
    v_pk_add_f32 v[18:19], v[18:19], v[98:99]
    v_pk_add_f32 v[16:17], v[16:17], v[104:105]
    v_pk_add_f32 v[18:19], v[18:19], v[106:107]
    buffer_store_dwordx4 v[16:19], v240, s[16:19], s71 offen sc1
    s_waitcnt lgkmcnt(12)
    v_pk_add_f32 v[112:113], v[112:113], v[116:117]
    v_pk_add_f32 v[120:121], v[120:121], v[124:125]
    v_pk_add_f32 v[32:33], v[32:33], v[112:113]
    v_pk_add_f32 v[114:115], v[114:115], v[118:119]
    v_pk_add_f32 v[122:123], v[122:123], v[126:127]
    v_pk_add_f32 v[34:35], v[34:35], v[114:115]
    v_pk_add_f32 v[32:33], v[32:33], v[120:121]
    v_pk_add_f32 v[34:35], v[34:35], v[122:123]
    buffer_store_dwordx4 v[32:35], v241, s[16:19], s71 offen sc1
    s_waitcnt lgkmcnt(8)
    v_pk_add_f32 v[128:129], v[128:129], v[132:133]
    v_pk_add_f32 v[136:137], v[136:137], v[140:141]
    v_pk_add_f32 v[48:49], v[48:49], v[128:129]
    v_pk_add_f32 v[130:131], v[130:131], v[134:135]
    v_pk_add_f32 v[138:139], v[138:139], v[142:143]
    v_pk_add_f32 v[50:51], v[50:51], v[130:131]
    v_pk_add_f32 v[48:49], v[48:49], v[136:137]
    v_pk_add_f32 v[50:51], v[50:51], v[138:139]
    buffer_store_dwordx4 v[48:51], v242, s[16:19], s71 offen sc1
    s_waitcnt lgkmcnt(4)
    v_pk_add_f32 v[144:145], v[144:145], v[148:149]
    v_pk_add_f32 v[152:153], v[152:153], v[156:157]
    v_pk_add_f32 v[64:65], v[64:65], v[144:145]
    v_pk_add_f32 v[146:147], v[146:147], v[150:151]
    v_pk_add_f32 v[154:155], v[154:155], v[158:159]
    v_pk_add_f32 v[66:67], v[66:67], v[146:147]
    v_pk_add_f32 v[64:65], v[64:65], v[152:153]
    v_pk_add_f32 v[66:67], v[66:67], v[154:155]
    buffer_store_dwordx4 v[64:67], v243, s[16:19], s71 offen sc1
    s_waitcnt lgkmcnt(0)
    v_pk_add_f32 v[160:161], v[160:161], v[164:165]
    v_pk_add_f32 v[168:169], v[168:169], v[172:173]
    v_pk_add_f32 v[80:81], v[80:81], v[160:161]
    v_pk_add_f32 v[162:163], v[162:163], v[166:167]
    v_pk_add_f32 v[170:171], v[170:171], v[174:175]
    v_pk_add_f32 v[82:83], v[82:83], v[162:163]
    v_pk_add_f32 v[80:81], v[80:81], v[168:169]
    v_pk_add_f32 v[82:83], v[82:83], v[170:171]
    buffer_store_dwordx4 v[80:83], v244, s[16:19], s71 offen sc1
    s_or_b32 s32, s2, s4
    s_cmp_eq_u32 s32, 0
    s_cselect_b32 s32, 17039360, s69
    v_mov_b32_e64 v250, s85
    s_mov_b64 exec, 1
    buffer_store_dword v250, off, s[20:23], s32 sc1
    s_mov_b64 exec, -1
K1_END:
    s_endpgm
K2_SLOW:
    s_sleep 2
    s_add_u32 s92, s92, 1
    s_cmp_gt_u32 s92, 100000
    s_cbranch_scc1 K2_OK
    buffer_load_dwordx4 v[24:27], v3, s[20:23], s73 offen offset:0 sc1
    buffer_load_dwordx4 v[40:43], v3, s[20:23], s73 offen offset:1024 sc1
    buffer_load_dwordx4 v[56:59], v3, s[20:23], s73 offen offset:2048 sc1
    buffer_load_dwordx4 v[72:75], v3, s[20:23], s73 offen offset:3072 sc1
    buffer_load_dwordx4 v[88:91], v4, s[20:23], s73 offen offset:0 sc1
    s_waitcnt vmcnt(0)
    v_xor_b32 v251, s76, v24
    v_bitop3_b32 v251, v251, v25, s77 bitop3:0xf6
    v_bitop3_b32 v251, v251, v26, s78 bitop3:0xf6
    v_bitop3_b32 v251, v251, v27, s79 bitop3:0xf6
    v_bitop3_b32 v251, v251, v40, s76 bitop3:0xf6
    v_bitop3_b32 v251, v251, v41, s77 bitop3:0xf6
    v_bitop3_b32 v251, v251, v42, s78 bitop3:0xf6
    v_bitop3_b32 v251, v251, v43, s79 bitop3:0xf6
    v_bitop3_b32 v251, v251, v56, s76 bitop3:0xf6
    v_bitop3_b32 v251, v251, v57, s77 bitop3:0xf6
    v_bitop3_b32 v251, v251, v58, s78 bitop3:0xf6
    v_bitop3_b32 v251, v251, v59, s79 bitop3:0xf6
    v_bitop3_b32 v251, v251, v72, s76 bitop3:0xf6
    v_bitop3_b32 v251, v251, v73, s77 bitop3:0xf6
    v_bitop3_b32 v251, v251, v74, s78 bitop3:0xf6
    v_bitop3_b32 v251, v251, v75, s79 bitop3:0xf6
    v_bitop3_b32 v251, v251, v88, s76 bitop3:0xf6
    v_bitop3_b32 v251, v251, v89, s77 bitop3:0xf6
    v_bitop3_b32 v251, v251, v90, s78 bitop3:0xf6
    v_bitop3_b32 v251, v251, v91, s79 bitop3:0xf6
    v_and_b32_e64 v251, v250, v251
    v_cmp_ne_u32 vcc, 0, v251
    s_nop 1
    s_cbranch_vccnz K2_SLOW
    s_branch K2_OK
TEXT_END:
.section .rodata,"a"
.p2align 6
.amdhsa_kernel parallel_sum__ssm_conv_s5__glu_gated_geglu__prompt_kernel
  .amdhsa_next_free_vgpr 512
  .amdhsa_next_free_sgpr 102
  .amdhsa_accum_offset 256
  .amdhsa_group_segment_fixed_size 0
  .amdhsa_kernarg_size 128
  .amdhsa_user_sgpr_count 2
  .amdhsa_user_sgpr_kernarg_segment_ptr 1
  .amdhsa_system_sgpr_workgroup_id_x 1
  .amdhsa_float_denorm_mode_32 3
.end_amdhsa_kernel
```
